```python
import torch

def _softmax(x, axis=-1):
    return torch.softmax(x, dim=axis)

def _gelu(x):
    return torch.nn.functional.gelu(x, approximate='tanh')

def _silu(x):
    return torch.nn.functional.silu(x)

def _sigmoid(x):
    return torch.sigmoid(x)

def _layernorm(x, axis=-1, eps=1e-05):
    m = x.mean(dim=axis, keepdim=True)
    v = x.var(dim=axis, keepdim=True, unbiased=False)
    return (x - m) / torch.sqrt(v + eps)

def _scatter_add(tgt, idx, src, axis=0):
    return tgt.clone().index_add_(axis, idx, src)

def _segment_sum(src, seg, n):
    out = torch.zeros((n,) + src.shape[1:], dtype=src.dtype)
    return out.index_add_(0, seg, src)

def _pad(x, pw):
    flat = tuple((v for pair in reversed(pw) for v in pair))
    return torch.nn.functional.pad(x, flat)
kernel_name = 'adaLN_cond__sliding_local_dilated__glu_gated_bilinear__prompt'

def setup_inputs():

    _w = lambda a: (lambda t: t.to(torch.bfloat16) if t.is_floating_point() else t)(torch.as_tensor(a))

    def _A_setup():
        B, S, D = (1, 2048, 576)
        return {'x': _w((lambda *s: torch.randn(*s, dtype=torch.bfloat16) * 0.05)(B, S, D)), 'wqkv': _w((lambda *s: torch.randn(*s, dtype=torch.bfloat16) * 0.05)(D, 3 * D)), 'wo': _w((lambda *s: torch.randn(*s, dtype=torch.bfloat16) * 0.05)(D, D))}
    _A_in = _A_setup()

    def _B_setup():
        B, S, D, F = (1, 2048, 576, 4608)
        return {'x': _w((lambda *s: torch.randn(*s, dtype=torch.bfloat16) * 0.05)(B, S, D)), 'w_gate': _w((lambda *s: torch.randn(*s, dtype=torch.bfloat16) * 0.8)(D, F) * D ** (-0.5)), 'w_up': _w((lambda *s: torch.randn(*s, dtype=torch.bfloat16) * 0.8)(D, F) * D ** (-0.5)), 'w_down': _w((lambda *s: torch.randn(*s, dtype=torch.bfloat16) * 0.8)(F, D) * F ** (-0.5))}
    _B_in = _B_setup()
    return {'A_x': _A_in['x'], 'A_wqkv': _A_in['wqkv'], 'A_wo': _A_in['wo'], 'B_x': _B_in['x'], 'B_w_gate': _B_in['w_gate'], 'B_w_up': _B_in['w_up'], 'B_w_down': _B_in['w_down'], 'c': _w((lambda *s: torch.randn(*s, dtype=torch.bfloat16) * 0.1)(1, 576) * 8.0), 'w_mod': _w((lambda *s: torch.randn(*s, dtype=torch.bfloat16) * 0.1)(576, 6 * 576) * 576 ** (-0.5) * 8.0)}

def reference(A_x, A_wqkv, A_wo, B_x, B_w_gate, B_w_up, B_w_down, c, w_mod):

    def _A_ref(x, wqkv, wo):
        B, S, D = x.shape
        H = 32
        Dh = D // H
        W, dil = (8, 2)
        qkv = (lambda x, *d: x.permute(*d))((x @ wqkv).reshape(B, S, 3, H, Dh), 2, 0, 3, 1, 4)
        q, k, v = (qkv[0], qkv[1], qkv[2])
        scale = Dh ** (-0.5)
        pos = torch.arange(S)
        off = torch.arange(W) * dil
        idx = pos[:, None] - off[None, :]
        mask = idx >= 0
        idx_c = torch.where(mask, idx, 0).reshape(-1)
        kg = k[:, :, idx_c, :].reshape(B, H, S, W, Dh)
        vg = v[:, :, idx_c, :].reshape(B, H, S, W, Dh)
        logits = torch.einsum('bhsd,bhswd->bhsw', q, kg) * scale
        logits = torch.where(mask[None, None, :, :], logits, -1000000000.0)
        attn = _softmax(logits, axis=-1)
        o = torch.einsum('bhsw,bhswd->bhsd', attn, vg)
        return (lambda x, *d: x.permute(*d))(o, 0, 2, 1, 3).reshape(B, S, D) @ wo

    def _B_ref(x, w_gate, w_up, w_down):
        g = torch.einsum('bsd,df->bsf', x, w_gate)
        u = torch.einsum('bsd,df->bsf', x, w_up)
        h = g * u
        return torch.einsum('bsf,fd->bsd', h, w_down)
    x = A_x
    mod = (_silu(c) @ w_mod).reshape(c.shape[0], 6, 1, -1)
    sa, ca, ga, sb, cb, gb = (mod[:, 0].clone(), mod[:, 1].clone(), mod[:, 2].clone(), mod[:, 3].clone(), mod[:, 4].clone(), mod[:, 5].clone())
    h = _layernorm(x, axis=-1) * (1 + ca) + sa
    x = x + ga * _A_ref(h, A_wqkv, A_wo)
    h = _layernorm(x, axis=-1) * (1 + cb) + sb
    x = x + gb * _B_ref(h, B_w_gate, B_w_up, B_w_down)
    return x
```

```asm
; @launch kernel=k1_kernel grid=(400,1,1) block=(256,1,1) lds=512
; @launch kernel=f_kernel grid=(256,1,1) block=(256,1,1) lds=154624
.amdgcn_target "amdgcn-amd-amdhsa--gfx950"
.text
.globl k1_kernel
.p2align 8
.type k1_kernel,@function
k1_kernel:
  s_cmp_ge_u32 s2, 400
  s_cbranch_scc1 k1_kernel_exit

  s_load_dwordx2 s[34:35], s[0:1], 88
  v_lshrrev_b32 v10, 6, v0
  v_and_b32 v1, 63, v0
  v_readfirstlane_b32 s20, v10
  s_cmp_ge_u32 s2, 172
  s_cbranch_scc1 k1_kernel_rp
  s_cmp_lt_u32 s2, 108
  s_cbranch_scc1 k1_kernel_mod
  s_sub_u32 s2, s2, 108
  s_load_dwordx2 s[4:5], s[0:1], 0
  s_waitcnt lgkmcnt(0)
  s_mov_b32 s8, s4
  s_and_b32 s9, s5, 0xffff
  s_mov_b32 s10, 2359296
  s_mov_b32 s11, 0x20000

  s_mov_b32 s16, s34
  s_and_b32 s17, s35, 0xffff
  s_mov_b32 s18, 268435456
  s_mov_b32 s19, 0x20000

  s_lshl_b32 s21, s2, 5
  s_lshl_b32 s22, s20, 3
  s_add_u32 s21, s21, s22
  v_and_b32 v2, 7, v1
  v_lshrrev_b32 v3, 3, v1
  v_add_u32 v4, s21, v2
  v_mul_u32_u24 v5, 1152, v4
  v_lshl_add_u32 v5, v3, 4, v5
  buffer_load_dwordx4 v[16:19], v5, s[8:11], 0 offen offset:0
  buffer_load_dwordx4 v[20:23], v5, s[8:11], 0 offen offset:128
  buffer_load_dwordx4 v[24:27], v5, s[8:11], 0 offen offset:256
  buffer_load_dwordx4 v[28:31], v5, s[8:11], 0 offen offset:384
  buffer_load_dwordx4 v[32:35], v5, s[8:11], 0 offen offset:512
  buffer_load_dwordx4 v[36:39], v5, s[8:11], 0 offen offset:640
  buffer_load_dwordx4 v[40:43], v5, s[8:11], 0 offen offset:768
  buffer_load_dwordx4 v[44:47], v5, s[8:11], 0 offen offset:896
  buffer_load_dwordx4 v[48:51], v5, s[8:11], 0 offen offset:1024
  v_lshrrev_b32 v6, 4, v4
  v_mul_u32_u24 v6, 72, v6
  v_add_u32 v6, v6, v3
  v_lshlrev_b32 v6, 8, v6
  v_and_b32 v7, 15, v4
  v_lshl_add_u32 v6, v7, 4, v6
  v_add_u32 v6, 65536, v6
  v_mov_b32 v12, 0
  v_mov_b32 v14, 0x3f803f80
  s_waitcnt vmcnt(8)
  v_dot2c_f32_bf16 v12, v16, v14
  v_dot2c_f32_bf16 v12, v17, v14
  v_dot2c_f32_bf16 v12, v18, v14
  v_dot2c_f32_bf16 v12, v19, v14
  s_waitcnt vmcnt(7)
  v_dot2c_f32_bf16 v12, v20, v14
  v_dot2c_f32_bf16 v12, v21, v14
  v_dot2c_f32_bf16 v12, v22, v14
  v_dot2c_f32_bf16 v12, v23, v14
  s_waitcnt vmcnt(6)
  v_dot2c_f32_bf16 v12, v24, v14
  v_dot2c_f32_bf16 v12, v25, v14
  v_dot2c_f32_bf16 v12, v26, v14
  v_dot2c_f32_bf16 v12, v27, v14
  s_waitcnt vmcnt(5)
  v_dot2c_f32_bf16 v12, v28, v14
  v_dot2c_f32_bf16 v12, v29, v14
  v_dot2c_f32_bf16 v12, v30, v14
  v_dot2c_f32_bf16 v12, v31, v14
  s_waitcnt vmcnt(4)
  v_dot2c_f32_bf16 v12, v32, v14
  v_dot2c_f32_bf16 v12, v33, v14
  v_dot2c_f32_bf16 v12, v34, v14
  v_dot2c_f32_bf16 v12, v35, v14
  s_waitcnt vmcnt(3)
  v_dot2c_f32_bf16 v12, v36, v14
  v_dot2c_f32_bf16 v12, v37, v14
  v_dot2c_f32_bf16 v12, v38, v14
  v_dot2c_f32_bf16 v12, v39, v14
  s_waitcnt vmcnt(2)
  v_dot2c_f32_bf16 v12, v40, v14
  v_dot2c_f32_bf16 v12, v41, v14
  v_dot2c_f32_bf16 v12, v42, v14
  v_dot2c_f32_bf16 v12, v43, v14
  s_waitcnt vmcnt(1)
  v_dot2c_f32_bf16 v12, v44, v14
  v_dot2c_f32_bf16 v12, v45, v14
  v_dot2c_f32_bf16 v12, v46, v14
  v_dot2c_f32_bf16 v12, v47, v14
  s_waitcnt vmcnt(0)
  v_dot2c_f32_bf16 v12, v48, v14
  v_dot2c_f32_bf16 v12, v49, v14
  v_dot2c_f32_bf16 v12, v50, v14
  v_dot2c_f32_bf16 v12, v51, v14
  s_nop 2
  v_add_f32_dpp v12, v12, v12 row_ror:8 row_mask:0xf bank_mask:0xf
  s_nop 1
  v_mov_b32 v13, v12
  s_nop 1
  v_permlane16_swap_b32 v13, v12
  s_nop 1
  v_add_f32 v12, v13, v12
  s_nop 1
  v_mov_b32 v13, v12
  s_nop 1
  v_permlane32_swap_b32 v13, v12
  s_nop 1
  v_add_f32 v12, v13, v12
  s_nop 1
  v_mul_f32 v12, 0x3ae38e39, v12
  v_mov_b32 v13, 0
  v_lshlrev_b32 v64, 16, v16
  v_and_b32 v65, 0xffff0000, v16
  v_sub_f32 v64, v64, v12
  v_sub_f32 v65, v65, v12
  v_fmac_f32 v13, v64, v64
  v_fmac_f32 v13, v65, v65
  v_lshlrev_b32 v66, 16, v17
  v_and_b32 v67, 0xffff0000, v17
  v_sub_f32 v66, v66, v12
  v_sub_f32 v67, v67, v12
  v_fmac_f32 v13, v66, v66
  v_fmac_f32 v13, v67, v67
  v_lshlrev_b32 v68, 16, v18
  v_and_b32 v69, 0xffff0000, v18
  v_sub_f32 v68, v68, v12
  v_sub_f32 v69, v69, v12
  v_fmac_f32 v13, v68, v68
  v_fmac_f32 v13, v69, v69
  v_lshlrev_b32 v70, 16, v19
  v_and_b32 v71, 0xffff0000, v19
  v_sub_f32 v70, v70, v12
  v_sub_f32 v71, v71, v12
  v_fmac_f32 v13, v70, v70
  v_fmac_f32 v13, v71, v71
  v_lshlrev_b32 v72, 16, v20
  v_and_b32 v73, 0xffff0000, v20
  v_sub_f32 v72, v72, v12
  v_sub_f32 v73, v73, v12
  v_fmac_f32 v13, v72, v72
  v_fmac_f32 v13, v73, v73
  v_lshlrev_b32 v74, 16, v21
  v_and_b32 v75, 0xffff0000, v21
  v_sub_f32 v74, v74, v12
  v_sub_f32 v75, v75, v12
  v_fmac_f32 v13, v74, v74
  v_fmac_f32 v13, v75, v75
  v_lshlrev_b32 v76, 16, v22
  v_and_b32 v77, 0xffff0000, v22
  v_sub_f32 v76, v76, v12
  v_sub_f32 v77, v77, v12
  v_fmac_f32 v13, v76, v76
  v_fmac_f32 v13, v77, v77
  v_lshlrev_b32 v78, 16, v23
  v_and_b32 v79, 0xffff0000, v23
  v_sub_f32 v78, v78, v12
  v_sub_f32 v79, v79, v12
  v_fmac_f32 v13, v78, v78
  v_fmac_f32 v13, v79, v79
  v_lshlrev_b32 v80, 16, v24
  v_and_b32 v81, 0xffff0000, v24
  v_sub_f32 v80, v80, v12
  v_sub_f32 v81, v81, v12
  v_fmac_f32 v13, v80, v80
  v_fmac_f32 v13, v81, v81
  v_lshlrev_b32 v82, 16, v25
  v_and_b32 v83, 0xffff0000, v25
  v_sub_f32 v82, v82, v12
  v_sub_f32 v83, v83, v12
  v_fmac_f32 v13, v82, v82
  v_fmac_f32 v13, v83, v83
  v_lshlrev_b32 v84, 16, v26
  v_and_b32 v85, 0xffff0000, v26
  v_sub_f32 v84, v84, v12
  v_sub_f32 v85, v85, v12
  v_fmac_f32 v13, v84, v84
  v_fmac_f32 v13, v85, v85
  v_lshlrev_b32 v86, 16, v27
  v_and_b32 v87, 0xffff0000, v27
  v_sub_f32 v86, v86, v12
  v_sub_f32 v87, v87, v12
  v_fmac_f32 v13, v86, v86
  v_fmac_f32 v13, v87, v87
  v_lshlrev_b32 v88, 16, v28
  v_and_b32 v89, 0xffff0000, v28
  v_sub_f32 v88, v88, v12
  v_sub_f32 v89, v89, v12
  v_fmac_f32 v13, v88, v88
  v_fmac_f32 v13, v89, v89
  v_lshlrev_b32 v90, 16, v29
  v_and_b32 v91, 0xffff0000, v29
  v_sub_f32 v90, v90, v12
  v_sub_f32 v91, v91, v12
  v_fmac_f32 v13, v90, v90
  v_fmac_f32 v13, v91, v91
  v_lshlrev_b32 v92, 16, v30
  v_and_b32 v93, 0xffff0000, v30
  v_sub_f32 v92, v92, v12
  v_sub_f32 v93, v93, v12
  v_fmac_f32 v13, v92, v92
  v_fmac_f32 v13, v93, v93
  v_lshlrev_b32 v94, 16, v31
  v_and_b32 v95, 0xffff0000, v31
  v_sub_f32 v94, v94, v12
  v_sub_f32 v95, v95, v12
  v_fmac_f32 v13, v94, v94
  v_fmac_f32 v13, v95, v95
  v_lshlrev_b32 v96, 16, v32
  v_and_b32 v97, 0xffff0000, v32
  v_sub_f32 v96, v96, v12
  v_sub_f32 v97, v97, v12
  v_fmac_f32 v13, v96, v96
  v_fmac_f32 v13, v97, v97
  v_lshlrev_b32 v98, 16, v33
  v_and_b32 v99, 0xffff0000, v33
  v_sub_f32 v98, v98, v12
  v_sub_f32 v99, v99, v12
  v_fmac_f32 v13, v98, v98
  v_fmac_f32 v13, v99, v99
  v_lshlrev_b32 v100, 16, v34
  v_and_b32 v101, 0xffff0000, v34
  v_sub_f32 v100, v100, v12
  v_sub_f32 v101, v101, v12
  v_fmac_f32 v13, v100, v100
  v_fmac_f32 v13, v101, v101
  v_lshlrev_b32 v102, 16, v35
  v_and_b32 v103, 0xffff0000, v35
  v_sub_f32 v102, v102, v12
  v_sub_f32 v103, v103, v12
  v_fmac_f32 v13, v102, v102
  v_fmac_f32 v13, v103, v103
  v_lshlrev_b32 v104, 16, v36
  v_and_b32 v105, 0xffff0000, v36
  v_sub_f32 v104, v104, v12
  v_sub_f32 v105, v105, v12
  v_fmac_f32 v13, v104, v104
  v_fmac_f32 v13, v105, v105
  v_lshlrev_b32 v106, 16, v37
  v_and_b32 v107, 0xffff0000, v37
  v_sub_f32 v106, v106, v12
  v_sub_f32 v107, v107, v12
  v_fmac_f32 v13, v106, v106
  v_fmac_f32 v13, v107, v107
  v_lshlrev_b32 v108, 16, v38
  v_and_b32 v109, 0xffff0000, v38
  v_sub_f32 v108, v108, v12
  v_sub_f32 v109, v109, v12
  v_fmac_f32 v13, v108, v108
  v_fmac_f32 v13, v109, v109
  v_lshlrev_b32 v110, 16, v39
  v_and_b32 v111, 0xffff0000, v39
  v_sub_f32 v110, v110, v12
  v_sub_f32 v111, v111, v12
  v_fmac_f32 v13, v110, v110
  v_fmac_f32 v13, v111, v111
  v_lshlrev_b32 v112, 16, v40
  v_and_b32 v113, 0xffff0000, v40
  v_sub_f32 v112, v112, v12
  v_sub_f32 v113, v113, v12
  v_fmac_f32 v13, v112, v112
  v_fmac_f32 v13, v113, v113
  v_lshlrev_b32 v114, 16, v41
  v_and_b32 v115, 0xffff0000, v41
  v_sub_f32 v114, v114, v12
  v_sub_f32 v115, v115, v12
  v_fmac_f32 v13, v114, v114
  v_fmac_f32 v13, v115, v115
  v_lshlrev_b32 v116, 16, v42
  v_and_b32 v117, 0xffff0000, v42
  v_sub_f32 v116, v116, v12
  v_sub_f32 v117, v117, v12
  v_fmac_f32 v13, v116, v116
  v_fmac_f32 v13, v117, v117
  v_lshlrev_b32 v118, 16, v43
  v_and_b32 v119, 0xffff0000, v43
  v_sub_f32 v118, v118, v12
  v_sub_f32 v119, v119, v12
  v_fmac_f32 v13, v118, v118
  v_fmac_f32 v13, v119, v119
  v_lshlrev_b32 v120, 16, v44
  v_and_b32 v121, 0xffff0000, v44
  v_sub_f32 v120, v120, v12
  v_sub_f32 v121, v121, v12
  v_fmac_f32 v13, v120, v120
  v_fmac_f32 v13, v121, v121
  v_lshlrev_b32 v122, 16, v45
  v_and_b32 v123, 0xffff0000, v45
  v_sub_f32 v122, v122, v12
  v_sub_f32 v123, v123, v12
  v_fmac_f32 v13, v122, v122
  v_fmac_f32 v13, v123, v123
  v_lshlrev_b32 v124, 16, v46
  v_and_b32 v125, 0xffff0000, v46
  v_sub_f32 v124, v124, v12
  v_sub_f32 v125, v125, v12
  v_fmac_f32 v13, v124, v124
  v_fmac_f32 v13, v125, v125
  v_lshlrev_b32 v126, 16, v47
  v_and_b32 v127, 0xffff0000, v47
  v_sub_f32 v126, v126, v12
  v_sub_f32 v127, v127, v12
  v_fmac_f32 v13, v126, v126
  v_fmac_f32 v13, v127, v127
  v_lshlrev_b32 v128, 16, v48
  v_and_b32 v129, 0xffff0000, v48
  v_sub_f32 v128, v128, v12
  v_sub_f32 v129, v129, v12
  v_fmac_f32 v13, v128, v128
  v_fmac_f32 v13, v129, v129
  v_lshlrev_b32 v130, 16, v49
  v_and_b32 v131, 0xffff0000, v49
  v_sub_f32 v130, v130, v12
  v_sub_f32 v131, v131, v12
  v_fmac_f32 v13, v130, v130
  v_fmac_f32 v13, v131, v131
  v_lshlrev_b32 v132, 16, v50
  v_and_b32 v133, 0xffff0000, v50
  v_sub_f32 v132, v132, v12
  v_sub_f32 v133, v133, v12
  v_fmac_f32 v13, v132, v132
  v_fmac_f32 v13, v133, v133
  v_lshlrev_b32 v134, 16, v51
  v_and_b32 v135, 0xffff0000, v51
  v_sub_f32 v134, v134, v12
  v_sub_f32 v135, v135, v12
  v_fmac_f32 v13, v134, v134
  v_fmac_f32 v13, v135, v135
  s_nop 1
  v_add_f32_dpp v13, v13, v13 row_ror:8 row_mask:0xf bank_mask:0xf
  s_nop 1
  v_mov_b32 v15, v13
  s_nop 1
  v_permlane16_swap_b32 v15, v13
  s_nop 1
  v_add_f32 v13, v15, v13
  s_nop 1
  v_mov_b32 v15, v13
  s_nop 1
  v_permlane32_swap_b32 v15, v13
  s_nop 1
  v_add_f32 v13, v15, v13
  s_nop 1
  v_mul_f32 v13, 0x3ae38e39, v13
  v_add_f32 v13, 0x3727c5ac, v13
  v_rsq_f32 v13, v13
  s_nop 0
  v_mul_f32 v64, v64, v13
  v_mul_f32 v65, v65, v13
  v_cvt_pk_bf16_f32 v16, v64, v65
  v_mul_f32 v66, v66, v13
  v_mul_f32 v67, v67, v13
  v_cvt_pk_bf16_f32 v17, v66, v67
  v_mul_f32 v68, v68, v13
  v_mul_f32 v69, v69, v13
  v_cvt_pk_bf16_f32 v18, v68, v69
  v_mul_f32 v70, v70, v13
  v_mul_f32 v71, v71, v13
  v_cvt_pk_bf16_f32 v19, v70, v71
  s_mov_b32 s23, 0
  buffer_store_dwordx4 v[16:19], v6, s[16:19], s23 offen
  v_mul_f32 v72, v72, v13
  v_mul_f32 v73, v73, v13
  v_cvt_pk_bf16_f32 v20, v72, v73
  v_mul_f32 v74, v74, v13
  v_mul_f32 v75, v75, v13
  v_cvt_pk_bf16_f32 v21, v74, v75
  v_mul_f32 v76, v76, v13
  v_mul_f32 v77, v77, v13
  v_cvt_pk_bf16_f32 v22, v76, v77
  v_mul_f32 v78, v78, v13
  v_mul_f32 v79, v79, v13
  v_cvt_pk_bf16_f32 v23, v78, v79
  s_mov_b32 s23, 2048
  buffer_store_dwordx4 v[20:23], v6, s[16:19], s23 offen
  v_mul_f32 v80, v80, v13
  v_mul_f32 v81, v81, v13
  v_cvt_pk_bf16_f32 v24, v80, v81
  v_mul_f32 v82, v82, v13
  v_mul_f32 v83, v83, v13
  v_cvt_pk_bf16_f32 v25, v82, v83
  v_mul_f32 v84, v84, v13
  v_mul_f32 v85, v85, v13
  v_cvt_pk_bf16_f32 v26, v84, v85
  v_mul_f32 v86, v86, v13
  v_mul_f32 v87, v87, v13
  v_cvt_pk_bf16_f32 v27, v86, v87
  s_mov_b32 s23, 4096
  buffer_store_dwordx4 v[24:27], v6, s[16:19], s23 offen
  v_mul_f32 v88, v88, v13
  v_mul_f32 v89, v89, v13
  v_cvt_pk_bf16_f32 v28, v88, v89
  v_mul_f32 v90, v90, v13
  v_mul_f32 v91, v91, v13
  v_cvt_pk_bf16_f32 v29, v90, v91
  v_mul_f32 v92, v92, v13
  v_mul_f32 v93, v93, v13
  v_cvt_pk_bf16_f32 v30, v92, v93
  v_mul_f32 v94, v94, v13
  v_mul_f32 v95, v95, v13
  v_cvt_pk_bf16_f32 v31, v94, v95
  s_mov_b32 s23, 6144
  buffer_store_dwordx4 v[28:31], v6, s[16:19], s23 offen
  v_mul_f32 v96, v96, v13
  v_mul_f32 v97, v97, v13
  v_cvt_pk_bf16_f32 v32, v96, v97
  v_mul_f32 v98, v98, v13
  v_mul_f32 v99, v99, v13
  v_cvt_pk_bf16_f32 v33, v98, v99
  v_mul_f32 v100, v100, v13
  v_mul_f32 v101, v101, v13
  v_cvt_pk_bf16_f32 v34, v100, v101
  v_mul_f32 v102, v102, v13
  v_mul_f32 v103, v103, v13
  v_cvt_pk_bf16_f32 v35, v102, v103
  s_mov_b32 s23, 8192
  buffer_store_dwordx4 v[32:35], v6, s[16:19], s23 offen
  v_mul_f32 v104, v104, v13
  v_mul_f32 v105, v105, v13
  v_cvt_pk_bf16_f32 v36, v104, v105
  v_mul_f32 v106, v106, v13
  v_mul_f32 v107, v107, v13
  v_cvt_pk_bf16_f32 v37, v106, v107
  v_mul_f32 v108, v108, v13
  v_mul_f32 v109, v109, v13
  v_cvt_pk_bf16_f32 v38, v108, v109
  v_mul_f32 v110, v110, v13
  v_mul_f32 v111, v111, v13
  v_cvt_pk_bf16_f32 v39, v110, v111
  s_mov_b32 s23, 10240
  buffer_store_dwordx4 v[36:39], v6, s[16:19], s23 offen
  v_mul_f32 v112, v112, v13
  v_mul_f32 v113, v113, v13
  v_cvt_pk_bf16_f32 v40, v112, v113
  v_mul_f32 v114, v114, v13
  v_mul_f32 v115, v115, v13
  v_cvt_pk_bf16_f32 v41, v114, v115
  v_mul_f32 v116, v116, v13
  v_mul_f32 v117, v117, v13
  v_cvt_pk_bf16_f32 v42, v116, v117
  v_mul_f32 v118, v118, v13
  v_mul_f32 v119, v119, v13
  v_cvt_pk_bf16_f32 v43, v118, v119
  s_mov_b32 s23, 12288
  buffer_store_dwordx4 v[40:43], v6, s[16:19], s23 offen
  v_mul_f32 v120, v120, v13
  v_mul_f32 v121, v121, v13
  v_cvt_pk_bf16_f32 v44, v120, v121
  v_mul_f32 v122, v122, v13
  v_mul_f32 v123, v123, v13
  v_cvt_pk_bf16_f32 v45, v122, v123
  v_mul_f32 v124, v124, v13
  v_mul_f32 v125, v125, v13
  v_cvt_pk_bf16_f32 v46, v124, v125
  v_mul_f32 v126, v126, v13
  v_mul_f32 v127, v127, v13
  v_cvt_pk_bf16_f32 v47, v126, v127
  s_mov_b32 s23, 14336
  buffer_store_dwordx4 v[44:47], v6, s[16:19], s23 offen
  v_mul_f32 v128, v128, v13
  v_mul_f32 v129, v129, v13
  v_cvt_pk_bf16_f32 v48, v128, v129
  v_mul_f32 v130, v130, v13
  v_mul_f32 v131, v131, v13
  v_cvt_pk_bf16_f32 v49, v130, v131
  v_mul_f32 v132, v132, v13
  v_mul_f32 v133, v133, v13
  v_cvt_pk_bf16_f32 v50, v132, v133
  v_mul_f32 v134, v134, v13
  v_mul_f32 v135, v135, v13
  v_cvt_pk_bf16_f32 v51, v134, v135
  s_mov_b32 s23, 16384
  buffer_store_dwordx4 v[48:51], v6, s[16:19], s23 offen
  s_branch k1_kernel_end
k1_kernel_mod:
  s_load_dwordx4 s[4:7], s[0:1], 56
  s_waitcnt lgkmcnt(0)
  s_mov_b32 s8, s4
  s_and_b32 s9, s5, 0xffff
  s_mov_b32 s10, 1152
  s_mov_b32 s11, 0x20000

  s_mov_b32 s12, s6
  s_and_b32 s13, s7, 0xffff
  s_mov_b32 s14, 3981312
  s_mov_b32 s15, 0x20000

  s_mov_b32 s16, s34
  s_and_b32 s17, s35, 0xffff
  s_mov_b32 s18, 268435456
  s_mov_b32 s19, 0x20000

  s_sub_u32 s21, s2, 0
  s_cmp_lg_u32 s21, 0
  s_cbranch_scc1 k1_kernel_noclr
  v_lshlrev_b32 v2, 4, v0
  v_mov_b32 v16, 0
  v_mov_b32 v17, 0
  v_mov_b32 v18, 0
  v_mov_b32 v19, 0
  s_mov_b32 s22, 32768
  buffer_store_dwordx4 v[16:19], v2, s[16:19], s22 offen
  s_mov_b32 s22, 36864
  buffer_store_dwordx4 v[16:19], v2, s[16:19], s22 offen
  s_mov_b32 s22, 40960
  buffer_store_dwordx4 v[16:19], v2, s[16:19], s22 offen
  s_nop 1
k1_kernel_noclr:
  v_lshrrev_b32 v2, 2, v0
  v_and_b32 v3, 3, v0
  v_lshlrev_b32 v4, 1, v2
  v_mul_u32_u24 v5, 6912, v2
  v_lshl_add_u32 v5, v3, 4, v5
  s_lshl_b32 s22, s21, 6
  buffer_load_ushort v56, v4, s[8:11], 0 offen offset:0
  buffer_load_ushort v57, v4, s[8:11], 0 offen offset:128
  buffer_load_ushort v58, v4, s[8:11], 0 offen offset:256
  buffer_load_ushort v59, v4, s[8:11], 0 offen offset:384
  buffer_load_ushort v60, v4, s[8:11], 0 offen offset:512
  buffer_load_ushort v61, v4, s[8:11], 0 offen offset:640
  buffer_load_ushort v62, v4, s[8:11], 0 offen offset:768
  buffer_load_ushort v63, v4, s[8:11], 0 offen offset:896
  buffer_load_ushort v64, v4, s[8:11], 0 offen offset:1024
  buffer_load_dwordx4 v[16:19], v5, s[12:15], s22 offen
  s_add_u32 s22, s22, 442368
  buffer_load_dwordx4 v[20:23], v5, s[12:15], s22 offen
  s_add_u32 s22, s22, 442368
  buffer_load_dwordx4 v[24:27], v5, s[12:15], s22 offen
  s_add_u32 s22, s22, 442368
  buffer_load_dwordx4 v[28:31], v5, s[12:15], s22 offen
  s_add_u32 s22, s22, 442368
  buffer_load_dwordx4 v[32:35], v5, s[12:15], s22 offen
  s_add_u32 s22, s22, 442368
  buffer_load_dwordx4 v[36:39], v5, s[12:15], s22 offen
  s_add_u32 s22, s22, 442368
  buffer_load_dwordx4 v[40:43], v5, s[12:15], s22 offen
  s_add_u32 s22, s22, 442368
  buffer_load_dwordx4 v[44:47], v5, s[12:15], s22 offen
  s_add_u32 s22, s22, 442368
  buffer_load_dwordx4 v[48:51], v5, s[12:15], s22 offen
  v_mov_b32 v72, 0
  v_mov_b32 v73, 0
  v_mov_b32 v74, 0
  v_mov_b32 v75, 0
  v_mov_b32 v76, 0
  v_mov_b32 v77, 0
  v_mov_b32 v78, 0
  v_mov_b32 v79, 0
  s_waitcnt vmcnt(9)
  v_lshlrev_b32 v56, 16, v56
  v_lshlrev_b32 v57, 16, v57
  v_lshlrev_b32 v58, 16, v58
  v_lshlrev_b32 v59, 16, v59
  v_lshlrev_b32 v60, 16, v60
  v_lshlrev_b32 v61, 16, v61
  v_lshlrev_b32 v62, 16, v62
  v_lshlrev_b32 v63, 16, v63
  v_lshlrev_b32 v64, 16, v64
  v_mul_f32 v84, 0xbfb8aa3b, v56
  v_mul_f32 v85, 0xbfb8aa3b, v57
  v_mul_f32 v86, 0xbfb8aa3b, v58
  v_mul_f32 v87, 0xbfb8aa3b, v59
  v_mul_f32 v88, 0xbfb8aa3b, v60
  v_mul_f32 v89, 0xbfb8aa3b, v61
  v_mul_f32 v90, 0xbfb8aa3b, v62
  v_mul_f32 v91, 0xbfb8aa3b, v63
  v_mul_f32 v92, 0xbfb8aa3b, v64
  v_exp_f32 v84, v84
  v_exp_f32 v85, v85
  v_exp_f32 v86, v86
  v_exp_f32 v87, v87
  v_exp_f32 v88, v88
  v_exp_f32 v89, v89
  v_exp_f32 v90, v90
  v_exp_f32 v91, v91
  v_exp_f32 v92, v92
  v_add_f32 v84, 1.0, v84
  v_add_f32 v85, 1.0, v85
  v_add_f32 v86, 1.0, v86
  v_add_f32 v87, 1.0, v87
  v_add_f32 v88, 1.0, v88
  v_add_f32 v89, 1.0, v89
  v_add_f32 v90, 1.0, v90
  v_add_f32 v91, 1.0, v91
  v_add_f32 v92, 1.0, v92
  v_rcp_f32 v84, v84
  v_rcp_f32 v85, v85
  v_rcp_f32 v86, v86
  v_rcp_f32 v87, v87
  v_rcp_f32 v88, v88
  v_rcp_f32 v89, v89
  v_rcp_f32 v90, v90
  v_rcp_f32 v91, v91
  v_rcp_f32 v92, v92
  v_mul_f32 v84, v84, v56
  v_mul_f32 v85, v85, v57
  v_mul_f32 v86, v86, v58
  v_mul_f32 v87, v87, v59
  v_mul_f32 v88, v88, v60
  v_mul_f32 v89, v89, v61
  v_mul_f32 v90, v90, v62
  v_mul_f32 v91, v91, v63
  v_mul_f32 v92, v92, v64
  v_cvt_pk_bf16_f32 v84, v84, v84
  v_cvt_pk_bf16_f32 v85, v85, v85
  v_cvt_pk_bf16_f32 v86, v86, v86
  v_cvt_pk_bf16_f32 v87, v87, v87
  v_cvt_pk_bf16_f32 v88, v88, v88
  v_cvt_pk_bf16_f32 v89, v89, v89
  v_cvt_pk_bf16_f32 v90, v90, v90
  v_cvt_pk_bf16_f32 v91, v91, v91
  v_cvt_pk_bf16_f32 v92, v92, v92
  v_lshlrev_b32 v56, 16, v84
  v_lshlrev_b32 v57, 16, v85
  v_lshlrev_b32 v58, 16, v86
  v_lshlrev_b32 v59, 16, v87
  v_lshlrev_b32 v60, 16, v88
  v_lshlrev_b32 v61, 16, v89
  v_lshlrev_b32 v62, 16, v90
  v_lshlrev_b32 v63, 16, v91
  v_lshlrev_b32 v64, 16, v92
  s_waitcnt vmcnt(8)
  v_lshlrev_b32 v70, 16, v16
  v_and_b32 v71, 0xffff0000, v16
  v_fmac_f32 v72, v70, v56
  v_fmac_f32 v73, v71, v56
  v_lshlrev_b32 v70, 16, v17
  v_and_b32 v71, 0xffff0000, v17
  v_fmac_f32 v74, v70, v56
  v_fmac_f32 v75, v71, v56
  v_lshlrev_b32 v70, 16, v18
  v_and_b32 v71, 0xffff0000, v18
  v_fmac_f32 v76, v70, v56
  v_fmac_f32 v77, v71, v56
  v_lshlrev_b32 v70, 16, v19
  v_and_b32 v71, 0xffff0000, v19
  v_fmac_f32 v78, v70, v56
  v_fmac_f32 v79, v71, v56
  s_waitcnt vmcnt(7)
  v_lshlrev_b32 v70, 16, v20
  v_and_b32 v71, 0xffff0000, v20
  v_fmac_f32 v72, v70, v57
  v_fmac_f32 v73, v71, v57
  v_lshlrev_b32 v70, 16, v21
  v_and_b32 v71, 0xffff0000, v21
  v_fmac_f32 v74, v70, v57
  v_fmac_f32 v75, v71, v57
  v_lshlrev_b32 v70, 16, v22
  v_and_b32 v71, 0xffff0000, v22
  v_fmac_f32 v76, v70, v57
  v_fmac_f32 v77, v71, v57
  v_lshlrev_b32 v70, 16, v23
  v_and_b32 v71, 0xffff0000, v23
  v_fmac_f32 v78, v70, v57
  v_fmac_f32 v79, v71, v57
  s_waitcnt vmcnt(6)
  v_lshlrev_b32 v70, 16, v24
  v_and_b32 v71, 0xffff0000, v24
  v_fmac_f32 v72, v70, v58
  v_fmac_f32 v73, v71, v58
  v_lshlrev_b32 v70, 16, v25
  v_and_b32 v71, 0xffff0000, v25
  v_fmac_f32 v74, v70, v58
  v_fmac_f32 v75, v71, v58
  v_lshlrev_b32 v70, 16, v26
  v_and_b32 v71, 0xffff0000, v26
  v_fmac_f32 v76, v70, v58
  v_fmac_f32 v77, v71, v58
  v_lshlrev_b32 v70, 16, v27
  v_and_b32 v71, 0xffff0000, v27
  v_fmac_f32 v78, v70, v58
  v_fmac_f32 v79, v71, v58
  s_waitcnt vmcnt(5)
  v_lshlrev_b32 v70, 16, v28
  v_and_b32 v71, 0xffff0000, v28
  v_fmac_f32 v72, v70, v59
  v_fmac_f32 v73, v71, v59
  v_lshlrev_b32 v70, 16, v29
  v_and_b32 v71, 0xffff0000, v29
  v_fmac_f32 v74, v70, v59
  v_fmac_f32 v75, v71, v59
  v_lshlrev_b32 v70, 16, v30
  v_and_b32 v71, 0xffff0000, v30
  v_fmac_f32 v76, v70, v59
  v_fmac_f32 v77, v71, v59
  v_lshlrev_b32 v70, 16, v31
  v_and_b32 v71, 0xffff0000, v31
  v_fmac_f32 v78, v70, v59
  v_fmac_f32 v79, v71, v59
  s_waitcnt vmcnt(4)
  v_lshlrev_b32 v70, 16, v32
  v_and_b32 v71, 0xffff0000, v32
  v_fmac_f32 v72, v70, v60
  v_fmac_f32 v73, v71, v60
  v_lshlrev_b32 v70, 16, v33
  v_and_b32 v71, 0xffff0000, v33
  v_fmac_f32 v74, v70, v60
  v_fmac_f32 v75, v71, v60
  v_lshlrev_b32 v70, 16, v34
  v_and_b32 v71, 0xffff0000, v34
  v_fmac_f32 v76, v70, v60
  v_fmac_f32 v77, v71, v60
  v_lshlrev_b32 v70, 16, v35
  v_and_b32 v71, 0xffff0000, v35
  v_fmac_f32 v78, v70, v60
  v_fmac_f32 v79, v71, v60
  s_waitcnt vmcnt(3)
  v_lshlrev_b32 v70, 16, v36
  v_and_b32 v71, 0xffff0000, v36
  v_fmac_f32 v72, v70, v61
  v_fmac_f32 v73, v71, v61
  v_lshlrev_b32 v70, 16, v37
  v_and_b32 v71, 0xffff0000, v37
  v_fmac_f32 v74, v70, v61
  v_fmac_f32 v75, v71, v61
  v_lshlrev_b32 v70, 16, v38
  v_and_b32 v71, 0xffff0000, v38
  v_fmac_f32 v76, v70, v61
  v_fmac_f32 v77, v71, v61
  v_lshlrev_b32 v70, 16, v39
  v_and_b32 v71, 0xffff0000, v39
  v_fmac_f32 v78, v70, v61
  v_fmac_f32 v79, v71, v61
  s_waitcnt vmcnt(2)
  v_lshlrev_b32 v70, 16, v40
  v_and_b32 v71, 0xffff0000, v40
  v_fmac_f32 v72, v70, v62
  v_fmac_f32 v73, v71, v62
  v_lshlrev_b32 v70, 16, v41
  v_and_b32 v71, 0xffff0000, v41
  v_fmac_f32 v74, v70, v62
  v_fmac_f32 v75, v71, v62
  v_lshlrev_b32 v70, 16, v42
  v_and_b32 v71, 0xffff0000, v42
  v_fmac_f32 v76, v70, v62
  v_fmac_f32 v77, v71, v62
  v_lshlrev_b32 v70, 16, v43
  v_and_b32 v71, 0xffff0000, v43
  v_fmac_f32 v78, v70, v62
  v_fmac_f32 v79, v71, v62
  s_waitcnt vmcnt(1)
  v_lshlrev_b32 v70, 16, v44
  v_and_b32 v71, 0xffff0000, v44
  v_fmac_f32 v72, v70, v63
  v_fmac_f32 v73, v71, v63
  v_lshlrev_b32 v70, 16, v45
  v_and_b32 v71, 0xffff0000, v45
  v_fmac_f32 v74, v70, v63
  v_fmac_f32 v75, v71, v63
  v_lshlrev_b32 v70, 16, v46
  v_and_b32 v71, 0xffff0000, v46
  v_fmac_f32 v76, v70, v63
  v_fmac_f32 v77, v71, v63
  v_lshlrev_b32 v70, 16, v47
  v_and_b32 v71, 0xffff0000, v47
  v_fmac_f32 v78, v70, v63
  v_fmac_f32 v79, v71, v63
  s_waitcnt vmcnt(0)
  v_lshlrev_b32 v70, 16, v48
  v_and_b32 v71, 0xffff0000, v48
  v_fmac_f32 v72, v70, v64
  v_fmac_f32 v73, v71, v64
  v_lshlrev_b32 v70, 16, v49
  v_and_b32 v71, 0xffff0000, v49
  v_fmac_f32 v74, v70, v64
  v_fmac_f32 v75, v71, v64
  v_lshlrev_b32 v70, 16, v50
  v_and_b32 v71, 0xffff0000, v50
  v_fmac_f32 v76, v70, v64
  v_fmac_f32 v77, v71, v64
  v_lshlrev_b32 v70, 16, v51
  v_and_b32 v71, 0xffff0000, v51
  v_fmac_f32 v78, v70, v64
  v_fmac_f32 v79, v71, v64
  s_nop 1
  v_add_f32_dpp v72, v72, v72 row_ror:4 row_mask:0xf bank_mask:0xf
  v_add_f32_dpp v73, v73, v73 row_ror:4 row_mask:0xf bank_mask:0xf
  v_add_f32_dpp v74, v74, v74 row_ror:4 row_mask:0xf bank_mask:0xf
  v_add_f32_dpp v75, v75, v75 row_ror:4 row_mask:0xf bank_mask:0xf
  v_add_f32_dpp v76, v76, v76 row_ror:4 row_mask:0xf bank_mask:0xf
  v_add_f32_dpp v77, v77, v77 row_ror:4 row_mask:0xf bank_mask:0xf
  v_add_f32_dpp v78, v78, v78 row_ror:4 row_mask:0xf bank_mask:0xf
  v_add_f32_dpp v79, v79, v79 row_ror:4 row_mask:0xf bank_mask:0xf
  v_add_f32_dpp v72, v72, v72 row_ror:8 row_mask:0xf bank_mask:0xf
  v_add_f32_dpp v73, v73, v73 row_ror:8 row_mask:0xf bank_mask:0xf
  v_add_f32_dpp v74, v74, v74 row_ror:8 row_mask:0xf bank_mask:0xf
  v_add_f32_dpp v75, v75, v75 row_ror:8 row_mask:0xf bank_mask:0xf
  v_add_f32_dpp v76, v76, v76 row_ror:8 row_mask:0xf bank_mask:0xf
  v_add_f32_dpp v77, v77, v77 row_ror:8 row_mask:0xf bank_mask:0xf
  v_add_f32_dpp v78, v78, v78 row_ror:8 row_mask:0xf bank_mask:0xf
  v_add_f32_dpp v79, v79, v79 row_ror:8 row_mask:0xf bank_mask:0xf
  v_mov_b32 v84, v72
  v_mov_b32 v85, v73
  v_mov_b32 v86, v74
  v_mov_b32 v87, v75
  v_mov_b32 v88, v76
  v_mov_b32 v89, v77
  v_mov_b32 v90, v78
  v_mov_b32 v91, v79
  v_permlane16_swap_b32 v84, v72
  v_permlane16_swap_b32 v85, v73
  v_permlane16_swap_b32 v86, v74
  v_permlane16_swap_b32 v87, v75
  v_permlane16_swap_b32 v88, v76
  v_permlane16_swap_b32 v89, v77
  v_permlane16_swap_b32 v90, v78
  v_permlane16_swap_b32 v91, v79
  v_add_f32 v72, v84, v72
  v_add_f32 v73, v85, v73
  v_add_f32 v74, v86, v74
  v_add_f32 v75, v87, v75
  v_add_f32 v76, v88, v76
  v_add_f32 v77, v89, v77
  v_add_f32 v78, v90, v78
  v_add_f32 v79, v91, v79
  v_mov_b32 v84, v72
  v_mov_b32 v85, v73
  v_mov_b32 v86, v74
  v_mov_b32 v87, v75
  v_mov_b32 v88, v76
  v_mov_b32 v89, v77
  v_mov_b32 v90, v78
  v_mov_b32 v91, v79
  v_permlane32_swap_b32 v84, v72
  v_permlane32_swap_b32 v85, v73
  v_permlane32_swap_b32 v86, v74
  v_permlane32_swap_b32 v87, v75
  v_permlane32_swap_b32 v88, v76
  v_permlane32_swap_b32 v89, v77
  v_permlane32_swap_b32 v90, v78
  v_permlane32_swap_b32 v91, v79
  v_add_f32 v72, v84, v72
  v_add_f32 v73, v85, v73
  v_add_f32 v74, v86, v74
  v_add_f32 v75, v87, v75
  v_add_f32 v76, v88, v76
  v_add_f32 v77, v89, v77
  v_add_f32 v78, v90, v78
  v_add_f32 v79, v91, v79
  s_nop 1
  s_lshl_b32 s23, s20, 7
  v_lshl_add_u32 v6, v1, 5, s23
  v_cmp_gt_u32 vcc, 4, v1
  s_and_saveexec_b64 s[44:45], vcc
  ds_write_b128 v6, v[72:75]
  ds_write_b128 v6, v[76:79] offset:16
  s_mov_b64 exec, s[44:45]
  s_waitcnt lgkmcnt(0)
  s_barrier
  v_lshlrev_b32 v6, 2, v0
  v_cmp_gt_u32 vcc, 32, v0
  s_and_saveexec_b64 s[44:45], vcc
  s_cbranch_execz k1_kernel_end
  ds_read_b32 v16, v6 offset:0
  ds_read_b32 v17, v6 offset:128
  ds_read_b32 v18, v6 offset:256
  ds_read_b32 v19, v6 offset:384
  s_waitcnt lgkmcnt(0)
  v_add_f32 v16, v16, v17
  v_add_f32 v18, v18, v19
  v_add_f32 v16, v16, v18
  v_cvt_pk_bf16_f32 v16, v16, v16
  v_lshlrev_b32 v16, 16, v16
  s_mul_hi_u32 s24, s21, 238609295
  s_mov_b32 s25, 0
  s_cmp_eq_u32 s24, 1
  s_cselect_b32 s25, 1.0, s25
  s_cmp_eq_u32 s24, 4
  s_cselect_b32 s25, 1.0, s25
  v_add_f32 v16, s25, v16
  v_cvt_pk_bf16_f32 v16, v16, v16
  v_lshlrev_b32 v16, 16, v16
  s_lshl_b32 s22, s21, 7
  s_add_u32 s22, s22, 0
  buffer_store_dword v16, v6, s[16:19], s22 offen
  s_branch k1_kernel_end
k1_kernel_rp:
  s_load_dwordx4 s[4:7], s[0:1], 8
  s_load_dwordx4 s[44:47], s[0:1], 32
  s_sub_u32 s21, s2, 172
  s_lshl_b32 s37, s21, 2
  s_add_u32 s37, s37, s20
  s_waitcnt lgkmcnt(0)
  s_bitcmp1_b32 s37, 0
  s_cselect_b32 s44, s46, s44
  s_cselect_b32 s45, s47, s45
  s_mov_b32 s40, s44
  s_and_b32 s41, s45, 0xffff
  s_mov_b32 s42, 5308416
  s_mov_b32 s43, 0x20000

  s_cmp_ge_u32 s21, 168
  s_cbranch_scc1 k1_kernel_ro
  s_waitcnt lgkmcnt(0)
  s_mov_b32 s8, s4
  s_and_b32 s9, s5, 0xffff
  s_mov_b32 s10, 1990656
  s_mov_b32 s11, 0x20000

  s_mov_b32 s16, s34
  s_and_b32 s17, s35, 0xffff
  s_mov_b32 s18, 268435456
  s_mov_b32 s19, 0x20000

  s_lshl_b32 s21, s21, 2
  s_add_u32 s21, s21, s20
  s_mul_hi_u32 s22, s21, 715827883
  s_mul_i32 s23, s22, 6
  s_sub_u32 s23, s21, s23
  s_mul_hi_u32 s24, s22, 306783379
  s_mul_i32 s25, s24, 14
  s_sub_u32 s25, s22, s25
  v_and_b32 v2, 15, v1
  v_lshrrev_b32 v3, 4, v1
  s_lshl_b32 s26, s25, 4
  v_add_u32 v2, s26, v2
  s_mul_i32 s27, s24, 72
  v_add_u32 v4, 576, v2
  v_add_u32 v5, 1080, v2
  v_cmp_le_u32 vcc, 72, v2
  v_cndmask_b32 v4, v4, v5, vcc
  v_subrev_u32 v5, 144, v2
  v_cmp_le_u32 vcc, 144, v2
  v_cndmask_b32 v4, v4, v5, vcc
  v_add_u32 v4, s27, v4
  v_lshlrev_b32 v4, 1, v4
  s_mul_i32 s28, s23, 96
  v_lshl_add_u32 v3, v3, 3, s28
  v_mul_u32_u24 v3, 3456, v3
  v_add_u32 v4, v3, v4
  v_mov_b32 v5, 0x7ff00000
  v_cmp_gt_u32 vcc, 216, v2
  v_cndmask_b32 v4, v5, v4, vcc
  s_mov_b32 s29, 0
  buffer_load_ushort v16, v4, s[8:11], s29 offen
  s_mov_b32 s29, 3456
  buffer_load_ushort v17, v4, s[8:11], s29 offen
  s_mov_b32 s29, 6912
  buffer_load_ushort v18, v4, s[8:11], s29 offen
  s_mov_b32 s29, 10368
  buffer_load_ushort v19, v4, s[8:11], s29 offen
  s_mov_b32 s29, 13824
  buffer_load_ushort v20, v4, s[8:11], s29 offen
  s_mov_b32 s29, 17280
  buffer_load_ushort v21, v4, s[8:11], s29 offen
  s_mov_b32 s29, 20736
  buffer_load_ushort v22, v4, s[8:11], s29 offen
  s_mov_b32 s29, 24192
  buffer_load_ushort v23, v4, s[8:11], s29 offen
  s_mov_b32 s29, 110592
  buffer_load_ushort v24, v4, s[8:11], s29 offen
  s_mov_b32 s29, 114048
  buffer_load_ushort v25, v4, s[8:11], s29 offen
  s_mov_b32 s29, 117504
  buffer_load_ushort v26, v4, s[8:11], s29 offen
  s_mov_b32 s29, 120960
  buffer_load_ushort v27, v4, s[8:11], s29 offen
  s_mov_b32 s29, 124416
  buffer_load_ushort v28, v4, s[8:11], s29 offen
  s_mov_b32 s29, 127872
  buffer_load_ushort v29, v4, s[8:11], s29 offen
  s_mov_b32 s29, 131328
  buffer_load_ushort v30, v4, s[8:11], s29 offen
  s_mov_b32 s29, 134784
  buffer_load_ushort v31, v4, s[8:11], s29 offen
  s_mov_b32 s29, 221184
  buffer_load_ushort v32, v4, s[8:11], s29 offen
  s_mov_b32 s29, 224640
  buffer_load_ushort v33, v4, s[8:11], s29 offen
  s_mov_b32 s29, 228096
  buffer_load_ushort v34, v4, s[8:11], s29 offen
  s_mov_b32 s29, 231552
  buffer_load_ushort v35, v4, s[8:11], s29 offen
  s_mov_b32 s29, 235008
  buffer_load_ushort v36, v4, s[8:11], s29 offen
  s_mov_b32 s29, 238464
  buffer_load_ushort v37, v4, s[8:11], s29 offen
  s_mov_b32 s29, 241920
  buffer_load_ushort v38, v4, s[8:11], s29 offen
  s_mov_b32 s29, 245376
  buffer_load_ushort v39, v4, s[8:11], s29 offen
  s_mul_i32 s30, s22, 18
  s_mul_i32 s31, s23, 3
  s_add_u32 s30, s30, s31
  s_lshl_b32 s30, s30, 10
  s_add_u32 s30, s30, 2490368
  v_lshlrev_b32 v9, 4, v1
  s_waitcnt vmcnt(16)
  v_lshl_or_b32 v48, v17, 16, v16
  v_lshl_or_b32 v49, v19, 16, v18
  v_lshl_or_b32 v50, v21, 16, v20
  v_lshl_or_b32 v51, v23, 16, v22
  buffer_store_dwordx4 v[48:51], v9, s[16:19], s30 offen offset:0
  s_waitcnt vmcnt(9)
  v_lshl_or_b32 v52, v25, 16, v24
  v_lshl_or_b32 v53, v27, 16, v26
  v_lshl_or_b32 v54, v29, 16, v28
  v_lshl_or_b32 v55, v31, 16, v30
  buffer_store_dwordx4 v[52:55], v9, s[16:19], s30 offen offset:1024
  s_waitcnt vmcnt(2)
  v_lshl_or_b32 v56, v33, 16, v32
  v_lshl_or_b32 v57, v35, 16, v34
  v_lshl_or_b32 v58, v37, 16, v36
  v_lshl_or_b32 v59, v39, 16, v38
  buffer_store_dwordx4 v[56:59], v9, s[16:19], s30 offen offset:2048
  s_branch k1_kernel_end
k1_kernel_ro:
  s_waitcnt lgkmcnt(0)
  s_mov_b32 s8, s6
  s_and_b32 s9, s7, 0xffff
  s_mov_b32 s10, 663552
  s_mov_b32 s11, 0x20000

  s_mov_b32 s16, s34
  s_and_b32 s17, s35, 0xffff
  s_mov_b32 s18, 268435456
  s_mov_b32 s19, 0x20000

  s_sub_u32 s21, s21, 168
  s_lshl_b32 s21, s21, 2
  s_add_u32 s21, s21, s20
  s_mul_hi_u32 s22, s21, 715827883
  s_mul_i32 s23, s22, 6
  s_sub_u32 s23, s21, s23
  s_mul_hi_u32 s24, s22, 858993460
  s_mul_i32 s25, s24, 5
  s_sub_u32 s25, s22, s25
  v_and_b32 v2, 15, v1
  v_lshrrev_b32 v3, 4, v1
  s_lshl_b32 s26, s25, 4
  v_add_u32 v2, s26, v2
  s_mul_i32 s27, s24, 72
  v_mov_b32 v4, v2
  v_add_u32 v4, s27, v4
  v_lshlrev_b32 v4, 1, v4
  s_mul_i32 s28, s23, 96
  v_lshl_add_u32 v3, v3, 3, s28
  v_mul_u32_u24 v3, 1152, v3
  v_add_u32 v4, v3, v4
  v_mov_b32 v5, 0x7ff00000
  v_cmp_gt_u32 vcc, 72, v2
  v_cndmask_b32 v4, v5, v4, vcc
  s_mov_b32 s29, 0
  buffer_load_ushort v16, v4, s[8:11], s29 offen
  s_mov_b32 s29, 1152
  buffer_load_ushort v17, v4, s[8:11], s29 offen
  s_mov_b32 s29, 2304
  buffer_load_ushort v18, v4, s[8:11], s29 offen
  s_mov_b32 s29, 3456
  buffer_load_ushort v19, v4, s[8:11], s29 offen
  s_mov_b32 s29, 4608
  buffer_load_ushort v20, v4, s[8:11], s29 offen
  s_mov_b32 s29, 5760
  buffer_load_ushort v21, v4, s[8:11], s29 offen
  s_mov_b32 s29, 6912
  buffer_load_ushort v22, v4, s[8:11], s29 offen
  s_mov_b32 s29, 8064
  buffer_load_ushort v23, v4, s[8:11], s29 offen
  s_mov_b32 s29, 36864
  buffer_load_ushort v24, v4, s[8:11], s29 offen
  s_mov_b32 s29, 38016
  buffer_load_ushort v25, v4, s[8:11], s29 offen
  s_mov_b32 s29, 39168
  buffer_load_ushort v26, v4, s[8:11], s29 offen
  s_mov_b32 s29, 40320
  buffer_load_ushort v27, v4, s[8:11], s29 offen
  s_mov_b32 s29, 41472
  buffer_load_ushort v28, v4, s[8:11], s29 offen
  s_mov_b32 s29, 42624
  buffer_load_ushort v29, v4, s[8:11], s29 offen
  s_mov_b32 s29, 43776
  buffer_load_ushort v30, v4, s[8:11], s29 offen
  s_mov_b32 s29, 44928
  buffer_load_ushort v31, v4, s[8:11], s29 offen
  s_mov_b32 s29, 73728
  buffer_load_ushort v32, v4, s[8:11], s29 offen
  s_mov_b32 s29, 74880
  buffer_load_ushort v33, v4, s[8:11], s29 offen
  s_mov_b32 s29, 76032
  buffer_load_ushort v34, v4, s[8:11], s29 offen
  s_mov_b32 s29, 77184
  buffer_load_ushort v35, v4, s[8:11], s29 offen
  s_mov_b32 s29, 78336
  buffer_load_ushort v36, v4, s[8:11], s29 offen
  s_mov_b32 s29, 79488
  buffer_load_ushort v37, v4, s[8:11], s29 offen
  s_mov_b32 s29, 80640
  buffer_load_ushort v38, v4, s[8:11], s29 offen
  s_mov_b32 s29, 81792
  buffer_load_ushort v39, v4, s[8:11], s29 offen
  s_mul_i32 s30, s22, 18
  s_mul_i32 s31, s23, 3
  s_add_u32 s30, s30, s31
  s_lshl_b32 s30, s30, 10
  s_add_u32 s30, s30, 4587520
  v_lshlrev_b32 v9, 4, v1
  s_waitcnt vmcnt(16)
  v_lshl_or_b32 v48, v17, 16, v16
  v_lshl_or_b32 v49, v19, 16, v18
  v_lshl_or_b32 v50, v21, 16, v20
  v_lshl_or_b32 v51, v23, 16, v22
  buffer_store_dwordx4 v[48:51], v9, s[16:19], s30 offen offset:0
  s_waitcnt vmcnt(9)
  v_lshl_or_b32 v52, v25, 16, v24
  v_lshl_or_b32 v53, v27, 16, v26
  v_lshl_or_b32 v54, v29, 16, v28
  v_lshl_or_b32 v55, v31, 16, v30
  buffer_store_dwordx4 v[52:55], v9, s[16:19], s30 offen offset:1024
  s_waitcnt vmcnt(2)
  v_lshl_or_b32 v56, v33, 16, v32
  v_lshl_or_b32 v57, v35, 16, v34
  v_lshl_or_b32 v58, v37, 16, v36
  v_lshl_or_b32 v59, v39, 16, v38
  buffer_store_dwordx4 v[56:59], v9, s[16:19], s30 offen offset:2048
  s_branch k1_kernel_end
k1_kernel_end:

k1_kernel_exit:
  s_endpgm
.section .rodata,"a"
.p2align 6
.amdhsa_kernel k1_kernel
  .amdhsa_next_free_vgpr 144
  .amdhsa_next_free_sgpr 102
  .amdhsa_accum_offset 144
  .amdhsa_group_segment_fixed_size 0
  .amdhsa_kernarg_size 96
  .amdhsa_user_sgpr_count 2
  .amdhsa_user_sgpr_kernarg_segment_ptr 1
  .amdhsa_system_sgpr_workgroup_id_x 1
.end_amdhsa_kernel
.text

.globl f_kernel
.p2align 8
.type f_kernel,@function
f_kernel:
  s_cmp_ge_u32 s2, 256
  s_cbranch_scc1 f_kernel_end

  s_load_dwordx2 s[36:37], s[0:1], 88
  s_load_dwordx4 s[4:7], s[0:1], 32
  v_lshrrev_b32 v10, 6, v0
  v_and_b32 v1, 63, v0
  v_readfirstlane_b32 s20, v10
  s_and_b32 s22, s2, 7
  s_lshr_b32 s21, s2, 3
  s_lshr_b32 s23, s22, 2
  s_and_b32 s22, s22, 3
  s_lshl_b32 s22, s22, 1
  s_and_b32 s24, s21, 1
  s_add_u32 s22, s22, s24
  s_lshr_b32 s21, s21, 1
  s_lshl_b32 s23, s23, 4
  s_add_u32 s21, s21, s23

  v_lshlrev_b32 v9, 4, v1
  s_mul_i32 s23, s2, 36
  s_and_b32 s24, s20, 1
  s_mul_i32 s24, s24, 18
  s_add_u32 s23, s23, s24
  v_add_u32 v5, s23, v1
  v_mov_b32 v6, 0xffffff
  v_cmp_gt_u32 vcc, 18, v1
  v_cndmask_b32 v5, v6, v5, vcc
  v_lshrrev_b32 v4, 4, v5
  v_mul_u32_u24 v16, 16, v4
  v_sub_u32 v16, v5, v16
  v_mul_u32_u24 v4, 9216, v4
  v_mul_u32_u24 v17, 128, v16
  v_lshrrev_b32 v17, 8, v17
  v_mul_u32_u24 v18, 2, v17
  v_sub_u32 v16, v16, v18
  v_mul_u32_u24 v17, 1152, v17
  v_add_u32 v4, v4, v17
  v_lshl_add_u32 v4, v16, 7, v4
  v_add_u32 v4, 0, v4
  v_mov_b32 v16, 0x7ff00000
  v_cmp_gt_u32 vcc, 9216, v5
  v_cndmask_b32 v4, v16, v4, vcc
  s_lshl_b32 s23, s21, 2
  s_add_i32 s23, s23, -1
  s_max_i32 s23, s23, 0
  s_mul_i32 s23, s23, 18
  s_add_u32 s23, s23, s20
  s_lshl_b32 s23, s23, 10
  s_add_u32 s30, s23, 65536
  s_lshl_b32 s23, s21, 2
  s_add_i32 s23, s23, 0
  s_max_i32 s23, s23, 0
  s_mul_i32 s23, s23, 18
  s_add_u32 s23, s23, s20
  s_lshl_b32 s23, s23, 10
  s_add_u32 s31, s23, 65536
  s_lshl_b32 s23, s21, 2
  s_add_i32 s23, s23, 1
  s_max_i32 s23, s23, 0
  s_mul_i32 s23, s23, 18
  s_add_u32 s23, s23, s20
  s_lshl_b32 s23, s23, 10
  s_add_u32 s32, s23, 65536
  s_lshl_b32 s23, s21, 2
  s_add_i32 s23, s23, 2
  s_max_i32 s23, s23, 0
  s_mul_i32 s23, s23, 18
  s_add_u32 s23, s23, s20
  s_lshl_b32 s23, s23, 10
  s_add_u32 s33, s23, 65536
  s_lshl_b32 s23, s21, 2
  s_add_i32 s23, s23, 3
  s_max_i32 s23, s23, 0
  s_mul_i32 s23, s23, 18
  s_add_u32 s23, s23, s20
  s_lshl_b32 s23, s23, 10
  s_add_u32 s34, s23, 65536
  v_lshrrev_b32 v11, 4, v1
  v_lshlrev_b32 v11, 5, v11
  s_lshl_b32 s23, s20, 7
  s_add_u32 s46, s23, 0
  s_add_u32 s47, s23, 2304
  s_lshl_b32 s23, s20, 10
  v_add_u32 v10, s23, v9
  v_add_u32 v12, 55296, v10
  v_add_u32 v13, 0, v9
  v_add_u32 v14, 55296, v9
  v_and_b32 v8, 15, v1
  v_mul_u32_u24 v8, 452, v8
  v_lshrrev_b32 v15, 4, v1
  v_lshl_add_u32 v8, v15, 3, v8
  s_waitcnt lgkmcnt(0)
  s_mov_b32 s16, s36
  s_and_b32 s17, s37, 0xffff
  s_mov_b32 s18, 268435456
  s_mov_b32 s19, 0x20000

  s_cmp_ge_u32 s20, 2
  s_cselect_b32 s4, s6, s4
  s_cselect_b32 s5, s7, s5
  s_mov_b32 s60, s4
  s_and_b32 s61, s5, 0xffff
  s_mov_b32 s62, 5308416
  s_mov_b32 s63, 0x20000

  s_cmp_lg_u32 s20, 0
  s_cbranch_scc1 f_kernel_t1
  s_mul_i32 s25, s22, 258048
  s_add_u32 s40, s25, 2490368
  s_mov_b32 s50, 92160
  s_mul_i32 s25, s22, 258048
  s_add_u32 s41, s25, 2508800
  s_mov_b32 s51, 92192
  s_mul_i32 s25, s22, 258048
  s_add_u32 s42, s25, 2656256
  s_mov_b32 s52, 99680
  s_mul_i32 s25, s22, 258048
  s_add_u32 s43, s25, 2674688
  s_mov_b32 s53, 99712
  s_branch f_kernel_pA
f_kernel_t1:
  s_cmp_lg_u32 s20, 1
  s_cbranch_scc1 f_kernel_t2
  s_mul_i32 s25, s22, 258048
  s_add_u32 s40, s25, 2527232
  s_mov_b32 s50, 92224
  s_mul_i32 s25, s22, 258048
  s_add_u32 s41, s25, 2545664
  s_mov_b32 s51, 92256
  s_mul_i32 s25, s22, 258048
  s_add_u32 s42, s25, 2693120
  s_mov_b32 s52, 99744
  s_mul_i32 s25, s22, 258048
  s_add_u32 s43, s25, 2711552
  s_mov_b32 s53, 99776
  s_branch f_kernel_pA
f_kernel_t2:
  s_cmp_lg_u32 s20, 2
  s_cbranch_scc1 f_kernel_t3
  s_mul_i32 s25, s22, 258048
  s_add_u32 s40, s25, 2564096
  s_mov_b32 s50, 92288
  s_mul_i32 s25, s22, 258048
  s_add_u32 s41, s25, 2582528
  s_mov_b32 s51, 92320
  s_mul_i32 s25, s22, 258048
  s_add_u32 s42, s25, 2600960
  s_mov_b32 s52, 92352
  s_branch f_kernel_pB
f_kernel_t3:
  s_mul_i32 s25, s22, 258048
  s_add_u32 s40, s25, 2619392
  s_mov_b32 s50, 92384
  s_mul_i32 s25, s22, 258048
  s_add_u32 s41, s25, 2637824
  s_mov_b32 s51, 92416
  s_mul_i32 s25, s22, 258048
  s_add_u32 s42, s25, 2729984
  s_mov_b32 s52, 92576
  s_branch f_kernel_pB
f_kernel_pA:
  buffer_load_dwordx4 v[156:159], v11, s[16:19], s47 offen offset:0
  buffer_load_dwordx4 v[160:163], v11, s[16:19], s47 offen offset:16
  buffer_load_dwordx4 v[164:167], v11, s[16:19], s46 offen offset:0
  buffer_load_dwordx4 v[168:171], v11, s[16:19], s46 offen offset:16
  buffer_load_dwordx4 v[56:59], v9, s[16:19], s30 offen
  s_add_u32 s30, s30, 4096
  buffer_load_dwordx4 v[60:63], v9, s[16:19], s31 offen
  s_add_u32 s31, s31, 4096
  buffer_load_dwordx4 v[64:67], v9, s[16:19], s32 offen
  s_add_u32 s32, s32, 4096
  buffer_load_dwordx4 v[68:71], v9, s[16:19], s33 offen
  s_add_u32 s33, s33, 4096
  buffer_load_dwordx4 v[72:75], v9, s[16:19], s34 offen
  s_add_u32 s34, s34, 4096
  buffer_load_dwordx4 v[172:175], v11, s[16:19], s47 offen offset:512
  buffer_load_dwordx4 v[176:179], v11, s[16:19], s47 offen offset:528
  buffer_load_dwordx4 v[180:183], v11, s[16:19], s46 offen offset:512
  buffer_load_dwordx4 v[184:187], v11, s[16:19], s46 offen offset:528
  buffer_load_dwordx4 v[76:79], v9, s[16:19], s30 offen
  s_add_u32 s30, s30, 4096
  buffer_load_dwordx4 v[80:83], v9, s[16:19], s31 offen
  s_add_u32 s31, s31, 4096
  buffer_load_dwordx4 v[84:87], v9, s[16:19], s32 offen
  s_add_u32 s32, s32, 4096
  buffer_load_dwordx4 v[88:91], v9, s[16:19], s33 offen
  s_add_u32 s33, s33, 4096
  buffer_load_dwordx4 v[92:95], v9, s[16:19], s34 offen
  s_add_u32 s34, s34, 4096
  buffer_load_dwordx4 v[188:191], v11, s[16:19], s47 offen offset:1024
  buffer_load_dwordx4 v[192:195], v11, s[16:19], s47 offen offset:1040
  buffer_load_dwordx4 v[196:199], v11, s[16:19], s46 offen offset:1024
  buffer_load_dwordx4 v[200:203], v11, s[16:19], s46 offen offset:1040
  buffer_load_dwordx4 v[96:99], v9, s[16:19], s30 offen
  s_add_u32 s30, s30, 4096
  buffer_load_dwordx4 v[100:103], v9, s[16:19], s31 offen
  s_add_u32 s31, s31, 4096
  buffer_load_dwordx4 v[104:107], v9, s[16:19], s32 offen
  s_add_u32 s32, s32, 4096
  buffer_load_dwordx4 v[108:111], v9, s[16:19], s33 offen
  s_add_u32 s33, s33, 4096
  buffer_load_dwordx4 v[112:115], v9, s[16:19], s34 offen
  s_add_u32 s34, s34, 4096
  buffer_load_dwordx4 v[204:207], v11, s[16:19], s47 offen offset:1536
  buffer_load_dwordx4 v[208:211], v11, s[16:19], s47 offen offset:1552
  buffer_load_dwordx4 v[212:215], v11, s[16:19], s46 offen offset:1536
  buffer_load_dwordx4 v[216:219], v11, s[16:19], s46 offen offset:1552
  buffer_load_dwordx4 v[116:119], v9, s[16:19], s30 offen
  s_add_u32 s30, s30, 4096
  buffer_load_dwordx4 v[120:123], v9, s[16:19], s31 offen
  s_add_u32 s31, s31, 4096
  buffer_load_dwordx4 v[124:127], v9, s[16:19], s32 offen
  s_add_u32 s32, s32, 4096
  buffer_load_dwordx4 v[128:131], v9, s[16:19], s33 offen
  s_add_u32 s33, s33, 4096
  buffer_load_dwordx4 v[132:135], v9, s[16:19], s34 offen
  s_add_u32 s34, s34, 4096
  buffer_load_dwordx4 v[136:139], v9, s[16:19], s30 offen
  s_add_u32 s30, s30, 4096
  buffer_load_dwordx4 v[140:143], v9, s[16:19], s31 offen
  s_add_u32 s31, s31, 4096
  buffer_load_dwordx4 v[144:147], v9, s[16:19], s32 offen
  s_add_u32 s32, s32, 4096
  buffer_load_dwordx4 v[148:151], v9, s[16:19], s33 offen
  s_add_u32 s33, s33, 4096
  buffer_load_dwordx4 v[152:155], v9, s[16:19], s34 offen
  s_add_u32 s34, s34, 4096
  buffer_load_dwordx4 a[0:3], v9, s[16:19], s40 offen offset:0
  buffer_load_dwordx4 a[72:75], v9, s[16:19], s41 offen offset:0
  buffer_load_dwordx4 a[144:147], v9, s[16:19], s42 offen offset:0
  buffer_load_dwordx4 a[216:219], v9, s[16:19], s43 offen offset:0
  buffer_load_dwordx4 a[4:7], v9, s[16:19], s40 offen offset:1024
  buffer_load_dwordx4 a[76:79], v9, s[16:19], s41 offen offset:1024
  buffer_load_dwordx4 a[148:151], v9, s[16:19], s42 offen offset:1024
  buffer_load_dwordx4 a[220:223], v9, s[16:19], s43 offen offset:1024
  buffer_load_dwordx4 a[8:11], v9, s[16:19], s40 offen offset:2048
  buffer_load_dwordx4 a[80:83], v9, s[16:19], s41 offen offset:2048
  buffer_load_dwordx4 a[152:155], v9, s[16:19], s42 offen offset:2048
  buffer_load_dwordx4 a[224:227], v9, s[16:19], s43 offen offset:2048
  buffer_load_dwordx4 a[12:15], v9, s[16:19], s40 offen offset:3072
  s_add_u32 s40, s40, 4096
  buffer_load_dwordx4 a[84:87], v9, s[16:19], s41 offen offset:3072
  s_add_u32 s41, s41, 4096
  buffer_load_dwordx4 a[156:159], v9, s[16:19], s42 offen offset:3072
  s_add_u32 s42, s42, 4096
  buffer_load_dwordx4 a[228:231], v9, s[16:19], s43 offen offset:3072
  s_add_u32 s43, s43, 4096
  buffer_load_dwordx4 a[16:19], v9, s[16:19], s40 offen offset:0
  buffer_load_dwordx4 a[88:91], v9, s[16:19], s41 offen offset:0
  buffer_load_dwordx4 a[160:163], v9, s[16:19], s42 offen offset:0
  buffer_load_dwordx4 a[232:235], v9, s[16:19], s43 offen offset:0
  s_waitcnt vmcnt(52)
  v_lshlrev_b32 v16, 16, v56
  v_and_b32 v17, 0xffff0000, v56
  v_lshlrev_b32 v18, 16, v57
  v_and_b32 v19, 0xffff0000, v57
  v_lshlrev_b32 v20, 16, v58
  v_and_b32 v21, 0xffff0000, v58
  v_lshlrev_b32 v22, 16, v59
  v_and_b32 v23, 0xffff0000, v59
  v_pk_fma_f32 v[16:17], v[16:17], v[156:157], v[164:165]
  v_pk_fma_f32 v[18:19], v[18:19], v[158:159], v[166:167]
  v_pk_fma_f32 v[20:21], v[20:21], v[160:161], v[168:169]
  v_pk_fma_f32 v[22:23], v[22:23], v[162:163], v[170:171]
  v_cvt_pk_bf16_f32 v24, v16, v17
  v_cvt_pk_bf16_f32 v25, v18, v19
  v_cvt_pk_bf16_f32 v26, v20, v21
  v_cvt_pk_bf16_f32 v27, v22, v23
  ds_write_b128 v10, v[24:27] offset:0
  v_lshlrev_b32 v28, 16, v60
  v_and_b32 v29, 0xffff0000, v60
  v_lshlrev_b32 v30, 16, v61
  v_and_b32 v31, 0xffff0000, v61
  v_lshlrev_b32 v32, 16, v62
  v_and_b32 v33, 0xffff0000, v62
  v_lshlrev_b32 v34, 16, v63
  v_and_b32 v35, 0xffff0000, v63
  v_pk_fma_f32 v[28:29], v[28:29], v[156:157], v[164:165]
  v_pk_fma_f32 v[30:31], v[30:31], v[158:159], v[166:167]
  v_pk_fma_f32 v[32:33], v[32:33], v[160:161], v[168:169]
  v_pk_fma_f32 v[34:35], v[34:35], v[162:163], v[170:171]
  v_cvt_pk_bf16_f32 v36, v28, v29
  v_cvt_pk_bf16_f32 v37, v30, v31
  v_cvt_pk_bf16_f32 v38, v32, v33
  v_cvt_pk_bf16_f32 v39, v34, v35
  ds_write_b128 v10, v[36:39] offset:18432
  v_lshlrev_b32 v16, 16, v64
  v_and_b32 v17, 0xffff0000, v64
  v_lshlrev_b32 v18, 16, v65
  v_and_b32 v19, 0xffff0000, v65
  v_lshlrev_b32 v20, 16, v66
  v_and_b32 v21, 0xffff0000, v66
  v_lshlrev_b32 v22, 16, v67
  v_and_b32 v23, 0xffff0000, v67
  v_pk_fma_f32 v[16:17], v[16:17], v[156:157], v[164:165]
  v_pk_fma_f32 v[18:19], v[18:19], v[158:159], v[166:167]
  v_pk_fma_f32 v[20:21], v[20:21], v[160:161], v[168:169]
  v_pk_fma_f32 v[22:23], v[22:23], v[162:163], v[170:171]
  v_cvt_pk_bf16_f32 v24, v16, v17
  v_cvt_pk_bf16_f32 v25, v18, v19
  v_cvt_pk_bf16_f32 v26, v20, v21
  v_cvt_pk_bf16_f32 v27, v22, v23
  ds_write_b128 v10, v[24:27] offset:36864
  v_lshlrev_b32 v28, 16, v68
  v_and_b32 v29, 0xffff0000, v68
  v_lshlrev_b32 v30, 16, v69
  v_and_b32 v31, 0xffff0000, v69
  v_lshlrev_b32 v32, 16, v70
  v_and_b32 v33, 0xffff0000, v70
  v_lshlrev_b32 v34, 16, v71
  v_and_b32 v35, 0xffff0000, v71
  v_pk_fma_f32 v[28:29], v[28:29], v[156:157], v[164:165]
  v_pk_fma_f32 v[30:31], v[30:31], v[158:159], v[166:167]
  v_pk_fma_f32 v[32:33], v[32:33], v[160:161], v[168:169]
  v_pk_fma_f32 v[34:35], v[34:35], v[162:163], v[170:171]
  v_cvt_pk_bf16_f32 v36, v28, v29
  v_cvt_pk_bf16_f32 v37, v30, v31
  v_cvt_pk_bf16_f32 v38, v32, v33
  v_cvt_pk_bf16_f32 v39, v34, v35
  ds_write_b128 v12, v[36:39] offset:0
  v_lshlrev_b32 v16, 16, v72
  v_and_b32 v17, 0xffff0000, v72
  v_lshlrev_b32 v18, 16, v73
  v_and_b32 v19, 0xffff0000, v73
  v_lshlrev_b32 v20, 16, v74
  v_and_b32 v21, 0xffff0000, v74
  v_lshlrev_b32 v22, 16, v75
  v_and_b32 v23, 0xffff0000, v75
  v_pk_fma_f32 v[16:17], v[16:17], v[156:157], v[164:165]
  v_pk_fma_f32 v[18:19], v[18:19], v[158:159], v[166:167]
  v_pk_fma_f32 v[20:21], v[20:21], v[160:161], v[168:169]
  v_pk_fma_f32 v[22:23], v[22:23], v[162:163], v[170:171]
  v_cvt_pk_bf16_f32 v24, v16, v17
  v_cvt_pk_bf16_f32 v25, v18, v19
  v_cvt_pk_bf16_f32 v26, v20, v21
  v_cvt_pk_bf16_f32 v27, v22, v23
  ds_write_b128 v12, v[24:27] offset:18432
  buffer_load_dwordx4 v[156:159], v11, s[16:19], s47 offen offset:2048
  buffer_load_dwordx4 v[160:163], v11, s[16:19], s47 offen offset:2064
  buffer_load_dwordx4 v[164:167], v11, s[16:19], s46 offen offset:2048
  buffer_load_dwordx4 v[168:171], v11, s[16:19], s46 offen offset:2064
  buffer_load_dwordx4 a[20:23], v9, s[16:19], s40 offen offset:1024
  buffer_load_dwordx4 a[92:95], v9, s[16:19], s41 offen offset:1024
  buffer_load_dwordx4 a[164:167], v9, s[16:19], s42 offen offset:1024
  buffer_load_dwordx4 a[236:239], v9, s[16:19], s43 offen offset:1024
  buffer_load_dwordx4 a[24:27], v9, s[16:19], s40 offen offset:2048
  buffer_load_dwordx4 a[96:99], v9, s[16:19], s41 offen offset:2048
  buffer_load_dwordx4 a[168:171], v9, s[16:19], s42 offen offset:2048
  buffer_load_dwordx4 a[240:243], v9, s[16:19], s43 offen offset:2048
  buffer_load_dwordx4 a[28:31], v9, s[16:19], s40 offen offset:3072
  s_add_u32 s40, s40, 4096
  s_waitcnt vmcnt(56)
  v_lshlrev_b32 v16, 16, v76
  v_and_b32 v17, 0xffff0000, v76
  v_lshlrev_b32 v18, 16, v77
  v_and_b32 v19, 0xffff0000, v77
  v_lshlrev_b32 v20, 16, v78
  v_and_b32 v21, 0xffff0000, v78
  v_lshlrev_b32 v22, 16, v79
  v_and_b32 v23, 0xffff0000, v79
  v_pk_fma_f32 v[16:17], v[16:17], v[172:173], v[180:181]
  v_pk_fma_f32 v[18:19], v[18:19], v[174:175], v[182:183]
  v_pk_fma_f32 v[20:21], v[20:21], v[176:177], v[184:185]
  v_pk_fma_f32 v[22:23], v[22:23], v[178:179], v[186:187]
  v_cvt_pk_bf16_f32 v24, v16, v17
  v_cvt_pk_bf16_f32 v25, v18, v19
  v_cvt_pk_bf16_f32 v26, v20, v21
  v_cvt_pk_bf16_f32 v27, v22, v23
  ds_write_b128 v10, v[24:27] offset:4096
  v_lshlrev_b32 v28, 16, v80
  v_and_b32 v29, 0xffff0000, v80
  v_lshlrev_b32 v30, 16, v81
  v_and_b32 v31, 0xffff0000, v81
  v_lshlrev_b32 v32, 16, v82
  v_and_b32 v33, 0xffff0000, v82
  v_lshlrev_b32 v34, 16, v83
  v_and_b32 v35, 0xffff0000, v83
  v_pk_fma_f32 v[28:29], v[28:29], v[172:173], v[180:181]
  v_pk_fma_f32 v[30:31], v[30:31], v[174:175], v[182:183]
  v_pk_fma_f32 v[32:33], v[32:33], v[176:177], v[184:185]
  v_pk_fma_f32 v[34:35], v[34:35], v[178:179], v[186:187]
  v_cvt_pk_bf16_f32 v36, v28, v29
  v_cvt_pk_bf16_f32 v37, v30, v31
  v_cvt_pk_bf16_f32 v38, v32, v33
  v_cvt_pk_bf16_f32 v39, v34, v35
  ds_write_b128 v10, v[36:39] offset:22528
  v_lshlrev_b32 v16, 16, v84
  v_and_b32 v17, 0xffff0000, v84
  v_lshlrev_b32 v18, 16, v85
  v_and_b32 v19, 0xffff0000, v85
  v_lshlrev_b32 v20, 16, v86
  v_and_b32 v21, 0xffff0000, v86
  v_lshlrev_b32 v22, 16, v87
  v_and_b32 v23, 0xffff0000, v87
  v_pk_fma_f32 v[16:17], v[16:17], v[172:173], v[180:181]
  v_pk_fma_f32 v[18:19], v[18:19], v[174:175], v[182:183]
  v_pk_fma_f32 v[20:21], v[20:21], v[176:177], v[184:185]
  v_pk_fma_f32 v[22:23], v[22:23], v[178:179], v[186:187]
  v_cvt_pk_bf16_f32 v24, v16, v17
  v_cvt_pk_bf16_f32 v25, v18, v19
  v_cvt_pk_bf16_f32 v26, v20, v21
  v_cvt_pk_bf16_f32 v27, v22, v23
  ds_write_b128 v10, v[24:27] offset:40960
  v_lshlrev_b32 v28, 16, v88
  v_and_b32 v29, 0xffff0000, v88
  v_lshlrev_b32 v30, 16, v89
  v_and_b32 v31, 0xffff0000, v89
  v_lshlrev_b32 v32, 16, v90
  v_and_b32 v33, 0xffff0000, v90
  v_lshlrev_b32 v34, 16, v91
  v_and_b32 v35, 0xffff0000, v91
  v_pk_fma_f32 v[28:29], v[28:29], v[172:173], v[180:181]
  v_pk_fma_f32 v[30:31], v[30:31], v[174:175], v[182:183]
  v_pk_fma_f32 v[32:33], v[32:33], v[176:177], v[184:185]
  v_pk_fma_f32 v[34:35], v[34:35], v[178:179], v[186:187]
  v_cvt_pk_bf16_f32 v36, v28, v29
  v_cvt_pk_bf16_f32 v37, v30, v31
  v_cvt_pk_bf16_f32 v38, v32, v33
  v_cvt_pk_bf16_f32 v39, v34, v35
  ds_write_b128 v12, v[36:39] offset:4096
  v_lshlrev_b32 v16, 16, v92
  v_and_b32 v17, 0xffff0000, v92
  v_lshlrev_b32 v18, 16, v93
  v_and_b32 v19, 0xffff0000, v93
  v_lshlrev_b32 v20, 16, v94
  v_and_b32 v21, 0xffff0000, v94
  v_lshlrev_b32 v22, 16, v95
  v_and_b32 v23, 0xffff0000, v95
  v_pk_fma_f32 v[16:17], v[16:17], v[172:173], v[180:181]
  v_pk_fma_f32 v[18:19], v[18:19], v[174:175], v[182:183]
  v_pk_fma_f32 v[20:21], v[20:21], v[176:177], v[184:185]
  v_pk_fma_f32 v[22:23], v[22:23], v[178:179], v[186:187]
  v_cvt_pk_bf16_f32 v24, v16, v17
  v_cvt_pk_bf16_f32 v25, v18, v19
  v_cvt_pk_bf16_f32 v26, v20, v21
  v_cvt_pk_bf16_f32 v27, v22, v23
  ds_write_b128 v12, v[24:27] offset:22528
  buffer_load_dwordx4 a[100:103], v9, s[16:19], s41 offen offset:3072
  s_add_u32 s41, s41, 4096
  buffer_load_dwordx4 a[172:175], v9, s[16:19], s42 offen offset:3072
  s_add_u32 s42, s42, 4096
  buffer_load_dwordx4 a[244:247], v9, s[16:19], s43 offen offset:3072
  s_add_u32 s43, s43, 4096
  buffer_load_dwordx4 a[32:35], v9, s[16:19], s40 offen offset:0
  buffer_load_dwordx4 a[104:107], v9, s[16:19], s41 offen offset:0
  buffer_load_dwordx4 a[176:179], v9, s[16:19], s42 offen offset:0
  buffer_load_dwordx4 a[248:251], v9, s[16:19], s43 offen offset:0
  buffer_load_dwordx4 a[36:39], v9, s[16:19], s40 offen offset:1024
  buffer_load_dwordx4 a[108:111], v9, s[16:19], s41 offen offset:1024
  s_waitcnt vmcnt(56)
  v_lshlrev_b32 v16, 16, v96
  v_and_b32 v17, 0xffff0000, v96
  v_lshlrev_b32 v18, 16, v97
  v_and_b32 v19, 0xffff0000, v97
  v_lshlrev_b32 v20, 16, v98
  v_and_b32 v21, 0xffff0000, v98
  v_lshlrev_b32 v22, 16, v99
  v_and_b32 v23, 0xffff0000, v99
  v_pk_fma_f32 v[16:17], v[16:17], v[188:189], v[196:197]
  v_pk_fma_f32 v[18:19], v[18:19], v[190:191], v[198:199]
  v_pk_fma_f32 v[20:21], v[20:21], v[192:193], v[200:201]
  v_pk_fma_f32 v[22:23], v[22:23], v[194:195], v[202:203]
  v_cvt_pk_bf16_f32 v24, v16, v17
  v_cvt_pk_bf16_f32 v25, v18, v19
  v_cvt_pk_bf16_f32 v26, v20, v21
  v_cvt_pk_bf16_f32 v27, v22, v23
  ds_write_b128 v10, v[24:27] offset:8192
  v_lshlrev_b32 v28, 16, v100
  v_and_b32 v29, 0xffff0000, v100
  v_lshlrev_b32 v30, 16, v101
  v_and_b32 v31, 0xffff0000, v101
  v_lshlrev_b32 v32, 16, v102
  v_and_b32 v33, 0xffff0000, v102
  v_lshlrev_b32 v34, 16, v103
  v_and_b32 v35, 0xffff0000, v103
  v_pk_fma_f32 v[28:29], v[28:29], v[188:189], v[196:197]
  v_pk_fma_f32 v[30:31], v[30:31], v[190:191], v[198:199]
  v_pk_fma_f32 v[32:33], v[32:33], v[192:193], v[200:201]
  v_pk_fma_f32 v[34:35], v[34:35], v[194:195], v[202:203]
  v_cvt_pk_bf16_f32 v36, v28, v29
  v_cvt_pk_bf16_f32 v37, v30, v31
  v_cvt_pk_bf16_f32 v38, v32, v33
  v_cvt_pk_bf16_f32 v39, v34, v35
  ds_write_b128 v10, v[36:39] offset:26624
  v_lshlrev_b32 v16, 16, v104
  v_and_b32 v17, 0xffff0000, v104
  v_lshlrev_b32 v18, 16, v105
  v_and_b32 v19, 0xffff0000, v105
  v_lshlrev_b32 v20, 16, v106
  v_and_b32 v21, 0xffff0000, v106
  v_lshlrev_b32 v22, 16, v107
  v_and_b32 v23, 0xffff0000, v107
  v_pk_fma_f32 v[16:17], v[16:17], v[188:189], v[196:197]
  v_pk_fma_f32 v[18:19], v[18:19], v[190:191], v[198:199]
  v_pk_fma_f32 v[20:21], v[20:21], v[192:193], v[200:201]
  v_pk_fma_f32 v[22:23], v[22:23], v[194:195], v[202:203]
  v_cvt_pk_bf16_f32 v24, v16, v17
  v_cvt_pk_bf16_f32 v25, v18, v19
  v_cvt_pk_bf16_f32 v26, v20, v21
  v_cvt_pk_bf16_f32 v27, v22, v23
  ds_write_b128 v10, v[24:27] offset:45056
  v_lshlrev_b32 v28, 16, v108
  v_and_b32 v29, 0xffff0000, v108
  v_lshlrev_b32 v30, 16, v109
  v_and_b32 v31, 0xffff0000, v109
  v_lshlrev_b32 v32, 16, v110
  v_and_b32 v33, 0xffff0000, v110
  v_lshlrev_b32 v34, 16, v111
  v_and_b32 v35, 0xffff0000, v111
  v_pk_fma_f32 v[28:29], v[28:29], v[188:189], v[196:197]
  v_pk_fma_f32 v[30:31], v[30:31], v[190:191], v[198:199]
  v_pk_fma_f32 v[32:33], v[32:33], v[192:193], v[200:201]
  v_pk_fma_f32 v[34:35], v[34:35], v[194:195], v[202:203]
  v_cvt_pk_bf16_f32 v36, v28, v29
  v_cvt_pk_bf16_f32 v37, v30, v31
  v_cvt_pk_bf16_f32 v38, v32, v33
  v_cvt_pk_bf16_f32 v39, v34, v35
  ds_write_b128 v12, v[36:39] offset:8192
  v_lshlrev_b32 v16, 16, v112
  v_and_b32 v17, 0xffff0000, v112
  v_lshlrev_b32 v18, 16, v113
  v_and_b32 v19, 0xffff0000, v113
  v_lshlrev_b32 v20, 16, v114
  v_and_b32 v21, 0xffff0000, v114
  v_lshlrev_b32 v22, 16, v115
  v_and_b32 v23, 0xffff0000, v115
  v_pk_fma_f32 v[16:17], v[16:17], v[188:189], v[196:197]
  v_pk_fma_f32 v[18:19], v[18:19], v[190:191], v[198:199]
  v_pk_fma_f32 v[20:21], v[20:21], v[192:193], v[200:201]
  v_pk_fma_f32 v[22:23], v[22:23], v[194:195], v[202:203]
  v_cvt_pk_bf16_f32 v24, v16, v17
  v_cvt_pk_bf16_f32 v25, v18, v19
  v_cvt_pk_bf16_f32 v26, v20, v21
  v_cvt_pk_bf16_f32 v27, v22, v23
  ds_write_b128 v12, v[24:27] offset:26624
  buffer_load_dwordx4 a[180:183], v9, s[16:19], s42 offen offset:1024
  buffer_load_dwordx4 a[252:255], v9, s[16:19], s43 offen offset:1024
  buffer_load_dwordx4 a[40:43], v9, s[16:19], s40 offen offset:2048
  buffer_load_dwordx4 a[112:115], v9, s[16:19], s41 offen offset:2048
  buffer_load_dwordx4 a[184:187], v9, s[16:19], s42 offen offset:2048
  buffer_load_dwordx4 v[224:227], v9, s[16:19], s43 offen offset:2048
  buffer_load_dwordx4 a[44:47], v9, s[16:19], s40 offen offset:3072
  s_add_u32 s40, s40, 4096
  buffer_load_dwordx4 a[116:119], v9, s[16:19], s41 offen offset:3072
  s_add_u32 s41, s41, 4096
  buffer_load_dwordx4 a[188:191], v9, s[16:19], s42 offen offset:3072
  s_add_u32 s42, s42, 4096
  s_waitcnt vmcnt(56)
  v_lshlrev_b32 v16, 16, v116
  v_and_b32 v17, 0xffff0000, v116
  v_lshlrev_b32 v18, 16, v117
  v_and_b32 v19, 0xffff0000, v117
  v_lshlrev_b32 v20, 16, v118
  v_and_b32 v21, 0xffff0000, v118
  v_lshlrev_b32 v22, 16, v119
  v_and_b32 v23, 0xffff0000, v119
  v_pk_fma_f32 v[16:17], v[16:17], v[204:205], v[212:213]
  v_pk_fma_f32 v[18:19], v[18:19], v[206:207], v[214:215]
  v_pk_fma_f32 v[20:21], v[20:21], v[208:209], v[216:217]
  v_pk_fma_f32 v[22:23], v[22:23], v[210:211], v[218:219]
  v_cvt_pk_bf16_f32 v24, v16, v17
  v_cvt_pk_bf16_f32 v25, v18, v19
  v_cvt_pk_bf16_f32 v26, v20, v21
  v_cvt_pk_bf16_f32 v27, v22, v23
  ds_write_b128 v10, v[24:27] offset:12288
  v_lshlrev_b32 v28, 16, v120
  v_and_b32 v29, 0xffff0000, v120
  v_lshlrev_b32 v30, 16, v121
  v_and_b32 v31, 0xffff0000, v121
  v_lshlrev_b32 v32, 16, v122
  v_and_b32 v33, 0xffff0000, v122
  v_lshlrev_b32 v34, 16, v123
  v_and_b32 v35, 0xffff0000, v123
  v_pk_fma_f32 v[28:29], v[28:29], v[204:205], v[212:213]
  v_pk_fma_f32 v[30:31], v[30:31], v[206:207], v[214:215]
  v_pk_fma_f32 v[32:33], v[32:33], v[208:209], v[216:217]
  v_pk_fma_f32 v[34:35], v[34:35], v[210:211], v[218:219]
  v_cvt_pk_bf16_f32 v36, v28, v29
  v_cvt_pk_bf16_f32 v37, v30, v31
  v_cvt_pk_bf16_f32 v38, v32, v33
  v_cvt_pk_bf16_f32 v39, v34, v35
  ds_write_b128 v10, v[36:39] offset:30720
  v_lshlrev_b32 v16, 16, v124
  v_and_b32 v17, 0xffff0000, v124
  v_lshlrev_b32 v18, 16, v125
  v_and_b32 v19, 0xffff0000, v125
  v_lshlrev_b32 v20, 16, v126
  v_and_b32 v21, 0xffff0000, v126
  v_lshlrev_b32 v22, 16, v127
  v_and_b32 v23, 0xffff0000, v127
  v_pk_fma_f32 v[16:17], v[16:17], v[204:205], v[212:213]
  v_pk_fma_f32 v[18:19], v[18:19], v[206:207], v[214:215]
  v_pk_fma_f32 v[20:21], v[20:21], v[208:209], v[216:217]
  v_pk_fma_f32 v[22:23], v[22:23], v[210:211], v[218:219]
  v_cvt_pk_bf16_f32 v24, v16, v17
  v_cvt_pk_bf16_f32 v25, v18, v19
  v_cvt_pk_bf16_f32 v26, v20, v21
  v_cvt_pk_bf16_f32 v27, v22, v23
  ds_write_b128 v10, v[24:27] offset:49152
  v_lshlrev_b32 v28, 16, v128
  v_and_b32 v29, 0xffff0000, v128
  v_lshlrev_b32 v30, 16, v129
  v_and_b32 v31, 0xffff0000, v129
  v_lshlrev_b32 v32, 16, v130
  v_and_b32 v33, 0xffff0000, v130
  v_lshlrev_b32 v34, 16, v131
  v_and_b32 v35, 0xffff0000, v131
  v_pk_fma_f32 v[28:29], v[28:29], v[204:205], v[212:213]
  v_pk_fma_f32 v[30:31], v[30:31], v[206:207], v[214:215]
  v_pk_fma_f32 v[32:33], v[32:33], v[208:209], v[216:217]
  v_pk_fma_f32 v[34:35], v[34:35], v[210:211], v[218:219]
  v_cvt_pk_bf16_f32 v36, v28, v29
  v_cvt_pk_bf16_f32 v37, v30, v31
  v_cvt_pk_bf16_f32 v38, v32, v33
  v_cvt_pk_bf16_f32 v39, v34, v35
  ds_write_b128 v12, v[36:39] offset:12288
  v_lshlrev_b32 v16, 16, v132
  v_and_b32 v17, 0xffff0000, v132
  v_lshlrev_b32 v18, 16, v133
  v_and_b32 v19, 0xffff0000, v133
  v_lshlrev_b32 v20, 16, v134
  v_and_b32 v21, 0xffff0000, v134
  v_lshlrev_b32 v22, 16, v135
  v_and_b32 v23, 0xffff0000, v135
  v_pk_fma_f32 v[16:17], v[16:17], v[204:205], v[212:213]
  v_pk_fma_f32 v[18:19], v[18:19], v[206:207], v[214:215]
  v_pk_fma_f32 v[20:21], v[20:21], v[208:209], v[216:217]
  v_pk_fma_f32 v[22:23], v[22:23], v[210:211], v[218:219]
  v_cvt_pk_bf16_f32 v24, v16, v17
  v_cvt_pk_bf16_f32 v25, v18, v19
  v_cvt_pk_bf16_f32 v26, v20, v21
  v_cvt_pk_bf16_f32 v27, v22, v23
  ds_write_b128 v12, v[24:27] offset:30720
  buffer_load_dwordx4 v[228:231], v9, s[16:19], s43 offen offset:3072
  s_add_u32 s43, s43, 4096
  buffer_load_dwordx4 a[48:51], v9, s[16:19], s40 offen offset:0
  buffer_load_dwordx4 a[120:123], v9, s[16:19], s41 offen offset:0
  buffer_load_dwordx4 a[192:195], v9, s[16:19], s42 offen offset:0
  buffer_load_dwordx4 v[232:235], v9, s[16:19], s43 offen offset:0
  buffer_load_dwordx4 a[52:55], v9, s[16:19], s40 offen offset:1024
  buffer_load_dwordx4 a[124:127], v9, s[16:19], s41 offen offset:1024
  buffer_load_dwordx4 a[196:199], v9, s[16:19], s42 offen offset:1024
  buffer_load_dwordx4 v[236:239], v9, s[16:19], s43 offen offset:1024
  s_waitcnt vmcnt(60)
  s_waitcnt vmcnt(36)
  v_lshlrev_b32 v16, 16, v136
  v_and_b32 v17, 0xffff0000, v136
  v_lshlrev_b32 v18, 16, v137
  v_and_b32 v19, 0xffff0000, v137
  v_lshlrev_b32 v20, 16, v138
  v_and_b32 v21, 0xffff0000, v138
  v_lshlrev_b32 v22, 16, v139
  v_and_b32 v23, 0xffff0000, v139
  v_pk_fma_f32 v[16:17], v[16:17], v[156:157], v[164:165]
  v_pk_fma_f32 v[18:19], v[18:19], v[158:159], v[166:167]
  v_pk_fma_f32 v[20:21], v[20:21], v[160:161], v[168:169]
  v_pk_fma_f32 v[22:23], v[22:23], v[162:163], v[170:171]
  v_cvt_pk_bf16_f32 v24, v16, v17
  v_cvt_pk_bf16_f32 v25, v18, v19
  v_cvt_pk_bf16_f32 v26, v20, v21
  v_cvt_pk_bf16_f32 v27, v22, v23
  ds_write_b128 v10, v[24:27] offset:16384
  v_lshlrev_b32 v28, 16, v140
  v_and_b32 v29, 0xffff0000, v140
  v_lshlrev_b32 v30, 16, v141
  v_and_b32 v31, 0xffff0000, v141
  v_lshlrev_b32 v32, 16, v142
  v_and_b32 v33, 0xffff0000, v142
  v_lshlrev_b32 v34, 16, v143
  v_and_b32 v35, 0xffff0000, v143
  v_pk_fma_f32 v[28:29], v[28:29], v[156:157], v[164:165]
  v_pk_fma_f32 v[30:31], v[30:31], v[158:159], v[166:167]
  v_pk_fma_f32 v[32:33], v[32:33], v[160:161], v[168:169]
  v_pk_fma_f32 v[34:35], v[34:35], v[162:163], v[170:171]
  v_cvt_pk_bf16_f32 v36, v28, v29
  v_cvt_pk_bf16_f32 v37, v30, v31
  v_cvt_pk_bf16_f32 v38, v32, v33
  v_cvt_pk_bf16_f32 v39, v34, v35
  ds_write_b128 v10, v[36:39] offset:34816
  v_lshlrev_b32 v16, 16, v144
  v_and_b32 v17, 0xffff0000, v144
  v_lshlrev_b32 v18, 16, v145
  v_and_b32 v19, 0xffff0000, v145
  v_lshlrev_b32 v20, 16, v146
  v_and_b32 v21, 0xffff0000, v146
  v_lshlrev_b32 v22, 16, v147
  v_and_b32 v23, 0xffff0000, v147
  v_pk_fma_f32 v[16:17], v[16:17], v[156:157], v[164:165]
  v_pk_fma_f32 v[18:19], v[18:19], v[158:159], v[166:167]
  v_pk_fma_f32 v[20:21], v[20:21], v[160:161], v[168:169]
  v_pk_fma_f32 v[22:23], v[22:23], v[162:163], v[170:171]
  v_cvt_pk_bf16_f32 v24, v16, v17
  v_cvt_pk_bf16_f32 v25, v18, v19
  v_cvt_pk_bf16_f32 v26, v20, v21
  v_cvt_pk_bf16_f32 v27, v22, v23
  ds_write_b128 v10, v[24:27] offset:53248
  v_lshlrev_b32 v28, 16, v148
  v_and_b32 v29, 0xffff0000, v148
  v_lshlrev_b32 v30, 16, v149
  v_and_b32 v31, 0xffff0000, v149
  v_lshlrev_b32 v32, 16, v150
  v_and_b32 v33, 0xffff0000, v150
  v_lshlrev_b32 v34, 16, v151
  v_and_b32 v35, 0xffff0000, v151
  v_pk_fma_f32 v[28:29], v[28:29], v[156:157], v[164:165]
  v_pk_fma_f32 v[30:31], v[30:31], v[158:159], v[166:167]
  v_pk_fma_f32 v[32:33], v[32:33], v[160:161], v[168:169]
  v_pk_fma_f32 v[34:35], v[34:35], v[162:163], v[170:171]
  v_cvt_pk_bf16_f32 v36, v28, v29
  v_cvt_pk_bf16_f32 v37, v30, v31
  v_cvt_pk_bf16_f32 v38, v32, v33
  v_cvt_pk_bf16_f32 v39, v34, v35
  ds_write_b128 v12, v[36:39] offset:16384
  v_lshlrev_b32 v16, 16, v152
  v_and_b32 v17, 0xffff0000, v152
  v_lshlrev_b32 v18, 16, v153
  v_and_b32 v19, 0xffff0000, v153
  v_lshlrev_b32 v20, 16, v154
  v_and_b32 v21, 0xffff0000, v154
  v_lshlrev_b32 v22, 16, v155
  v_and_b32 v23, 0xffff0000, v155
  v_pk_fma_f32 v[16:17], v[16:17], v[156:157], v[164:165]
  v_pk_fma_f32 v[18:19], v[18:19], v[158:159], v[166:167]
  v_pk_fma_f32 v[20:21], v[20:21], v[160:161], v[168:169]
  v_pk_fma_f32 v[22:23], v[22:23], v[162:163], v[170:171]
  v_cvt_pk_bf16_f32 v24, v16, v17
  v_cvt_pk_bf16_f32 v25, v18, v19
  v_cvt_pk_bf16_f32 v26, v20, v21
  v_cvt_pk_bf16_f32 v27, v22, v23
  ds_write_b128 v12, v[24:27] offset:34816
  buffer_load_dwordx4 a[56:59], v9, s[16:19], s40 offen offset:2048
  buffer_load_dwordx4 a[128:131], v9, s[16:19], s41 offen offset:2048
  buffer_load_dwordx4 a[200:203], v9, s[16:19], s42 offen offset:2048
  buffer_load_dwordx4 v[240:243], v9, s[16:19], s43 offen offset:2048
  buffer_load_dwordx4 a[60:63], v9, s[16:19], s40 offen offset:3072
  s_add_u32 s40, s40, 4096
  buffer_load_dwordx4 a[132:135], v9, s[16:19], s41 offen offset:3072
  s_add_u32 s41, s41, 4096
  buffer_load_dwordx4 a[204:207], v9, s[16:19], s42 offen offset:3072
  s_add_u32 s42, s42, 4096
  buffer_load_dwordx4 v[244:247], v9, s[16:19], s43 offen offset:3072
  s_add_u32 s43, s43, 4096
  buffer_load_dwordx4 a[64:67], v9, s[16:19], s40 offen offset:0
  s_waitcnt lgkmcnt(0)
  s_barrier
  ds_read_b128 v[16:19], v13 offset:0
  ds_read_b128 v[20:23], v13 offset:18432
  ds_read_b128 v[24:27], v13 offset:36864
  ds_read_b128 v[28:31], v14 offset:0
  ds_read_b128 v[32:35], v14 offset:18432
  buffer_load_dwordx4 a[136:139], v9, s[16:19], s41 offen offset:0
  buffer_load_dwordx4 a[208:211], v9, s[16:19], s42 offen offset:0
  buffer_load_dwordx4 v[248:251], v9, s[16:19], s43 offen offset:0
  buffer_load_dwordx4 a[68:71], v9, s[16:19], s40 offen offset:1024
  s_waitcnt lgkmcnt(0)
  v_mfma_f32_16x16x32_bf16 v[128:131], a[0:3], v[16:19], 0
  v_mfma_f32_16x16x32_bf16 v[132:135], a[0:3], v[20:23], 0
  v_mfma_f32_16x16x32_bf16 v[136:139], a[0:3], v[24:27], 0
  v_mfma_f32_16x16x32_bf16 v[140:143], a[0:3], v[28:31], 0
  v_mfma_f32_16x16x32_bf16 v[144:147], a[0:3], v[32:35], 0
  ds_read_b128 v[36:39], v13 offset:1024
  ds_read_b128 v[40:43], v13 offset:19456
  ds_read_b128 v[44:47], v13 offset:37888
  ds_read_b128 v[48:51], v14 offset:1024
  ds_read_b128 v[52:55], v14 offset:19456
  v_mfma_f32_16x16x32_bf16 v[148:151], a[72:75], v[16:19], 0
  v_mfma_f32_16x16x32_bf16 v[152:155], a[72:75], v[20:23], 0
  v_mfma_f32_16x16x32_bf16 v[156:159], a[72:75], v[24:27], 0
  v_mfma_f32_16x16x32_bf16 v[160:163], a[72:75], v[28:31], 0
  v_mfma_f32_16x16x32_bf16 v[164:167], a[72:75], v[32:35], 0
  v_mfma_f32_16x16x32_bf16 v[172:175], a[144:147], v[20:23], 0
  v_mfma_f32_16x16x32_bf16 v[176:179], a[144:147], v[24:27], 0
  v_mfma_f32_16x16x32_bf16 v[180:183], a[144:147], v[28:31], 0
  v_mfma_f32_16x16x32_bf16 v[184:187], a[144:147], v[32:35], 0
  v_mfma_f32_16x16x32_bf16 v[192:195], a[216:219], v[20:23], 0
  v_mfma_f32_16x16x32_bf16 v[196:199], a[216:219], v[24:27], 0
  v_mfma_f32_16x16x32_bf16 v[200:203], a[216:219], v[28:31], 0
  v_mfma_f32_16x16x32_bf16 v[204:207], a[216:219], v[32:35], 0
  buffer_load_dwordx4 a[140:143], v9, s[16:19], s41 offen offset:1024
  buffer_load_dwordx4 a[212:215], v9, s[16:19], s42 offen offset:1024
  buffer_load_dwordx4 v[252:255], v9, s[16:19], s43 offen offset:1024
  s_waitcnt lgkmcnt(0)
  v_mfma_f32_16x16x32_bf16 v[128:131], a[4:7], v[36:39], v[128:131]
  v_mfma_f32_16x16x32_bf16 v[132:135], a[4:7], v[40:43], v[132:135]
  v_mfma_f32_16x16x32_bf16 v[136:139], a[4:7], v[44:47], v[136:139]
  v_mfma_f32_16x16x32_bf16 v[140:143], a[4:7], v[48:51], v[140:143]
  v_mfma_f32_16x16x32_bf16 v[144:147], a[4:7], v[52:55], v[144:147]
  ds_read_b128 v[16:19], v13 offset:2048
  ds_read_b128 v[20:23], v13 offset:20480
  ds_read_b128 v[24:27], v13 offset:38912
  ds_read_b128 v[28:31], v14 offset:2048
  ds_read_b128 v[32:35], v14 offset:20480
  v_mfma_f32_16x16x32_bf16 v[148:151], a[76:79], v[36:39], v[148:151]
  v_mfma_f32_16x16x32_bf16 v[152:155], a[76:79], v[40:43], v[152:155]
  v_mfma_f32_16x16x32_bf16 v[156:159], a[76:79], v[44:47], v[156:159]
  v_mfma_f32_16x16x32_bf16 v[160:163], a[76:79], v[48:51], v[160:163]
  v_mfma_f32_16x16x32_bf16 v[164:167], a[76:79], v[52:55], v[164:167]
  v_mfma_f32_16x16x32_bf16 v[172:175], a[148:151], v[40:43], v[172:175]
  v_mfma_f32_16x16x32_bf16 v[176:179], a[148:151], v[44:47], v[176:179]
  v_mfma_f32_16x16x32_bf16 v[180:183], a[148:151], v[48:51], v[180:183]
  v_mfma_f32_16x16x32_bf16 v[184:187], a[148:151], v[52:55], v[184:187]
  v_mfma_f32_16x16x32_bf16 v[192:195], a[220:223], v[40:43], v[192:195]
  v_mfma_f32_16x16x32_bf16 v[196:199], a[220:223], v[44:47], v[196:199]
  v_mfma_f32_16x16x32_bf16 v[200:203], a[220:223], v[48:51], v[200:203]
  v_mfma_f32_16x16x32_bf16 v[204:207], a[220:223], v[52:55], v[204:207]
  s_waitcnt lgkmcnt(0)
  v_mfma_f32_16x16x32_bf16 v[128:131], a[8:11], v[16:19], v[128:131]
  v_mfma_f32_16x16x32_bf16 v[132:135], a[8:11], v[20:23], v[132:135]
  v_mfma_f32_16x16x32_bf16 v[136:139], a[8:11], v[24:27], v[136:139]
  v_mfma_f32_16x16x32_bf16 v[140:143], a[8:11], v[28:31], v[140:143]
  v_mfma_f32_16x16x32_bf16 v[144:147], a[8:11], v[32:35], v[144:147]
  ds_read_b128 v[36:39], v13 offset:3072
  ds_read_b128 v[40:43], v13 offset:21504
  ds_read_b128 v[44:47], v13 offset:39936
  ds_read_b128 v[48:51], v14 offset:3072
  ds_read_b128 v[52:55], v14 offset:21504
  v_mfma_f32_16x16x32_bf16 v[148:151], a[80:83], v[16:19], v[148:151]
  v_mfma_f32_16x16x32_bf16 v[152:155], a[80:83], v[20:23], v[152:155]
  v_mfma_f32_16x16x32_bf16 v[156:159], a[80:83], v[24:27], v[156:159]
  v_mfma_f32_16x16x32_bf16 v[160:163], a[80:83], v[28:31], v[160:163]
  v_mfma_f32_16x16x32_bf16 v[164:167], a[80:83], v[32:35], v[164:167]
  v_mfma_f32_16x16x32_bf16 v[172:175], a[152:155], v[20:23], v[172:175]
  v_mfma_f32_16x16x32_bf16 v[176:179], a[152:155], v[24:27], v[176:179]
  v_mfma_f32_16x16x32_bf16 v[180:183], a[152:155], v[28:31], v[180:183]
  v_mfma_f32_16x16x32_bf16 v[184:187], a[152:155], v[32:35], v[184:187]
  v_mfma_f32_16x16x32_bf16 v[192:195], a[224:227], v[20:23], v[192:195]
  v_mfma_f32_16x16x32_bf16 v[196:199], a[224:227], v[24:27], v[196:199]
  v_mfma_f32_16x16x32_bf16 v[200:203], a[224:227], v[28:31], v[200:203]
  v_mfma_f32_16x16x32_bf16 v[204:207], a[224:227], v[32:35], v[204:207]
  buffer_load_dword v7, v4, s[60:63], 0 offen
  s_waitcnt lgkmcnt(0)
  v_mfma_f32_16x16x32_bf16 v[128:131], a[12:15], v[36:39], v[128:131]
  v_mfma_f32_16x16x32_bf16 v[132:135], a[12:15], v[40:43], v[132:135]
  v_mfma_f32_16x16x32_bf16 v[136:139], a[12:15], v[44:47], v[136:139]
  v_mfma_f32_16x16x32_bf16 v[140:143], a[12:15], v[48:51], v[140:143]
  v_mfma_f32_16x16x32_bf16 v[144:147], a[12:15], v[52:55], v[144:147]
  ds_read_b128 v[16:19], v13 offset:4096
  ds_read_b128 v[20:23], v13 offset:22528
  ds_read_b128 v[24:27], v13 offset:40960
  ds_read_b128 v[28:31], v14 offset:4096
  ds_read_b128 v[32:35], v14 offset:22528
  v_mfma_f32_16x16x32_bf16 v[148:151], a[84:87], v[36:39], v[148:151]
  v_mfma_f32_16x16x32_bf16 v[152:155], a[84:87], v[40:43], v[152:155]
  v_mfma_f32_16x16x32_bf16 v[156:159], a[84:87], v[44:47], v[156:159]
  v_mfma_f32_16x16x32_bf16 v[160:163], a[84:87], v[48:51], v[160:163]
  v_mfma_f32_16x16x32_bf16 v[164:167], a[84:87], v[52:55], v[164:167]
  v_mfma_f32_16x16x32_bf16 v[172:175], a[156:159], v[40:43], v[172:175]
  v_mfma_f32_16x16x32_bf16 v[176:179], a[156:159], v[44:47], v[176:179]
  v_mfma_f32_16x16x32_bf16 v[180:183], a[156:159], v[48:51], v[180:183]
  v_mfma_f32_16x16x32_bf16 v[184:187], a[156:159], v[52:55], v[184:187]
  v_mfma_f32_16x16x32_bf16 v[192:195], a[228:231], v[40:43], v[192:195]
  v_mfma_f32_16x16x32_bf16 v[196:199], a[228:231], v[44:47], v[196:199]
  v_mfma_f32_16x16x32_bf16 v[200:203], a[228:231], v[48:51], v[200:203]
  v_mfma_f32_16x16x32_bf16 v[204:207], a[228:231], v[52:55], v[204:207]
  s_waitcnt lgkmcnt(0)
  v_mfma_f32_16x16x32_bf16 v[128:131], a[16:19], v[16:19], v[128:131]
  v_mfma_f32_16x16x32_bf16 v[132:135], a[16:19], v[20:23], v[132:135]
  v_mfma_f32_16x16x32_bf16 v[136:139], a[16:19], v[24:27], v[136:139]
  v_mfma_f32_16x16x32_bf16 v[140:143], a[16:19], v[28:31], v[140:143]
  v_mfma_f32_16x16x32_bf16 v[144:147], a[16:19], v[32:35], v[144:147]
  ds_read_b128 v[36:39], v13 offset:5120
  ds_read_b128 v[40:43], v13 offset:23552
  ds_read_b128 v[44:47], v13 offset:41984
  ds_read_b128 v[48:51], v14 offset:5120
  ds_read_b128 v[52:55], v14 offset:23552
  v_mfma_f32_16x16x32_bf16 v[148:151], a[88:91], v[16:19], v[148:151]
  v_mfma_f32_16x16x32_bf16 v[152:155], a[88:91], v[20:23], v[152:155]
  v_mfma_f32_16x16x32_bf16 v[156:159], a[88:91], v[24:27], v[156:159]
  v_mfma_f32_16x16x32_bf16 v[160:163], a[88:91], v[28:31], v[160:163]
  v_mfma_f32_16x16x32_bf16 v[164:167], a[88:91], v[32:35], v[164:167]
  v_mfma_f32_16x16x32_bf16 v[172:175], a[160:163], v[20:23], v[172:175]
  v_mfma_f32_16x16x32_bf16 v[176:179], a[160:163], v[24:27], v[176:179]
  v_mfma_f32_16x16x32_bf16 v[180:183], a[160:163], v[28:31], v[180:183]
  v_mfma_f32_16x16x32_bf16 v[184:187], a[160:163], v[32:35], v[184:187]
  v_mfma_f32_16x16x32_bf16 v[192:195], a[232:235], v[20:23], v[192:195]
  v_mfma_f32_16x16x32_bf16 v[196:199], a[232:235], v[24:27], v[196:199]
  v_mfma_f32_16x16x32_bf16 v[200:203], a[232:235], v[28:31], v[200:203]
  v_mfma_f32_16x16x32_bf16 v[204:207], a[232:235], v[32:35], v[204:207]
  s_waitcnt vmcnt(49) lgkmcnt(0)
  v_mfma_f32_16x16x32_bf16 v[128:131], a[20:23], v[36:39], v[128:131]
  v_mfma_f32_16x16x32_bf16 v[132:135], a[20:23], v[40:43], v[132:135]
  v_mfma_f32_16x16x32_bf16 v[136:139], a[20:23], v[44:47], v[136:139]
  v_mfma_f32_16x16x32_bf16 v[140:143], a[20:23], v[48:51], v[140:143]
  v_mfma_f32_16x16x32_bf16 v[144:147], a[20:23], v[52:55], v[144:147]
  ds_read_b128 v[16:19], v13 offset:6144
  ds_read_b128 v[20:23], v13 offset:24576
  ds_read_b128 v[24:27], v13 offset:43008
  ds_read_b128 v[28:31], v14 offset:6144
  ds_read_b128 v[32:35], v14 offset:24576
  v_mfma_f32_16x16x32_bf16 v[148:151], a[92:95], v[36:39], v[148:151]
  v_mfma_f32_16x16x32_bf16 v[152:155], a[92:95], v[40:43], v[152:155]
  v_mfma_f32_16x16x32_bf16 v[156:159], a[92:95], v[44:47], v[156:159]
  v_mfma_f32_16x16x32_bf16 v[160:163], a[92:95], v[48:51], v[160:163]
  v_mfma_f32_16x16x32_bf16 v[164:167], a[92:95], v[52:55], v[164:167]
  v_mfma_f32_16x16x32_bf16 v[172:175], a[164:167], v[40:43], v[172:175]
  v_mfma_f32_16x16x32_bf16 v[176:179], a[164:167], v[44:47], v[176:179]
  v_mfma_f32_16x16x32_bf16 v[180:183], a[164:167], v[48:51], v[180:183]
  v_mfma_f32_16x16x32_bf16 v[184:187], a[164:167], v[52:55], v[184:187]
  v_mfma_f32_16x16x32_bf16 v[192:195], a[236:239], v[40:43], v[192:195]
  v_mfma_f32_16x16x32_bf16 v[196:199], a[236:239], v[44:47], v[196:199]
  v_mfma_f32_16x16x32_bf16 v[200:203], a[236:239], v[48:51], v[200:203]
  v_mfma_f32_16x16x32_bf16 v[204:207], a[236:239], v[52:55], v[204:207]
  s_waitcnt vmcnt(45) lgkmcnt(0)
  v_mfma_f32_16x16x32_bf16 v[128:131], a[24:27], v[16:19], v[128:131]
  v_mfma_f32_16x16x32_bf16 v[132:135], a[24:27], v[20:23], v[132:135]
  v_mfma_f32_16x16x32_bf16 v[136:139], a[24:27], v[24:27], v[136:139]
  v_mfma_f32_16x16x32_bf16 v[140:143], a[24:27], v[28:31], v[140:143]
  v_mfma_f32_16x16x32_bf16 v[144:147], a[24:27], v[32:35], v[144:147]
  ds_read_b128 v[36:39], v13 offset:7168
  ds_read_b128 v[40:43], v13 offset:25600
  ds_read_b128 v[44:47], v13 offset:44032
  ds_read_b128 v[48:51], v14 offset:7168
  ds_read_b128 v[52:55], v14 offset:25600
  v_mfma_f32_16x16x32_bf16 v[148:151], a[96:99], v[16:19], v[148:151]
  v_mfma_f32_16x16x32_bf16 v[152:155], a[96:99], v[20:23], v[152:155]
  v_mfma_f32_16x16x32_bf16 v[156:159], a[96:99], v[24:27], v[156:159]
  v_mfma_f32_16x16x32_bf16 v[160:163], a[96:99], v[28:31], v[160:163]
  v_mfma_f32_16x16x32_bf16 v[164:167], a[96:99], v[32:35], v[164:167]
  v_mfma_f32_16x16x32_bf16 v[172:175], a[168:171], v[20:23], v[172:175]
  v_mfma_f32_16x16x32_bf16 v[176:179], a[168:171], v[24:27], v[176:179]
  v_mfma_f32_16x16x32_bf16 v[180:183], a[168:171], v[28:31], v[180:183]
  v_mfma_f32_16x16x32_bf16 v[184:187], a[168:171], v[32:35], v[184:187]
  v_mfma_f32_16x16x32_bf16 v[192:195], a[240:243], v[20:23], v[192:195]
  v_mfma_f32_16x16x32_bf16 v[196:199], a[240:243], v[24:27], v[196:199]
  v_mfma_f32_16x16x32_bf16 v[200:203], a[240:243], v[28:31], v[200:203]
  v_mfma_f32_16x16x32_bf16 v[204:207], a[240:243], v[32:35], v[204:207]
  s_waitcnt vmcnt(41) lgkmcnt(0)
  v_mfma_f32_16x16x32_bf16 v[128:131], a[28:31], v[36:39], v[128:131]
  v_mfma_f32_16x16x32_bf16 v[132:135], a[28:31], v[40:43], v[132:135]
  v_mfma_f32_16x16x32_bf16 v[136:139], a[28:31], v[44:47], v[136:139]
  v_mfma_f32_16x16x32_bf16 v[140:143], a[28:31], v[48:51], v[140:143]
  v_mfma_f32_16x16x32_bf16 v[144:147], a[28:31], v[52:55], v[144:147]
  ds_read_b128 v[16:19], v13 offset:8192
  ds_read_b128 v[20:23], v13 offset:26624
  ds_read_b128 v[24:27], v13 offset:45056
  ds_read_b128 v[28:31], v14 offset:8192
  ds_read_b128 v[32:35], v14 offset:26624
  v_mfma_f32_16x16x32_bf16 v[148:151], a[100:103], v[36:39], v[148:151]
  v_mfma_f32_16x16x32_bf16 v[152:155], a[100:103], v[40:43], v[152:155]
  v_mfma_f32_16x16x32_bf16 v[156:159], a[100:103], v[44:47], v[156:159]
  v_mfma_f32_16x16x32_bf16 v[160:163], a[100:103], v[48:51], v[160:163]
  v_mfma_f32_16x16x32_bf16 v[164:167], a[100:103], v[52:55], v[164:167]
  v_mfma_f32_16x16x32_bf16 v[172:175], a[172:175], v[40:43], v[172:175]
  v_mfma_f32_16x16x32_bf16 v[176:179], a[172:175], v[44:47], v[176:179]
  v_mfma_f32_16x16x32_bf16 v[180:183], a[172:175], v[48:51], v[180:183]
  v_mfma_f32_16x16x32_bf16 v[184:187], a[172:175], v[52:55], v[184:187]
  v_mfma_f32_16x16x32_bf16 v[192:195], a[244:247], v[40:43], v[192:195]
  v_mfma_f32_16x16x32_bf16 v[196:199], a[244:247], v[44:47], v[196:199]
  v_mfma_f32_16x16x32_bf16 v[200:203], a[244:247], v[48:51], v[200:203]
  v_mfma_f32_16x16x32_bf16 v[204:207], a[244:247], v[52:55], v[204:207]
  s_waitcnt vmcnt(37) lgkmcnt(0)
  v_mfma_f32_16x16x32_bf16 v[128:131], a[32:35], v[16:19], v[128:131]
  v_mfma_f32_16x16x32_bf16 v[132:135], a[32:35], v[20:23], v[132:135]
  v_mfma_f32_16x16x32_bf16 v[136:139], a[32:35], v[24:27], v[136:139]
  v_mfma_f32_16x16x32_bf16 v[140:143], a[32:35], v[28:31], v[140:143]
  v_mfma_f32_16x16x32_bf16 v[144:147], a[32:35], v[32:35], v[144:147]
  ds_read_b128 v[36:39], v13 offset:9216
  ds_read_b128 v[40:43], v13 offset:27648
  ds_read_b128 v[44:47], v13 offset:46080
  ds_read_b128 v[48:51], v14 offset:9216
  ds_read_b128 v[52:55], v14 offset:27648
  v_mfma_f32_16x16x32_bf16 v[148:151], a[104:107], v[16:19], v[148:151]
  v_mfma_f32_16x16x32_bf16 v[152:155], a[104:107], v[20:23], v[152:155]
  v_mfma_f32_16x16x32_bf16 v[156:159], a[104:107], v[24:27], v[156:159]
  v_mfma_f32_16x16x32_bf16 v[160:163], a[104:107], v[28:31], v[160:163]
  v_mfma_f32_16x16x32_bf16 v[164:167], a[104:107], v[32:35], v[164:167]
  v_mfma_f32_16x16x32_bf16 v[172:175], a[176:179], v[20:23], v[172:175]
  v_mfma_f32_16x16x32_bf16 v[176:179], a[176:179], v[24:27], v[176:179]
  v_mfma_f32_16x16x32_bf16 v[180:183], a[176:179], v[28:31], v[180:183]
  v_mfma_f32_16x16x32_bf16 v[184:187], a[176:179], v[32:35], v[184:187]
  v_mfma_f32_16x16x32_bf16 v[192:195], a[248:251], v[20:23], v[192:195]
  v_mfma_f32_16x16x32_bf16 v[196:199], a[248:251], v[24:27], v[196:199]
  v_mfma_f32_16x16x32_bf16 v[200:203], a[248:251], v[28:31], v[200:203]
  v_mfma_f32_16x16x32_bf16 v[204:207], a[248:251], v[32:35], v[204:207]
  s_waitcnt vmcnt(33) lgkmcnt(0)
  v_mfma_f32_16x16x32_bf16 v[128:131], a[36:39], v[36:39], v[128:131]
  v_mfma_f32_16x16x32_bf16 v[132:135], a[36:39], v[40:43], v[132:135]
  v_mfma_f32_16x16x32_bf16 v[136:139], a[36:39], v[44:47], v[136:139]
  v_mfma_f32_16x16x32_bf16 v[140:143], a[36:39], v[48:51], v[140:143]
  v_mfma_f32_16x16x32_bf16 v[144:147], a[36:39], v[52:55], v[144:147]
  ds_read_b128 v[16:19], v13 offset:10240
  ds_read_b128 v[20:23], v13 offset:28672
  ds_read_b128 v[24:27], v13 offset:47104
  ds_read_b128 v[28:31], v14 offset:10240
  ds_read_b128 v[32:35], v14 offset:28672
  v_mfma_f32_16x16x32_bf16 v[148:151], a[108:111], v[36:39], v[148:151]
  v_mfma_f32_16x16x32_bf16 v[152:155], a[108:111], v[40:43], v[152:155]
  v_mfma_f32_16x16x32_bf16 v[156:159], a[108:111], v[44:47], v[156:159]
  v_mfma_f32_16x16x32_bf16 v[160:163], a[108:111], v[48:51], v[160:163]
  v_mfma_f32_16x16x32_bf16 v[164:167], a[108:111], v[52:55], v[164:167]
  v_mfma_f32_16x16x32_bf16 v[172:175], a[180:183], v[40:43], v[172:175]
  v_mfma_f32_16x16x32_bf16 v[176:179], a[180:183], v[44:47], v[176:179]
  v_mfma_f32_16x16x32_bf16 v[180:183], a[180:183], v[48:51], v[180:183]
  v_mfma_f32_16x16x32_bf16 v[184:187], a[180:183], v[52:55], v[184:187]
  v_mfma_f32_16x16x32_bf16 v[192:195], a[252:255], v[40:43], v[192:195]
  v_mfma_f32_16x16x32_bf16 v[196:199], a[252:255], v[44:47], v[196:199]
  v_mfma_f32_16x16x32_bf16 v[200:203], a[252:255], v[48:51], v[200:203]
  v_mfma_f32_16x16x32_bf16 v[204:207], a[252:255], v[52:55], v[204:207]
  s_waitcnt vmcnt(29) lgkmcnt(0)
  v_mfma_f32_16x16x32_bf16 v[128:131], a[40:43], v[16:19], v[128:131]
  v_mfma_f32_16x16x32_bf16 v[132:135], a[40:43], v[20:23], v[132:135]
  v_mfma_f32_16x16x32_bf16 v[136:139], a[40:43], v[24:27], v[136:139]
  v_mfma_f32_16x16x32_bf16 v[140:143], a[40:43], v[28:31], v[140:143]
  v_mfma_f32_16x16x32_bf16 v[144:147], a[40:43], v[32:35], v[144:147]
  ds_read_b128 v[36:39], v13 offset:11264
  ds_read_b128 v[40:43], v13 offset:29696
  ds_read_b128 v[44:47], v13 offset:48128
  ds_read_b128 v[48:51], v14 offset:11264
  ds_read_b128 v[52:55], v14 offset:29696
  v_mfma_f32_16x16x32_bf16 v[148:151], a[112:115], v[16:19], v[148:151]
  v_mfma_f32_16x16x32_bf16 v[152:155], a[112:115], v[20:23], v[152:155]
  v_mfma_f32_16x16x32_bf16 v[156:159], a[112:115], v[24:27], v[156:159]
  v_mfma_f32_16x16x32_bf16 v[160:163], a[112:115], v[28:31], v[160:163]
  v_mfma_f32_16x16x32_bf16 v[164:167], a[112:115], v[32:35], v[164:167]
  v_mfma_f32_16x16x32_bf16 v[172:175], a[184:187], v[20:23], v[172:175]
  v_mfma_f32_16x16x32_bf16 v[176:179], a[184:187], v[24:27], v[176:179]
  v_mfma_f32_16x16x32_bf16 v[180:183], a[184:187], v[28:31], v[180:183]
  v_mfma_f32_16x16x32_bf16 v[184:187], a[184:187], v[32:35], v[184:187]
  v_mfma_f32_16x16x32_bf16 v[192:195], v[224:227], v[20:23], v[192:195]
  v_mfma_f32_16x16x32_bf16 v[196:199], v[224:227], v[24:27], v[196:199]
  v_mfma_f32_16x16x32_bf16 v[200:203], v[224:227], v[28:31], v[200:203]
  v_mfma_f32_16x16x32_bf16 v[204:207], v[224:227], v[32:35], v[204:207]
  s_waitcnt vmcnt(25) lgkmcnt(0)
  v_mfma_f32_16x16x32_bf16 v[128:131], a[44:47], v[36:39], v[128:131]
  v_mfma_f32_16x16x32_bf16 v[132:135], a[44:47], v[40:43], v[132:135]
  v_mfma_f32_16x16x32_bf16 v[136:139], a[44:47], v[44:47], v[136:139]
  v_mfma_f32_16x16x32_bf16 v[140:143], a[44:47], v[48:51], v[140:143]
  v_mfma_f32_16x16x32_bf16 v[144:147], a[44:47], v[52:55], v[144:147]
  ds_read_b128 v[16:19], v13 offset:12288
  ds_read_b128 v[20:23], v13 offset:30720
  ds_read_b128 v[24:27], v13 offset:49152
  ds_read_b128 v[28:31], v14 offset:12288
  ds_read_b128 v[32:35], v14 offset:30720
  v_mfma_f32_16x16x32_bf16 v[148:151], a[116:119], v[36:39], v[148:151]
  v_mfma_f32_16x16x32_bf16 v[152:155], a[116:119], v[40:43], v[152:155]
  v_mfma_f32_16x16x32_bf16 v[156:159], a[116:119], v[44:47], v[156:159]
  v_mfma_f32_16x16x32_bf16 v[160:163], a[116:119], v[48:51], v[160:163]
  v_mfma_f32_16x16x32_bf16 v[164:167], a[116:119], v[52:55], v[164:167]
  v_mfma_f32_16x16x32_bf16 v[172:175], a[188:191], v[40:43], v[172:175]
  v_mfma_f32_16x16x32_bf16 v[176:179], a[188:191], v[44:47], v[176:179]
  v_mfma_f32_16x16x32_bf16 v[180:183], a[188:191], v[48:51], v[180:183]
  v_mfma_f32_16x16x32_bf16 v[184:187], a[188:191], v[52:55], v[184:187]
  v_mfma_f32_16x16x32_bf16 v[192:195], v[228:231], v[40:43], v[192:195]
  v_mfma_f32_16x16x32_bf16 v[196:199], v[228:231], v[44:47], v[196:199]
  v_mfma_f32_16x16x32_bf16 v[200:203], v[228:231], v[48:51], v[200:203]
  v_mfma_f32_16x16x32_bf16 v[204:207], v[228:231], v[52:55], v[204:207]
  s_waitcnt vmcnt(21) lgkmcnt(0)
  v_mfma_f32_16x16x32_bf16 v[128:131], a[48:51], v[16:19], v[128:131]
  v_mfma_f32_16x16x32_bf16 v[132:135], a[48:51], v[20:23], v[132:135]
  v_mfma_f32_16x16x32_bf16 v[136:139], a[48:51], v[24:27], v[136:139]
  v_mfma_f32_16x16x32_bf16 v[140:143], a[48:51], v[28:31], v[140:143]
  v_mfma_f32_16x16x32_bf16 v[144:147], a[48:51], v[32:35], v[144:147]
  ds_read_b128 v[36:39], v13 offset:13312
  ds_read_b128 v[40:43], v13 offset:31744
  ds_read_b128 v[44:47], v13 offset:50176
  ds_read_b128 v[48:51], v14 offset:13312
  ds_read_b128 v[52:55], v14 offset:31744
  v_mfma_f32_16x16x32_bf16 v[148:151], a[120:123], v[16:19], v[148:151]
  v_mfma_f32_16x16x32_bf16 v[152:155], a[120:123], v[20:23], v[152:155]
  v_mfma_f32_16x16x32_bf16 v[156:159], a[120:123], v[24:27], v[156:159]
  v_mfma_f32_16x16x32_bf16 v[160:163], a[120:123], v[28:31], v[160:163]
  v_mfma_f32_16x16x32_bf16 v[164:167], a[120:123], v[32:35], v[164:167]
  v_mfma_f32_16x16x32_bf16 v[172:175], a[192:195], v[20:23], v[172:175]
  v_mfma_f32_16x16x32_bf16 v[176:179], a[192:195], v[24:27], v[176:179]
  v_mfma_f32_16x16x32_bf16 v[180:183], a[192:195], v[28:31], v[180:183]
  v_mfma_f32_16x16x32_bf16 v[184:187], a[192:195], v[32:35], v[184:187]
  v_mfma_f32_16x16x32_bf16 v[192:195], v[232:235], v[20:23], v[192:195]
  v_mfma_f32_16x16x32_bf16 v[196:199], v[232:235], v[24:27], v[196:199]
  v_mfma_f32_16x16x32_bf16 v[200:203], v[232:235], v[28:31], v[200:203]
  v_mfma_f32_16x16x32_bf16 v[204:207], v[232:235], v[32:35], v[204:207]
  s_waitcnt vmcnt(17) lgkmcnt(0)
  v_mfma_f32_16x16x32_bf16 v[128:131], a[52:55], v[36:39], v[128:131]
  v_mfma_f32_16x16x32_bf16 v[132:135], a[52:55], v[40:43], v[132:135]
  v_mfma_f32_16x16x32_bf16 v[136:139], a[52:55], v[44:47], v[136:139]
  v_mfma_f32_16x16x32_bf16 v[140:143], a[52:55], v[48:51], v[140:143]
  v_mfma_f32_16x16x32_bf16 v[144:147], a[52:55], v[52:55], v[144:147]
  ds_read_b128 v[16:19], v13 offset:14336
  ds_read_b128 v[20:23], v13 offset:32768
  ds_read_b128 v[24:27], v13 offset:51200
  ds_read_b128 v[28:31], v14 offset:14336
  ds_read_b128 v[32:35], v14 offset:32768
  v_mfma_f32_16x16x32_bf16 v[148:151], a[124:127], v[36:39], v[148:151]
  v_mfma_f32_16x16x32_bf16 v[152:155], a[124:127], v[40:43], v[152:155]
  v_mfma_f32_16x16x32_bf16 v[156:159], a[124:127], v[44:47], v[156:159]
  v_mfma_f32_16x16x32_bf16 v[160:163], a[124:127], v[48:51], v[160:163]
  v_mfma_f32_16x16x32_bf16 v[164:167], a[124:127], v[52:55], v[164:167]
  v_mfma_f32_16x16x32_bf16 v[172:175], a[196:199], v[40:43], v[172:175]
  v_mfma_f32_16x16x32_bf16 v[176:179], a[196:199], v[44:47], v[176:179]
  v_mfma_f32_16x16x32_bf16 v[180:183], a[196:199], v[48:51], v[180:183]
  v_mfma_f32_16x16x32_bf16 v[184:187], a[196:199], v[52:55], v[184:187]
  v_mfma_f32_16x16x32_bf16 v[192:195], v[236:239], v[40:43], v[192:195]
  v_mfma_f32_16x16x32_bf16 v[196:199], v[236:239], v[44:47], v[196:199]
  v_mfma_f32_16x16x32_bf16 v[200:203], v[236:239], v[48:51], v[200:203]
  v_mfma_f32_16x16x32_bf16 v[204:207], v[236:239], v[52:55], v[204:207]
  s_waitcnt vmcnt(13) lgkmcnt(0)
  v_mfma_f32_16x16x32_bf16 v[128:131], a[56:59], v[16:19], v[128:131]
  v_mfma_f32_16x16x32_bf16 v[132:135], a[56:59], v[20:23], v[132:135]
  v_mfma_f32_16x16x32_bf16 v[136:139], a[56:59], v[24:27], v[136:139]
  v_mfma_f32_16x16x32_bf16 v[140:143], a[56:59], v[28:31], v[140:143]
  v_mfma_f32_16x16x32_bf16 v[144:147], a[56:59], v[32:35], v[144:147]
  ds_read_b128 v[36:39], v13 offset:15360
  ds_read_b128 v[40:43], v13 offset:33792
  ds_read_b128 v[44:47], v13 offset:52224
  ds_read_b128 v[48:51], v14 offset:15360
  ds_read_b128 v[52:55], v14 offset:33792
  v_mfma_f32_16x16x32_bf16 v[148:151], a[128:131], v[16:19], v[148:151]
  v_mfma_f32_16x16x32_bf16 v[152:155], a[128:131], v[20:23], v[152:155]
  v_mfma_f32_16x16x32_bf16 v[156:159], a[128:131], v[24:27], v[156:159]
  v_mfma_f32_16x16x32_bf16 v[160:163], a[128:131], v[28:31], v[160:163]
  v_mfma_f32_16x16x32_bf16 v[164:167], a[128:131], v[32:35], v[164:167]
  v_mfma_f32_16x16x32_bf16 v[172:175], a[200:203], v[20:23], v[172:175]
  v_mfma_f32_16x16x32_bf16 v[176:179], a[200:203], v[24:27], v[176:179]
  v_mfma_f32_16x16x32_bf16 v[180:183], a[200:203], v[28:31], v[180:183]
  v_mfma_f32_16x16x32_bf16 v[184:187], a[200:203], v[32:35], v[184:187]
  v_mfma_f32_16x16x32_bf16 v[192:195], v[240:243], v[20:23], v[192:195]
  v_mfma_f32_16x16x32_bf16 v[196:199], v[240:243], v[24:27], v[196:199]
  v_mfma_f32_16x16x32_bf16 v[200:203], v[240:243], v[28:31], v[200:203]
  v_mfma_f32_16x16x32_bf16 v[204:207], v[240:243], v[32:35], v[204:207]
  s_waitcnt vmcnt(9) lgkmcnt(0)
  v_mfma_f32_16x16x32_bf16 v[128:131], a[60:63], v[36:39], v[128:131]
  v_mfma_f32_16x16x32_bf16 v[132:135], a[60:63], v[40:43], v[132:135]
  v_mfma_f32_16x16x32_bf16 v[136:139], a[60:63], v[44:47], v[136:139]
  v_mfma_f32_16x16x32_bf16 v[140:143], a[60:63], v[48:51], v[140:143]
  v_mfma_f32_16x16x32_bf16 v[144:147], a[60:63], v[52:55], v[144:147]
  ds_read_b128 v[16:19], v13 offset:16384
  ds_read_b128 v[20:23], v13 offset:34816
  ds_read_b128 v[24:27], v13 offset:53248
  ds_read_b128 v[28:31], v14 offset:16384
  ds_read_b128 v[32:35], v14 offset:34816
  v_mfma_f32_16x16x32_bf16 v[148:151], a[132:135], v[36:39], v[148:151]
  v_mfma_f32_16x16x32_bf16 v[152:155], a[132:135], v[40:43], v[152:155]
  v_mfma_f32_16x16x32_bf16 v[156:159], a[132:135], v[44:47], v[156:159]
  v_mfma_f32_16x16x32_bf16 v[160:163], a[132:135], v[48:51], v[160:163]
  v_mfma_f32_16x16x32_bf16 v[164:167], a[132:135], v[52:55], v[164:167]
  v_mfma_f32_16x16x32_bf16 v[172:175], a[204:207], v[40:43], v[172:175]
  v_mfma_f32_16x16x32_bf16 v[176:179], a[204:207], v[44:47], v[176:179]
  v_mfma_f32_16x16x32_bf16 v[180:183], a[204:207], v[48:51], v[180:183]
  v_mfma_f32_16x16x32_bf16 v[184:187], a[204:207], v[52:55], v[184:187]
  v_mfma_f32_16x16x32_bf16 v[192:195], v[244:247], v[40:43], v[192:195]
  v_mfma_f32_16x16x32_bf16 v[196:199], v[244:247], v[44:47], v[196:199]
  v_mfma_f32_16x16x32_bf16 v[200:203], v[244:247], v[48:51], v[200:203]
  v_mfma_f32_16x16x32_bf16 v[204:207], v[244:247], v[52:55], v[204:207]
  s_waitcnt vmcnt(5) lgkmcnt(0)
  v_mfma_f32_16x16x32_bf16 v[128:131], a[64:67], v[16:19], v[128:131]
  v_mfma_f32_16x16x32_bf16 v[132:135], a[64:67], v[20:23], v[132:135]
  v_mfma_f32_16x16x32_bf16 v[136:139], a[64:67], v[24:27], v[136:139]
  v_mfma_f32_16x16x32_bf16 v[140:143], a[64:67], v[28:31], v[140:143]
  v_mfma_f32_16x16x32_bf16 v[144:147], a[64:67], v[32:35], v[144:147]
  ds_read_b128 v[36:39], v13 offset:17408
  ds_read_b128 v[40:43], v13 offset:35840
  ds_read_b128 v[44:47], v13 offset:54272
  ds_read_b128 v[48:51], v14 offset:17408
  ds_read_b128 v[52:55], v14 offset:35840
  v_mfma_f32_16x16x32_bf16 v[148:151], a[136:139], v[16:19], v[148:151]
  v_mfma_f32_16x16x32_bf16 v[152:155], a[136:139], v[20:23], v[152:155]
  v_mfma_f32_16x16x32_bf16 v[156:159], a[136:139], v[24:27], v[156:159]
  v_mfma_f32_16x16x32_bf16 v[160:163], a[136:139], v[28:31], v[160:163]
  v_mfma_f32_16x16x32_bf16 v[164:167], a[136:139], v[32:35], v[164:167]
  v_mfma_f32_16x16x32_bf16 v[172:175], a[208:211], v[20:23], v[172:175]
  v_mfma_f32_16x16x32_bf16 v[176:179], a[208:211], v[24:27], v[176:179]
  v_mfma_f32_16x16x32_bf16 v[180:183], a[208:211], v[28:31], v[180:183]
  v_mfma_f32_16x16x32_bf16 v[184:187], a[208:211], v[32:35], v[184:187]
  v_mfma_f32_16x16x32_bf16 v[192:195], v[248:251], v[20:23], v[192:195]
  v_mfma_f32_16x16x32_bf16 v[196:199], v[248:251], v[24:27], v[196:199]
  v_mfma_f32_16x16x32_bf16 v[200:203], v[248:251], v[28:31], v[200:203]
  v_mfma_f32_16x16x32_bf16 v[204:207], v[248:251], v[32:35], v[204:207]
  s_waitcnt vmcnt(1) lgkmcnt(0)
  v_mfma_f32_16x16x32_bf16 v[128:131], a[68:71], v[36:39], v[128:131]
  v_mfma_f32_16x16x32_bf16 v[132:135], a[68:71], v[40:43], v[132:135]
  v_mfma_f32_16x16x32_bf16 v[136:139], a[68:71], v[44:47], v[136:139]
  v_mfma_f32_16x16x32_bf16 v[140:143], a[68:71], v[48:51], v[140:143]
  v_mfma_f32_16x16x32_bf16 v[144:147], a[68:71], v[52:55], v[144:147]
  v_mfma_f32_16x16x32_bf16 v[148:151], a[140:143], v[36:39], v[148:151]
  v_mfma_f32_16x16x32_bf16 v[152:155], a[140:143], v[40:43], v[152:155]
  v_mfma_f32_16x16x32_bf16 v[156:159], a[140:143], v[44:47], v[156:159]
  v_mfma_f32_16x16x32_bf16 v[160:163], a[140:143], v[48:51], v[160:163]
  v_mfma_f32_16x16x32_bf16 v[164:167], a[140:143], v[52:55], v[164:167]
  v_mfma_f32_16x16x32_bf16 v[172:175], a[212:215], v[40:43], v[172:175]
  v_mfma_f32_16x16x32_bf16 v[176:179], a[212:215], v[44:47], v[176:179]
  v_mfma_f32_16x16x32_bf16 v[180:183], a[212:215], v[48:51], v[180:183]
  v_mfma_f32_16x16x32_bf16 v[184:187], a[212:215], v[52:55], v[184:187]
  v_mfma_f32_16x16x32_bf16 v[192:195], v[252:255], v[40:43], v[192:195]
  v_mfma_f32_16x16x32_bf16 v[196:199], v[252:255], v[44:47], v[196:199]
  v_mfma_f32_16x16x32_bf16 v[200:203], v[252:255], v[48:51], v[200:203]
  v_mfma_f32_16x16x32_bf16 v[204:207], v[252:255], v[52:55], v[204:207]
  s_nop 7
  v_cvt_pk_bf16_f32 v128, v128, v129
  v_cvt_pk_bf16_f32 v129, v130, v131
  v_add_u32 v15, s50, v8
  ds_write2_b32 v15, v128, v129 offset0:0 offset1:1
  s_add_u32 s50, s50, 7232
  v_cvt_pk_bf16_f32 v132, v132, v133
  v_cvt_pk_bf16_f32 v133, v134, v135
  v_add_u32 v15, s50, v8
  ds_write2_b32 v15, v132, v133 offset0:0 offset1:1
  s_add_u32 s50, s50, 7232
  v_cvt_pk_bf16_f32 v136, v136, v137
  v_cvt_pk_bf16_f32 v137, v138, v139
  v_add_u32 v15, s50, v8
  ds_write2_b32 v15, v136, v137 offset0:0 offset1:1
  s_add_u32 s50, s50, 7232
  v_cvt_pk_bf16_f32 v140, v140, v141
  v_cvt_pk_bf16_f32 v141, v142, v143
  v_add_u32 v15, s50, v8
  ds_write2_b32 v15, v140, v141 offset0:0 offset1:1
  s_add_u32 s50, s50, 7232
  v_cvt_pk_bf16_f32 v144, v144, v145
  v_cvt_pk_bf16_f32 v145, v146, v147
  v_add_u32 v15, s50, v8
  ds_write2_b32 v15, v144, v145 offset0:0 offset1:1
  s_add_u32 s50, s50, 7232
  v_cvt_pk_bf16_f32 v148, v148, v149
  v_cvt_pk_bf16_f32 v149, v150, v151
  v_add_u32 v15, s51, v8
  ds_write2_b32 v15, v148, v149 offset0:0 offset1:1
  s_add_u32 s51, s51, 7232
  v_cvt_pk_bf16_f32 v152, v152, v153
  v_cvt_pk_bf16_f32 v153, v154, v155
  v_add_u32 v15, s51, v8
  ds_write2_b32 v15, v152, v153 offset0:0 offset1:1
  s_add_u32 s51, s51, 7232
  v_cvt_pk_bf16_f32 v156, v156, v157
  v_cvt_pk_bf16_f32 v157, v158, v159
  v_add_u32 v15, s51, v8
  ds_write2_b32 v15, v156, v157 offset0:0 offset1:1
  s_add_u32 s51, s51, 7232
  v_cvt_pk_bf16_f32 v160, v160, v161
  v_cvt_pk_bf16_f32 v161, v162, v163
  v_add_u32 v15, s51, v8
  ds_write2_b32 v15, v160, v161 offset0:0 offset1:1
  s_add_u32 s51, s51, 7232
  v_cvt_pk_bf16_f32 v164, v164, v165
  v_cvt_pk_bf16_f32 v165, v166, v167
  v_add_u32 v15, s51, v8
  ds_write2_b32 v15, v164, v165 offset0:0 offset1:1
  s_add_u32 s51, s51, 7232
  v_cvt_pk_bf16_f32 v172, v172, v173
  v_cvt_pk_bf16_f32 v173, v174, v175
  v_add_u32 v15, s52, v8
  ds_write2_b32 v15, v172, v173 offset0:0 offset1:1
  s_add_u32 s52, s52, 7232
  v_cvt_pk_bf16_f32 v176, v176, v177
  v_cvt_pk_bf16_f32 v177, v178, v179
  v_add_u32 v15, s52, v8
  ds_write2_b32 v15, v176, v177 offset0:0 offset1:1
  s_add_u32 s52, s52, 7232
  v_cvt_pk_bf16_f32 v180, v180, v181
  v_cvt_pk_bf16_f32 v181, v182, v183
  v_add_u32 v15, s52, v8
  ds_write2_b32 v15, v180, v181 offset0:0 offset1:1
  s_add_u32 s52, s52, 7232
  v_cvt_pk_bf16_f32 v184, v184, v185
  v_cvt_pk_bf16_f32 v185, v186, v187
  v_add_u32 v15, s52, v8
  ds_write2_b32 v15, v184, v185 offset0:0 offset1:1
  s_add_u32 s52, s52, 7232
  v_cvt_pk_bf16_f32 v192, v192, v193
  v_cvt_pk_bf16_f32 v193, v194, v195
  v_add_u32 v15, s53, v8
  ds_write2_b32 v15, v192, v193 offset0:0 offset1:1
  s_add_u32 s53, s53, 7232
  v_cvt_pk_bf16_f32 v196, v196, v197
  v_cvt_pk_bf16_f32 v197, v198, v199
  v_add_u32 v15, s53, v8
  ds_write2_b32 v15, v196, v197 offset0:0 offset1:1
  s_add_u32 s53, s53, 7232
  v_cvt_pk_bf16_f32 v200, v200, v201
  v_cvt_pk_bf16_f32 v201, v202, v203
  v_add_u32 v15, s53, v8
  ds_write2_b32 v15, v200, v201 offset0:0 offset1:1
  s_add_u32 s53, s53, 7232
  v_cvt_pk_bf16_f32 v204, v204, v205
  v_cvt_pk_bf16_f32 v205, v206, v207
  v_add_u32 v15, s53, v8
  ds_write2_b32 v15, v204, v205 offset0:0 offset1:1
  s_add_u32 s53, s53, 7232
  s_waitcnt lgkmcnt(0)
  s_branch f_kernel_att
f_kernel_pB:
  buffer_load_dwordx4 v[156:159], v11, s[16:19], s47 offen offset:0
  buffer_load_dwordx4 v[160:163], v11, s[16:19], s47 offen offset:16
  buffer_load_dwordx4 v[164:167], v11, s[16:19], s46 offen offset:0
  buffer_load_dwordx4 v[168:171], v11, s[16:19], s46 offen offset:16
  buffer_load_dwordx4 v[56:59], v9, s[16:19], s30 offen
  s_add_u32 s30, s30, 4096
  buffer_load_dwordx4 v[60:63], v9, s[16:19], s31 offen
  s_add_u32 s31, s31, 4096
  buffer_load_dwordx4 v[64:67], v9, s[16:19], s32 offen
  s_add_u32 s32, s32, 4096
  buffer_load_dwordx4 v[68:71], v9, s[16:19], s33 offen
  s_add_u32 s33, s33, 4096
  buffer_load_dwordx4 v[72:75], v9, s[16:19], s34 offen
  s_add_u32 s34, s34, 4096
  buffer_load_dwordx4 v[172:175], v11, s[16:19], s47 offen offset:512
  buffer_load_dwordx4 v[176:179], v11, s[16:19], s47 offen offset:528
  buffer_load_dwordx4 v[180:183], v11, s[16:19], s46 offen offset:512
  buffer_load_dwordx4 v[184:187], v11, s[16:19], s46 offen offset:528
  buffer_load_dwordx4 v[76:79], v9, s[16:19], s30 offen
  s_add_u32 s30, s30, 4096
  buffer_load_dwordx4 v[80:83], v9, s[16:19], s31 offen
  s_add_u32 s31, s31, 4096
  buffer_load_dwordx4 v[84:87], v9, s[16:19], s32 offen
  s_add_u32 s32, s32, 4096
  buffer_load_dwordx4 v[88:91], v9, s[16:19], s33 offen
  s_add_u32 s33, s33, 4096
  buffer_load_dwordx4 v[92:95], v9, s[16:19], s34 offen
  s_add_u32 s34, s34, 4096
  buffer_load_dwordx4 v[188:191], v11, s[16:19], s47 offen offset:1024
  buffer_load_dwordx4 v[192:195], v11, s[16:19], s47 offen offset:1040
  buffer_load_dwordx4 v[196:199], v11, s[16:19], s46 offen offset:1024
  buffer_load_dwordx4 v[200:203], v11, s[16:19], s46 offen offset:1040
  buffer_load_dwordx4 v[96:99], v9, s[16:19], s30 offen
  s_add_u32 s30, s30, 4096
  buffer_load_dwordx4 v[100:103], v9, s[16:19], s31 offen
  s_add_u32 s31, s31, 4096
  buffer_load_dwordx4 v[104:107], v9, s[16:19], s32 offen
  s_add_u32 s32, s32, 4096
  buffer_load_dwordx4 v[108:111], v9, s[16:19], s33 offen
  s_add_u32 s33, s33, 4096
  buffer_load_dwordx4 v[112:115], v9, s[16:19], s34 offen
  s_add_u32 s34, s34, 4096
  buffer_load_dwordx4 v[204:207], v11, s[16:19], s47 offen offset:1536
  buffer_load_dwordx4 v[208:211], v11, s[16:19], s47 offen offset:1552
  buffer_load_dwordx4 v[212:215], v11, s[16:19], s46 offen offset:1536
  buffer_load_dwordx4 v[216:219], v11, s[16:19], s46 offen offset:1552
  buffer_load_dwordx4 v[116:119], v9, s[16:19], s30 offen
  s_add_u32 s30, s30, 4096
  buffer_load_dwordx4 v[120:123], v9, s[16:19], s31 offen
  s_add_u32 s31, s31, 4096
  buffer_load_dwordx4 v[124:127], v9, s[16:19], s32 offen
  s_add_u32 s32, s32, 4096
  buffer_load_dwordx4 v[128:131], v9, s[16:19], s33 offen
  s_add_u32 s33, s33, 4096
  buffer_load_dwordx4 v[132:135], v9, s[16:19], s34 offen
  s_add_u32 s34, s34, 4096
  buffer_load_dwordx4 a[0:3], v9, s[16:19], s40 offen offset:0
  buffer_load_dwordx4 a[72:75], v9, s[16:19], s41 offen offset:0
  buffer_load_dwordx4 a[144:147], v9, s[16:19], s42 offen offset:0
  buffer_load_dwordx4 a[4:7], v9, s[16:19], s40 offen offset:1024
  buffer_load_dwordx4 a[76:79], v9, s[16:19], s41 offen offset:1024
  buffer_load_dwordx4 a[148:151], v9, s[16:19], s42 offen offset:1024
  buffer_load_dwordx4 a[8:11], v9, s[16:19], s40 offen offset:2048
  buffer_load_dwordx4 a[80:83], v9, s[16:19], s41 offen offset:2048
  buffer_load_dwordx4 a[152:155], v9, s[16:19], s42 offen offset:2048
  buffer_load_dwordx4 a[12:15], v9, s[16:19], s40 offen offset:3072
  s_add_u32 s40, s40, 4096
  buffer_load_dwordx4 a[84:87], v9, s[16:19], s41 offen offset:3072
  s_add_u32 s41, s41, 4096
  buffer_load_dwordx4 a[156:159], v9, s[16:19], s42 offen offset:3072
  s_add_u32 s42, s42, 4096
  buffer_load_dwordx4 a[16:19], v9, s[16:19], s40 offen offset:0
  buffer_load_dwordx4 a[88:91], v9, s[16:19], s41 offen offset:0
  buffer_load_dwordx4 a[160:163], v9, s[16:19], s42 offen offset:0
  buffer_load_dwordx4 a[20:23], v9, s[16:19], s40 offen offset:1024
  buffer_load_dwordx4 a[92:95], v9, s[16:19], s41 offen offset:1024
  buffer_load_dwordx4 a[164:167], v9, s[16:19], s42 offen offset:1024
  buffer_load_dwordx4 a[24:27], v9, s[16:19], s40 offen offset:2048
  buffer_load_dwordx4 a[96:99], v9, s[16:19], s41 offen offset:2048
  buffer_load_dwordx4 a[168:171], v9, s[16:19], s42 offen offset:2048
  buffer_load_dwordx4 a[28:31], v9, s[16:19], s40 offen offset:3072
  s_add_u32 s40, s40, 4096
  buffer_load_dwordx4 a[100:103], v9, s[16:19], s41 offen offset:3072
  s_add_u32 s41, s41, 4096
  buffer_load_dwordx4 a[172:175], v9, s[16:19], s42 offen offset:3072
  s_add_u32 s42, s42, 4096
  buffer_load_dwordx4 a[32:35], v9, s[16:19], s40 offen offset:0
  s_waitcnt vmcnt(52)
  v_lshlrev_b32 v16, 16, v56
  v_and_b32 v17, 0xffff0000, v56
  v_lshlrev_b32 v18, 16, v57
  v_and_b32 v19, 0xffff0000, v57
  v_lshlrev_b32 v20, 16, v58
  v_and_b32 v21, 0xffff0000, v58
  v_lshlrev_b32 v22, 16, v59
  v_and_b32 v23, 0xffff0000, v59
  v_pk_fma_f32 v[16:17], v[16:17], v[156:157], v[164:165]
  v_pk_fma_f32 v[18:19], v[18:19], v[158:159], v[166:167]
  v_pk_fma_f32 v[20:21], v[20:21], v[160:161], v[168:169]
  v_pk_fma_f32 v[22:23], v[22:23], v[162:163], v[170:171]
  v_cvt_pk_bf16_f32 v24, v16, v17
  v_cvt_pk_bf16_f32 v25, v18, v19
  v_cvt_pk_bf16_f32 v26, v20, v21
  v_cvt_pk_bf16_f32 v27, v22, v23
  ds_write_b128 v10, v[24:27] offset:0
  v_lshlrev_b32 v28, 16, v60
  v_and_b32 v29, 0xffff0000, v60
  v_lshlrev_b32 v30, 16, v61
  v_and_b32 v31, 0xffff0000, v61
  v_lshlrev_b32 v32, 16, v62
  v_and_b32 v33, 0xffff0000, v62
  v_lshlrev_b32 v34, 16, v63
  v_and_b32 v35, 0xffff0000, v63
  v_pk_fma_f32 v[28:29], v[28:29], v[156:157], v[164:165]
  v_pk_fma_f32 v[30:31], v[30:31], v[158:159], v[166:167]
  v_pk_fma_f32 v[32:33], v[32:33], v[160:161], v[168:169]
  v_pk_fma_f32 v[34:35], v[34:35], v[162:163], v[170:171]
  v_cvt_pk_bf16_f32 v36, v28, v29
  v_cvt_pk_bf16_f32 v37, v30, v31
  v_cvt_pk_bf16_f32 v38, v32, v33
  v_cvt_pk_bf16_f32 v39, v34, v35
  ds_write_b128 v10, v[36:39] offset:18432
  v_lshlrev_b32 v16, 16, v64
  v_and_b32 v17, 0xffff0000, v64
  v_lshlrev_b32 v18, 16, v65
  v_and_b32 v19, 0xffff0000, v65
  v_lshlrev_b32 v20, 16, v66
  v_and_b32 v21, 0xffff0000, v66
  v_lshlrev_b32 v22, 16, v67
  v_and_b32 v23, 0xffff0000, v67
  v_pk_fma_f32 v[16:17], v[16:17], v[156:157], v[164:165]
  v_pk_fma_f32 v[18:19], v[18:19], v[158:159], v[166:167]
  v_pk_fma_f32 v[20:21], v[20:21], v[160:161], v[168:169]
  v_pk_fma_f32 v[22:23], v[22:23], v[162:163], v[170:171]
  v_cvt_pk_bf16_f32 v24, v16, v17
  v_cvt_pk_bf16_f32 v25, v18, v19
  v_cvt_pk_bf16_f32 v26, v20, v21
  v_cvt_pk_bf16_f32 v27, v22, v23
  ds_write_b128 v10, v[24:27] offset:36864
  v_lshlrev_b32 v28, 16, v68
  v_and_b32 v29, 0xffff0000, v68
  v_lshlrev_b32 v30, 16, v69
  v_and_b32 v31, 0xffff0000, v69
  v_lshlrev_b32 v32, 16, v70
  v_and_b32 v33, 0xffff0000, v70
  v_lshlrev_b32 v34, 16, v71
  v_and_b32 v35, 0xffff0000, v71
  v_pk_fma_f32 v[28:29], v[28:29], v[156:157], v[164:165]
  v_pk_fma_f32 v[30:31], v[30:31], v[158:159], v[166:167]
  v_pk_fma_f32 v[32:33], v[32:33], v[160:161], v[168:169]
  v_pk_fma_f32 v[34:35], v[34:35], v[162:163], v[170:171]
  v_cvt_pk_bf16_f32 v36, v28, v29
  v_cvt_pk_bf16_f32 v37, v30, v31
  v_cvt_pk_bf16_f32 v38, v32, v33
  v_cvt_pk_bf16_f32 v39, v34, v35
  ds_write_b128 v12, v[36:39] offset:0
  v_lshlrev_b32 v16, 16, v72
  v_and_b32 v17, 0xffff0000, v72
  v_lshlrev_b32 v18, 16, v73
  v_and_b32 v19, 0xffff0000, v73
  v_lshlrev_b32 v20, 16, v74
  v_and_b32 v21, 0xffff0000, v74
  v_lshlrev_b32 v22, 16, v75
  v_and_b32 v23, 0xffff0000, v75
  v_pk_fma_f32 v[16:17], v[16:17], v[156:157], v[164:165]
  v_pk_fma_f32 v[18:19], v[18:19], v[158:159], v[166:167]
  v_pk_fma_f32 v[20:21], v[20:21], v[160:161], v[168:169]
  v_pk_fma_f32 v[22:23], v[22:23], v[162:163], v[170:171]
  v_cvt_pk_bf16_f32 v24, v16, v17
  v_cvt_pk_bf16_f32 v25, v18, v19
  v_cvt_pk_bf16_f32 v26, v20, v21
  v_cvt_pk_bf16_f32 v27, v22, v23
  ds_write_b128 v12, v[24:27] offset:18432
  buffer_load_dwordx4 a[104:107], v9, s[16:19], s41 offen offset:0
  buffer_load_dwordx4 a[176:179], v9, s[16:19], s42 offen offset:0
  buffer_load_dwordx4 a[36:39], v9, s[16:19], s40 offen offset:1024
  buffer_load_dwordx4 a[108:111], v9, s[16:19], s41 offen offset:1024
  buffer_load_dwordx4 a[180:183], v9, s[16:19], s42 offen offset:1024
  buffer_load_dwordx4 a[40:43], v9, s[16:19], s40 offen offset:2048
  buffer_load_dwordx4 a[112:115], v9, s[16:19], s41 offen offset:2048
  buffer_load_dwordx4 a[184:187], v9, s[16:19], s42 offen offset:2048
  buffer_load_dwordx4 a[44:47], v9, s[16:19], s40 offen offset:3072
  s_add_u32 s40, s40, 4096
  s_waitcnt vmcnt(52)
  v_lshlrev_b32 v16, 16, v76
  v_and_b32 v17, 0xffff0000, v76
  v_lshlrev_b32 v18, 16, v77
  v_and_b32 v19, 0xffff0000, v77
  v_lshlrev_b32 v20, 16, v78
  v_and_b32 v21, 0xffff0000, v78
  v_lshlrev_b32 v22, 16, v79
  v_and_b32 v23, 0xffff0000, v79
  v_pk_fma_f32 v[16:17], v[16:17], v[172:173], v[180:181]
  v_pk_fma_f32 v[18:19], v[18:19], v[174:175], v[182:183]
  v_pk_fma_f32 v[20:21], v[20:21], v[176:177], v[184:185]
  v_pk_fma_f32 v[22:23], v[22:23], v[178:179], v[186:187]
  v_cvt_pk_bf16_f32 v24, v16, v17
  v_cvt_pk_bf16_f32 v25, v18, v19
  v_cvt_pk_bf16_f32 v26, v20, v21
  v_cvt_pk_bf16_f32 v27, v22, v23
  ds_write_b128 v10, v[24:27] offset:4096
  v_lshlrev_b32 v28, 16, v80
  v_and_b32 v29, 0xffff0000, v80
  v_lshlrev_b32 v30, 16, v81
  v_and_b32 v31, 0xffff0000, v81
  v_lshlrev_b32 v32, 16, v82
  v_and_b32 v33, 0xffff0000, v82
  v_lshlrev_b32 v34, 16, v83
  v_and_b32 v35, 0xffff0000, v83
  v_pk_fma_f32 v[28:29], v[28:29], v[172:173], v[180:181]
  v_pk_fma_f32 v[30:31], v[30:31], v[174:175], v[182:183]
  v_pk_fma_f32 v[32:33], v[32:33], v[176:177], v[184:185]
  v_pk_fma_f32 v[34:35], v[34:35], v[178:179], v[186:187]
  v_cvt_pk_bf16_f32 v36, v28, v29
  v_cvt_pk_bf16_f32 v37, v30, v31
  v_cvt_pk_bf16_f32 v38, v32, v33
  v_cvt_pk_bf16_f32 v39, v34, v35
  ds_write_b128 v10, v[36:39] offset:22528
  v_lshlrev_b32 v16, 16, v84
  v_and_b32 v17, 0xffff0000, v84
  v_lshlrev_b32 v18, 16, v85
  v_and_b32 v19, 0xffff0000, v85
  v_lshlrev_b32 v20, 16, v86
  v_and_b32 v21, 0xffff0000, v86
  v_lshlrev_b32 v22, 16, v87
  v_and_b32 v23, 0xffff0000, v87
  v_pk_fma_f32 v[16:17], v[16:17], v[172:173], v[180:181]
  v_pk_fma_f32 v[18:19], v[18:19], v[174:175], v[182:183]
  v_pk_fma_f32 v[20:21], v[20:21], v[176:177], v[184:185]
  v_pk_fma_f32 v[22:23], v[22:23], v[178:179], v[186:187]
  v_cvt_pk_bf16_f32 v24, v16, v17
  v_cvt_pk_bf16_f32 v25, v18, v19
  v_cvt_pk_bf16_f32 v26, v20, v21
  v_cvt_pk_bf16_f32 v27, v22, v23
  ds_write_b128 v10, v[24:27] offset:40960
  v_lshlrev_b32 v28, 16, v88
  v_and_b32 v29, 0xffff0000, v88
  v_lshlrev_b32 v30, 16, v89
  v_and_b32 v31, 0xffff0000, v89
  v_lshlrev_b32 v32, 16, v90
  v_and_b32 v33, 0xffff0000, v90
  v_lshlrev_b32 v34, 16, v91
  v_and_b32 v35, 0xffff0000, v91
  v_pk_fma_f32 v[28:29], v[28:29], v[172:173], v[180:181]
  v_pk_fma_f32 v[30:31], v[30:31], v[174:175], v[182:183]
  v_pk_fma_f32 v[32:33], v[32:33], v[176:177], v[184:185]
  v_pk_fma_f32 v[34:35], v[34:35], v[178:179], v[186:187]
  v_cvt_pk_bf16_f32 v36, v28, v29
  v_cvt_pk_bf16_f32 v37, v30, v31
  v_cvt_pk_bf16_f32 v38, v32, v33
  v_cvt_pk_bf16_f32 v39, v34, v35
  ds_write_b128 v12, v[36:39] offset:4096
  v_lshlrev_b32 v16, 16, v92
  v_and_b32 v17, 0xffff0000, v92
  v_lshlrev_b32 v18, 16, v93
  v_and_b32 v19, 0xffff0000, v93
  v_lshlrev_b32 v20, 16, v94
  v_and_b32 v21, 0xffff0000, v94
  v_lshlrev_b32 v22, 16, v95
  v_and_b32 v23, 0xffff0000, v95
  v_pk_fma_f32 v[16:17], v[16:17], v[172:173], v[180:181]
  v_pk_fma_f32 v[18:19], v[18:19], v[174:175], v[182:183]
  v_pk_fma_f32 v[20:21], v[20:21], v[176:177], v[184:185]
  v_pk_fma_f32 v[22:23], v[22:23], v[178:179], v[186:187]
  v_cvt_pk_bf16_f32 v24, v16, v17
  v_cvt_pk_bf16_f32 v25, v18, v19
  v_cvt_pk_bf16_f32 v26, v20, v21
  v_cvt_pk_bf16_f32 v27, v22, v23
  ds_write_b128 v12, v[24:27] offset:22528
  buffer_load_dwordx4 a[116:119], v9, s[16:19], s41 offen offset:3072
  s_add_u32 s41, s41, 4096
  buffer_load_dwordx4 a[188:191], v9, s[16:19], s42 offen offset:3072
  s_add_u32 s42, s42, 4096
  buffer_load_dwordx4 a[48:51], v9, s[16:19], s40 offen offset:0
  buffer_load_dwordx4 a[120:123], v9, s[16:19], s41 offen offset:0
  buffer_load_dwordx4 a[192:195], v9, s[16:19], s42 offen offset:0
  buffer_load_dwordx4 a[52:55], v9, s[16:19], s40 offen offset:1024
  buffer_load_dwordx4 a[124:127], v9, s[16:19], s41 offen offset:1024
  buffer_load_dwordx4 a[196:199], v9, s[16:19], s42 offen offset:1024
  buffer_load_dwordx4 a[56:59], v9, s[16:19], s40 offen offset:2048
  s_waitcnt vmcnt(52)
  v_lshlrev_b32 v16, 16, v96
  v_and_b32 v17, 0xffff0000, v96
  v_lshlrev_b32 v18, 16, v97
  v_and_b32 v19, 0xffff0000, v97
  v_lshlrev_b32 v20, 16, v98
  v_and_b32 v21, 0xffff0000, v98
  v_lshlrev_b32 v22, 16, v99
  v_and_b32 v23, 0xffff0000, v99
  v_pk_fma_f32 v[16:17], v[16:17], v[188:189], v[196:197]
  v_pk_fma_f32 v[18:19], v[18:19], v[190:191], v[198:199]
  v_pk_fma_f32 v[20:21], v[20:21], v[192:193], v[200:201]
  v_pk_fma_f32 v[22:23], v[22:23], v[194:195], v[202:203]
  v_cvt_pk_bf16_f32 v24, v16, v17
  v_cvt_pk_bf16_f32 v25, v18, v19
  v_cvt_pk_bf16_f32 v26, v20, v21
  v_cvt_pk_bf16_f32 v27, v22, v23
  ds_write_b128 v10, v[24:27] offset:8192
  v_lshlrev_b32 v28, 16, v100
  v_and_b32 v29, 0xffff0000, v100
  v_lshlrev_b32 v30, 16, v101
  v_and_b32 v31, 0xffff0000, v101
  v_lshlrev_b32 v32, 16, v102
  v_and_b32 v33, 0xffff0000, v102
  v_lshlrev_b32 v34, 16, v103
  v_and_b32 v35, 0xffff0000, v103
  v_pk_fma_f32 v[28:29], v[28:29], v[188:189], v[196:197]
  v_pk_fma_f32 v[30:31], v[30:31], v[190:191], v[198:199]
  v_pk_fma_f32 v[32:33], v[32:33], v[192:193], v[200:201]
  v_pk_fma_f32 v[34:35], v[34:35], v[194:195], v[202:203]
  v_cvt_pk_bf16_f32 v36, v28, v29
  v_cvt_pk_bf16_f32 v37, v30, v31
  v_cvt_pk_bf16_f32 v38, v32, v33
  v_cvt_pk_bf16_f32 v39, v34, v35
  ds_write_b128 v10, v[36:39] offset:26624
  v_lshlrev_b32 v16, 16, v104
  v_and_b32 v17, 0xffff0000, v104
  v_lshlrev_b32 v18, 16, v105
  v_and_b32 v19, 0xffff0000, v105
  v_lshlrev_b32 v20, 16, v106
  v_and_b32 v21, 0xffff0000, v106
  v_lshlrev_b32 v22, 16, v107
  v_and_b32 v23, 0xffff0000, v107
  v_pk_fma_f32 v[16:17], v[16:17], v[188:189], v[196:197]
  v_pk_fma_f32 v[18:19], v[18:19], v[190:191], v[198:199]
  v_pk_fma_f32 v[20:21], v[20:21], v[192:193], v[200:201]
  v_pk_fma_f32 v[22:23], v[22:23], v[194:195], v[202:203]
  v_cvt_pk_bf16_f32 v24, v16, v17
  v_cvt_pk_bf16_f32 v25, v18, v19
  v_cvt_pk_bf16_f32 v26, v20, v21
  v_cvt_pk_bf16_f32 v27, v22, v23
  ds_write_b128 v10, v[24:27] offset:45056
  v_lshlrev_b32 v28, 16, v108
  v_and_b32 v29, 0xffff0000, v108
  v_lshlrev_b32 v30, 16, v109
  v_and_b32 v31, 0xffff0000, v109
  v_lshlrev_b32 v32, 16, v110
  v_and_b32 v33, 0xffff0000, v110
  v_lshlrev_b32 v34, 16, v111
  v_and_b32 v35, 0xffff0000, v111
  v_pk_fma_f32 v[28:29], v[28:29], v[188:189], v[196:197]
  v_pk_fma_f32 v[30:31], v[30:31], v[190:191], v[198:199]
  v_pk_fma_f32 v[32:33], v[32:33], v[192:193], v[200:201]
  v_pk_fma_f32 v[34:35], v[34:35], v[194:195], v[202:203]
  v_cvt_pk_bf16_f32 v36, v28, v29
  v_cvt_pk_bf16_f32 v37, v30, v31
  v_cvt_pk_bf16_f32 v38, v32, v33
  v_cvt_pk_bf16_f32 v39, v34, v35
  ds_write_b128 v12, v[36:39] offset:8192
  v_lshlrev_b32 v16, 16, v112
  v_and_b32 v17, 0xffff0000, v112
  v_lshlrev_b32 v18, 16, v113
  v_and_b32 v19, 0xffff0000, v113
  v_lshlrev_b32 v20, 16, v114
  v_and_b32 v21, 0xffff0000, v114
  v_lshlrev_b32 v22, 16, v115
  v_and_b32 v23, 0xffff0000, v115
  v_pk_fma_f32 v[16:17], v[16:17], v[188:189], v[196:197]
  v_pk_fma_f32 v[18:19], v[18:19], v[190:191], v[198:199]
  v_pk_fma_f32 v[20:21], v[20:21], v[192:193], v[200:201]
  v_pk_fma_f32 v[22:23], v[22:23], v[194:195], v[202:203]
  v_cvt_pk_bf16_f32 v24, v16, v17
  v_cvt_pk_bf16_f32 v25, v18, v19
  v_cvt_pk_bf16_f32 v26, v20, v21
  v_cvt_pk_bf16_f32 v27, v22, v23
  ds_write_b128 v12, v[24:27] offset:26624
  buffer_load_dwordx4 a[128:131], v9, s[16:19], s41 offen offset:2048
  buffer_load_dwordx4 a[200:203], v9, s[16:19], s42 offen offset:2048
  buffer_load_dwordx4 a[60:63], v9, s[16:19], s40 offen offset:3072
  s_add_u32 s40, s40, 4096
  buffer_load_dwordx4 a[132:135], v9, s[16:19], s41 offen offset:3072
  s_add_u32 s41, s41, 4096
  buffer_load_dwordx4 a[204:207], v9, s[16:19], s42 offen offset:3072
  s_add_u32 s42, s42, 4096
  buffer_load_dwordx4 a[64:67], v9, s[16:19], s40 offen offset:0
  buffer_load_dwordx4 a[136:139], v9, s[16:19], s41 offen offset:0
  buffer_load_dwordx4 a[208:211], v9, s[16:19], s42 offen offset:0
  buffer_load_dwordx4 a[68:71], v9, s[16:19], s40 offen offset:1024
  s_waitcnt vmcnt(52)
  v_lshlrev_b32 v16, 16, v116
  v_and_b32 v17, 0xffff0000, v116
  v_lshlrev_b32 v18, 16, v117
  v_and_b32 v19, 0xffff0000, v117
  v_lshlrev_b32 v20, 16, v118
  v_and_b32 v21, 0xffff0000, v118
  v_lshlrev_b32 v22, 16, v119
  v_and_b32 v23, 0xffff0000, v119
  v_pk_fma_f32 v[16:17], v[16:17], v[204:205], v[212:213]
  v_pk_fma_f32 v[18:19], v[18:19], v[206:207], v[214:215]
  v_pk_fma_f32 v[20:21], v[20:21], v[208:209], v[216:217]
  v_pk_fma_f32 v[22:23], v[22:23], v[210:211], v[218:219]
  v_cvt_pk_bf16_f32 v24, v16, v17
  v_cvt_pk_bf16_f32 v25, v18, v19
  v_cvt_pk_bf16_f32 v26, v20, v21
  v_cvt_pk_bf16_f32 v27, v22, v23
  ds_write_b128 v10, v[24:27] offset:12288
  v_lshlrev_b32 v28, 16, v120
  v_and_b32 v29, 0xffff0000, v120
  v_lshlrev_b32 v30, 16, v121
  v_and_b32 v31, 0xffff0000, v121
  v_lshlrev_b32 v32, 16, v122
  v_and_b32 v33, 0xffff0000, v122
  v_lshlrev_b32 v34, 16, v123
  v_and_b32 v35, 0xffff0000, v123
  v_pk_fma_f32 v[28:29], v[28:29], v[204:205], v[212:213]
  v_pk_fma_f32 v[30:31], v[30:31], v[206:207], v[214:215]
  v_pk_fma_f32 v[32:33], v[32:33], v[208:209], v[216:217]
  v_pk_fma_f32 v[34:35], v[34:35], v[210:211], v[218:219]
  v_cvt_pk_bf16_f32 v36, v28, v29
  v_cvt_pk_bf16_f32 v37, v30, v31
  v_cvt_pk_bf16_f32 v38, v32, v33
  v_cvt_pk_bf16_f32 v39, v34, v35
  ds_write_b128 v10, v[36:39] offset:30720
  v_lshlrev_b32 v16, 16, v124
  v_and_b32 v17, 0xffff0000, v124
  v_lshlrev_b32 v18, 16, v125
  v_and_b32 v19, 0xffff0000, v125
  v_lshlrev_b32 v20, 16, v126
  v_and_b32 v21, 0xffff0000, v126
  v_lshlrev_b32 v22, 16, v127
  v_and_b32 v23, 0xffff0000, v127
  v_pk_fma_f32 v[16:17], v[16:17], v[204:205], v[212:213]
  v_pk_fma_f32 v[18:19], v[18:19], v[206:207], v[214:215]
  v_pk_fma_f32 v[20:21], v[20:21], v[208:209], v[216:217]
  v_pk_fma_f32 v[22:23], v[22:23], v[210:211], v[218:219]
  v_cvt_pk_bf16_f32 v24, v16, v17
  v_cvt_pk_bf16_f32 v25, v18, v19
  v_cvt_pk_bf16_f32 v26, v20, v21
  v_cvt_pk_bf16_f32 v27, v22, v23
  ds_write_b128 v10, v[24:27] offset:49152
  v_lshlrev_b32 v28, 16, v128
  v_and_b32 v29, 0xffff0000, v128
  v_lshlrev_b32 v30, 16, v129
  v_and_b32 v31, 0xffff0000, v129
  v_lshlrev_b32 v32, 16, v130
  v_and_b32 v33, 0xffff0000, v130
  v_lshlrev_b32 v34, 16, v131
  v_and_b32 v35, 0xffff0000, v131
  v_pk_fma_f32 v[28:29], v[28:29], v[204:205], v[212:213]
  v_pk_fma_f32 v[30:31], v[30:31], v[206:207], v[214:215]
  v_pk_fma_f32 v[32:33], v[32:33], v[208:209], v[216:217]
  v_pk_fma_f32 v[34:35], v[34:35], v[210:211], v[218:219]
  v_cvt_pk_bf16_f32 v36, v28, v29
  v_cvt_pk_bf16_f32 v37, v30, v31
  v_cvt_pk_bf16_f32 v38, v32, v33
  v_cvt_pk_bf16_f32 v39, v34, v35
  ds_write_b128 v12, v[36:39] offset:12288
  v_lshlrev_b32 v16, 16, v132
  v_and_b32 v17, 0xffff0000, v132
  v_lshlrev_b32 v18, 16, v133
  v_and_b32 v19, 0xffff0000, v133
  v_lshlrev_b32 v20, 16, v134
  v_and_b32 v21, 0xffff0000, v134
  v_lshlrev_b32 v22, 16, v135
  v_and_b32 v23, 0xffff0000, v135
  v_pk_fma_f32 v[16:17], v[16:17], v[204:205], v[212:213]
  v_pk_fma_f32 v[18:19], v[18:19], v[206:207], v[214:215]
  v_pk_fma_f32 v[20:21], v[20:21], v[208:209], v[216:217]
  v_pk_fma_f32 v[22:23], v[22:23], v[210:211], v[218:219]
  v_cvt_pk_bf16_f32 v24, v16, v17
  v_cvt_pk_bf16_f32 v25, v18, v19
  v_cvt_pk_bf16_f32 v26, v20, v21
  v_cvt_pk_bf16_f32 v27, v22, v23
  ds_write_b128 v12, v[24:27] offset:30720
  buffer_load_dwordx4 a[140:143], v9, s[16:19], s41 offen offset:1024
  buffer_load_dwordx4 a[212:215], v9, s[16:19], s42 offen offset:1024
  s_waitcnt lgkmcnt(0)
  s_barrier
  ds_read_b128 v[16:19], v13 offset:0
  ds_read_b128 v[20:23], v13 offset:18432
  ds_read_b128 v[24:27], v13 offset:36864
  ds_read_b128 v[28:31], v14 offset:0
  ds_read_b128 v[32:35], v14 offset:18432
  s_waitcnt vmcnt(51) lgkmcnt(0)
  v_mfma_f32_16x16x32_bf16 v[128:131], a[0:3], v[16:19], 0
  v_mfma_f32_16x16x32_bf16 v[132:135], a[0:3], v[20:23], 0
  v_mfma_f32_16x16x32_bf16 v[136:139], a[0:3], v[24:27], 0
  v_mfma_f32_16x16x32_bf16 v[140:143], a[0:3], v[28:31], 0
  v_mfma_f32_16x16x32_bf16 v[144:147], a[0:3], v[32:35], 0
  ds_read_b128 v[36:39], v13 offset:1024
  ds_read_b128 v[40:43], v13 offset:19456
  ds_read_b128 v[44:47], v13 offset:37888
  ds_read_b128 v[48:51], v14 offset:1024
  ds_read_b128 v[52:55], v14 offset:19456
  v_mfma_f32_16x16x32_bf16 v[148:151], a[72:75], v[16:19], 0
  v_mfma_f32_16x16x32_bf16 v[152:155], a[72:75], v[20:23], 0
  v_mfma_f32_16x16x32_bf16 v[156:159], a[72:75], v[24:27], 0
  v_mfma_f32_16x16x32_bf16 v[160:163], a[72:75], v[28:31], 0
  v_mfma_f32_16x16x32_bf16 v[164:167], a[72:75], v[32:35], 0
  v_mfma_f32_16x16x32_bf16 v[168:171], a[144:147], v[16:19], 0
  v_mfma_f32_16x16x32_bf16 v[172:175], a[144:147], v[20:23], 0
  v_mfma_f32_16x16x32_bf16 v[176:179], a[144:147], v[24:27], 0
  v_mfma_f32_16x16x32_bf16 v[180:183], a[144:147], v[28:31], 0
  v_mfma_f32_16x16x32_bf16 v[184:187], a[144:147], v[32:35], 0
  s_waitcnt vmcnt(48) lgkmcnt(0)
  v_mfma_f32_16x16x32_bf16 v[128:131], a[4:7], v[36:39], v[128:131]
  v_mfma_f32_16x16x32_bf16 v[132:135], a[4:7], v[40:43], v[132:135]
  v_mfma_f32_16x16x32_bf16 v[136:139], a[4:7], v[44:47], v[136:139]
  v_mfma_f32_16x16x32_bf16 v[140:143], a[4:7], v[48:51], v[140:143]
  v_mfma_f32_16x16x32_bf16 v[144:147], a[4:7], v[52:55], v[144:147]
  ds_read_b128 v[16:19], v13 offset:2048
  ds_read_b128 v[20:23], v13 offset:20480
  ds_read_b128 v[24:27], v13 offset:38912
  ds_read_b128 v[28:31], v14 offset:2048
  ds_read_b128 v[32:35], v14 offset:20480
  v_mfma_f32_16x16x32_bf16 v[148:151], a[76:79], v[36:39], v[148:151]
  v_mfma_f32_16x16x32_bf16 v[152:155], a[76:79], v[40:43], v[152:155]
  v_mfma_f32_16x16x32_bf16 v[156:159], a[76:79], v[44:47], v[156:159]
  v_mfma_f32_16x16x32_bf16 v[160:163], a[76:79], v[48:51], v[160:163]
  v_mfma_f32_16x16x32_bf16 v[164:167], a[76:79], v[52:55], v[164:167]
  v_mfma_f32_16x16x32_bf16 v[168:171], a[148:151], v[36:39], v[168:171]
  v_mfma_f32_16x16x32_bf16 v[172:175], a[148:151], v[40:43], v[172:175]
  v_mfma_f32_16x16x32_bf16 v[176:179], a[148:151], v[44:47], v[176:179]
  v_mfma_f32_16x16x32_bf16 v[180:183], a[148:151], v[48:51], v[180:183]
  v_mfma_f32_16x16x32_bf16 v[184:187], a[148:151], v[52:55], v[184:187]
  s_waitcnt vmcnt(45) lgkmcnt(0)
  v_mfma_f32_16x16x32_bf16 v[128:131], a[8:11], v[16:19], v[128:131]
  v_mfma_f32_16x16x32_bf16 v[132:135], a[8:11], v[20:23], v[132:135]
  v_mfma_f32_16x16x32_bf16 v[136:139], a[8:11], v[24:27], v[136:139]
  v_mfma_f32_16x16x32_bf16 v[140:143], a[8:11], v[28:31], v[140:143]
  v_mfma_f32_16x16x32_bf16 v[144:147], a[8:11], v[32:35], v[144:147]
  ds_read_b128 v[36:39], v13 offset:3072
  ds_read_b128 v[40:43], v13 offset:21504
  ds_read_b128 v[44:47], v13 offset:39936
  ds_read_b128 v[48:51], v14 offset:3072
  ds_read_b128 v[52:55], v14 offset:21504
  v_mfma_f32_16x16x32_bf16 v[148:151], a[80:83], v[16:19], v[148:151]
  v_mfma_f32_16x16x32_bf16 v[152:155], a[80:83], v[20:23], v[152:155]
  v_mfma_f32_16x16x32_bf16 v[156:159], a[80:83], v[24:27], v[156:159]
  v_mfma_f32_16x16x32_bf16 v[160:163], a[80:83], v[28:31], v[160:163]
  v_mfma_f32_16x16x32_bf16 v[164:167], a[80:83], v[32:35], v[164:167]
  v_mfma_f32_16x16x32_bf16 v[168:171], a[152:155], v[16:19], v[168:171]
  v_mfma_f32_16x16x32_bf16 v[172:175], a[152:155], v[20:23], v[172:175]
  v_mfma_f32_16x16x32_bf16 v[176:179], a[152:155], v[24:27], v[176:179]
  v_mfma_f32_16x16x32_bf16 v[180:183], a[152:155], v[28:31], v[180:183]
  v_mfma_f32_16x16x32_bf16 v[184:187], a[152:155], v[32:35], v[184:187]
  buffer_load_dword v7, v4, s[60:63], 0 offen
  s_waitcnt vmcnt(43) lgkmcnt(0)
  v_mfma_f32_16x16x32_bf16 v[128:131], a[12:15], v[36:39], v[128:131]
  v_mfma_f32_16x16x32_bf16 v[132:135], a[12:15], v[40:43], v[132:135]
  v_mfma_f32_16x16x32_bf16 v[136:139], a[12:15], v[44:47], v[136:139]
  v_mfma_f32_16x16x32_bf16 v[140:143], a[12:15], v[48:51], v[140:143]
  v_mfma_f32_16x16x32_bf16 v[144:147], a[12:15], v[52:55], v[144:147]
  ds_read_b128 v[16:19], v13 offset:4096
  ds_read_b128 v[20:23], v13 offset:22528
  ds_read_b128 v[24:27], v13 offset:40960
  ds_read_b128 v[28:31], v14 offset:4096
  ds_read_b128 v[32:35], v14 offset:22528
  v_mfma_f32_16x16x32_bf16 v[148:151], a[84:87], v[36:39], v[148:151]
  v_mfma_f32_16x16x32_bf16 v[152:155], a[84:87], v[40:43], v[152:155]
  v_mfma_f32_16x16x32_bf16 v[156:159], a[84:87], v[44:47], v[156:159]
  v_mfma_f32_16x16x32_bf16 v[160:163], a[84:87], v[48:51], v[160:163]
  v_mfma_f32_16x16x32_bf16 v[164:167], a[84:87], v[52:55], v[164:167]
  v_mfma_f32_16x16x32_bf16 v[168:171], a[156:159], v[36:39], v[168:171]
  v_mfma_f32_16x16x32_bf16 v[172:175], a[156:159], v[40:43], v[172:175]
  v_mfma_f32_16x16x32_bf16 v[176:179], a[156:159], v[44:47], v[176:179]
  v_mfma_f32_16x16x32_bf16 v[180:183], a[156:159], v[48:51], v[180:183]
  v_mfma_f32_16x16x32_bf16 v[184:187], a[156:159], v[52:55], v[184:187]
  s_waitcnt vmcnt(40) lgkmcnt(0)
  v_mfma_f32_16x16x32_bf16 v[128:131], a[16:19], v[16:19], v[128:131]
  v_mfma_f32_16x16x32_bf16 v[132:135], a[16:19], v[20:23], v[132:135]
  v_mfma_f32_16x16x32_bf16 v[136:139], a[16:19], v[24:27], v[136:139]
  v_mfma_f32_16x16x32_bf16 v[140:143], a[16:19], v[28:31], v[140:143]
  v_mfma_f32_16x16x32_bf16 v[144:147], a[16:19], v[32:35], v[144:147]
  ds_read_b128 v[36:39], v13 offset:5120
  ds_read_b128 v[40:43], v13 offset:23552
  ds_read_b128 v[44:47], v13 offset:41984
  ds_read_b128 v[48:51], v14 offset:5120
  ds_read_b128 v[52:55], v14 offset:23552
  v_mfma_f32_16x16x32_bf16 v[148:151], a[88:91], v[16:19], v[148:151]
  v_mfma_f32_16x16x32_bf16 v[152:155], a[88:91], v[20:23], v[152:155]
  v_mfma_f32_16x16x32_bf16 v[156:159], a[88:91], v[24:27], v[156:159]
  v_mfma_f32_16x16x32_bf16 v[160:163], a[88:91], v[28:31], v[160:163]
  v_mfma_f32_16x16x32_bf16 v[164:167], a[88:91], v[32:35], v[164:167]
  v_mfma_f32_16x16x32_bf16 v[168:171], a[160:163], v[16:19], v[168:171]
  v_mfma_f32_16x16x32_bf16 v[172:175], a[160:163], v[20:23], v[172:175]
  v_mfma_f32_16x16x32_bf16 v[176:179], a[160:163], v[24:27], v[176:179]
  v_mfma_f32_16x16x32_bf16 v[180:183], a[160:163], v[28:31], v[180:183]
  v_mfma_f32_16x16x32_bf16 v[184:187], a[160:163], v[32:35], v[184:187]
  s_waitcnt vmcnt(37) lgkmcnt(0)
  v_mfma_f32_16x16x32_bf16 v[128:131], a[20:23], v[36:39], v[128:131]
  v_mfma_f32_16x16x32_bf16 v[132:135], a[20:23], v[40:43], v[132:135]
  v_mfma_f32_16x16x32_bf16 v[136:139], a[20:23], v[44:47], v[136:139]
  v_mfma_f32_16x16x32_bf16 v[140:143], a[20:23], v[48:51], v[140:143]
  v_mfma_f32_16x16x32_bf16 v[144:147], a[20:23], v[52:55], v[144:147]
  ds_read_b128 v[16:19], v13 offset:6144
  ds_read_b128 v[20:23], v13 offset:24576
  ds_read_b128 v[24:27], v13 offset:43008
  ds_read_b128 v[28:31], v14 offset:6144
  ds_read_b128 v[32:35], v14 offset:24576
  v_mfma_f32_16x16x32_bf16 v[148:151], a[92:95], v[36:39], v[148:151]
  v_mfma_f32_16x16x32_bf16 v[152:155], a[92:95], v[40:43], v[152:155]
  v_mfma_f32_16x16x32_bf16 v[156:159], a[92:95], v[44:47], v[156:159]
  v_mfma_f32_16x16x32_bf16 v[160:163], a[92:95], v[48:51], v[160:163]
  v_mfma_f32_16x16x32_bf16 v[164:167], a[92:95], v[52:55], v[164:167]
  v_mfma_f32_16x16x32_bf16 v[168:171], a[164:167], v[36:39], v[168:171]
  v_mfma_f32_16x16x32_bf16 v[172:175], a[164:167], v[40:43], v[172:175]
  v_mfma_f32_16x16x32_bf16 v[176:179], a[164:167], v[44:47], v[176:179]
  v_mfma_f32_16x16x32_bf16 v[180:183], a[164:167], v[48:51], v[180:183]
  v_mfma_f32_16x16x32_bf16 v[184:187], a[164:167], v[52:55], v[184:187]
  s_waitcnt vmcnt(34) lgkmcnt(0)
  v_mfma_f32_16x16x32_bf16 v[128:131], a[24:27], v[16:19], v[128:131]
  v_mfma_f32_16x16x32_bf16 v[132:135], a[24:27], v[20:23], v[132:135]
  v_mfma_f32_16x16x32_bf16 v[136:139], a[24:27], v[24:27], v[136:139]
  v_mfma_f32_16x16x32_bf16 v[140:143], a[24:27], v[28:31], v[140:143]
  v_mfma_f32_16x16x32_bf16 v[144:147], a[24:27], v[32:35], v[144:147]
  ds_read_b128 v[36:39], v13 offset:7168
  ds_read_b128 v[40:43], v13 offset:25600
  ds_read_b128 v[44:47], v13 offset:44032
  ds_read_b128 v[48:51], v14 offset:7168
  ds_read_b128 v[52:55], v14 offset:25600
  v_mfma_f32_16x16x32_bf16 v[148:151], a[96:99], v[16:19], v[148:151]
  v_mfma_f32_16x16x32_bf16 v[152:155], a[96:99], v[20:23], v[152:155]
  v_mfma_f32_16x16x32_bf16 v[156:159], a[96:99], v[24:27], v[156:159]
  v_mfma_f32_16x16x32_bf16 v[160:163], a[96:99], v[28:31], v[160:163]
  v_mfma_f32_16x16x32_bf16 v[164:167], a[96:99], v[32:35], v[164:167]
  v_mfma_f32_16x16x32_bf16 v[168:171], a[168:171], v[16:19], v[168:171]
  v_mfma_f32_16x16x32_bf16 v[172:175], a[168:171], v[20:23], v[172:175]
  v_mfma_f32_16x16x32_bf16 v[176:179], a[168:171], v[24:27], v[176:179]
  v_mfma_f32_16x16x32_bf16 v[180:183], a[168:171], v[28:31], v[180:183]
  v_mfma_f32_16x16x32_bf16 v[184:187], a[168:171], v[32:35], v[184:187]
  s_waitcnt vmcnt(31) lgkmcnt(0)
  v_mfma_f32_16x16x32_bf16 v[128:131], a[28:31], v[36:39], v[128:131]
  v_mfma_f32_16x16x32_bf16 v[132:135], a[28:31], v[40:43], v[132:135]
  v_mfma_f32_16x16x32_bf16 v[136:139], a[28:31], v[44:47], v[136:139]
  v_mfma_f32_16x16x32_bf16 v[140:143], a[28:31], v[48:51], v[140:143]
  v_mfma_f32_16x16x32_bf16 v[144:147], a[28:31], v[52:55], v[144:147]
  ds_read_b128 v[16:19], v13 offset:8192
  ds_read_b128 v[20:23], v13 offset:26624
  ds_read_b128 v[24:27], v13 offset:45056
  ds_read_b128 v[28:31], v14 offset:8192
  ds_read_b128 v[32:35], v14 offset:26624
  v_mfma_f32_16x16x32_bf16 v[148:151], a[100:103], v[36:39], v[148:151]
  v_mfma_f32_16x16x32_bf16 v[152:155], a[100:103], v[40:43], v[152:155]
  v_mfma_f32_16x16x32_bf16 v[156:159], a[100:103], v[44:47], v[156:159]
  v_mfma_f32_16x16x32_bf16 v[160:163], a[100:103], v[48:51], v[160:163]
  v_mfma_f32_16x16x32_bf16 v[164:167], a[100:103], v[52:55], v[164:167]
  v_mfma_f32_16x16x32_bf16 v[168:171], a[172:175], v[36:39], v[168:171]
  v_mfma_f32_16x16x32_bf16 v[172:175], a[172:175], v[40:43], v[172:175]
  v_mfma_f32_16x16x32_bf16 v[176:179], a[172:175], v[44:47], v[176:179]
  v_mfma_f32_16x16x32_bf16 v[180:183], a[172:175], v[48:51], v[180:183]
  v_mfma_f32_16x16x32_bf16 v[184:187], a[172:175], v[52:55], v[184:187]
  s_waitcnt vmcnt(28) lgkmcnt(0)
  v_mfma_f32_16x16x32_bf16 v[128:131], a[32:35], v[16:19], v[128:131]
  v_mfma_f32_16x16x32_bf16 v[132:135], a[32:35], v[20:23], v[132:135]
  v_mfma_f32_16x16x32_bf16 v[136:139], a[32:35], v[24:27], v[136:139]
  v_mfma_f32_16x16x32_bf16 v[140:143], a[32:35], v[28:31], v[140:143]
  v_mfma_f32_16x16x32_bf16 v[144:147], a[32:35], v[32:35], v[144:147]
  ds_read_b128 v[36:39], v13 offset:9216
  ds_read_b128 v[40:43], v13 offset:27648
  ds_read_b128 v[44:47], v13 offset:46080
  ds_read_b128 v[48:51], v14 offset:9216
  ds_read_b128 v[52:55], v14 offset:27648
  v_mfma_f32_16x16x32_bf16 v[148:151], a[104:107], v[16:19], v[148:151]
  v_mfma_f32_16x16x32_bf16 v[152:155], a[104:107], v[20:23], v[152:155]
  v_mfma_f32_16x16x32_bf16 v[156:159], a[104:107], v[24:27], v[156:159]
  v_mfma_f32_16x16x32_bf16 v[160:163], a[104:107], v[28:31], v[160:163]
  v_mfma_f32_16x16x32_bf16 v[164:167], a[104:107], v[32:35], v[164:167]
  v_mfma_f32_16x16x32_bf16 v[168:171], a[176:179], v[16:19], v[168:171]
  v_mfma_f32_16x16x32_bf16 v[172:175], a[176:179], v[20:23], v[172:175]
  v_mfma_f32_16x16x32_bf16 v[176:179], a[176:179], v[24:27], v[176:179]
  v_mfma_f32_16x16x32_bf16 v[180:183], a[176:179], v[28:31], v[180:183]
  v_mfma_f32_16x16x32_bf16 v[184:187], a[176:179], v[32:35], v[184:187]
  s_waitcnt vmcnt(25) lgkmcnt(0)
  v_mfma_f32_16x16x32_bf16 v[128:131], a[36:39], v[36:39], v[128:131]
  v_mfma_f32_16x16x32_bf16 v[132:135], a[36:39], v[40:43], v[132:135]
  v_mfma_f32_16x16x32_bf16 v[136:139], a[36:39], v[44:47], v[136:139]
  v_mfma_f32_16x16x32_bf16 v[140:143], a[36:39], v[48:51], v[140:143]
  v_mfma_f32_16x16x32_bf16 v[144:147], a[36:39], v[52:55], v[144:147]
  ds_read_b128 v[16:19], v13 offset:10240
  ds_read_b128 v[20:23], v13 offset:28672
  ds_read_b128 v[24:27], v13 offset:47104
  ds_read_b128 v[28:31], v14 offset:10240
  ds_read_b128 v[32:35], v14 offset:28672
  v_mfma_f32_16x16x32_bf16 v[148:151], a[108:111], v[36:39], v[148:151]
  v_mfma_f32_16x16x32_bf16 v[152:155], a[108:111], v[40:43], v[152:155]
  v_mfma_f32_16x16x32_bf16 v[156:159], a[108:111], v[44:47], v[156:159]
  v_mfma_f32_16x16x32_bf16 v[160:163], a[108:111], v[48:51], v[160:163]
  v_mfma_f32_16x16x32_bf16 v[164:167], a[108:111], v[52:55], v[164:167]
  v_mfma_f32_16x16x32_bf16 v[168:171], a[180:183], v[36:39], v[168:171]
  v_mfma_f32_16x16x32_bf16 v[172:175], a[180:183], v[40:43], v[172:175]
  v_mfma_f32_16x16x32_bf16 v[176:179], a[180:183], v[44:47], v[176:179]
  v_mfma_f32_16x16x32_bf16 v[180:183], a[180:183], v[48:51], v[180:183]
  v_mfma_f32_16x16x32_bf16 v[184:187], a[180:183], v[52:55], v[184:187]
  s_waitcnt vmcnt(22) lgkmcnt(0)
  v_mfma_f32_16x16x32_bf16 v[128:131], a[40:43], v[16:19], v[128:131]
  v_mfma_f32_16x16x32_bf16 v[132:135], a[40:43], v[20:23], v[132:135]
  v_mfma_f32_16x16x32_bf16 v[136:139], a[40:43], v[24:27], v[136:139]
  v_mfma_f32_16x16x32_bf16 v[140:143], a[40:43], v[28:31], v[140:143]
  v_mfma_f32_16x16x32_bf16 v[144:147], a[40:43], v[32:35], v[144:147]
  ds_read_b128 v[36:39], v13 offset:11264
  ds_read_b128 v[40:43], v13 offset:29696
  ds_read_b128 v[44:47], v13 offset:48128
  ds_read_b128 v[48:51], v14 offset:11264
  ds_read_b128 v[52:55], v14 offset:29696
  v_mfma_f32_16x16x32_bf16 v[148:151], a[112:115], v[16:19], v[148:151]
  v_mfma_f32_16x16x32_bf16 v[152:155], a[112:115], v[20:23], v[152:155]
  v_mfma_f32_16x16x32_bf16 v[156:159], a[112:115], v[24:27], v[156:159]
  v_mfma_f32_16x16x32_bf16 v[160:163], a[112:115], v[28:31], v[160:163]
  v_mfma_f32_16x16x32_bf16 v[164:167], a[112:115], v[32:35], v[164:167]
  v_mfma_f32_16x16x32_bf16 v[168:171], a[184:187], v[16:19], v[168:171]
  v_mfma_f32_16x16x32_bf16 v[172:175], a[184:187], v[20:23], v[172:175]
  v_mfma_f32_16x16x32_bf16 v[176:179], a[184:187], v[24:27], v[176:179]
  v_mfma_f32_16x16x32_bf16 v[180:183], a[184:187], v[28:31], v[180:183]
  v_mfma_f32_16x16x32_bf16 v[184:187], a[184:187], v[32:35], v[184:187]
  s_waitcnt vmcnt(19) lgkmcnt(0)
  v_mfma_f32_16x16x32_bf16 v[128:131], a[44:47], v[36:39], v[128:131]
  v_mfma_f32_16x16x32_bf16 v[132:135], a[44:47], v[40:43], v[132:135]
  v_mfma_f32_16x16x32_bf16 v[136:139], a[44:47], v[44:47], v[136:139]
  v_mfma_f32_16x16x32_bf16 v[140:143], a[44:47], v[48:51], v[140:143]
  v_mfma_f32_16x16x32_bf16 v[144:147], a[44:47], v[52:55], v[144:147]
  ds_read_b128 v[16:19], v13 offset:12288
  ds_read_b128 v[20:23], v13 offset:30720
  ds_read_b128 v[24:27], v13 offset:49152
  ds_read_b128 v[28:31], v14 offset:12288
  ds_read_b128 v[32:35], v14 offset:30720
  v_mfma_f32_16x16x32_bf16 v[148:151], a[116:119], v[36:39], v[148:151]
  v_mfma_f32_16x16x32_bf16 v[152:155], a[116:119], v[40:43], v[152:155]
  v_mfma_f32_16x16x32_bf16 v[156:159], a[116:119], v[44:47], v[156:159]
  v_mfma_f32_16x16x32_bf16 v[160:163], a[116:119], v[48:51], v[160:163]
  v_mfma_f32_16x16x32_bf16 v[164:167], a[116:119], v[52:55], v[164:167]
  v_mfma_f32_16x16x32_bf16 v[168:171], a[188:191], v[36:39], v[168:171]
  v_mfma_f32_16x16x32_bf16 v[172:175], a[188:191], v[40:43], v[172:175]
  v_mfma_f32_16x16x32_bf16 v[176:179], a[188:191], v[44:47], v[176:179]
  v_mfma_f32_16x16x32_bf16 v[180:183], a[188:191], v[48:51], v[180:183]
  v_mfma_f32_16x16x32_bf16 v[184:187], a[188:191], v[52:55], v[184:187]
  s_waitcnt vmcnt(16) lgkmcnt(0)
  v_mfma_f32_16x16x32_bf16 v[128:131], a[48:51], v[16:19], v[128:131]
  v_mfma_f32_16x16x32_bf16 v[132:135], a[48:51], v[20:23], v[132:135]
  v_mfma_f32_16x16x32_bf16 v[136:139], a[48:51], v[24:27], v[136:139]
  v_mfma_f32_16x16x32_bf16 v[140:143], a[48:51], v[28:31], v[140:143]
  v_mfma_f32_16x16x32_bf16 v[144:147], a[48:51], v[32:35], v[144:147]
  ds_read_b128 v[36:39], v13 offset:13312
  ds_read_b128 v[40:43], v13 offset:31744
  ds_read_b128 v[44:47], v13 offset:50176
  ds_read_b128 v[48:51], v14 offset:13312
  ds_read_b128 v[52:55], v14 offset:31744
  v_mfma_f32_16x16x32_bf16 v[148:151], a[120:123], v[16:19], v[148:151]
  v_mfma_f32_16x16x32_bf16 v[152:155], a[120:123], v[20:23], v[152:155]
  v_mfma_f32_16x16x32_bf16 v[156:159], a[120:123], v[24:27], v[156:159]
  v_mfma_f32_16x16x32_bf16 v[160:163], a[120:123], v[28:31], v[160:163]
  v_mfma_f32_16x16x32_bf16 v[164:167], a[120:123], v[32:35], v[164:167]
  v_mfma_f32_16x16x32_bf16 v[168:171], a[192:195], v[16:19], v[168:171]
  v_mfma_f32_16x16x32_bf16 v[172:175], a[192:195], v[20:23], v[172:175]
  v_mfma_f32_16x16x32_bf16 v[176:179], a[192:195], v[24:27], v[176:179]
  v_mfma_f32_16x16x32_bf16 v[180:183], a[192:195], v[28:31], v[180:183]
  v_mfma_f32_16x16x32_bf16 v[184:187], a[192:195], v[32:35], v[184:187]
  s_waitcnt vmcnt(13) lgkmcnt(0)
  v_mfma_f32_16x16x32_bf16 v[128:131], a[52:55], v[36:39], v[128:131]
  v_mfma_f32_16x16x32_bf16 v[132:135], a[52:55], v[40:43], v[132:135]
  v_mfma_f32_16x16x32_bf16 v[136:139], a[52:55], v[44:47], v[136:139]
  v_mfma_f32_16x16x32_bf16 v[140:143], a[52:55], v[48:51], v[140:143]
  v_mfma_f32_16x16x32_bf16 v[144:147], a[52:55], v[52:55], v[144:147]
  ds_read_b128 v[16:19], v13 offset:14336
  ds_read_b128 v[20:23], v13 offset:32768
  ds_read_b128 v[24:27], v13 offset:51200
  ds_read_b128 v[28:31], v14 offset:14336
  ds_read_b128 v[32:35], v14 offset:32768
  v_mfma_f32_16x16x32_bf16 v[148:151], a[124:127], v[36:39], v[148:151]
  v_mfma_f32_16x16x32_bf16 v[152:155], a[124:127], v[40:43], v[152:155]
  v_mfma_f32_16x16x32_bf16 v[156:159], a[124:127], v[44:47], v[156:159]
  v_mfma_f32_16x16x32_bf16 v[160:163], a[124:127], v[48:51], v[160:163]
  v_mfma_f32_16x16x32_bf16 v[164:167], a[124:127], v[52:55], v[164:167]
  v_mfma_f32_16x16x32_bf16 v[168:171], a[196:199], v[36:39], v[168:171]
  v_mfma_f32_16x16x32_bf16 v[172:175], a[196:199], v[40:43], v[172:175]
  v_mfma_f32_16x16x32_bf16 v[176:179], a[196:199], v[44:47], v[176:179]
  v_mfma_f32_16x16x32_bf16 v[180:183], a[196:199], v[48:51], v[180:183]
  v_mfma_f32_16x16x32_bf16 v[184:187], a[196:199], v[52:55], v[184:187]
  s_waitcnt vmcnt(10) lgkmcnt(0)
  v_mfma_f32_16x16x32_bf16 v[128:131], a[56:59], v[16:19], v[128:131]
  v_mfma_f32_16x16x32_bf16 v[132:135], a[56:59], v[20:23], v[132:135]
  v_mfma_f32_16x16x32_bf16 v[136:139], a[56:59], v[24:27], v[136:139]
  v_mfma_f32_16x16x32_bf16 v[140:143], a[56:59], v[28:31], v[140:143]
  v_mfma_f32_16x16x32_bf16 v[144:147], a[56:59], v[32:35], v[144:147]
  ds_read_b128 v[36:39], v13 offset:15360
  ds_read_b128 v[40:43], v13 offset:33792
  ds_read_b128 v[44:47], v13 offset:52224
  ds_read_b128 v[48:51], v14 offset:15360
  ds_read_b128 v[52:55], v14 offset:33792
  v_mfma_f32_16x16x32_bf16 v[148:151], a[128:131], v[16:19], v[148:151]
  v_mfma_f32_16x16x32_bf16 v[152:155], a[128:131], v[20:23], v[152:155]
  v_mfma_f32_16x16x32_bf16 v[156:159], a[128:131], v[24:27], v[156:159]
  v_mfma_f32_16x16x32_bf16 v[160:163], a[128:131], v[28:31], v[160:163]
  v_mfma_f32_16x16x32_bf16 v[164:167], a[128:131], v[32:35], v[164:167]
  v_mfma_f32_16x16x32_bf16 v[168:171], a[200:203], v[16:19], v[168:171]
  v_mfma_f32_16x16x32_bf16 v[172:175], a[200:203], v[20:23], v[172:175]
  v_mfma_f32_16x16x32_bf16 v[176:179], a[200:203], v[24:27], v[176:179]
  v_mfma_f32_16x16x32_bf16 v[180:183], a[200:203], v[28:31], v[180:183]
  v_mfma_f32_16x16x32_bf16 v[184:187], a[200:203], v[32:35], v[184:187]
  s_waitcnt vmcnt(7) lgkmcnt(0)
  v_mfma_f32_16x16x32_bf16 v[128:131], a[60:63], v[36:39], v[128:131]
  v_mfma_f32_16x16x32_bf16 v[132:135], a[60:63], v[40:43], v[132:135]
  v_mfma_f32_16x16x32_bf16 v[136:139], a[60:63], v[44:47], v[136:139]
  v_mfma_f32_16x16x32_bf16 v[140:143], a[60:63], v[48:51], v[140:143]
  v_mfma_f32_16x16x32_bf16 v[144:147], a[60:63], v[52:55], v[144:147]
  ds_read_b128 v[16:19], v13 offset:16384
  ds_read_b128 v[20:23], v13 offset:34816
  ds_read_b128 v[24:27], v13 offset:53248
  ds_read_b128 v[28:31], v14 offset:16384
  ds_read_b128 v[32:35], v14 offset:34816
  v_mfma_f32_16x16x32_bf16 v[148:151], a[132:135], v[36:39], v[148:151]
  v_mfma_f32_16x16x32_bf16 v[152:155], a[132:135], v[40:43], v[152:155]
  v_mfma_f32_16x16x32_bf16 v[156:159], a[132:135], v[44:47], v[156:159]
  v_mfma_f32_16x16x32_bf16 v[160:163], a[132:135], v[48:51], v[160:163]
  v_mfma_f32_16x16x32_bf16 v[164:167], a[132:135], v[52:55], v[164:167]
  v_mfma_f32_16x16x32_bf16 v[168:171], a[204:207], v[36:39], v[168:171]
  v_mfma_f32_16x16x32_bf16 v[172:175], a[204:207], v[40:43], v[172:175]
  v_mfma_f32_16x16x32_bf16 v[176:179], a[204:207], v[44:47], v[176:179]
  v_mfma_f32_16x16x32_bf16 v[180:183], a[204:207], v[48:51], v[180:183]
  v_mfma_f32_16x16x32_bf16 v[184:187], a[204:207], v[52:55], v[184:187]
  s_waitcnt vmcnt(4) lgkmcnt(0)
  v_mfma_f32_16x16x32_bf16 v[128:131], a[64:67], v[16:19], v[128:131]
  v_mfma_f32_16x16x32_bf16 v[132:135], a[64:67], v[20:23], v[132:135]
  v_mfma_f32_16x16x32_bf16 v[136:139], a[64:67], v[24:27], v[136:139]
  v_mfma_f32_16x16x32_bf16 v[140:143], a[64:67], v[28:31], v[140:143]
  v_mfma_f32_16x16x32_bf16 v[144:147], a[64:67], v[32:35], v[144:147]
  ds_read_b128 v[36:39], v13 offset:17408
  ds_read_b128 v[40:43], v13 offset:35840
  ds_read_b128 v[44:47], v13 offset:54272
  ds_read_b128 v[48:51], v14 offset:17408
  ds_read_b128 v[52:55], v14 offset:35840
  v_mfma_f32_16x16x32_bf16 v[148:151], a[136:139], v[16:19], v[148:151]
  v_mfma_f32_16x16x32_bf16 v[152:155], a[136:139], v[20:23], v[152:155]
  v_mfma_f32_16x16x32_bf16 v[156:159], a[136:139], v[24:27], v[156:159]
  v_mfma_f32_16x16x32_bf16 v[160:163], a[136:139], v[28:31], v[160:163]
  v_mfma_f32_16x16x32_bf16 v[164:167], a[136:139], v[32:35], v[164:167]
  v_mfma_f32_16x16x32_bf16 v[168:171], a[208:211], v[16:19], v[168:171]
  v_mfma_f32_16x16x32_bf16 v[172:175], a[208:211], v[20:23], v[172:175]
  v_mfma_f32_16x16x32_bf16 v[176:179], a[208:211], v[24:27], v[176:179]
  v_mfma_f32_16x16x32_bf16 v[180:183], a[208:211], v[28:31], v[180:183]
  v_mfma_f32_16x16x32_bf16 v[184:187], a[208:211], v[32:35], v[184:187]
  s_waitcnt vmcnt(1) lgkmcnt(0)
  v_mfma_f32_16x16x32_bf16 v[128:131], a[68:71], v[36:39], v[128:131]
  v_mfma_f32_16x16x32_bf16 v[132:135], a[68:71], v[40:43], v[132:135]
  v_mfma_f32_16x16x32_bf16 v[136:139], a[68:71], v[44:47], v[136:139]
  v_mfma_f32_16x16x32_bf16 v[140:143], a[68:71], v[48:51], v[140:143]
  v_mfma_f32_16x16x32_bf16 v[144:147], a[68:71], v[52:55], v[144:147]
  v_mfma_f32_16x16x32_bf16 v[148:151], a[140:143], v[36:39], v[148:151]
  v_mfma_f32_16x16x32_bf16 v[152:155], a[140:143], v[40:43], v[152:155]
  v_mfma_f32_16x16x32_bf16 v[156:159], a[140:143], v[44:47], v[156:159]
  v_mfma_f32_16x16x32_bf16 v[160:163], a[140:143], v[48:51], v[160:163]
  v_mfma_f32_16x16x32_bf16 v[164:167], a[140:143], v[52:55], v[164:167]
  v_mfma_f32_16x16x32_bf16 v[168:171], a[212:215], v[36:39], v[168:171]
  v_mfma_f32_16x16x32_bf16 v[172:175], a[212:215], v[40:43], v[172:175]
  v_mfma_f32_16x16x32_bf16 v[176:179], a[212:215], v[44:47], v[176:179]
  v_mfma_f32_16x16x32_bf16 v[180:183], a[212:215], v[48:51], v[180:183]
  v_mfma_f32_16x16x32_bf16 v[184:187], a[212:215], v[52:55], v[184:187]
  s_nop 7
  v_cvt_pk_bf16_f32 v128, v128, v129
  v_cvt_pk_bf16_f32 v129, v130, v131
  v_add_u32 v15, s50, v8
  ds_write2_b32 v15, v128, v129 offset0:0 offset1:1
  s_add_u32 s50, s50, 7232
  v_cvt_pk_bf16_f32 v132, v132, v133
  v_cvt_pk_bf16_f32 v133, v134, v135
  v_add_u32 v15, s50, v8
  ds_write2_b32 v15, v132, v133 offset0:0 offset1:1
  s_add_u32 s50, s50, 7232
  v_cvt_pk_bf16_f32 v136, v136, v137
  v_cvt_pk_bf16_f32 v137, v138, v139
  v_add_u32 v15, s50, v8
  ds_write2_b32 v15, v136, v137 offset0:0 offset1:1
  s_add_u32 s50, s50, 7232
  v_cvt_pk_bf16_f32 v140, v140, v141
  v_cvt_pk_bf16_f32 v141, v142, v143
  v_add_u32 v15, s50, v8
  ds_write2_b32 v15, v140, v141 offset0:0 offset1:1
  s_add_u32 s50, s50, 7232
  v_cvt_pk_bf16_f32 v144, v144, v145
  v_cvt_pk_bf16_f32 v145, v146, v147
  v_add_u32 v15, s50, v8
  ds_write2_b32 v15, v144, v145 offset0:0 offset1:1
  s_add_u32 s50, s50, 7232
  v_cvt_pk_bf16_f32 v148, v148, v149
  v_cvt_pk_bf16_f32 v149, v150, v151
  v_add_u32 v15, s51, v8
  ds_write2_b32 v15, v148, v149 offset0:0 offset1:1
  s_add_u32 s51, s51, 7232
  v_cvt_pk_bf16_f32 v152, v152, v153
  v_cvt_pk_bf16_f32 v153, v154, v155
  v_add_u32 v15, s51, v8
  ds_write2_b32 v15, v152, v153 offset0:0 offset1:1
  s_add_u32 s51, s51, 7232
  v_cvt_pk_bf16_f32 v156, v156, v157
  v_cvt_pk_bf16_f32 v157, v158, v159
  v_add_u32 v15, s51, v8
  ds_write2_b32 v15, v156, v157 offset0:0 offset1:1
  s_add_u32 s51, s51, 7232
  v_cvt_pk_bf16_f32 v160, v160, v161
  v_cvt_pk_bf16_f32 v161, v162, v163
  v_add_u32 v15, s51, v8
  ds_write2_b32 v15, v160, v161 offset0:0 offset1:1
  s_add_u32 s51, s51, 7232
  v_cvt_pk_bf16_f32 v164, v164, v165
  v_cvt_pk_bf16_f32 v165, v166, v167
  v_add_u32 v15, s51, v8
  ds_write2_b32 v15, v164, v165 offset0:0 offset1:1
  s_add_u32 s51, s51, 7232
  v_cvt_pk_bf16_f32 v168, v168, v169
  v_cvt_pk_bf16_f32 v169, v170, v171
  v_add_u32 v15, s52, v8
  ds_write2_b32 v15, v168, v169 offset0:0 offset1:1
  s_add_u32 s52, s52, 7232
  v_cvt_pk_bf16_f32 v172, v172, v173
  v_cvt_pk_bf16_f32 v173, v174, v175
  v_add_u32 v15, s52, v8
  ds_write2_b32 v15, v172, v173 offset0:0 offset1:1
  s_add_u32 s52, s52, 7232
  v_cvt_pk_bf16_f32 v176, v176, v177
  v_cvt_pk_bf16_f32 v177, v178, v179
  v_add_u32 v15, s52, v8
  ds_write2_b32 v15, v176, v177 offset0:0 offset1:1
  s_add_u32 s52, s52, 7232
  v_cvt_pk_bf16_f32 v180, v180, v181
  v_cvt_pk_bf16_f32 v181, v182, v183
  v_add_u32 v15, s52, v8
  ds_write2_b32 v15, v180, v181 offset0:0 offset1:1
  s_add_u32 s52, s52, 7232
  v_cvt_pk_bf16_f32 v184, v184, v185
  v_cvt_pk_bf16_f32 v185, v186, v187
  v_add_u32 v15, s52, v8
  ds_write2_b32 v15, v184, v185 offset0:0 offset1:1
  s_add_u32 s52, s52, 7232
  s_waitcnt lgkmcnt(0)
f_kernel_att:
  s_barrier
  v_mul_u32_u24 v2, 452, v1
  s_mul_i32 s23, s20, 36
  s_add_u32 s23, s23, 92160
  v_add_u32 v2, s23, v2
  v_add_u32 v3, 7232, v2
  ds_read2_b32 v[160:161], v3 offset0:72 offset1:73
  ds_read2_b32 v[162:163], v3 offset0:74 offset1:75
  ds_read2_b32 v[164:165], v3 offset0:76 offset1:77
  ds_read2_b32 v[166:167], v3 offset0:78 offset1:79
  ds_read_b32 v168, v3 offset:320
  v_add_u32 v170, 7232, v2
  v_add_u32 v171, 6328, v2
  v_add_u32 v172, 5424, v2
  v_add_u32 v173, 4520, v2
  v_add_u32 v174, 3616, v2
  v_add_u32 v175, 2712, v2
  v_add_u32 v176, 1808, v2
  v_add_u32 v177, 904, v2
  ds_read2_b32 v[16:17], v170 offset0:0 offset1:1
  ds_read2_b32 v[18:19], v170 offset0:2 offset1:3
  ds_read2_b32 v[20:21], v170 offset0:4 offset1:5
  ds_read2_b32 v[22:23], v170 offset0:6 offset1:7
  ds_read_b32 v24, v170 offset:32
  ds_read2_b32 v[26:27], v171 offset0:0 offset1:1
  ds_read2_b32 v[28:29], v171 offset0:2 offset1:3
  ds_read2_b32 v[30:31], v171 offset0:4 offset1:5
  ds_read2_b32 v[32:33], v171 offset0:6 offset1:7
  ds_read_b32 v34, v171 offset:32
  ds_read2_b32 v[36:37], v172 offset0:0 offset1:1
  ds_read2_b32 v[38:39], v172 offset0:2 offset1:3
  ds_read2_b32 v[40:41], v172 offset0:4 offset1:5
  ds_read2_b32 v[42:43], v172 offset0:6 offset1:7
  ds_read_b32 v44, v172 offset:32
  ds_read2_b32 v[46:47], v173 offset0:0 offset1:1
  ds_read2_b32 v[48:49], v173 offset0:2 offset1:3
  ds_read2_b32 v[50:51], v173 offset0:4 offset1:5
  ds_read2_b32 v[52:53], v173 offset0:6 offset1:7
  ds_read_b32 v54, v173 offset:32
  ds_read2_b32 v[56:57], v174 offset0:0 offset1:1
  ds_read2_b32 v[58:59], v174 offset0:2 offset1:3
  ds_read2_b32 v[60:61], v174 offset0:4 offset1:5
  ds_read2_b32 v[62:63], v174 offset0:6 offset1:7
  ds_read_b32 v64, v174 offset:32
  ds_read2_b32 v[66:67], v175 offset0:0 offset1:1
  ds_read2_b32 v[68:69], v175 offset0:2 offset1:3
  ds_read2_b32 v[70:71], v175 offset0:4 offset1:5
  ds_read2_b32 v[72:73], v175 offset0:6 offset1:7
  ds_read_b32 v74, v175 offset:32
  ds_read2_b32 v[76:77], v176 offset0:0 offset1:1
  ds_read2_b32 v[78:79], v176 offset0:2 offset1:3
  ds_read2_b32 v[80:81], v176 offset0:4 offset1:5
  ds_read2_b32 v[82:83], v176 offset0:6 offset1:7
  ds_read_b32 v84, v176 offset:32
  ds_read2_b32 v[86:87], v177 offset0:0 offset1:1
  ds_read2_b32 v[88:89], v177 offset0:2 offset1:3
  ds_read2_b32 v[90:91], v177 offset0:4 offset1:5
  ds_read2_b32 v[92:93], v177 offset0:6 offset1:7
  ds_read_b32 v94, v177 offset:32
  ds_read2_b32 v[96:97], v170 offset0:36 offset1:37
  ds_read2_b32 v[98:99], v170 offset0:38 offset1:39
  ds_read2_b32 v[100:101], v170 offset0:40 offset1:41
  ds_read2_b32 v[102:103], v170 offset0:42 offset1:43
  ds_read_b32 v104, v170 offset:176
  ds_read2_b32 v[106:107], v171 offset0:36 offset1:37
  ds_read2_b32 v[108:109], v171 offset0:38 offset1:39
  ds_read2_b32 v[110:111], v171 offset0:40 offset1:41
  ds_read2_b32 v[112:113], v171 offset0:42 offset1:43
  ds_read_b32 v114, v171 offset:176
  ds_read2_b32 v[116:117], v172 offset0:36 offset1:37
  ds_read2_b32 v[118:119], v172 offset0:38 offset1:39
  ds_read2_b32 v[120:121], v172 offset0:40 offset1:41
  ds_read2_b32 v[122:123], v172 offset0:42 offset1:43
  ds_read_b32 v124, v172 offset:176
  ds_read2_b32 v[126:127], v173 offset0:36 offset1:37
  ds_read2_b32 v[128:129], v173 offset0:38 offset1:39
  ds_read2_b32 v[130:131], v173 offset0:40 offset1:41
  ds_read2_b32 v[132:133], v173 offset0:42 offset1:43
  ds_read_b32 v134, v173 offset:176
  ds_read2_b32 v[136:137], v174 offset0:36 offset1:37
  ds_read2_b32 v[138:139], v174 offset0:38 offset1:39
  ds_read2_b32 v[140:141], v174 offset0:40 offset1:41
  ds_read2_b32 v[142:143], v174 offset0:42 offset1:43
  ds_read_b32 v144, v174 offset:176
  ds_read2_b32 v[146:147], v175 offset0:36 offset1:37
  ds_read2_b32 v[148:149], v175 offset0:38 offset1:39
  ds_read2_b32 v[150:151], v175 offset0:40 offset1:41
  ds_read2_b32 v[152:153], v175 offset0:42 offset1:43
  ds_read_b32 v154, v175 offset:176
  ds_read2_b32 v[180:181], v176 offset0:36 offset1:37
  ds_read2_b32 v[182:183], v176 offset0:38 offset1:39
  ds_read2_b32 v[184:185], v176 offset0:40 offset1:41
  ds_read2_b32 v[186:187], v176 offset0:42 offset1:43
  ds_read_b32 v188, v176 offset:176
  ds_read2_b32 v[190:191], v177 offset0:36 offset1:37
  ds_read2_b32 v[192:193], v177 offset0:38 offset1:39
  ds_read2_b32 v[194:195], v177 offset0:40 offset1:41
  ds_read2_b32 v[196:197], v177 offset0:42 offset1:43
  ds_read_b32 v198, v177 offset:176
  s_lshl_b32 s23, s21, 6
  v_add_u32 v4, s23, v1
  s_waitcnt lgkmcnt(0)
  v_mov_b32 v200, 0
  v_mov_b32 v201, 0
  v_mov_b32 v202, 0
  v_mov_b32 v203, 0
  v_mov_b32 v204, 0
  v_mov_b32 v205, 0
  v_mov_b32 v206, 0
  v_mov_b32 v207, 0
  v_dot2c_f32_bf16 v200, v160, v16
  v_dot2c_f32_bf16 v201, v160, v26
  v_dot2c_f32_bf16 v202, v160, v36
  v_dot2c_f32_bf16 v203, v160, v46
  v_dot2c_f32_bf16 v204, v160, v56
  v_dot2c_f32_bf16 v205, v160, v66
  v_dot2c_f32_bf16 v206, v160, v76
  v_dot2c_f32_bf16 v207, v160, v86
  v_dot2c_f32_bf16 v200, v161, v17
  v_dot2c_f32_bf16 v201, v161, v27
  v_dot2c_f32_bf16 v202, v161, v37
  v_dot2c_f32_bf16 v203, v161, v47
  v_dot2c_f32_bf16 v204, v161, v57
  v_dot2c_f32_bf16 v205, v161, v67
  v_dot2c_f32_bf16 v206, v161, v77
  v_dot2c_f32_bf16 v207, v161, v87
  v_dot2c_f32_bf16 v200, v162, v18
  v_dot2c_f32_bf16 v201, v162, v28
  v_dot2c_f32_bf16 v202, v162, v38
  v_dot2c_f32_bf16 v203, v162, v48
  v_dot2c_f32_bf16 v204, v162, v58
  v_dot2c_f32_bf16 v205, v162, v68
  v_dot2c_f32_bf16 v206, v162, v78
  v_dot2c_f32_bf16 v207, v162, v88
  v_dot2c_f32_bf16 v200, v163, v19
  v_dot2c_f32_bf16 v201, v163, v29
  v_dot2c_f32_bf16 v202, v163, v39
  v_dot2c_f32_bf16 v203, v163, v49
  v_dot2c_f32_bf16 v204, v163, v59
  v_dot2c_f32_bf16 v205, v163, v69
  v_dot2c_f32_bf16 v206, v163, v79
  v_dot2c_f32_bf16 v207, v163, v89
  v_dot2c_f32_bf16 v200, v164, v20
  v_dot2c_f32_bf16 v201, v164, v30
  v_dot2c_f32_bf16 v202, v164, v40
  v_dot2c_f32_bf16 v203, v164, v50
  v_dot2c_f32_bf16 v204, v164, v60
  v_dot2c_f32_bf16 v205, v164, v70
  v_dot2c_f32_bf16 v206, v164, v80
  v_dot2c_f32_bf16 v207, v164, v90
  v_dot2c_f32_bf16 v200, v165, v21
  v_dot2c_f32_bf16 v201, v165, v31
  v_dot2c_f32_bf16 v202, v165, v41
  v_dot2c_f32_bf16 v203, v165, v51
  v_dot2c_f32_bf16 v204, v165, v61
  v_dot2c_f32_bf16 v205, v165, v71
  v_dot2c_f32_bf16 v206, v165, v81
  v_dot2c_f32_bf16 v207, v165, v91
  v_dot2c_f32_bf16 v200, v166, v22
  v_dot2c_f32_bf16 v201, v166, v32
  v_dot2c_f32_bf16 v202, v166, v42
  v_dot2c_f32_bf16 v203, v166, v52
  v_dot2c_f32_bf16 v204, v166, v62
  v_dot2c_f32_bf16 v205, v166, v72
  v_dot2c_f32_bf16 v206, v166, v82
  v_dot2c_f32_bf16 v207, v166, v92
  v_dot2c_f32_bf16 v200, v167, v23
  v_dot2c_f32_bf16 v201, v167, v33
  v_dot2c_f32_bf16 v202, v167, v43
  v_dot2c_f32_bf16 v203, v167, v53
  v_dot2c_f32_bf16 v204, v167, v63
  v_dot2c_f32_bf16 v205, v167, v73
  v_dot2c_f32_bf16 v206, v167, v83
  v_dot2c_f32_bf16 v207, v167, v93
  v_dot2c_f32_bf16 v200, v168, v24
  v_dot2c_f32_bf16 v201, v168, v34
  v_dot2c_f32_bf16 v202, v168, v44
  v_dot2c_f32_bf16 v203, v168, v54
  v_dot2c_f32_bf16 v204, v168, v64
  v_dot2c_f32_bf16 v205, v168, v74
  v_dot2c_f32_bf16 v206, v168, v84
  v_dot2c_f32_bf16 v207, v168, v94
  s_nop 2
  v_mov_b32 v5, 0xf149f2ca
  v_cmp_le_u32 vcc, 2, v4
  v_cndmask_b32 v201, v5, v201, vcc
  v_cmp_le_u32 vcc, 4, v4
  v_cndmask_b32 v202, v5, v202, vcc
  v_cmp_le_u32 vcc, 6, v4
  v_cndmask_b32 v203, v5, v203, vcc
  v_cmp_le_u32 vcc, 8, v4
  v_cndmask_b32 v204, v5, v204, vcc
  v_cmp_le_u32 vcc, 10, v4
  v_cndmask_b32 v205, v5, v205, vcc
  v_cmp_le_u32 vcc, 12, v4
  v_cndmask_b32 v206, v5, v206, vcc
  v_cmp_le_u32 vcc, 14, v4
  v_cndmask_b32 v207, v5, v207, vcc
  v_max3_f32 v6, v200, v201, v202
  v_max3_f32 v6, v6, v203, v204
  v_max3_f32 v6, v6, v205, v206
  v_max_f32 v6, v6, v207
  s_mov_b32 s24, 1051597459
  v_sub_f32 v200, v200, v6
  v_mul_f32 v200, s24, v200
  v_exp_f32 v200, v200
  v_sub_f32 v201, v201, v6
  v_mul_f32 v201, s24, v201
  v_exp_f32 v201, v201
  v_sub_f32 v202, v202, v6
  v_mul_f32 v202, s24, v202
  v_exp_f32 v202, v202
  v_sub_f32 v203, v203, v6
  v_mul_f32 v203, s24, v203
  v_exp_f32 v203, v203
  v_sub_f32 v204, v204, v6
  v_mul_f32 v204, s24, v204
  v_exp_f32 v204, v204
  v_sub_f32 v205, v205, v6
  v_mul_f32 v205, s24, v205
  v_exp_f32 v205, v205
  v_sub_f32 v206, v206, v6
  v_mul_f32 v206, s24, v206
  v_exp_f32 v206, v206
  v_sub_f32 v207, v207, v6
  v_mul_f32 v207, s24, v207
  v_exp_f32 v207, v207
  s_nop 0
  v_add_f32 v6, v200, v201
  v_add_f32 v6, v6, v202
  v_add_f32 v6, v6, v203
  v_add_f32 v6, v6, v204
  v_add_f32 v6, v6, v205
  v_add_f32 v6, v6, v206
  v_add_f32 v6, v6, v207
  v_rcp_f32 v6, v6
  s_nop 0
  v_mul_f32 v200, v200, v6
  v_mul_f32 v201, v201, v6
  v_mul_f32 v202, v202, v6
  v_mul_f32 v203, v203, v6
  v_mul_f32 v204, v204, v6
  v_mul_f32 v205, v205, v6
  v_mul_f32 v206, v206, v6
  v_mul_f32 v207, v207, v6
  v_cvt_pk_bf16_f32 v208, v200, v201
  v_cvt_pk_bf16_f32 v209, v202, v203
  v_cvt_pk_bf16_f32 v210, v204, v205
  v_cvt_pk_bf16_f32 v211, v206, v207
  v_mov_b32 v16, 0
  v_mov_b32 v17, 0
  v_mov_b32 v18, 0
  v_mov_b32 v19, 0
  v_mov_b32 v20, 0
  v_mov_b32 v21, 0
  v_mov_b32 v22, 0
  v_mov_b32 v23, 0
  v_mov_b32 v24, 0
  v_mov_b32 v25, 0
  v_mov_b32 v26, 0
  v_mov_b32 v27, 0
  v_mov_b32 v28, 0
  v_mov_b32 v29, 0
  v_mov_b32 v30, 0
  v_mov_b32 v31, 0
  v_mov_b32 v32, 0
  v_mov_b32 v33, 0
  s_mov_b32 s25, 0x05040100
  s_mov_b32 s26, 0x07060302
  v_perm_b32 v40, v106, v96, s25
  v_perm_b32 v41, v106, v96, s26
  v_dot2c_f32_bf16 v16, v40, v208
  v_dot2c_f32_bf16 v17, v41, v208
  v_perm_b32 v42, v107, v97, s25
  v_perm_b32 v43, v107, v97, s26
  v_dot2c_f32_bf16 v18, v42, v208
  v_dot2c_f32_bf16 v19, v43, v208
  v_perm_b32 v44, v108, v98, s25
  v_perm_b32 v45, v108, v98, s26
  v_dot2c_f32_bf16 v20, v44, v208
  v_dot2c_f32_bf16 v21, v45, v208
  v_perm_b32 v46, v109, v99, s25
  v_perm_b32 v47, v109, v99, s26
  v_dot2c_f32_bf16 v22, v46, v208
  v_dot2c_f32_bf16 v23, v47, v208
  v_perm_b32 v40, v110, v100, s25
  v_perm_b32 v41, v110, v100, s26
  v_dot2c_f32_bf16 v24, v40, v208
  v_dot2c_f32_bf16 v25, v41, v208
  v_perm_b32 v42, v111, v101, s25
  v_perm_b32 v43, v111, v101, s26
  v_dot2c_f32_bf16 v26, v42, v208
  v_dot2c_f32_bf16 v27, v43, v208
  v_perm_b32 v44, v112, v102, s25
  v_perm_b32 v45, v112, v102, s26
  v_dot2c_f32_bf16 v28, v44, v208
  v_dot2c_f32_bf16 v29, v45, v208
  v_perm_b32 v46, v113, v103, s25
  v_perm_b32 v47, v113, v103, s26
  v_dot2c_f32_bf16 v30, v46, v208
  v_dot2c_f32_bf16 v31, v47, v208
  v_perm_b32 v40, v114, v104, s25
  v_perm_b32 v41, v114, v104, s26
  v_dot2c_f32_bf16 v32, v40, v208
  v_dot2c_f32_bf16 v33, v41, v208
  v_perm_b32 v40, v126, v116, s25
  v_perm_b32 v41, v126, v116, s26
  v_dot2c_f32_bf16 v16, v40, v209
  v_dot2c_f32_bf16 v17, v41, v209
  v_perm_b32 v42, v127, v117, s25
  v_perm_b32 v43, v127, v117, s26
  v_dot2c_f32_bf16 v18, v42, v209
  v_dot2c_f32_bf16 v19, v43, v209
  v_perm_b32 v44, v128, v118, s25
  v_perm_b32 v45, v128, v118, s26
  v_dot2c_f32_bf16 v20, v44, v209
  v_dot2c_f32_bf16 v21, v45, v209
  v_perm_b32 v46, v129, v119, s25
  v_perm_b32 v47, v129, v119, s26
  v_dot2c_f32_bf16 v22, v46, v209
  v_dot2c_f32_bf16 v23, v47, v209
  v_perm_b32 v40, v130, v120, s25
  v_perm_b32 v41, v130, v120, s26
  v_dot2c_f32_bf16 v24, v40, v209
  v_dot2c_f32_bf16 v25, v41, v209
  v_perm_b32 v42, v131, v121, s25
  v_perm_b32 v43, v131, v121, s26
  v_dot2c_f32_bf16 v26, v42, v209
  v_dot2c_f32_bf16 v27, v43, v209
  v_perm_b32 v44, v132, v122, s25
  v_perm_b32 v45, v132, v122, s26
  v_dot2c_f32_bf16 v28, v44, v209
  v_dot2c_f32_bf16 v29, v45, v209
  v_perm_b32 v46, v133, v123, s25
  v_perm_b32 v47, v133, v123, s26
  v_dot2c_f32_bf16 v30, v46, v209
  v_dot2c_f32_bf16 v31, v47, v209
  v_perm_b32 v40, v134, v124, s25
  v_perm_b32 v41, v134, v124, s26
  v_dot2c_f32_bf16 v32, v40, v209
  v_dot2c_f32_bf16 v33, v41, v209
  v_perm_b32 v40, v146, v136, s25
  v_perm_b32 v41, v146, v136, s26
  v_dot2c_f32_bf16 v16, v40, v210
  v_dot2c_f32_bf16 v17, v41, v210
  v_perm_b32 v42, v147, v137, s25
  v_perm_b32 v43, v147, v137, s26
  v_dot2c_f32_bf16 v18, v42, v210
  v_dot2c_f32_bf16 v19, v43, v210
  v_perm_b32 v44, v148, v138, s25
  v_perm_b32 v45, v148, v138, s26
  v_dot2c_f32_bf16 v20, v44, v210
  v_dot2c_f32_bf16 v21, v45, v210
  v_perm_b32 v46, v149, v139, s25
  v_perm_b32 v47, v149, v139, s26
  v_dot2c_f32_bf16 v22, v46, v210
  v_dot2c_f32_bf16 v23, v47, v210
  v_perm_b32 v40, v150, v140, s25
  v_perm_b32 v41, v150, v140, s26
  v_dot2c_f32_bf16 v24, v40, v210
  v_dot2c_f32_bf16 v25, v41, v210
  v_perm_b32 v42, v151, v141, s25
  v_perm_b32 v43, v151, v141, s26
  v_dot2c_f32_bf16 v26, v42, v210
  v_dot2c_f32_bf16 v27, v43, v210
  v_perm_b32 v44, v152, v142, s25
  v_perm_b32 v45, v152, v142, s26
  v_dot2c_f32_bf16 v28, v44, v210
  v_dot2c_f32_bf16 v29, v45, v210
  v_perm_b32 v46, v153, v143, s25
  v_perm_b32 v47, v153, v143, s26
  v_dot2c_f32_bf16 v30, v46, v210
  v_dot2c_f32_bf16 v31, v47, v210
  v_perm_b32 v40, v154, v144, s25
  v_perm_b32 v41, v154, v144, s26
  v_dot2c_f32_bf16 v32, v40, v210
  v_dot2c_f32_bf16 v33, v41, v210
  v_perm_b32 v40, v190, v180, s25
  v_perm_b32 v41, v190, v180, s26
  v_dot2c_f32_bf16 v16, v40, v211
  v_dot2c_f32_bf16 v17, v41, v211
  v_perm_b32 v42, v191, v181, s25
  v_perm_b32 v43, v191, v181, s26
  v_dot2c_f32_bf16 v18, v42, v211
  v_dot2c_f32_bf16 v19, v43, v211
  v_perm_b32 v44, v192, v182, s25
  v_perm_b32 v45, v192, v182, s26
  v_dot2c_f32_bf16 v20, v44, v211
  v_dot2c_f32_bf16 v21, v45, v211
  v_perm_b32 v46, v193, v183, s25
  v_perm_b32 v47, v193, v183, s26
  v_dot2c_f32_bf16 v22, v46, v211
  v_dot2c_f32_bf16 v23, v47, v211
  v_perm_b32 v40, v194, v184, s25
  v_perm_b32 v41, v194, v184, s26
  v_dot2c_f32_bf16 v24, v40, v211
  v_dot2c_f32_bf16 v25, v41, v211
  v_perm_b32 v42, v195, v185, s25
  v_perm_b32 v43, v195, v185, s26
  v_dot2c_f32_bf16 v26, v42, v211
  v_dot2c_f32_bf16 v27, v43, v211
  v_perm_b32 v44, v196, v186, s25
  v_perm_b32 v45, v196, v186, s26
  v_dot2c_f32_bf16 v28, v44, v211
  v_dot2c_f32_bf16 v29, v45, v211
  v_perm_b32 v46, v197, v187, s25
  v_perm_b32 v47, v197, v187, s26
  v_dot2c_f32_bf16 v30, v46, v211
  v_dot2c_f32_bf16 v31, v47, v211
  v_perm_b32 v40, v198, v188, s25
  v_perm_b32 v41, v198, v188, s26
  v_dot2c_f32_bf16 v32, v40, v211
  v_dot2c_f32_bf16 v33, v41, v211
  s_nop 2
  v_cvt_pk_bf16_f32 v50, v16, v17
  v_cvt_pk_bf16_f32 v51, v18, v19
  v_cvt_pk_bf16_f32 v52, v20, v21
  v_cvt_pk_bf16_f32 v53, v22, v23
  v_cvt_pk_bf16_f32 v54, v24, v25
  v_cvt_pk_bf16_f32 v55, v26, v27
  v_cvt_pk_bf16_f32 v56, v28, v29
  v_cvt_pk_bf16_f32 v57, v30, v31
  v_cvt_pk_bf16_f32 v58, v32, v33
  v_mul_u32_u24 v2, 148, v1
  s_mul_i32 s23, s20, 36
  s_add_u32 s23, s23, 0
  v_add_u32 v2, s23, v2
  ds_write2_b32 v2, v50, v51 offset0:0 offset1:1
  ds_write2_b32 v2, v52, v53 offset0:2 offset1:3
  ds_write2_b32 v2, v54, v55 offset0:4 offset1:5
  ds_write2_b32 v2, v56, v57 offset0:6 offset1:7
  ds_write_b32 v2, v58 offset:32
  s_waitcnt lgkmcnt(0)
  s_barrier
  v_and_b32 v2, 15, v1
  v_lshrrev_b32 v3, 4, v1
  s_lshl_b32 s23, s20, 4
  v_add_u32 v4, s23, v2
  v_mul_u32_u24 v4, 148, v4
  v_lshl_add_u32 v4, v3, 4, v4
  v_add_u32 v4, 0, v4
  ds_read2_b32 v[16:17], v4 offset0:0 offset1:1
  ds_read2_b32 v[18:19], v4 offset0:2 offset1:3
  ds_read2_b32 v[20:21], v4 offset0:16 offset1:17
  ds_read2_b32 v[22:23], v4 offset0:18 offset1:19
  ds_read2_b32 v[24:25], v4 offset0:32 offset1:33
  ds_read2_b32 v[26:27], v4 offset0:34 offset1:35
  s_lshl_b32 s23, s21, 2
  s_add_u32 s23, s23, s20
  s_mul_i32 s23, s23, 72
  s_mul_i32 s24, s22, 9
  s_add_u32 s23, s23, s24
  s_lshl_b32 s23, s23, 8
  s_add_u32 s23, s23, 5373952
  v_lshlrev_b32 v5, 4, v2
  v_lshl_add_u32 v5, v3, 8, v5
  v_mov_b32 v6, 0x7ff00000
  v_cmp_gt_u32 vcc, 16, v1
  v_cndmask_b32 v6, v6, v5, vcc
  s_waitcnt lgkmcnt(0)
  buffer_store_dwordx4 v[16:19], v5, s[16:19], s23 offen sc1
  buffer_store_dwordx4 v[20:23], v5, s[16:19], s23 offen offset:1024 sc1
  buffer_store_dwordx4 v[24:27], v6, s[16:19], s23 offen offset:2048 sc1
  s_barrier

  s_load_dwordx2 s[34:35], s[0:1], 88
  s_load_dwordx2 s[4:5], s[0:1], 0
  s_load_dwordx2 s[6:7], s[0:1], 48
  v_lshrrev_b32 v10, 6, v0
  v_and_b32 v1, 63, v0
  v_readfirstlane_b32 s20, v10
  s_and_b32 s22, s2, 7
  s_lshr_b32 s21, s2, 3
  s_lshr_b32 s23, s22, 2
  s_and_b32 s22, s22, 3
  s_lshl_b32 s22, s22, 1
  s_and_b32 s24, s21, 1
  s_add_u32 s22, s22, s24
  s_lshr_b32 s21, s21, 1
  s_lshl_b32 s23, s23, 4
  s_add_u32 s21, s21, s23

  s_waitcnt lgkmcnt(0)
  s_mov_b32 s16, s34
  s_and_b32 s17, s35, 0xffff
  s_mov_b32 s18, 268435456
  s_mov_b32 s19, 0x20000

  s_mov_b32 s8, s4
  s_and_b32 s9, s5, 0xffff
  s_mov_b32 s10, 2359296
  s_mov_b32 s11, 0x20000

  v_lshlrev_b32 v9, 4, v1
  s_mul_i32 s23, s22, 92160
  s_add_u32 s23, s23, 4587520
  s_mul_i32 s24, s20, 18432
  s_add_u32 s25, s20, 4
  s_min_u32 s25, s25, 5
  s_lshl_b32 s26, s20, 10
  s_lshl_b32 s25, s25, 10
  s_add_u32 s26, s26, 73728
  s_add_u32 s25, s25, 73728
  s_lshl_b32 s27, s21, 2
  s_add_u32 s27, s27, s20
  s_mul_i32 s28, s27, 18432
  s_add_u32 s28, s28, 5373952
  s_waitcnt vmcnt(0)
  s_barrier
  s_cmp_lg_u32 s20, 0
  s_cbranch_scc1 f_kernel_h0_seen
  s_lshl_b32 s36, s21, 7
  s_add_u32 s36, s36, 32768
  s_lshl_b32 s37, s22, 2
  s_add_u32 s37, s37, s36
  v_mov_b32 v10, 0
  v_mov_b32 v11, 1
  v_lshlrev_b32 v14, 2, v1
  s_mov_b64 exec, 1
  buffer_store_dword v11, v10, s[16:19], s37 offen sc1
  s_mov_b64 exec, 0xff
  s_mov_b32 s40, 0
  f_kernel_h0_poll:
  buffer_load_dword v15, v14, s[16:19], s36 offen sc1
  s_waitcnt vmcnt(0)
  v_cmp_eq_u32 vcc, 1, v15
  s_add_u32 s40, s40, 1
  s_cmp_eq_u32 vcc_lo, 0xff
  s_cbranch_scc1 f_kernel_h0_got
  s_cmp_lt_u32 s40, 400000
  s_cbranch_scc1 f_kernel_h0_poll
  f_kernel_h0_got:
  s_mov_b64 exec, -1
  f_kernel_h0_seen:
  s_add_u32 m0, s24, 0
  s_add_u32 s30, m0, s23
  buffer_load_dwordx4 v9, s[16:19], s30 offen offset:0 lds
  buffer_load_dwordx4 v9, s[16:19], s30 offen offset:1024 lds
  buffer_load_dwordx4 v9, s[16:19], s30 offen offset:2048 lds
  buffer_load_dwordx4 v9, s[16:19], s30 offen offset:3072 lds
  s_add_u32 m0, s24, 4096
  s_add_u32 s30, m0, s23
  buffer_load_dwordx4 v9, s[16:19], s30 offen offset:0 lds
  buffer_load_dwordx4 v9, s[16:19], s30 offen offset:1024 lds
  s_add_u32 m0, s26, 0
  s_add_u32 s30, m0, s23
  buffer_load_dwordx4 v9, s[16:19], s30 offen offset:0 lds
  s_add_u32 m0, s25, 0
  s_add_u32 s30, m0, s23
  buffer_load_dwordx4 v9, s[16:19], s30 offen offset:0 lds
  s_add_u32 m0, s24, 6144
  s_add_u32 s30, m0, s23
  buffer_load_dwordx4 v9, s[16:19], s30 offen offset:0 lds
  buffer_load_dwordx4 v9, s[16:19], s30 offen offset:1024 lds
  buffer_load_dwordx4 v9, s[16:19], s30 offen offset:2048 lds
  buffer_load_dwordx4 v9, s[16:19], s30 offen offset:3072 lds
  s_add_u32 m0, s24, 10240
  s_add_u32 s30, m0, s23
  buffer_load_dwordx4 v9, s[16:19], s30 offen offset:0 lds
  buffer_load_dwordx4 v9, s[16:19], s30 offen offset:1024 lds
  s_add_u32 m0, s26, 6144
  s_add_u32 s30, m0, s23
  buffer_load_dwordx4 v9, s[16:19], s30 offen offset:0 lds
  s_add_u32 m0, s25, 6144
  s_add_u32 s30, m0, s23
  buffer_load_dwordx4 v9, s[16:19], s30 offen offset:0 lds
  s_add_u32 m0, s24, 12288
  s_add_u32 s30, m0, s23
  buffer_load_dwordx4 v9, s[16:19], s30 offen offset:0 lds
  buffer_load_dwordx4 v9, s[16:19], s30 offen offset:1024 lds
  buffer_load_dwordx4 v9, s[16:19], s30 offen offset:2048 lds
  buffer_load_dwordx4 v9, s[16:19], s30 offen offset:3072 lds
  s_add_u32 m0, s24, 16384
  s_add_u32 s30, m0, s23
  buffer_load_dwordx4 v9, s[16:19], s30 offen offset:0 lds
  buffer_load_dwordx4 v9, s[16:19], s30 offen offset:1024 lds
  s_add_u32 m0, s26, 12288
  s_add_u32 s30, m0, s23
  buffer_load_dwordx4 v9, s[16:19], s30 offen offset:0 lds
  s_add_u32 m0, s25, 12288
  s_add_u32 s30, m0, s23
  buffer_load_dwordx4 v9, s[16:19], s30 offen offset:0 lds
  v_and_b32 v2, 15, v1
  v_lshrrev_b32 v3, 4, v1
  s_lshl_b32 s29, s27, 4
  v_add_u32 v4, s29, v2
  v_mul_u32_u24 v4, 1152, v4
  v_lshl_add_u32 v4, v3, 3, v4
  s_mul_i32 s31, s22, 144
  buffer_load_dwordx2 v[160:161], v4, s[8:11], s31 offen offset:0
  buffer_load_dwordx2 v[162:163], v4, s[8:11], s31 offen offset:32
  buffer_load_dwordx2 v[164:165], v4, s[8:11], s31 offen offset:64
  buffer_load_dwordx2 v[166:167], v4, s[8:11], s31 offen offset:96
  buffer_load_dwordx2 v[168:169], v4, s[8:11], s31 offen offset:128
  v_lshlrev_b32 v5, 4, v3
  s_mul_i32 s32, s22, 288
  s_add_u32 s32, s32, 4608
  buffer_load_dwordx4 v[172:175], v5, s[16:19], s32 offen offset:0
  buffer_load_dwordx4 v[176:179], v5, s[16:19], s32 offen offset:64
  buffer_load_dwordx4 v[180:183], v5, s[16:19], s32 offen offset:128
  buffer_load_dwordx4 v[184:187], v5, s[16:19], s32 offen offset:192
  buffer_load_dwordx4 v[188:191], v5, s[16:19], s32 offen offset:256
  s_barrier
  buffer_load_dwordx4 v[16:19], v9, s[16:19], s28 offen offset:0 sc1
  buffer_load_dwordx4 v[20:23], v9, s[16:19], s28 offen offset:1024 sc1
  buffer_load_dwordx4 v[24:27], v9, s[16:19], s28 offen offset:2048 sc1
  buffer_load_dwordx4 v[28:31], v9, s[16:19], s28 offen offset:3072 sc1
  s_add_u32 s28, s28, 4096
  buffer_load_dwordx4 v[32:35], v9, s[16:19], s28 offen offset:0 sc1
  buffer_load_dwordx4 v[36:39], v9, s[16:19], s28 offen offset:1024 sc1
  buffer_load_dwordx4 v[40:43], v9, s[16:19], s28 offen offset:2048 sc1
  buffer_load_dwordx4 v[44:47], v9, s[16:19], s28 offen offset:3072 sc1
  s_add_u32 s28, s28, 4096
  buffer_load_dwordx4 v[48:51], v9, s[16:19], s28 offen offset:0 sc1
  buffer_load_dwordx4 v[52:55], v9, s[16:19], s28 offen offset:1024 sc1
  buffer_load_dwordx4 v[56:59], v9, s[16:19], s28 offen offset:2048 sc1
  buffer_load_dwordx4 v[60:63], v9, s[16:19], s28 offen offset:3072 sc1
  s_add_u32 s28, s28, 4096
  buffer_load_dwordx4 v[64:67], v9, s[16:19], s28 offen offset:0 sc1
  buffer_load_dwordx4 v[68:71], v9, s[16:19], s28 offen offset:1024 sc1
  buffer_load_dwordx4 v[72:75], v9, s[16:19], s28 offen offset:2048 sc1
  buffer_load_dwordx4 v[76:79], v9, s[16:19], s28 offen offset:3072 sc1
  s_add_u32 s28, s28, 4096
  buffer_load_dwordx4 v[80:83], v9, s[16:19], s28 offen offset:0 sc1
  buffer_load_dwordx4 v[84:87], v9, s[16:19], s28 offen offset:1024 sc1
  v_add_u32 v12, 36864, v9
  v_add_u32 v13, 73728, v9
  s_waitcnt vmcnt(44)
  s_barrier
  ds_read_b128 v[120:123], v9 offset:0
  ds_read_b128 v[124:127], v9 offset:18432
  ds_read_b128 v[128:131], v12 offset:0
  ds_read_b128 v[132:135], v12 offset:18432
  ds_read_b128 v[136:139], v13 offset:0
  s_waitcnt vmcnt(17)
  s_waitcnt lgkmcnt(4)
  v_mfma_f32_16x16x32_bf16 v[96:99], v[120:123], v[16:19], 0
  ds_read_b128 v[140:143], v9 offset:1024
  ds_read_b128 v[144:147], v9 offset:19456
  ds_read_b128 v[148:151], v12 offset:1024
  ds_read_b128 v[152:155], v12 offset:19456
  ds_read_b128 v[156:159], v13 offset:1024
  s_waitcnt lgkmcnt(8)
  v_mfma_f32_16x16x32_bf16 v[100:103], v[124:127], v[16:19], 0
  s_waitcnt lgkmcnt(7)
  v_mfma_f32_16x16x32_bf16 v[104:107], v[128:131], v[16:19], 0
  s_waitcnt lgkmcnt(6)
  v_mfma_f32_16x16x32_bf16 v[108:111], v[132:135], v[16:19], 0
  s_waitcnt lgkmcnt(5)
  v_mfma_f32_16x16x32_bf16 v[112:115], v[136:139], v[16:19], 0
  s_waitcnt vmcnt(16)
  s_waitcnt lgkmcnt(4)
  v_mfma_f32_16x16x32_bf16 v[96:99], v[140:143], v[20:23], v[96:99]
  ds_read_b128 v[120:123], v9 offset:2048
  ds_read_b128 v[124:127], v9 offset:20480
  ds_read_b128 v[128:131], v12 offset:2048
  ds_read_b128 v[132:135], v12 offset:20480
  ds_read_b128 v[136:139], v13 offset:2048
  s_waitcnt lgkmcnt(8)
  v_mfma_f32_16x16x32_bf16 v[100:103], v[144:147], v[20:23], v[100:103]
  s_waitcnt lgkmcnt(7)
  v_mfma_f32_16x16x32_bf16 v[104:107], v[148:151], v[20:23], v[104:107]
  s_waitcnt lgkmcnt(6)
  v_mfma_f32_16x16x32_bf16 v[108:111], v[152:155], v[20:23], v[108:111]
  s_waitcnt lgkmcnt(5)
  v_mfma_f32_16x16x32_bf16 v[112:115], v[156:159], v[20:23], v[112:115]
  s_waitcnt vmcnt(15)
  s_waitcnt lgkmcnt(4)
  v_mfma_f32_16x16x32_bf16 v[96:99], v[120:123], v[24:27], v[96:99]
  ds_read_b128 v[140:143], v9 offset:3072
  ds_read_b128 v[144:147], v9 offset:21504
  ds_read_b128 v[148:151], v12 offset:3072
  ds_read_b128 v[152:155], v12 offset:21504
  ds_read_b128 v[156:159], v13 offset:3072
  s_waitcnt lgkmcnt(8)
  v_mfma_f32_16x16x32_bf16 v[100:103], v[124:127], v[24:27], v[100:103]
  s_waitcnt lgkmcnt(7)
  v_mfma_f32_16x16x32_bf16 v[104:107], v[128:131], v[24:27], v[104:107]
  s_waitcnt lgkmcnt(6)
  v_mfma_f32_16x16x32_bf16 v[108:111], v[132:135], v[24:27], v[108:111]
  s_waitcnt lgkmcnt(5)
  v_mfma_f32_16x16x32_bf16 v[112:115], v[136:139], v[24:27], v[112:115]
  s_waitcnt vmcnt(14)
  s_waitcnt lgkmcnt(4)
  v_mfma_f32_16x16x32_bf16 v[96:99], v[140:143], v[28:31], v[96:99]
  ds_read_b128 v[120:123], v9 offset:4096
  ds_read_b128 v[124:127], v9 offset:22528
  ds_read_b128 v[128:131], v12 offset:4096
  ds_read_b128 v[132:135], v12 offset:22528
  ds_read_b128 v[136:139], v13 offset:4096
  s_waitcnt lgkmcnt(8)
  v_mfma_f32_16x16x32_bf16 v[100:103], v[144:147], v[28:31], v[100:103]
  s_waitcnt lgkmcnt(7)
  v_mfma_f32_16x16x32_bf16 v[104:107], v[148:151], v[28:31], v[104:107]
  s_waitcnt lgkmcnt(6)
  v_mfma_f32_16x16x32_bf16 v[108:111], v[152:155], v[28:31], v[108:111]
  s_waitcnt lgkmcnt(5)
  v_mfma_f32_16x16x32_bf16 v[112:115], v[156:159], v[28:31], v[112:115]
  s_waitcnt vmcnt(13)
  s_waitcnt lgkmcnt(4)
  v_mfma_f32_16x16x32_bf16 v[96:99], v[120:123], v[32:35], v[96:99]
  ds_read_b128 v[140:143], v9 offset:5120
  ds_read_b128 v[144:147], v9 offset:23552
  ds_read_b128 v[148:151], v12 offset:5120
  ds_read_b128 v[152:155], v12 offset:23552
  ds_read_b128 v[156:159], v13 offset:5120
  s_waitcnt lgkmcnt(8)
  v_mfma_f32_16x16x32_bf16 v[100:103], v[124:127], v[32:35], v[100:103]
  s_waitcnt lgkmcnt(7)
  v_mfma_f32_16x16x32_bf16 v[104:107], v[128:131], v[32:35], v[104:107]
  s_waitcnt lgkmcnt(6)
  v_mfma_f32_16x16x32_bf16 v[108:111], v[132:135], v[32:35], v[108:111]
  s_waitcnt lgkmcnt(5)
  v_mfma_f32_16x16x32_bf16 v[112:115], v[136:139], v[32:35], v[112:115]
  s_waitcnt vmcnt(12)
  s_waitcnt lgkmcnt(4)
  v_mfma_f32_16x16x32_bf16 v[96:99], v[140:143], v[36:39], v[96:99]
  s_waitcnt lgkmcnt(3)
  v_mfma_f32_16x16x32_bf16 v[100:103], v[144:147], v[36:39], v[100:103]
  s_waitcnt lgkmcnt(2)
  v_mfma_f32_16x16x32_bf16 v[104:107], v[148:151], v[36:39], v[104:107]
  s_waitcnt lgkmcnt(1)
  v_mfma_f32_16x16x32_bf16 v[108:111], v[152:155], v[36:39], v[108:111]
  s_waitcnt lgkmcnt(0)
  v_mfma_f32_16x16x32_bf16 v[112:115], v[156:159], v[36:39], v[112:115]
  s_barrier
  ds_read_b128 v[120:123], v9 offset:6144
  ds_read_b128 v[124:127], v9 offset:24576
  ds_read_b128 v[128:131], v12 offset:6144
  ds_read_b128 v[132:135], v12 offset:24576
  ds_read_b128 v[136:139], v13 offset:6144
  s_waitcnt vmcnt(11)
  s_waitcnt lgkmcnt(4)
  v_mfma_f32_16x16x32_bf16 v[96:99], v[120:123], v[40:43], v[96:99]
  ds_read_b128 v[140:143], v9 offset:7168
  ds_read_b128 v[144:147], v9 offset:25600
  ds_read_b128 v[148:151], v12 offset:7168
  ds_read_b128 v[152:155], v12 offset:25600
  ds_read_b128 v[156:159], v13 offset:7168
  s_waitcnt lgkmcnt(8)
  v_mfma_f32_16x16x32_bf16 v[100:103], v[124:127], v[40:43], v[100:103]
  s_waitcnt lgkmcnt(7)
  v_mfma_f32_16x16x32_bf16 v[104:107], v[128:131], v[40:43], v[104:107]
  s_waitcnt lgkmcnt(6)
  v_mfma_f32_16x16x32_bf16 v[108:111], v[132:135], v[40:43], v[108:111]
  s_waitcnt lgkmcnt(5)
  v_mfma_f32_16x16x32_bf16 v[112:115], v[136:139], v[40:43], v[112:115]
  s_waitcnt vmcnt(10)
  s_waitcnt lgkmcnt(4)
  v_mfma_f32_16x16x32_bf16 v[96:99], v[140:143], v[44:47], v[96:99]
  ds_read_b128 v[120:123], v9 offset:8192
  ds_read_b128 v[124:127], v9 offset:26624
  ds_read_b128 v[128:131], v12 offset:8192
  ds_read_b128 v[132:135], v12 offset:26624
  ds_read_b128 v[136:139], v13 offset:8192
  s_waitcnt lgkmcnt(8)
  v_mfma_f32_16x16x32_bf16 v[100:103], v[144:147], v[44:47], v[100:103]
  s_waitcnt lgkmcnt(7)
  v_mfma_f32_16x16x32_bf16 v[104:107], v[148:151], v[44:47], v[104:107]
  s_waitcnt lgkmcnt(6)
  v_mfma_f32_16x16x32_bf16 v[108:111], v[152:155], v[44:47], v[108:111]
  s_waitcnt lgkmcnt(5)
  v_mfma_f32_16x16x32_bf16 v[112:115], v[156:159], v[44:47], v[112:115]
  s_waitcnt vmcnt(9)
  s_waitcnt lgkmcnt(4)
  v_mfma_f32_16x16x32_bf16 v[96:99], v[120:123], v[48:51], v[96:99]
  ds_read_b128 v[140:143], v9 offset:9216
  ds_read_b128 v[144:147], v9 offset:27648
  ds_read_b128 v[148:151], v12 offset:9216
  ds_read_b128 v[152:155], v12 offset:27648
  ds_read_b128 v[156:159], v13 offset:9216
  s_waitcnt lgkmcnt(8)
  v_mfma_f32_16x16x32_bf16 v[100:103], v[124:127], v[48:51], v[100:103]
  s_waitcnt lgkmcnt(7)
  v_mfma_f32_16x16x32_bf16 v[104:107], v[128:131], v[48:51], v[104:107]
  s_waitcnt lgkmcnt(6)
  v_mfma_f32_16x16x32_bf16 v[108:111], v[132:135], v[48:51], v[108:111]
  s_waitcnt lgkmcnt(5)
  v_mfma_f32_16x16x32_bf16 v[112:115], v[136:139], v[48:51], v[112:115]
  s_waitcnt vmcnt(8)
  s_waitcnt lgkmcnt(4)
  v_mfma_f32_16x16x32_bf16 v[96:99], v[140:143], v[52:55], v[96:99]
  ds_read_b128 v[120:123], v9 offset:10240
  ds_read_b128 v[124:127], v9 offset:28672
  ds_read_b128 v[128:131], v12 offset:10240
  ds_read_b128 v[132:135], v12 offset:28672
  ds_read_b128 v[136:139], v13 offset:10240
  s_waitcnt lgkmcnt(8)
  v_mfma_f32_16x16x32_bf16 v[100:103], v[144:147], v[52:55], v[100:103]
  s_waitcnt lgkmcnt(7)
  v_mfma_f32_16x16x32_bf16 v[104:107], v[148:151], v[52:55], v[104:107]
  s_waitcnt lgkmcnt(6)
  v_mfma_f32_16x16x32_bf16 v[108:111], v[152:155], v[52:55], v[108:111]
  s_waitcnt lgkmcnt(5)
  v_mfma_f32_16x16x32_bf16 v[112:115], v[156:159], v[52:55], v[112:115]
  s_waitcnt vmcnt(7)
  s_waitcnt lgkmcnt(4)
  v_mfma_f32_16x16x32_bf16 v[96:99], v[120:123], v[56:59], v[96:99]
  ds_read_b128 v[140:143], v9 offset:11264
  ds_read_b128 v[144:147], v9 offset:29696
  ds_read_b128 v[148:151], v12 offset:11264
  ds_read_b128 v[152:155], v12 offset:29696
  ds_read_b128 v[156:159], v13 offset:11264
  s_waitcnt lgkmcnt(8)
  v_mfma_f32_16x16x32_bf16 v[100:103], v[124:127], v[56:59], v[100:103]
  s_waitcnt lgkmcnt(7)
  v_mfma_f32_16x16x32_bf16 v[104:107], v[128:131], v[56:59], v[104:107]
  s_waitcnt lgkmcnt(6)
  v_mfma_f32_16x16x32_bf16 v[108:111], v[132:135], v[56:59], v[108:111]
  s_waitcnt lgkmcnt(5)
  v_mfma_f32_16x16x32_bf16 v[112:115], v[136:139], v[56:59], v[112:115]
  s_waitcnt vmcnt(6)
  s_waitcnt lgkmcnt(4)
  v_mfma_f32_16x16x32_bf16 v[96:99], v[140:143], v[60:63], v[96:99]
  s_waitcnt lgkmcnt(3)
  v_mfma_f32_16x16x32_bf16 v[100:103], v[144:147], v[60:63], v[100:103]
  s_waitcnt lgkmcnt(2)
  v_mfma_f32_16x16x32_bf16 v[104:107], v[148:151], v[60:63], v[104:107]
  s_waitcnt lgkmcnt(1)
  v_mfma_f32_16x16x32_bf16 v[108:111], v[152:155], v[60:63], v[108:111]
  s_waitcnt lgkmcnt(0)
  v_mfma_f32_16x16x32_bf16 v[112:115], v[156:159], v[60:63], v[112:115]
  s_barrier
  ds_read_b128 v[120:123], v9 offset:12288
  ds_read_b128 v[124:127], v9 offset:30720
  ds_read_b128 v[128:131], v12 offset:12288
  ds_read_b128 v[132:135], v12 offset:30720
  ds_read_b128 v[136:139], v13 offset:12288
  s_waitcnt vmcnt(5)
  s_waitcnt lgkmcnt(4)
  v_mfma_f32_16x16x32_bf16 v[96:99], v[120:123], v[64:67], v[96:99]
  ds_read_b128 v[140:143], v9 offset:13312
  ds_read_b128 v[144:147], v9 offset:31744
  ds_read_b128 v[148:151], v12 offset:13312
  ds_read_b128 v[152:155], v12 offset:31744
  ds_read_b128 v[156:159], v13 offset:13312
  s_waitcnt lgkmcnt(8)
  v_mfma_f32_16x16x32_bf16 v[100:103], v[124:127], v[64:67], v[100:103]
  s_waitcnt lgkmcnt(7)
  v_mfma_f32_16x16x32_bf16 v[104:107], v[128:131], v[64:67], v[104:107]
  s_waitcnt lgkmcnt(6)
  v_mfma_f32_16x16x32_bf16 v[108:111], v[132:135], v[64:67], v[108:111]
  s_waitcnt lgkmcnt(5)
  v_mfma_f32_16x16x32_bf16 v[112:115], v[136:139], v[64:67], v[112:115]
  s_waitcnt vmcnt(4)
  s_waitcnt lgkmcnt(4)
  v_mfma_f32_16x16x32_bf16 v[96:99], v[140:143], v[68:71], v[96:99]
  ds_read_b128 v[120:123], v9 offset:14336
  ds_read_b128 v[124:127], v9 offset:32768
  ds_read_b128 v[128:131], v12 offset:14336
  ds_read_b128 v[132:135], v12 offset:32768
  ds_read_b128 v[136:139], v13 offset:14336
  s_waitcnt lgkmcnt(8)
  v_mfma_f32_16x16x32_bf16 v[100:103], v[144:147], v[68:71], v[100:103]
  s_waitcnt lgkmcnt(7)
  v_mfma_f32_16x16x32_bf16 v[104:107], v[148:151], v[68:71], v[104:107]
  s_waitcnt lgkmcnt(6)
  v_mfma_f32_16x16x32_bf16 v[108:111], v[152:155], v[68:71], v[108:111]
  s_waitcnt lgkmcnt(5)
  v_mfma_f32_16x16x32_bf16 v[112:115], v[156:159], v[68:71], v[112:115]
  s_waitcnt vmcnt(3)
  s_waitcnt lgkmcnt(4)
  v_mfma_f32_16x16x32_bf16 v[96:99], v[120:123], v[72:75], v[96:99]
  ds_read_b128 v[140:143], v9 offset:15360
  ds_read_b128 v[144:147], v9 offset:33792
  ds_read_b128 v[148:151], v12 offset:15360
  ds_read_b128 v[152:155], v12 offset:33792
  ds_read_b128 v[156:159], v13 offset:15360
  s_waitcnt lgkmcnt(8)
  v_mfma_f32_16x16x32_bf16 v[100:103], v[124:127], v[72:75], v[100:103]
  s_waitcnt lgkmcnt(7)
  v_mfma_f32_16x16x32_bf16 v[104:107], v[128:131], v[72:75], v[104:107]
  s_waitcnt lgkmcnt(6)
  v_mfma_f32_16x16x32_bf16 v[108:111], v[132:135], v[72:75], v[108:111]
  s_waitcnt lgkmcnt(5)
  v_mfma_f32_16x16x32_bf16 v[112:115], v[136:139], v[72:75], v[112:115]
  s_waitcnt vmcnt(2)
  s_waitcnt lgkmcnt(4)
  v_mfma_f32_16x16x32_bf16 v[96:99], v[140:143], v[76:79], v[96:99]
  ds_read_b128 v[120:123], v9 offset:16384
  ds_read_b128 v[124:127], v9 offset:34816
  ds_read_b128 v[128:131], v12 offset:16384
  ds_read_b128 v[132:135], v12 offset:34816
  ds_read_b128 v[136:139], v13 offset:16384
  s_waitcnt lgkmcnt(8)
  v_mfma_f32_16x16x32_bf16 v[100:103], v[144:147], v[76:79], v[100:103]
  s_waitcnt lgkmcnt(7)
  v_mfma_f32_16x16x32_bf16 v[104:107], v[148:151], v[76:79], v[104:107]
  s_waitcnt lgkmcnt(6)
  v_mfma_f32_16x16x32_bf16 v[108:111], v[152:155], v[76:79], v[108:111]
  s_waitcnt lgkmcnt(5)
  v_mfma_f32_16x16x32_bf16 v[112:115], v[156:159], v[76:79], v[112:115]
  s_waitcnt vmcnt(1)
  s_waitcnt lgkmcnt(4)
  v_mfma_f32_16x16x32_bf16 v[96:99], v[120:123], v[80:83], v[96:99]
  ds_read_b128 v[140:143], v9 offset:17408
  ds_read_b128 v[144:147], v9 offset:35840
  ds_read_b128 v[148:151], v12 offset:17408
  ds_read_b128 v[152:155], v12 offset:35840
  ds_read_b128 v[156:159], v13 offset:17408
  s_waitcnt lgkmcnt(8)
  v_mfma_f32_16x16x32_bf16 v[100:103], v[124:127], v[80:83], v[100:103]
  s_waitcnt lgkmcnt(7)
  v_mfma_f32_16x16x32_bf16 v[104:107], v[128:131], v[80:83], v[104:107]
  s_waitcnt lgkmcnt(6)
  v_mfma_f32_16x16x32_bf16 v[108:111], v[132:135], v[80:83], v[108:111]
  s_waitcnt lgkmcnt(5)
  v_mfma_f32_16x16x32_bf16 v[112:115], v[136:139], v[80:83], v[112:115]
  s_waitcnt vmcnt(0)
  s_waitcnt lgkmcnt(4)
  v_mfma_f32_16x16x32_bf16 v[96:99], v[140:143], v[84:87], v[96:99]
  s_waitcnt lgkmcnt(3)
  v_mfma_f32_16x16x32_bf16 v[100:103], v[144:147], v[84:87], v[100:103]
  s_waitcnt lgkmcnt(2)
  v_mfma_f32_16x16x32_bf16 v[104:107], v[148:151], v[84:87], v[104:107]
  s_waitcnt lgkmcnt(1)
  v_mfma_f32_16x16x32_bf16 v[108:111], v[152:155], v[84:87], v[108:111]
  s_waitcnt lgkmcnt(0)
  v_mfma_f32_16x16x32_bf16 v[112:115], v[156:159], v[84:87], v[112:115]
  s_lshr_b32 s33, s27, 1
  s_mul_i32 s33, s33, 72
  s_mul_i32 s36, s22, 9
  s_add_u32 s33, s33, s36
  s_lshl_b32 s33, s33, 9
  s_and_b32 s36, s20, 1
  s_lshl_b32 s36, s36, 8
  s_add_u32 s33, s33, s36
  s_add_u32 s33, s33, 7798784
  v_lshrrev_b32 v6, 1, v3
  v_lshlrev_b32 v6, 9, v6
  v_lshl_add_u32 v6, v2, 4, v6
  v_and_b32 v7, 1, v3
  v_lshl_add_u32 v6, v7, 3, v6
  v_mov_b32 v7, 0x7ff00000
  v_cmp_gt_u32 vcc, 32, v1
  v_cndmask_b32 v7, v7, v6, vcc
  s_nop 4
  v_lshlrev_b32 v10, 16, v160
  v_and_b32 v11, 0xffff0000, v160
  v_fma_f32 v10, v96, v172, v10
  v_fma_f32 v11, v97, v173, v11
  v_cvt_pk_bf16_f32 v160, v10, v11
  v_lshlrev_b32 v10, 16, v161
  v_and_b32 v11, 0xffff0000, v161
  v_fma_f32 v10, v98, v174, v10
  v_fma_f32 v11, v99, v175, v11
  v_cvt_pk_bf16_f32 v161, v10, v11
  buffer_store_dwordx2 v[160:161], v6, s[16:19], s33 offen offset:0 sc1
  v_lshlrev_b32 v10, 16, v162
  v_and_b32 v11, 0xffff0000, v162
  v_fma_f32 v10, v100, v176, v10
  v_fma_f32 v11, v101, v177, v11
  v_cvt_pk_bf16_f32 v162, v10, v11
  v_lshlrev_b32 v10, 16, v163
  v_and_b32 v11, 0xffff0000, v163
  v_fma_f32 v10, v102, v178, v10
  v_fma_f32 v11, v103, v179, v11
  v_cvt_pk_bf16_f32 v163, v10, v11
  buffer_store_dwordx2 v[162:163], v6, s[16:19], s33 offen offset:1024 sc1
  v_lshlrev_b32 v10, 16, v164
  v_and_b32 v11, 0xffff0000, v164
  v_fma_f32 v10, v104, v180, v10
  v_fma_f32 v11, v105, v181, v11
  v_cvt_pk_bf16_f32 v164, v10, v11
  v_lshlrev_b32 v10, 16, v165
  v_and_b32 v11, 0xffff0000, v165
  v_fma_f32 v10, v106, v182, v10
  v_fma_f32 v11, v107, v183, v11
  v_cvt_pk_bf16_f32 v165, v10, v11
  buffer_store_dwordx2 v[164:165], v6, s[16:19], s33 offen offset:2048 sc1
  v_lshlrev_b32 v10, 16, v166
  v_and_b32 v11, 0xffff0000, v166
  v_fma_f32 v10, v108, v184, v10
  v_fma_f32 v11, v109, v185, v11
  v_cvt_pk_bf16_f32 v166, v10, v11
  v_lshlrev_b32 v10, 16, v167
  v_and_b32 v11, 0xffff0000, v167
  v_fma_f32 v10, v110, v186, v10
  v_fma_f32 v11, v111, v187, v11
  v_cvt_pk_bf16_f32 v167, v10, v11
  buffer_store_dwordx2 v[166:167], v6, s[16:19], s33 offen offset:3072 sc1
  s_add_u32 s33, s33, 4096
  v_lshlrev_b32 v10, 16, v168
  v_and_b32 v11, 0xffff0000, v168
  v_fma_f32 v10, v112, v188, v10
  v_fma_f32 v11, v113, v189, v11
  v_cvt_pk_bf16_f32 v168, v10, v11
  v_lshlrev_b32 v10, 16, v169
  v_and_b32 v11, 0xffff0000, v169
  v_fma_f32 v10, v114, v190, v10
  v_fma_f32 v11, v115, v191, v11
  v_cvt_pk_bf16_f32 v169, v10, v11
  buffer_store_dwordx2 v[168:169], v7, s[16:19], s33 offen offset:0 sc1
  s_barrier
  s_load_dwordx4 s[4:7], s[0:1], 32
  s_load_dwordx2 s[32:33], s[0:1], 48
  s_load_dwordx2 s[34:35], s[0:1], 88
  v_lshrrev_b32 v10, 6, v0
  v_and_b32 v1, 63, v0
  v_readfirstlane_b32 s20, v10
  s_and_b32 s22, s2, 7
  s_lshr_b32 s21, s2, 3
  s_lshr_b32 s23, s22, 2
  s_and_b32 s22, s22, 3
  s_lshl_b32 s22, s22, 1
  s_and_b32 s24, s21, 1
  s_add_u32 s22, s22, s24
  s_lshr_b32 s21, s21, 1
  s_lshl_b32 s23, s23, 4
  s_add_u32 s21, s21, s23

  s_waitcnt lgkmcnt(0)
  s_cmp_ge_u32 s20, 2
  s_cselect_b32 s4, s6, s4
  s_cselect_b32 s5, s7, s5
  s_mov_b32 s8, s4
  s_and_b32 s9, s5, 0xffff
  s_mov_b32 s10, 5308416
  s_mov_b32 s11, 0x20000

  s_mov_b32 s12, s32
  s_and_b32 s13, s33, 0xffff
  s_mov_b32 s14, 5308416
  s_mov_b32 s15, 0x20000

  s_mov_b32 s16, s34
  s_and_b32 s17, s35, 0xffff
  s_mov_b32 s18, 268435456
  s_mov_b32 s19, 0x20000

  s_mov_b32 s28, s4
  s_and_b32 s29, s5, 0xffff
  s_mov_b32 s30, 5308416
  s_mov_b32 s31, 0x20000

  s_lshl_b32 s23, s20, 10
  v_lshrrev_b32 v10, 3, v1
  s_and_b32 s36, s20, 1
  s_lshl_b32 s36, s36, 3
  v_add_u32 v10, s36, v10
  v_and_b32 v11, 2, v10
  s_lshr_b32 s37, s20, 1
  s_lshl_b32 s37, s37, 2
  v_or_b32 v11, s37, v11
  v_and_b32 v12, 7, v1
  v_xor_b32 v12, v12, v11
  v_mul_u32_u24 v10, 9216, v10
  v_lshl_add_u32 v5, v12, 4, v10
  v_lshrrev_b32 v10, 4, v1
  v_bfe_u32 v11, v1, 2, 2
  v_xor_b32 v11, v11, v10
  v_and_b32 v12, 3, v1
  v_lshl_add_u32 v11, v11, 2, v12
  s_lshl_b32 s36, s20, 2
  v_add_u32 v10, s36, v10
  v_mul_u32_u24 v10, 1152, v10
  v_lshl_add_u32 v6, v11, 4, v10
  v_lshrrev_b32 v10, 3, v1
  v_bfe_u32 v11, v1, 1, 2
  v_bfe_u32 v12, v10, 1, 1
  v_lshlrev_b32 v12, 1, v12
  v_xor_b32 v11, v11, v12
  v_and_b32 v12, 1, v1
  v_lshl_add_u32 v11, v11, 1, v12
  s_lshl_b32 s36, s20, 3
  v_add_u32 v10, s36, v10
  v_mul_u32_u24 v10, 1152, v10
  v_lshl_add_u32 v7, v11, 4, v10
  v_lshrrev_b32 v10, 4, v1
  v_bfe_u32 v11, v1, 2, 2
  v_and_b32 v12, 3, v1
  v_and_b32 v13, 1, v10
  v_lshrrev_b32 v14, 1, v10
  v_lshl_add_u32 v14, v14, 3, v11
  v_lshlrev_b32 v14, 7, v14
  v_lshl_add_u32 v14, v13, 11, v14
  v_lshrrev_b32 v15, 1, v11
  v_lshl_add_u32 v15, v13, 1, v15
  v_xor_b32 v15, s20, v15
  v_lshl_add_u32 v14, v15, 5, v14
  v_lshl_add_u32 v2, v12, 3, v14
  v_lshrrev_b32 v14, 1, v10
  v_lshl_add_u32 v14, v14, 2, v11
  v_lshlrev_b32 v14, 8, v14
  v_xor_b32 v15, s20, v11
  v_lshl_add_u32 v14, v15, 6, v14
  v_lshl_add_u32 v14, v13, 5, v14
  v_lshl_add_u32 v3, v12, 3, v14
  v_lshrrev_b32 v14, 1, v10
  v_lshl_add_u32 v14, v14, 2, v11
  v_lshlrev_b32 v14, 7, v14
  v_lshrrev_b32 v15, 1, v11
  s_lshr_b32 s36, s20, 1
  v_xor_b32 v15, s36, v15
  v_lshl_add_u32 v14, v15, 6, v14
  v_lshl_add_u32 v14, v13, 5, v14
  v_lshl_add_u32 v4, v12, 3, v14
  v_lshlrev_b32 v9, 4, v1
  v_add_u32 v90, 36864, v2
  v_add_u32 v91, 36864, v3
  v_add_u32 v92, 36864, v4
  v_add_u32 v93, 73728, v9
  v_add_u32 v94, 139264, v9
  s_lshl_b32 s36, s20, 11
  s_add_u32 s36, s36, 73728
  v_add_u32 v8, s36, v9
  s_mul_i32 s24, s22, 1152
  s_mul_i32 s38, s22, 663552
  s_add_u32 s39, s38, 1024
  s_lshl_b32 s26, s22, 5
  s_add_u32 s26, s26, s21
  s_mul_i32 s26, s26, 73728
  s_add_u32 s26, s26, 10485760
  s_waitcnt vmcnt(0)
  s_barrier
  s_cmp_lg_u32 s20, 0
  s_cbranch_scc1 f_kernel_h1_seen
  s_lshl_b32 s36, s21, 7
  s_add_u32 s36, s36, 36864
  s_lshl_b32 s37, s22, 2
  s_add_u32 s37, s37, s36
  v_mov_b32 v10, 0
  v_mov_b32 v11, 1
  v_lshlrev_b32 v14, 2, v1
  s_mov_b64 exec, 1
  buffer_store_dword v11, v10, s[16:19], s37 offen sc1
  s_mov_b64 exec, 0xff
  s_mov_b32 s40, 0
  f_kernel_h1_poll:
  buffer_load_dword v15, v14, s[16:19], s36 offen sc1
  s_waitcnt vmcnt(0)
  v_cmp_eq_u32 vcc, 1, v15
  s_add_u32 s40, s40, 1
  s_cmp_eq_u32 vcc_lo, 0xff
  s_cbranch_scc1 f_kernel_h1_got
  s_cmp_lt_u32 s40, 400000
  s_cbranch_scc1 f_kernel_h1_poll
  f_kernel_h1_got:
  s_mov_b64 exec, -1
  f_kernel_h1_seen:
  s_add_u32 m0, s23, 147456
  s_add_u32 s42, s23, 6912
  buffer_load_dwordx4 v9, s[16:19], s42 offen lds
  s_mov_b32 m0, 151552
  s_mov_b32 s42, 11008
  buffer_load_dwordx4 v9, s[16:19], s42 offen lds
  s_add_u32 m0, s23, 0
  s_nop 0
  buffer_load_dwordx4 v5, s[8:11], s24 offen lds
  s_add_u32 m0, s23, 4096
  s_add_u32 s24, s24, 147456
  buffer_load_dwordx4 v5, s[8:11], s24 offen lds
  s_add_u32 m0, s23, 8192
  s_add_u32 s24, s24, 147456
  buffer_load_dwordx4 v5, s[8:11], s24 offen lds
  s_add_u32 m0, s23, 12288
  s_add_u32 s24, s24, 147456
  buffer_load_dwordx4 v5, s[8:11], s24 offen lds
  s_add_u32 m0, s23, 16384
  s_add_u32 s24, s24, 147456
  buffer_load_dwordx4 v5, s[8:11], s24 offen lds
  s_add_u32 m0, s23, 20480
  s_add_u32 s24, s24, 147456
  buffer_load_dwordx4 v5, s[8:11], s24 offen lds
  s_add_u32 m0, s23, 24576
  s_add_u32 s24, s24, 147456
  buffer_load_dwordx4 v5, s[8:11], s24 offen lds
  s_add_u32 m0, s23, 28672
  s_add_u32 s24, s24, 147456
  buffer_load_dwordx4 v5, s[8:11], s24 offen lds
  s_add_u32 m0, s23, 32768
  s_add_u32 s24, s24, 147456
  buffer_load_dwordx4 v5, s[8:11], s24 offen lds
  s_add_u32 m0, s23, 36864
  s_add_u32 s24, s24, 147456
  buffer_load_dwordx4 v5, s[8:11], s24 offen lds
  s_add_u32 m0, s23, 40960
  s_add_u32 s24, s24, 147456
  buffer_load_dwordx4 v5, s[8:11], s24 offen lds
  s_add_u32 m0, s23, 45056
  s_add_u32 s24, s24, 147456
  buffer_load_dwordx4 v5, s[8:11], s24 offen lds
  s_add_u32 m0, s23, 49152
  s_add_u32 s24, s24, 147456
  buffer_load_dwordx4 v5, s[8:11], s24 offen lds
  s_add_u32 m0, s23, 53248
  s_add_u32 s24, s24, 147456
  buffer_load_dwordx4 v5, s[8:11], s24 offen lds
  s_barrier
  s_lshl_b32 s40, s21, 1
  s_mul_i32 s40, s40, 36
  s_mul_i32 s41, s20, 9
  s_add_u32 s40, s40, s41
  s_lshl_b32 s40, s40, 10
  s_add_u32 s40, s40, 7798784
  s_add_u32 s41, s40, 36864
  buffer_load_dwordx4 v[16:19], v9, s[16:19], s40 offen offset:0 sc1
  buffer_load_dwordx4 v[52:55], v9, s[16:19], s41 offen offset:0 sc1
  buffer_load_dwordx4 v[20:23], v9, s[16:19], s40 offen offset:1024 sc1
  buffer_load_dwordx4 v[56:59], v9, s[16:19], s41 offen offset:1024 sc1
  buffer_load_dwordx4 v[24:27], v9, s[16:19], s40 offen offset:2048 sc1
  buffer_load_dwordx4 v[60:63], v9, s[16:19], s41 offen offset:2048 sc1
  buffer_load_dwordx4 v[28:31], v9, s[16:19], s40 offen offset:3072 sc1
  buffer_load_dwordx4 v[64:67], v9, s[16:19], s41 offen offset:3072 sc1
  s_add_u32 s40, s40, 4096
  s_add_u32 s41, s41, 4096
  buffer_load_dwordx4 v[32:35], v9, s[16:19], s40 offen offset:0 sc1
  buffer_load_dwordx4 v[68:71], v9, s[16:19], s41 offen offset:0 sc1
  buffer_load_dwordx4 v[36:39], v9, s[16:19], s40 offen offset:1024 sc1
  buffer_load_dwordx4 v[72:75], v9, s[16:19], s41 offen offset:1024 sc1
  buffer_load_dwordx4 v[40:43], v9, s[16:19], s40 offen offset:2048 sc1
  buffer_load_dwordx4 v[76:79], v9, s[16:19], s41 offen offset:2048 sc1
  buffer_load_dwordx4 v[44:47], v9, s[16:19], s40 offen offset:3072 sc1
  buffer_load_dwordx4 v[80:83], v9, s[16:19], s41 offen offset:3072 sc1
  s_add_u32 s40, s40, 4096
  s_add_u32 s41, s41, 4096
  buffer_load_dwordx4 v[48:51], v9, s[16:19], s40 offen offset:0 sc1
  buffer_load_dwordx4 v[84:87], v9, s[16:19], s41 offen offset:0 sc1
  s_waitcnt vmcnt(32)
  s_barrier
  v_lshrrev_b32 v12, 5, v1
  v_lshlrev_b32 v12, 5, v12
  s_mul_i32 s36, s20, 576
  s_add_u32 s36, s36, 147456
  v_add_u32 v12, s36, v12
  ds_read_b128 v[96:99], v12 offset:2304
  ds_read_b128 v[100:103], v12 offset:2320
  ds_read_b128 v[104:107], v12 offset:0
  ds_read_b128 v[108:111], v12 offset:16
  ds_read_b128 v[112:115], v12 offset:2368
  ds_read_b128 v[116:119], v12 offset:2384
  ds_read_b128 v[120:123], v12 offset:64
  ds_read_b128 v[124:127], v12 offset:80
  ds_read_b128 v[128:131], v12 offset:2432
  ds_read_b128 v[132:135], v12 offset:2448
  ds_read_b128 v[136:139], v12 offset:128
  ds_read_b128 v[140:143], v12 offset:144
  ds_read_b128 v[144:147], v12 offset:2496
  ds_read_b128 v[148:151], v12 offset:2512
  ds_read_b128 v[152:155], v12 offset:192
  ds_read_b128 v[156:159], v12 offset:208
  ds_read_b128 v[160:163], v12 offset:2560
  ds_read_b128 v[164:167], v12 offset:2576
  ds_read_b128 v[168:171], v12 offset:256
  ds_read_b128 v[172:175], v12 offset:272
  ds_read_b128 v[176:179], v12 offset:2624
  ds_read_b128 v[180:183], v12 offset:2640
  ds_read_b128 v[184:187], v12 offset:320
  ds_read_b128 v[188:191], v12 offset:336
  ds_read_b128 v[192:195], v12 offset:2688
  ds_read_b128 v[196:199], v12 offset:2704
  ds_read_b128 v[200:203], v12 offset:384
  ds_read_b128 v[204:207], v12 offset:400
  ds_read_b128 v[208:211], v12 offset:2752
  ds_read_b128 v[212:215], v12 offset:2768
  ds_read_b128 v[216:219], v12 offset:448
  ds_read_b128 v[220:223], v12 offset:464
  ds_read_b128 v[224:227], v12 offset:2816
  ds_read_b128 v[228:231], v12 offset:2832
  ds_read_b128 v[232:235], v12 offset:512
  ds_read_b128 v[236:239], v12 offset:528
  v_mov_b32 v240, 0
  v_mov_b32 v241, 0
  v_mov_b32 v242, 0
  v_mov_b32 v243, 0
  v_mov_b32 v14, 0x3f803f80
  s_waitcnt vmcnt(17)
  v_dot2c_f32_bf16 v240, v16, v14
  v_dot2c_f32_bf16 v241, v16, v16
  v_dot2c_f32_bf16 v240, v17, v14
  v_dot2c_f32_bf16 v241, v17, v17
  v_dot2c_f32_bf16 v240, v18, v14
  v_dot2c_f32_bf16 v241, v18, v18
  v_dot2c_f32_bf16 v240, v19, v14
  v_dot2c_f32_bf16 v241, v19, v19
  s_waitcnt vmcnt(16)
  v_dot2c_f32_bf16 v242, v52, v14
  v_dot2c_f32_bf16 v243, v52, v52
  v_dot2c_f32_bf16 v242, v53, v14
  v_dot2c_f32_bf16 v243, v53, v53
  v_dot2c_f32_bf16 v242, v54, v14
  v_dot2c_f32_bf16 v243, v54, v54
  v_dot2c_f32_bf16 v242, v55, v14
  v_dot2c_f32_bf16 v243, v55, v55
  s_waitcnt vmcnt(15)
  v_dot2c_f32_bf16 v240, v20, v14
  v_dot2c_f32_bf16 v241, v20, v20
  v_dot2c_f32_bf16 v240, v21, v14
  v_dot2c_f32_bf16 v241, v21, v21
  v_dot2c_f32_bf16 v240, v22, v14
  v_dot2c_f32_bf16 v241, v22, v22
  v_dot2c_f32_bf16 v240, v23, v14
  v_dot2c_f32_bf16 v241, v23, v23
  s_waitcnt vmcnt(14)
  v_dot2c_f32_bf16 v242, v56, v14
  v_dot2c_f32_bf16 v243, v56, v56
  v_dot2c_f32_bf16 v242, v57, v14
  v_dot2c_f32_bf16 v243, v57, v57
  v_dot2c_f32_bf16 v242, v58, v14
  v_dot2c_f32_bf16 v243, v58, v58
  v_dot2c_f32_bf16 v242, v59, v14
  v_dot2c_f32_bf16 v243, v59, v59
  s_waitcnt vmcnt(13)
  v_dot2c_f32_bf16 v240, v24, v14
  v_dot2c_f32_bf16 v241, v24, v24
  v_dot2c_f32_bf16 v240, v25, v14
  v_dot2c_f32_bf16 v241, v25, v25
  v_dot2c_f32_bf16 v240, v26, v14
  v_dot2c_f32_bf16 v241, v26, v26
  v_dot2c_f32_bf16 v240, v27, v14
  v_dot2c_f32_bf16 v241, v27, v27
  s_waitcnt vmcnt(12)
  v_dot2c_f32_bf16 v242, v60, v14
  v_dot2c_f32_bf16 v243, v60, v60
  v_dot2c_f32_bf16 v242, v61, v14
  v_dot2c_f32_bf16 v243, v61, v61
  v_dot2c_f32_bf16 v242, v62, v14
  v_dot2c_f32_bf16 v243, v62, v62
  v_dot2c_f32_bf16 v242, v63, v14
  v_dot2c_f32_bf16 v243, v63, v63
  s_waitcnt vmcnt(11)
  v_dot2c_f32_bf16 v240, v28, v14
  v_dot2c_f32_bf16 v241, v28, v28
  v_dot2c_f32_bf16 v240, v29, v14
  v_dot2c_f32_bf16 v241, v29, v29
  v_dot2c_f32_bf16 v240, v30, v14
  v_dot2c_f32_bf16 v241, v30, v30
  v_dot2c_f32_bf16 v240, v31, v14
  v_dot2c_f32_bf16 v241, v31, v31
  s_waitcnt vmcnt(10)
  v_dot2c_f32_bf16 v242, v64, v14
  v_dot2c_f32_bf16 v243, v64, v64
  v_dot2c_f32_bf16 v242, v65, v14
  v_dot2c_f32_bf16 v243, v65, v65
  v_dot2c_f32_bf16 v242, v66, v14
  v_dot2c_f32_bf16 v243, v66, v66
  v_dot2c_f32_bf16 v242, v67, v14
  v_dot2c_f32_bf16 v243, v67, v67
  s_waitcnt vmcnt(9)
  v_dot2c_f32_bf16 v240, v32, v14
  v_dot2c_f32_bf16 v241, v32, v32
  v_dot2c_f32_bf16 v240, v33, v14
  v_dot2c_f32_bf16 v241, v33, v33
  v_dot2c_f32_bf16 v240, v34, v14
  v_dot2c_f32_bf16 v241, v34, v34
  v_dot2c_f32_bf16 v240, v35, v14
  v_dot2c_f32_bf16 v241, v35, v35
  s_waitcnt vmcnt(8)
  v_dot2c_f32_bf16 v242, v68, v14
  v_dot2c_f32_bf16 v243, v68, v68
  v_dot2c_f32_bf16 v242, v69, v14
  v_dot2c_f32_bf16 v243, v69, v69
  v_dot2c_f32_bf16 v242, v70, v14
  v_dot2c_f32_bf16 v243, v70, v70
  v_dot2c_f32_bf16 v242, v71, v14
  v_dot2c_f32_bf16 v243, v71, v71
  s_waitcnt vmcnt(7)
  v_dot2c_f32_bf16 v240, v36, v14
  v_dot2c_f32_bf16 v241, v36, v36
  v_dot2c_f32_bf16 v240, v37, v14
  v_dot2c_f32_bf16 v241, v37, v37
  v_dot2c_f32_bf16 v240, v38, v14
  v_dot2c_f32_bf16 v241, v38, v38
  v_dot2c_f32_bf16 v240, v39, v14
  v_dot2c_f32_bf16 v241, v39, v39
  s_waitcnt vmcnt(6)
  v_dot2c_f32_bf16 v242, v72, v14
  v_dot2c_f32_bf16 v243, v72, v72
  v_dot2c_f32_bf16 v242, v73, v14
  v_dot2c_f32_bf16 v243, v73, v73
  v_dot2c_f32_bf16 v242, v74, v14
  v_dot2c_f32_bf16 v243, v74, v74
  v_dot2c_f32_bf16 v242, v75, v14
  v_dot2c_f32_bf16 v243, v75, v75
  s_waitcnt vmcnt(5)
  v_dot2c_f32_bf16 v240, v40, v14
  v_dot2c_f32_bf16 v241, v40, v40
  v_dot2c_f32_bf16 v240, v41, v14
  v_dot2c_f32_bf16 v241, v41, v41
  v_dot2c_f32_bf16 v240, v42, v14
  v_dot2c_f32_bf16 v241, v42, v42
  v_dot2c_f32_bf16 v240, v43, v14
  v_dot2c_f32_bf16 v241, v43, v43
  s_waitcnt vmcnt(4)
  v_dot2c_f32_bf16 v242, v76, v14
  v_dot2c_f32_bf16 v243, v76, v76
  v_dot2c_f32_bf16 v242, v77, v14
  v_dot2c_f32_bf16 v243, v77, v77
  v_dot2c_f32_bf16 v242, v78, v14
  v_dot2c_f32_bf16 v243, v78, v78
  v_dot2c_f32_bf16 v242, v79, v14
  v_dot2c_f32_bf16 v243, v79, v79
  s_waitcnt vmcnt(3)
  v_dot2c_f32_bf16 v240, v44, v14
  v_dot2c_f32_bf16 v241, v44, v44
  v_dot2c_f32_bf16 v240, v45, v14
  v_dot2c_f32_bf16 v241, v45, v45
  v_dot2c_f32_bf16 v240, v46, v14
  v_dot2c_f32_bf16 v241, v46, v46
  v_dot2c_f32_bf16 v240, v47, v14
  v_dot2c_f32_bf16 v241, v47, v47
  s_waitcnt vmcnt(2)
  v_dot2c_f32_bf16 v242, v80, v14
  v_dot2c_f32_bf16 v243, v80, v80
  v_dot2c_f32_bf16 v242, v81, v14
  v_dot2c_f32_bf16 v243, v81, v81
  v_dot2c_f32_bf16 v242, v82, v14
  v_dot2c_f32_bf16 v243, v82, v82
  v_dot2c_f32_bf16 v242, v83, v14
  v_dot2c_f32_bf16 v243, v83, v83
  s_waitcnt vmcnt(1)
  v_dot2c_f32_bf16 v240, v48, v14
  v_dot2c_f32_bf16 v241, v48, v48
  v_dot2c_f32_bf16 v240, v49, v14
  v_dot2c_f32_bf16 v241, v49, v49
  v_dot2c_f32_bf16 v240, v50, v14
  v_dot2c_f32_bf16 v241, v50, v50
  v_dot2c_f32_bf16 v240, v51, v14
  v_dot2c_f32_bf16 v241, v51, v51
  s_waitcnt vmcnt(0)
  v_dot2c_f32_bf16 v242, v84, v14
  v_dot2c_f32_bf16 v243, v84, v84
  v_dot2c_f32_bf16 v242, v85, v14
  v_dot2c_f32_bf16 v243, v85, v85
  v_dot2c_f32_bf16 v242, v86, v14
  v_dot2c_f32_bf16 v243, v86, v86
  v_dot2c_f32_bf16 v242, v87, v14
  v_dot2c_f32_bf16 v243, v87, v87
  s_nop 2
  v_mov_b32 v244, v240
  v_mov_b32 v245, v241
  v_mov_b32 v246, v242
  v_mov_b32 v247, v243
  s_nop 1
  v_permlane32_swap_b32 v244, v240
  v_permlane32_swap_b32 v245, v241
  v_permlane32_swap_b32 v246, v242
  v_permlane32_swap_b32 v247, v243
  s_nop 1
  v_add_f32 v240, v244, v240
  v_add_f32 v241, v245, v241
  v_add_f32 v242, v246, v242
  v_add_f32 v243, v247, v243
  v_and_b32 v10, 31, v1
  v_lshlrev_b32 v10, 4, v10
  v_add_u32 v10, 152576, v10
  s_lshl_b32 s36, s20, 9
  v_add_u32 v11, s36, v10
  ds_write_b128 v11, v[240:243]
  s_waitcnt lgkmcnt(0)
  s_barrier
  ds_read_b128 v[240:243], v10 offset:0
  ds_read_b128 v[244:247], v10 offset:512
  ds_read_b128 v[248:251], v10 offset:1024
  ds_read_b128 v[252:255], v10 offset:1536
  s_waitcnt lgkmcnt(0)
  v_add_f32 v240, v240, v244
  v_add_f32 v248, v248, v252
  v_add_f32 v240, v240, v248
  v_add_f32 v241, v241, v245
  v_add_f32 v249, v249, v253
  v_add_f32 v241, v241, v249
  v_add_f32 v242, v242, v246
  v_add_f32 v250, v250, v254
  v_add_f32 v242, v242, v250
  v_add_f32 v243, v243, v247
  v_add_f32 v251, v251, v255
  v_add_f32 v243, v243, v251
  v_mul_f32 v240, 0x3ae38e39, v240
  v_mul_f32 v241, 0x3ae38e39, v241
  v_fma_f32 v241, -v240, v240, v241
  v_max_f32 v241, 0, v241
  v_add_f32 v241, 0x3727c5ac, v241
  v_rsq_f32 v241, v241
  s_nop 0
  v_mul_f32 v240, v240, v241
  v_sub_f32 v240, 0, v240
  v_mov_b32 v244, v241
  v_mov_b32 v245, v241
  v_mov_b32 v246, v240
  v_mov_b32 v247, v240
  v_mul_f32 v242, 0x3ae38e39, v242
  v_mul_f32 v243, 0x3ae38e39, v243
  v_fma_f32 v243, -v242, v242, v243
  v_max_f32 v243, 0, v243
  v_add_f32 v243, 0x3727c5ac, v243
  v_rsq_f32 v243, v243
  s_nop 0
  v_mul_f32 v242, v242, v243
  v_sub_f32 v242, 0, v242
  v_mov_b32 v248, v243
  v_mov_b32 v249, v243
  v_mov_b32 v250, v242
  v_mov_b32 v251, v242
  s_mul_i32 s36, s20, 18
  s_lshl_b32 s36, s36, 10
  s_add_u32 s36, s36, 73728
  v_add_u32 v13, s36, v9
  v_lshlrev_b32 v240, 16, v16
  v_and_b32 v241, 0xffff0000, v16
  v_lshlrev_b32 v242, 16, v17
  v_and_b32 v243, 0xffff0000, v17
  v_lshlrev_b32 v252, 16, v18
  v_and_b32 v253, 0xffff0000, v18
  v_lshlrev_b32 v254, 16, v19
  v_and_b32 v255, 0xffff0000, v19
  v_pk_fma_f32 v[240:241], v[240:241], v[244:245], v[246:247]
  v_pk_fma_f32 v[242:243], v[242:243], v[244:245], v[246:247]
  v_pk_fma_f32 v[252:253], v[252:253], v[244:245], v[246:247]
  v_pk_fma_f32 v[254:255], v[254:255], v[244:245], v[246:247]
  v_pk_fma_f32 v[240:241], v[240:241], v[96:97], v[104:105]
  v_pk_fma_f32 v[242:243], v[242:243], v[98:99], v[106:107]
  v_pk_fma_f32 v[252:253], v[252:253], v[100:101], v[108:109]
  v_pk_fma_f32 v[254:255], v[254:255], v[102:103], v[110:111]
  v_cvt_pk_bf16_f32 v16, v240, v241
  v_cvt_pk_bf16_f32 v17, v242, v243
  v_cvt_pk_bf16_f32 v18, v252, v253
  v_cvt_pk_bf16_f32 v19, v254, v255
  ds_write_b128 v13, v[16:19] offset:0
  v_lshlrev_b32 v240, 16, v52
  v_and_b32 v241, 0xffff0000, v52
  v_lshlrev_b32 v242, 16, v53
  v_and_b32 v243, 0xffff0000, v53
  v_lshlrev_b32 v252, 16, v54
  v_and_b32 v253, 0xffff0000, v54
  v_lshlrev_b32 v254, 16, v55
  v_and_b32 v255, 0xffff0000, v55
  v_pk_fma_f32 v[240:241], v[240:241], v[248:249], v[250:251]
  v_pk_fma_f32 v[242:243], v[242:243], v[248:249], v[250:251]
  v_pk_fma_f32 v[252:253], v[252:253], v[248:249], v[250:251]
  v_pk_fma_f32 v[254:255], v[254:255], v[248:249], v[250:251]
  v_pk_fma_f32 v[240:241], v[240:241], v[96:97], v[104:105]
  v_pk_fma_f32 v[242:243], v[242:243], v[98:99], v[106:107]
  v_pk_fma_f32 v[252:253], v[252:253], v[100:101], v[108:109]
  v_pk_fma_f32 v[254:255], v[254:255], v[102:103], v[110:111]
  v_cvt_pk_bf16_f32 v52, v240, v241
  v_cvt_pk_bf16_f32 v53, v242, v243
  v_cvt_pk_bf16_f32 v54, v252, v253
  v_cvt_pk_bf16_f32 v55, v254, v255
  ds_write_b128 v13, v[52:55] offset:1024
  v_lshlrev_b32 v240, 16, v20
  v_and_b32 v241, 0xffff0000, v20
  v_lshlrev_b32 v242, 16, v21
  v_and_b32 v243, 0xffff0000, v21
  v_lshlrev_b32 v252, 16, v22
  v_and_b32 v253, 0xffff0000, v22
  v_lshlrev_b32 v254, 16, v23
  v_and_b32 v255, 0xffff0000, v23
  v_pk_fma_f32 v[240:241], v[240:241], v[244:245], v[246:247]
  v_pk_fma_f32 v[242:243], v[242:243], v[244:245], v[246:247]
  v_pk_fma_f32 v[252:253], v[252:253], v[244:245], v[246:247]
  v_pk_fma_f32 v[254:255], v[254:255], v[244:245], v[246:247]
  v_pk_fma_f32 v[240:241], v[240:241], v[112:113], v[120:121]
  v_pk_fma_f32 v[242:243], v[242:243], v[114:115], v[122:123]
  v_pk_fma_f32 v[252:253], v[252:253], v[116:117], v[124:125]
  v_pk_fma_f32 v[254:255], v[254:255], v[118:119], v[126:127]
  v_cvt_pk_bf16_f32 v20, v240, v241
  v_cvt_pk_bf16_f32 v21, v242, v243
  v_cvt_pk_bf16_f32 v22, v252, v253
  v_cvt_pk_bf16_f32 v23, v254, v255
  ds_write_b128 v13, v[20:23] offset:2048
  v_lshlrev_b32 v240, 16, v56
  v_and_b32 v241, 0xffff0000, v56
  v_lshlrev_b32 v242, 16, v57
  v_and_b32 v243, 0xffff0000, v57
  v_lshlrev_b32 v252, 16, v58
  v_and_b32 v253, 0xffff0000, v58
  v_lshlrev_b32 v254, 16, v59
  v_and_b32 v255, 0xffff0000, v59
  v_pk_fma_f32 v[240:241], v[240:241], v[248:249], v[250:251]
  v_pk_fma_f32 v[242:243], v[242:243], v[248:249], v[250:251]
  v_pk_fma_f32 v[252:253], v[252:253], v[248:249], v[250:251]
  v_pk_fma_f32 v[254:255], v[254:255], v[248:249], v[250:251]
  v_pk_fma_f32 v[240:241], v[240:241], v[112:113], v[120:121]
  v_pk_fma_f32 v[242:243], v[242:243], v[114:115], v[122:123]
  v_pk_fma_f32 v[252:253], v[252:253], v[116:117], v[124:125]
  v_pk_fma_f32 v[254:255], v[254:255], v[118:119], v[126:127]
  v_cvt_pk_bf16_f32 v56, v240, v241
  v_cvt_pk_bf16_f32 v57, v242, v243
  v_cvt_pk_bf16_f32 v58, v252, v253
  v_cvt_pk_bf16_f32 v59, v254, v255
  ds_write_b128 v13, v[56:59] offset:3072
  v_lshlrev_b32 v240, 16, v24
  v_and_b32 v241, 0xffff0000, v24
  v_lshlrev_b32 v242, 16, v25
  v_and_b32 v243, 0xffff0000, v25
  v_lshlrev_b32 v252, 16, v26
  v_and_b32 v253, 0xffff0000, v26
  v_lshlrev_b32 v254, 16, v27
  v_and_b32 v255, 0xffff0000, v27
  v_pk_fma_f32 v[240:241], v[240:241], v[244:245], v[246:247]
  v_pk_fma_f32 v[242:243], v[242:243], v[244:245], v[246:247]
  v_pk_fma_f32 v[252:253], v[252:253], v[244:245], v[246:247]
  v_pk_fma_f32 v[254:255], v[254:255], v[244:245], v[246:247]
  v_pk_fma_f32 v[240:241], v[240:241], v[128:129], v[136:137]
  v_pk_fma_f32 v[242:243], v[242:243], v[130:131], v[138:139]
  v_pk_fma_f32 v[252:253], v[252:253], v[132:133], v[140:141]
  v_pk_fma_f32 v[254:255], v[254:255], v[134:135], v[142:143]
  v_cvt_pk_bf16_f32 v24, v240, v241
  v_cvt_pk_bf16_f32 v25, v242, v243
  v_cvt_pk_bf16_f32 v26, v252, v253
  v_cvt_pk_bf16_f32 v27, v254, v255
  ds_write_b128 v13, v[24:27] offset:4096
  v_lshlrev_b32 v240, 16, v60
  v_and_b32 v241, 0xffff0000, v60
  v_lshlrev_b32 v242, 16, v61
  v_and_b32 v243, 0xffff0000, v61
  v_lshlrev_b32 v252, 16, v62
  v_and_b32 v253, 0xffff0000, v62
  v_lshlrev_b32 v254, 16, v63
  v_and_b32 v255, 0xffff0000, v63
  v_pk_fma_f32 v[240:241], v[240:241], v[248:249], v[250:251]
  v_pk_fma_f32 v[242:243], v[242:243], v[248:249], v[250:251]
  v_pk_fma_f32 v[252:253], v[252:253], v[248:249], v[250:251]
  v_pk_fma_f32 v[254:255], v[254:255], v[248:249], v[250:251]
  v_pk_fma_f32 v[240:241], v[240:241], v[128:129], v[136:137]
  v_pk_fma_f32 v[242:243], v[242:243], v[130:131], v[138:139]
  v_pk_fma_f32 v[252:253], v[252:253], v[132:133], v[140:141]
  v_pk_fma_f32 v[254:255], v[254:255], v[134:135], v[142:143]
  v_cvt_pk_bf16_f32 v60, v240, v241
  v_cvt_pk_bf16_f32 v61, v242, v243
  v_cvt_pk_bf16_f32 v62, v252, v253
  v_cvt_pk_bf16_f32 v63, v254, v255
  ds_write_b128 v13, v[60:63] offset:5120
  v_lshlrev_b32 v240, 16, v28
  v_and_b32 v241, 0xffff0000, v28
  v_lshlrev_b32 v242, 16, v29
  v_and_b32 v243, 0xffff0000, v29
  v_lshlrev_b32 v252, 16, v30
  v_and_b32 v253, 0xffff0000, v30
  v_lshlrev_b32 v254, 16, v31
  v_and_b32 v255, 0xffff0000, v31
  v_pk_fma_f32 v[240:241], v[240:241], v[244:245], v[246:247]
  v_pk_fma_f32 v[242:243], v[242:243], v[244:245], v[246:247]
  v_pk_fma_f32 v[252:253], v[252:253], v[244:245], v[246:247]
  v_pk_fma_f32 v[254:255], v[254:255], v[244:245], v[246:247]
  v_pk_fma_f32 v[240:241], v[240:241], v[144:145], v[152:153]
  v_pk_fma_f32 v[242:243], v[242:243], v[146:147], v[154:155]
  v_pk_fma_f32 v[252:253], v[252:253], v[148:149], v[156:157]
  v_pk_fma_f32 v[254:255], v[254:255], v[150:151], v[158:159]
  v_cvt_pk_bf16_f32 v28, v240, v241
  v_cvt_pk_bf16_f32 v29, v242, v243
  v_cvt_pk_bf16_f32 v30, v252, v253
  v_cvt_pk_bf16_f32 v31, v254, v255
  ds_write_b128 v13, v[28:31] offset:6144
  v_lshlrev_b32 v240, 16, v64
  v_and_b32 v241, 0xffff0000, v64
  v_lshlrev_b32 v242, 16, v65
  v_and_b32 v243, 0xffff0000, v65
  v_lshlrev_b32 v252, 16, v66
  v_and_b32 v253, 0xffff0000, v66
  v_lshlrev_b32 v254, 16, v67
  v_and_b32 v255, 0xffff0000, v67
  v_pk_fma_f32 v[240:241], v[240:241], v[248:249], v[250:251]
  v_pk_fma_f32 v[242:243], v[242:243], v[248:249], v[250:251]
  v_pk_fma_f32 v[252:253], v[252:253], v[248:249], v[250:251]
  v_pk_fma_f32 v[254:255], v[254:255], v[248:249], v[250:251]
  v_pk_fma_f32 v[240:241], v[240:241], v[144:145], v[152:153]
  v_pk_fma_f32 v[242:243], v[242:243], v[146:147], v[154:155]
  v_pk_fma_f32 v[252:253], v[252:253], v[148:149], v[156:157]
  v_pk_fma_f32 v[254:255], v[254:255], v[150:151], v[158:159]
  v_cvt_pk_bf16_f32 v64, v240, v241
  v_cvt_pk_bf16_f32 v65, v242, v243
  v_cvt_pk_bf16_f32 v66, v252, v253
  v_cvt_pk_bf16_f32 v67, v254, v255
  ds_write_b128 v13, v[64:67] offset:7168
  v_lshlrev_b32 v240, 16, v32
  v_and_b32 v241, 0xffff0000, v32
  v_lshlrev_b32 v242, 16, v33
  v_and_b32 v243, 0xffff0000, v33
  v_lshlrev_b32 v252, 16, v34
  v_and_b32 v253, 0xffff0000, v34
  v_lshlrev_b32 v254, 16, v35
  v_and_b32 v255, 0xffff0000, v35
  v_pk_fma_f32 v[240:241], v[240:241], v[244:245], v[246:247]
  v_pk_fma_f32 v[242:243], v[242:243], v[244:245], v[246:247]
  v_pk_fma_f32 v[252:253], v[252:253], v[244:245], v[246:247]
  v_pk_fma_f32 v[254:255], v[254:255], v[244:245], v[246:247]
  v_pk_fma_f32 v[240:241], v[240:241], v[160:161], v[168:169]
  v_pk_fma_f32 v[242:243], v[242:243], v[162:163], v[170:171]
  v_pk_fma_f32 v[252:253], v[252:253], v[164:165], v[172:173]
  v_pk_fma_f32 v[254:255], v[254:255], v[166:167], v[174:175]
  v_cvt_pk_bf16_f32 v32, v240, v241
  v_cvt_pk_bf16_f32 v33, v242, v243
  v_cvt_pk_bf16_f32 v34, v252, v253
  v_cvt_pk_bf16_f32 v35, v254, v255
  ds_write_b128 v13, v[32:35] offset:8192
  v_lshlrev_b32 v240, 16, v68
  v_and_b32 v241, 0xffff0000, v68
  v_lshlrev_b32 v242, 16, v69
  v_and_b32 v243, 0xffff0000, v69
  v_lshlrev_b32 v252, 16, v70
  v_and_b32 v253, 0xffff0000, v70
  v_lshlrev_b32 v254, 16, v71
  v_and_b32 v255, 0xffff0000, v71
  v_pk_fma_f32 v[240:241], v[240:241], v[248:249], v[250:251]
  v_pk_fma_f32 v[242:243], v[242:243], v[248:249], v[250:251]
  v_pk_fma_f32 v[252:253], v[252:253], v[248:249], v[250:251]
  v_pk_fma_f32 v[254:255], v[254:255], v[248:249], v[250:251]
  v_pk_fma_f32 v[240:241], v[240:241], v[160:161], v[168:169]
  v_pk_fma_f32 v[242:243], v[242:243], v[162:163], v[170:171]
  v_pk_fma_f32 v[252:253], v[252:253], v[164:165], v[172:173]
  v_pk_fma_f32 v[254:255], v[254:255], v[166:167], v[174:175]
  v_cvt_pk_bf16_f32 v68, v240, v241
  v_cvt_pk_bf16_f32 v69, v242, v243
  v_cvt_pk_bf16_f32 v70, v252, v253
  v_cvt_pk_bf16_f32 v71, v254, v255
  ds_write_b128 v13, v[68:71] offset:9216
  v_lshlrev_b32 v240, 16, v36
  v_and_b32 v241, 0xffff0000, v36
  v_lshlrev_b32 v242, 16, v37
  v_and_b32 v243, 0xffff0000, v37
  v_lshlrev_b32 v252, 16, v38
  v_and_b32 v253, 0xffff0000, v38
  v_lshlrev_b32 v254, 16, v39
  v_and_b32 v255, 0xffff0000, v39
  v_pk_fma_f32 v[240:241], v[240:241], v[244:245], v[246:247]
  v_pk_fma_f32 v[242:243], v[242:243], v[244:245], v[246:247]
  v_pk_fma_f32 v[252:253], v[252:253], v[244:245], v[246:247]
  v_pk_fma_f32 v[254:255], v[254:255], v[244:245], v[246:247]
  v_pk_fma_f32 v[240:241], v[240:241], v[176:177], v[184:185]
  v_pk_fma_f32 v[242:243], v[242:243], v[178:179], v[186:187]
  v_pk_fma_f32 v[252:253], v[252:253], v[180:181], v[188:189]
  v_pk_fma_f32 v[254:255], v[254:255], v[182:183], v[190:191]
  v_cvt_pk_bf16_f32 v36, v240, v241
  v_cvt_pk_bf16_f32 v37, v242, v243
  v_cvt_pk_bf16_f32 v38, v252, v253
  v_cvt_pk_bf16_f32 v39, v254, v255
  ds_write_b128 v13, v[36:39] offset:10240
  v_lshlrev_b32 v240, 16, v72
  v_and_b32 v241, 0xffff0000, v72
  v_lshlrev_b32 v242, 16, v73
  v_and_b32 v243, 0xffff0000, v73
  v_lshlrev_b32 v252, 16, v74
  v_and_b32 v253, 0xffff0000, v74
  v_lshlrev_b32 v254, 16, v75
  v_and_b32 v255, 0xffff0000, v75
  v_pk_fma_f32 v[240:241], v[240:241], v[248:249], v[250:251]
  v_pk_fma_f32 v[242:243], v[242:243], v[248:249], v[250:251]
  v_pk_fma_f32 v[252:253], v[252:253], v[248:249], v[250:251]
  v_pk_fma_f32 v[254:255], v[254:255], v[248:249], v[250:251]
  v_pk_fma_f32 v[240:241], v[240:241], v[176:177], v[184:185]
  v_pk_fma_f32 v[242:243], v[242:243], v[178:179], v[186:187]
  v_pk_fma_f32 v[252:253], v[252:253], v[180:181], v[188:189]
  v_pk_fma_f32 v[254:255], v[254:255], v[182:183], v[190:191]
  v_cvt_pk_bf16_f32 v72, v240, v241
  v_cvt_pk_bf16_f32 v73, v242, v243
  v_cvt_pk_bf16_f32 v74, v252, v253
  v_cvt_pk_bf16_f32 v75, v254, v255
  ds_write_b128 v13, v[72:75] offset:11264
  v_lshlrev_b32 v240, 16, v40
  v_and_b32 v241, 0xffff0000, v40
  v_lshlrev_b32 v242, 16, v41
  v_and_b32 v243, 0xffff0000, v41
  v_lshlrev_b32 v252, 16, v42
  v_and_b32 v253, 0xffff0000, v42
  v_lshlrev_b32 v254, 16, v43
  v_and_b32 v255, 0xffff0000, v43
  v_pk_fma_f32 v[240:241], v[240:241], v[244:245], v[246:247]
  v_pk_fma_f32 v[242:243], v[242:243], v[244:245], v[246:247]
  v_pk_fma_f32 v[252:253], v[252:253], v[244:245], v[246:247]
  v_pk_fma_f32 v[254:255], v[254:255], v[244:245], v[246:247]
  v_pk_fma_f32 v[240:241], v[240:241], v[192:193], v[200:201]
  v_pk_fma_f32 v[242:243], v[242:243], v[194:195], v[202:203]
  v_pk_fma_f32 v[252:253], v[252:253], v[196:197], v[204:205]
  v_pk_fma_f32 v[254:255], v[254:255], v[198:199], v[206:207]
  v_cvt_pk_bf16_f32 v40, v240, v241
  v_cvt_pk_bf16_f32 v41, v242, v243
  v_cvt_pk_bf16_f32 v42, v252, v253
  v_cvt_pk_bf16_f32 v43, v254, v255
  ds_write_b128 v13, v[40:43] offset:12288
  v_lshlrev_b32 v240, 16, v76
  v_and_b32 v241, 0xffff0000, v76
  v_lshlrev_b32 v242, 16, v77
  v_and_b32 v243, 0xffff0000, v77
  v_lshlrev_b32 v252, 16, v78
  v_and_b32 v253, 0xffff0000, v78
  v_lshlrev_b32 v254, 16, v79
  v_and_b32 v255, 0xffff0000, v79
  v_pk_fma_f32 v[240:241], v[240:241], v[248:249], v[250:251]
  v_pk_fma_f32 v[242:243], v[242:243], v[248:249], v[250:251]
  v_pk_fma_f32 v[252:253], v[252:253], v[248:249], v[250:251]
  v_pk_fma_f32 v[254:255], v[254:255], v[248:249], v[250:251]
  v_pk_fma_f32 v[240:241], v[240:241], v[192:193], v[200:201]
  v_pk_fma_f32 v[242:243], v[242:243], v[194:195], v[202:203]
  v_pk_fma_f32 v[252:253], v[252:253], v[196:197], v[204:205]
  v_pk_fma_f32 v[254:255], v[254:255], v[198:199], v[206:207]
  v_cvt_pk_bf16_f32 v76, v240, v241
  v_cvt_pk_bf16_f32 v77, v242, v243
  v_cvt_pk_bf16_f32 v78, v252, v253
  v_cvt_pk_bf16_f32 v79, v254, v255
  ds_write_b128 v13, v[76:79] offset:13312
  v_lshlrev_b32 v240, 16, v44
  v_and_b32 v241, 0xffff0000, v44
  v_lshlrev_b32 v242, 16, v45
  v_and_b32 v243, 0xffff0000, v45
  v_lshlrev_b32 v252, 16, v46
  v_and_b32 v253, 0xffff0000, v46
  v_lshlrev_b32 v254, 16, v47
  v_and_b32 v255, 0xffff0000, v47
  v_pk_fma_f32 v[240:241], v[240:241], v[244:245], v[246:247]
  v_pk_fma_f32 v[242:243], v[242:243], v[244:245], v[246:247]
  v_pk_fma_f32 v[252:253], v[252:253], v[244:245], v[246:247]
  v_pk_fma_f32 v[254:255], v[254:255], v[244:245], v[246:247]
  v_pk_fma_f32 v[240:241], v[240:241], v[208:209], v[216:217]
  v_pk_fma_f32 v[242:243], v[242:243], v[210:211], v[218:219]
  v_pk_fma_f32 v[252:253], v[252:253], v[212:213], v[220:221]
  v_pk_fma_f32 v[254:255], v[254:255], v[214:215], v[222:223]
  v_cvt_pk_bf16_f32 v44, v240, v241
  v_cvt_pk_bf16_f32 v45, v242, v243
  v_cvt_pk_bf16_f32 v46, v252, v253
  v_cvt_pk_bf16_f32 v47, v254, v255
  ds_write_b128 v13, v[44:47] offset:14336
  v_lshlrev_b32 v240, 16, v80
  v_and_b32 v241, 0xffff0000, v80
  v_lshlrev_b32 v242, 16, v81
  v_and_b32 v243, 0xffff0000, v81
  v_lshlrev_b32 v252, 16, v82
  v_and_b32 v253, 0xffff0000, v82
  v_lshlrev_b32 v254, 16, v83
  v_and_b32 v255, 0xffff0000, v83
  v_pk_fma_f32 v[240:241], v[240:241], v[248:249], v[250:251]
  v_pk_fma_f32 v[242:243], v[242:243], v[248:249], v[250:251]
  v_pk_fma_f32 v[252:253], v[252:253], v[248:249], v[250:251]
  v_pk_fma_f32 v[254:255], v[254:255], v[248:249], v[250:251]
  v_pk_fma_f32 v[240:241], v[240:241], v[208:209], v[216:217]
  v_pk_fma_f32 v[242:243], v[242:243], v[210:211], v[218:219]
  v_pk_fma_f32 v[252:253], v[252:253], v[212:213], v[220:221]
  v_pk_fma_f32 v[254:255], v[254:255], v[214:215], v[222:223]
  v_cvt_pk_bf16_f32 v80, v240, v241
  v_cvt_pk_bf16_f32 v81, v242, v243
  v_cvt_pk_bf16_f32 v82, v252, v253
  v_cvt_pk_bf16_f32 v83, v254, v255
  ds_write_b128 v13, v[80:83] offset:15360
  v_lshlrev_b32 v240, 16, v48
  v_and_b32 v241, 0xffff0000, v48
  v_lshlrev_b32 v242, 16, v49
  v_and_b32 v243, 0xffff0000, v49
  v_lshlrev_b32 v252, 16, v50
  v_and_b32 v253, 0xffff0000, v50
  v_lshlrev_b32 v254, 16, v51
  v_and_b32 v255, 0xffff0000, v51
  v_pk_fma_f32 v[240:241], v[240:241], v[244:245], v[246:247]
  v_pk_fma_f32 v[242:243], v[242:243], v[244:245], v[246:247]
  v_pk_fma_f32 v[252:253], v[252:253], v[244:245], v[246:247]
  v_pk_fma_f32 v[254:255], v[254:255], v[244:245], v[246:247]
  v_pk_fma_f32 v[240:241], v[240:241], v[224:225], v[232:233]
  v_pk_fma_f32 v[242:243], v[242:243], v[226:227], v[234:235]
  v_pk_fma_f32 v[252:253], v[252:253], v[228:229], v[236:237]
  v_pk_fma_f32 v[254:255], v[254:255], v[230:231], v[238:239]
  v_cvt_pk_bf16_f32 v48, v240, v241
  v_cvt_pk_bf16_f32 v49, v242, v243
  v_cvt_pk_bf16_f32 v50, v252, v253
  v_cvt_pk_bf16_f32 v51, v254, v255
  ds_write_b128 v13, v[48:51] offset:16384
  v_lshlrev_b32 v240, 16, v84
  v_and_b32 v241, 0xffff0000, v84
  v_lshlrev_b32 v242, 16, v85
  v_and_b32 v243, 0xffff0000, v85
  v_lshlrev_b32 v252, 16, v86
  v_and_b32 v253, 0xffff0000, v86
  v_lshlrev_b32 v254, 16, v87
  v_and_b32 v255, 0xffff0000, v87
  v_pk_fma_f32 v[240:241], v[240:241], v[248:249], v[250:251]
  v_pk_fma_f32 v[242:243], v[242:243], v[248:249], v[250:251]
  v_pk_fma_f32 v[252:253], v[252:253], v[248:249], v[250:251]
  v_pk_fma_f32 v[254:255], v[254:255], v[248:249], v[250:251]
  v_pk_fma_f32 v[240:241], v[240:241], v[224:225], v[232:233]
  v_pk_fma_f32 v[242:243], v[242:243], v[226:227], v[234:235]
  v_pk_fma_f32 v[252:253], v[252:253], v[228:229], v[236:237]
  v_pk_fma_f32 v[254:255], v[254:255], v[230:231], v[238:239]
  v_cvt_pk_bf16_f32 v84, v240, v241
  v_cvt_pk_bf16_f32 v85, v242, v243
  v_cvt_pk_bf16_f32 v86, v252, v253
  v_cvt_pk_bf16_f32 v87, v254, v255
  ds_write_b128 v13, v[84:87] offset:17408
  s_waitcnt lgkmcnt(0)
  s_barrier
  ds_read_b128 a[0:3], v93 offset:0
  ds_read_b128 a[4:7], v93 offset:1024
  ds_read_b128 a[8:11], v93 offset:2048
  ds_read_b128 a[12:15], v93 offset:3072
  ds_read_b128 a[16:19], v93 offset:4096
  ds_read_b128 a[20:23], v93 offset:5120
  ds_read_b64_tr_b16 v[96:97], v2 offset:0
  ds_read_b64_tr_b16 v[98:99], v2 offset:512
  ds_read_b64_tr_b16 v[100:101], v2 offset:4096
  ds_read_b64_tr_b16 v[102:103], v2 offset:4608
  s_mov_b32 s46, 0x2000
  s_and_b32 s36, s21, 15
  s_mul_i32 s37, s36, 36
  s_and_b32 s56, s20, 1
  s_mul_i32 s56, s56, 18
  s_add_u32 s37, s37, s56
  v_add_u32 v95, s37, v1
  v_mul_u32_u24 v95, 9216, v95
  v_mov_b32 v15, 0x7ff00000
  v_cmp_gt_u32 vcc, 18, v1
  v_cndmask_b32 v95, v15, v95, vcc
  s_mul_i32 s56, s22, 1152
  s_add_u32 s56, s56, 256
  s_mul_i32 s37, s36, 324
  s_mul_i32 s57, s20, 27
  s_add_u32 s37, s37, s57
  v_add_u32 v14, s37, v1
  v_lshlrev_b32 v14, 7, v14
  v_cmp_gt_u32 vcc, 27, v1
  v_cndmask_b32 v14, v15, v14, vcc
  s_mov_b32 s57, s38
f_kernel_p1:
  s_waitcnt lgkmcnt(2)
  v_mfma_f32_32x32x16_bf16 v[128:143], v[96:99], a[0:3], 0
  ds_read_b64_tr_b16 v[104:105], v2 offset:8192
  ds_read_b64_tr_b16 v[106:107], v2 offset:8704
  ds_read_b128 a[24:27], v93 offset:6144
  v_mfma_f32_32x32x16_bf16 v[144:159], v[96:99], a[4:7], 0
  s_add_u32 m0, s23, 57344
  s_add_u32 s24, s24, 147456
  buffer_load_dwordx4 v5, s[8:11], s24 offen lds
  ds_read_b128 a[28:31], v93 offset:7168
  buffer_load_dword v15, v95, s[8:11], s56 offen
  s_add_u32 s56, s56, 128
  s_barrier
  s_waitcnt lgkmcnt(4)
  v_mfma_f32_32x32x16_bf16 v[128:143], v[100:103], a[8:11], v[128:143]
  ds_read_b64_tr_b16 v[108:109], v2 offset:12288
  ds_read_b64_tr_b16 v[110:111], v2 offset:12800
  ds_read_b128 a[32:35], v93 offset:8192
  v_mfma_f32_32x32x16_bf16 v[144:159], v[100:103], a[12:15], v[144:159]
  s_add_u32 m0, s23, 61440
  s_add_u32 s24, s24, 147456
  buffer_load_dwordx4 v5, s[8:11], s24 offen lds
  ds_read_b128 a[36:39], v93 offset:9216
  s_waitcnt lgkmcnt(6)
  v_mfma_f32_32x32x16_bf16 v[128:143], v[104:107], a[16:19], v[128:143]
  ds_read_b64_tr_b16 v[96:97], v2 offset:16384
  ds_read_b64_tr_b16 v[98:99], v2 offset:16896
  ds_read_b128 a[40:43], v93 offset:10240
  v_mfma_f32_32x32x16_bf16 v[144:159], v[104:107], a[20:23], v[144:159]
  s_add_u32 m0, s23, 65536
  s_add_u32 s24, s24, 147456
  buffer_load_dwordx4 v5, s[8:11], s24 offen lds
  ds_read_b128 a[44:47], v93 offset:11264
  s_waitcnt lgkmcnt(6)
  v_mfma_f32_32x32x16_bf16 v[128:143], v[108:111], a[24:27], v[128:143]
  ds_read_b64_tr_b16 v[100:101], v2 offset:20480
  ds_read_b64_tr_b16 v[102:103], v2 offset:20992
  ds_read_b128 a[48:51], v93 offset:12288
  v_mfma_f32_32x32x16_bf16 v[144:159], v[108:111], a[28:31], v[144:159]
  s_add_u32 m0, s23, 69632
  s_add_u32 s24, s24, 147456
  buffer_load_dwordx4 v5, s[8:11], s24 offen lds
  ds_read_b128 a[52:55], v93 offset:13312
  s_barrier
  s_waitcnt lgkmcnt(6)
  v_mfma_f32_32x32x16_bf16 v[128:143], v[96:99], a[32:35], v[128:143]
  ds_read_b64_tr_b16 v[104:105], v2 offset:24576
  ds_read_b64_tr_b16 v[106:107], v2 offset:25088
  ds_read_b128 a[56:59], v93 offset:14336
  v_mfma_f32_32x32x16_bf16 v[144:159], v[96:99], a[36:39], v[144:159]
  s_add_u32 m0, s23, 0
  s_add_u32 s24, s24, 147456
  buffer_load_dwordx4 v5, s[8:11], s24 offen lds
  ds_read_b128 a[60:63], v93 offset:15360
  s_waitcnt lgkmcnt(6)
  v_mfma_f32_32x32x16_bf16 v[128:143], v[100:103], a[40:43], v[128:143]
  ds_read_b64_tr_b16 v[108:109], v2 offset:28672
  ds_read_b64_tr_b16 v[110:111], v2 offset:29184
  ds_read_b128 a[64:67], v93 offset:16384
  v_mfma_f32_32x32x16_bf16 v[144:159], v[100:103], a[44:47], v[144:159]
  s_add_u32 m0, s23, 4096
  s_add_u32 s24, s24, 147456
  buffer_load_dwordx4 v5, s[8:11], s24 offen lds
  ds_read_b128 a[68:71], v93 offset:17408
  s_waitcnt lgkmcnt(6)
  v_mfma_f32_32x32x16_bf16 v[128:143], v[104:107], a[48:51], v[128:143]
  ds_read_b64_tr_b16 v[96:97], v2 offset:32768
  ds_read_b64_tr_b16 v[98:99], v2 offset:33280
  ds_read_b128 a[72:75], v93 offset:18432
  v_mfma_f32_32x32x16_bf16 v[144:159], v[104:107], a[52:55], v[144:159]
  s_add_u32 m0, s23, 8192
  s_add_u32 s24, s24, 147456
  buffer_load_dwordx4 v5, s[8:11], s24 offen lds
  ds_read_b128 a[76:79], v93 offset:19456
  s_barrier
  s_waitcnt lgkmcnt(6)
  v_mfma_f32_32x32x16_bf16 v[128:143], v[108:111], a[56:59], v[128:143]
  ds_read_b64_tr_b16 v[100:101], v90 offset:0
  ds_read_b64_tr_b16 v[102:103], v90 offset:512
  ds_read_b128 a[80:83], v93 offset:20480
  v_mfma_f32_32x32x16_bf16 v[144:159], v[108:111], a[60:63], v[144:159]
  s_add_u32 m0, s23, 12288
  s_add_u32 s24, s24, 147456
  buffer_load_dwordx4 v5, s[8:11], s24 offen lds
  ds_read_b128 a[84:87], v93 offset:21504
  s_waitcnt lgkmcnt(6)
  v_mfma_f32_32x32x16_bf16 v[128:143], v[96:99], a[64:67], v[128:143]
  ds_read_b64_tr_b16 v[104:105], v90 offset:4096
  ds_read_b64_tr_b16 v[106:107], v90 offset:4608
  ds_read_b128 a[88:91], v93 offset:22528
  v_mfma_f32_32x32x16_bf16 v[144:159], v[96:99], a[68:71], v[144:159]
  s_add_u32 m0, s23, 16384
  s_add_u32 s24, s24, 147456
  buffer_load_dwordx4 v5, s[8:11], s24 offen lds
  ds_read_b128 a[92:95], v93 offset:23552
  s_waitcnt lgkmcnt(6)
  v_mfma_f32_32x32x16_bf16 v[128:143], v[100:103], a[72:75], v[128:143]
  ds_read_b64_tr_b16 v[108:109], v90 offset:8192
  ds_read_b64_tr_b16 v[110:111], v90 offset:8704
  ds_read_b128 a[96:99], v93 offset:24576
  v_mfma_f32_32x32x16_bf16 v[144:159], v[100:103], a[76:79], v[144:159]
  s_add_u32 m0, s23, 20480
  s_add_u32 s24, s24, 147456
  buffer_load_dwordx4 v5, s[8:11], s24 offen lds
  ds_read_b128 a[100:103], v93 offset:25600
  s_waitcnt vmcnt(10)
  s_barrier
  s_waitcnt lgkmcnt(6)
  v_mfma_f32_32x32x16_bf16 v[128:143], v[104:107], a[80:83], v[128:143]
  ds_read_b64_tr_b16 v[96:97], v90 offset:12288
  ds_read_b64_tr_b16 v[98:99], v90 offset:12800
  ds_read_b128 a[104:107], v93 offset:26624
  v_mfma_f32_32x32x16_bf16 v[144:159], v[104:107], a[84:87], v[144:159]
  s_add_u32 m0, s23, 24576
  s_add_u32 s24, s24, 147456
  buffer_load_dwordx4 v5, s[8:11], s24 offen lds
  ds_read_b128 a[108:111], v93 offset:27648
  s_waitcnt lgkmcnt(6)
  v_mfma_f32_32x32x16_bf16 v[128:143], v[108:111], a[88:91], v[128:143]
  ds_read_b64_tr_b16 v[100:101], v90 offset:16384
  ds_read_b64_tr_b16 v[102:103], v90 offset:16896
  ds_read_b128 a[112:115], v93 offset:28672
  v_mfma_f32_32x32x16_bf16 v[144:159], v[108:111], a[92:95], v[144:159]
  s_add_u32 m0, s23, 28672
  s_add_u32 s24, s24, 147456
  buffer_load_dwordx4 v5, s[8:11], s24 offen lds
  ds_read_b128 a[116:119], v93 offset:29696
  s_waitcnt lgkmcnt(6)
  v_mfma_f32_32x32x16_bf16 v[128:143], v[96:99], a[96:99], v[128:143]
  ds_read_b64_tr_b16 v[104:105], v90 offset:20480
  ds_read_b64_tr_b16 v[106:107], v90 offset:20992
  ds_read_b128 a[120:123], v93 offset:30720
  v_mfma_f32_32x32x16_bf16 v[144:159], v[96:99], a[100:103], v[144:159]
  s_add_u32 m0, s23, 32768
  s_add_u32 s24, s24, 147456
  buffer_load_dwordx4 v5, s[8:11], s24 offen lds
  ds_read_b128 a[124:127], v93 offset:31744
  s_waitcnt vmcnt(9)
  s_barrier
  s_waitcnt lgkmcnt(6)
  v_mfma_f32_32x32x16_bf16 v[128:143], v[100:103], a[104:107], v[128:143]
  ds_read_b64_tr_b16 v[108:109], v90 offset:24576
  ds_read_b64_tr_b16 v[110:111], v90 offset:25088
  ds_read_b128 a[128:131], v93 offset:32768
  v_mfma_f32_32x32x16_bf16 v[144:159], v[100:103], a[108:111], v[144:159]
  s_add_u32 m0, s23, 36864
  s_add_u32 s24, s24, 147456
  buffer_load_dwordx4 v5, s[8:11], s24 offen lds
  ds_read_b128 a[132:135], v93 offset:33792
  s_waitcnt lgkmcnt(6)
  v_mfma_f32_32x32x16_bf16 v[128:143], v[104:107], a[112:115], v[128:143]
  ds_read_b64_tr_b16 v[96:97], v90 offset:28672
  ds_read_b64_tr_b16 v[98:99], v90 offset:29184
  ds_read_b128 a[136:139], v93 offset:34816
  v_mfma_f32_32x32x16_bf16 v[144:159], v[104:107], a[116:119], v[144:159]
  s_add_u32 m0, s23, 40960
  s_add_u32 s24, s24, 147456
  buffer_load_dwordx4 v5, s[8:11], s24 offen lds
  ds_read_b128 a[140:143], v93 offset:35840
  s_waitcnt lgkmcnt(6)
  v_mfma_f32_32x32x16_bf16 v[128:143], v[108:111], a[120:123], v[128:143]
  ds_read_b64_tr_b16 v[100:101], v90 offset:32768
  ds_read_b64_tr_b16 v[102:103], v90 offset:33280
  ds_read_b128 a[144:147], v93 offset:36864
  v_mfma_f32_32x32x16_bf16 v[144:159], v[108:111], a[124:127], v[144:159]
  s_add_u32 m0, s23, 45056
  s_add_u32 s24, s24, 147456
  buffer_load_dwordx4 v5, s[8:11], s24 offen lds
  ds_read_b128 a[148:151], v93 offset:37888
  s_waitcnt vmcnt(9)
  s_barrier
  s_waitcnt lgkmcnt(6)
  v_mfma_f32_32x32x16_bf16 v[128:143], v[96:99], a[128:131], v[128:143]
  ds_read_b64_tr_b16 v[104:105], v2 offset:0
  ds_read_b64_tr_b16 v[106:107], v2 offset:512
  ds_read_b128 a[152:155], v93 offset:38912
  v_mfma_f32_32x32x16_bf16 v[144:159], v[96:99], a[132:135], v[144:159]
  s_add_u32 m0, s23, 49152
  s_add_u32 s24, s24, 147456
  buffer_load_dwordx4 v5, s[8:11], s24 offen lds
  ds_read_b128 a[156:159], v93 offset:39936
  s_waitcnt lgkmcnt(6)
  v_mfma_f32_32x32x16_bf16 v[128:143], v[100:103], a[136:139], v[128:143]
  ds_read_b64_tr_b16 v[108:109], v2 offset:4096
  ds_read_b64_tr_b16 v[110:111], v2 offset:4608
  ds_read_b128 a[160:163], v93 offset:40960
  v_mfma_f32_32x32x16_bf16 v[144:159], v[100:103], a[140:143], v[144:159]
  s_add_u32 m0, s23, 53248
  s_add_u32 s24, s24, 147456
  buffer_load_dwordx4 v5, s[8:11], s24 offen lds
  ds_read_b128 a[164:167], v93 offset:41984
  s_waitcnt lgkmcnt(6)
  v_mfma_f32_32x32x16_bf16 v[128:143], v[104:107], a[144:147], v[128:143]
  ds_read_b64_tr_b16 v[96:97], v2 offset:8192
  ds_read_b64_tr_b16 v[98:99], v2 offset:8704
  ds_read_b128 a[168:171], v93 offset:43008
  v_mfma_f32_32x32x16_bf16 v[144:159], v[104:107], a[148:151], v[144:159]
  s_add_u32 m0, s23, 57344
  s_add_u32 s24, s24, 147456
  buffer_load_dwordx4 v5, s[8:11], s24 offen lds
  ds_read_b128 a[172:175], v93 offset:44032
  s_waitcnt vmcnt(9)
  s_barrier
  s_waitcnt lgkmcnt(6)
  v_mfma_f32_32x32x16_bf16 v[128:143], v[108:111], a[152:155], v[128:143]
  ds_read_b64_tr_b16 v[100:101], v2 offset:12288
  ds_read_b64_tr_b16 v[102:103], v2 offset:12800
  ds_read_b128 a[176:179], v93 offset:45056
  v_mfma_f32_32x32x16_bf16 v[144:159], v[108:111], a[156:159], v[144:159]
  s_add_u32 m0, s23, 61440
  s_add_u32 s24, s24, 147456
  buffer_load_dwordx4 v5, s[8:11], s24 offen lds
  ds_read_b128 a[180:183], v93 offset:46080
  s_waitcnt lgkmcnt(6)
  v_mfma_f32_32x32x16_bf16 v[128:143], v[96:99], a[160:163], v[128:143]
  ds_read_b64_tr_b16 v[104:105], v2 offset:16384
  ds_read_b64_tr_b16 v[106:107], v2 offset:16896
  ds_read_b128 a[184:187], v93 offset:47104
  v_mfma_f32_32x32x16_bf16 v[144:159], v[96:99], a[164:167], v[144:159]
  s_add_u32 m0, s23, 65536
  s_add_u32 s24, s24, 147456
  buffer_load_dwordx4 v5, s[8:11], s24 offen lds
  ds_read_b128 a[188:191], v93 offset:48128
  s_waitcnt lgkmcnt(6)
  v_mfma_f32_32x32x16_bf16 v[128:143], v[100:103], a[168:171], v[128:143]
  ds_read_b64_tr_b16 v[108:109], v2 offset:20480
  ds_read_b64_tr_b16 v[110:111], v2 offset:20992
  ds_read_b128 a[192:195], v93 offset:49152
  v_mfma_f32_32x32x16_bf16 v[144:159], v[100:103], a[172:175], v[144:159]
  s_add_u32 m0, s23, 69632
  s_add_u32 s24, s24, 147456
  buffer_load_dwordx4 v5, s[8:11], s24 offen lds
  ds_read_b128 a[196:199], v93 offset:50176
  s_waitcnt vmcnt(9)
  s_barrier
  s_waitcnt lgkmcnt(6)
  v_mfma_f32_32x32x16_bf16 v[128:143], v[104:107], a[176:179], v[128:143]
  ds_read_b64_tr_b16 v[96:97], v2 offset:24576
  ds_read_b64_tr_b16 v[98:99], v2 offset:25088
  ds_read_b128 a[200:203], v93 offset:51200
  v_mfma_f32_32x32x16_bf16 v[144:159], v[104:107], a[180:183], v[144:159]
  s_add_u32 m0, s23, 0
  s_sub_u32 s24, s24, 5160832
  buffer_load_dwordx4 v5, s[8:11], s24 offen lds
  ds_read_b128 a[204:207], v93 offset:52224
  s_waitcnt lgkmcnt(6)
  v_mfma_f32_32x32x16_bf16 v[128:143], v[108:111], a[184:187], v[128:143]
  ds_read_b64_tr_b16 v[100:101], v2 offset:28672
  ds_read_b64_tr_b16 v[102:103], v2 offset:29184
  ds_read_b128 a[208:211], v93 offset:53248
  v_mfma_f32_32x32x16_bf16 v[144:159], v[108:111], a[188:191], v[144:159]
  s_add_u32 m0, s23, 4096
  s_add_u32 s24, s24, 147456
  buffer_load_dwordx4 v5, s[8:11], s24 offen lds
  ds_read_b128 a[212:215], v93 offset:54272
  s_waitcnt lgkmcnt(6)
  v_mfma_f32_32x32x16_bf16 v[128:143], v[96:99], a[192:195], v[128:143]
  ds_read_b64_tr_b16 v[104:105], v2 offset:32768
  ds_read_b64_tr_b16 v[106:107], v2 offset:33280
  ds_read_b128 a[216:219], v93 offset:55296
  v_mfma_f32_32x32x16_bf16 v[144:159], v[96:99], a[196:199], v[144:159]
  s_add_u32 m0, s23, 8192
  s_add_u32 s24, s24, 147456
  buffer_load_dwordx4 v5, s[8:11], s24 offen lds
  ds_read_b128 a[220:223], v93 offset:56320
  s_waitcnt vmcnt(9)
  s_barrier
  s_waitcnt lgkmcnt(6)
  v_mfma_f32_32x32x16_bf16 v[128:143], v[100:103], a[200:203], v[128:143]
  ds_read_b64_tr_b16 v[108:109], v90 offset:0
  ds_read_b64_tr_b16 v[110:111], v90 offset:512
  ds_read_b128 a[224:227], v93 offset:57344
  v_mfma_f32_32x32x16_bf16 v[144:159], v[100:103], a[204:207], v[144:159]
  s_add_u32 m0, s23, 12288
  s_add_u32 s24, s24, 147456
  buffer_load_dwordx4 v5, s[8:11], s24 offen lds
  ds_read_b128 a[228:231], v93 offset:58368
  s_waitcnt lgkmcnt(6)
  v_mfma_f32_32x32x16_bf16 v[128:143], v[104:107], a[208:211], v[128:143]
  ds_read_b64_tr_b16 v[96:97], v90 offset:4096
  ds_read_b64_tr_b16 v[98:99], v90 offset:4608
  ds_read_b128 a[232:235], v93 offset:59392
  v_mfma_f32_32x32x16_bf16 v[144:159], v[104:107], a[212:215], v[144:159]
  s_add_u32 m0, s23, 16384
  s_add_u32 s24, s24, 147456
  buffer_load_dwordx4 v5, s[8:11], s24 offen lds
  ds_read_b128 a[236:239], v93 offset:60416
  s_waitcnt lgkmcnt(6)
  v_mfma_f32_32x32x16_bf16 v[128:143], v[108:111], a[216:219], v[128:143]
  ds_read_b64_tr_b16 v[100:101], v90 offset:8192
  ds_read_b64_tr_b16 v[102:103], v90 offset:8704
  ds_read_b128 a[240:243], v93 offset:61440
  v_mfma_f32_32x32x16_bf16 v[144:159], v[108:111], a[220:223], v[144:159]
  s_add_u32 m0, s23, 20480
  s_add_u32 s24, s24, 147456
  buffer_load_dwordx4 v5, s[8:11], s24 offen lds
  ds_read_b128 a[244:247], v93 offset:62464
  s_waitcnt vmcnt(9)
  s_barrier
  s_waitcnt lgkmcnt(6)
  v_mfma_f32_32x32x16_bf16 v[128:143], v[96:99], a[224:227], v[128:143]
  ds_read_b64_tr_b16 v[104:105], v90 offset:12288
  ds_read_b64_tr_b16 v[106:107], v90 offset:12800
  ds_read_b128 a[248:251], v93 offset:63488
  v_mfma_f32_32x32x16_bf16 v[144:159], v[96:99], a[228:231], v[144:159]
  s_add_u32 m0, s23, 24576
  s_add_u32 s24, s24, 147456
  buffer_load_dwordx4 v5, s[8:11], s24 offen lds
  ds_read_b128 a[252:255], v93 offset:64512
  s_waitcnt lgkmcnt(6)
  v_mfma_f32_32x32x16_bf16 v[128:143], v[100:103], a[232:235], v[128:143]
  ds_read_b64_tr_b16 v[108:109], v90 offset:16384
  ds_read_b64_tr_b16 v[110:111], v90 offset:16896
  ds_read_b128 v[224:227], v94 offset:0
  v_mfma_f32_32x32x16_bf16 v[144:159], v[100:103], a[236:239], v[144:159]
  s_add_u32 m0, s23, 28672
  s_add_u32 s24, s24, 147456
  buffer_load_dwordx4 v5, s[8:11], s24 offen lds
  ds_read_b128 v[228:231], v94 offset:1024
  s_waitcnt lgkmcnt(6)
  v_mfma_f32_32x32x16_bf16 v[128:143], v[104:107], a[240:243], v[128:143]
  ds_read_b64_tr_b16 v[96:97], v90 offset:20480
  ds_read_b64_tr_b16 v[98:99], v90 offset:20992
  ds_read_b128 v[232:235], v94 offset:2048
  v_mfma_f32_32x32x16_bf16 v[144:159], v[104:107], a[244:247], v[144:159]
  s_add_u32 m0, s23, 32768
  s_add_u32 s24, s24, 147456
  buffer_load_dwordx4 v5, s[8:11], s24 offen lds
  ds_read_b128 v[236:239], v94 offset:3072
  s_waitcnt vmcnt(9)
  s_barrier
  s_waitcnt lgkmcnt(6)
  v_mfma_f32_32x32x16_bf16 v[128:143], v[108:111], a[248:251], v[128:143]
  ds_read_b64_tr_b16 v[100:101], v90 offset:24576
  ds_read_b64_tr_b16 v[102:103], v90 offset:25088
  ds_read_b128 v[240:243], v94 offset:4096
  v_mfma_f32_32x32x16_bf16 v[144:159], v[108:111], a[252:255], v[144:159]
  s_add_u32 m0, s23, 36864
  s_add_u32 s24, s24, 147456
  buffer_load_dwordx4 v5, s[8:11], s24 offen lds
  ds_read_b128 v[244:247], v94 offset:5120
  s_waitcnt lgkmcnt(6)
  v_mfma_f32_32x32x16_bf16 v[128:143], v[96:99], v[224:227], v[128:143]
  ds_read_b64_tr_b16 v[104:105], v90 offset:28672
  ds_read_b64_tr_b16 v[106:107], v90 offset:29184
  ds_read_b128 v[248:251], v94 offset:6144
  v_mfma_f32_32x32x16_bf16 v[144:159], v[96:99], v[228:231], v[144:159]
  s_add_u32 m0, s23, 40960
  s_add_u32 s24, s24, 147456
  buffer_load_dwordx4 v5, s[8:11], s24 offen lds
  ds_read_b128 v[252:255], v94 offset:7168
  s_waitcnt lgkmcnt(6)
  v_mfma_f32_32x32x16_bf16 v[128:143], v[100:103], v[232:235], v[128:143]
  ds_read_b64_tr_b16 v[108:109], v90 offset:32768
  ds_read_b64_tr_b16 v[110:111], v90 offset:33280
  v_mfma_f32_32x32x16_bf16 v[144:159], v[100:103], v[236:239], v[144:159]
  s_add_u32 m0, s23, 45056
  s_add_u32 s24, s24, 147456
  buffer_load_dwordx4 v5, s[8:11], s24 offen lds
  s_waitcnt vmcnt(9)
  s_barrier
  s_waitcnt lgkmcnt(4)
  v_mfma_f32_32x32x16_bf16 v[128:143], v[104:107], v[240:243], v[128:143]
  ds_read_b64_tr_b16 v[96:97], v2 offset:0
  ds_read_b64_tr_b16 v[98:99], v2 offset:512
  v_mfma_f32_32x32x16_bf16 v[144:159], v[104:107], v[244:247], v[144:159]
  s_add_u32 m0, s23, 49152
  s_add_u32 s24, s24, 147456
  buffer_load_dwordx4 v5, s[8:11], s24 offen lds
  s_waitcnt lgkmcnt(2)
  v_mfma_f32_32x32x16_bf16 v[128:143], v[108:111], v[248:251], v[128:143]
  ds_read_b64_tr_b16 v[100:101], v2 offset:4096
  ds_read_b64_tr_b16 v[102:103], v2 offset:4608
  v_mfma_f32_32x32x16_bf16 v[144:159], v[108:111], v[252:255], v[144:159]
  s_add_u32 m0, s23, 53248
  s_add_u32 s24, s24, 147456
  buffer_load_dwordx4 v5, s[8:11], s24 offen lds
  s_waitcnt lgkmcnt(2)
  v_mfma_f32_32x32x16_bf16 v[160:175], v[96:99], a[0:3], 0
  ds_read_b64_tr_b16 v[104:105], v2 offset:8192
  ds_read_b64_tr_b16 v[106:107], v2 offset:8704
  v_mfma_f32_32x32x16_bf16 v[176:191], v[96:99], a[4:7], 0
  s_add_u32 m0, s23, 57344
  s_add_u32 s24, s24, 147456
  buffer_load_dwordx4 v5, s[8:11], s24 offen lds
  buffer_load_dword v15, v95, s[8:11], s56 offen
  s_add_u32 s56, s56, 128
  s_waitcnt vmcnt(10)
  s_barrier
  s_waitcnt lgkmcnt(2)
  v_mfma_f32_32x32x16_bf16 v[160:175], v[100:103], a[8:11], v[160:175]
  ds_read_b64_tr_b16 v[108:109], v2 offset:12288
  ds_read_b64_tr_b16 v[110:111], v2 offset:12800
  v_mfma_f32_32x32x16_bf16 v[176:191], v[100:103], a[12:15], v[176:191]
  s_add_u32 m0, s23, 61440
  s_add_u32 s24, s24, 147456
  buffer_load_dwordx4 v5, s[8:11], s24 offen lds
  s_waitcnt lgkmcnt(2)
  v_mfma_f32_32x32x16_bf16 v[160:175], v[104:107], a[16:19], v[160:175]
  ds_read_b64_tr_b16 v[96:97], v2 offset:16384
  ds_read_b64_tr_b16 v[98:99], v2 offset:16896
  v_mfma_f32_32x32x16_bf16 v[176:191], v[104:107], a[20:23], v[176:191]
  s_add_u32 m0, s23, 65536
  s_add_u32 s24, s24, 147456
  buffer_load_dwordx4 v5, s[8:11], s24 offen lds
  s_waitcnt lgkmcnt(2)
  v_mfma_f32_32x32x16_bf16 v[160:175], v[108:111], a[24:27], v[160:175]
  ds_read_b64_tr_b16 v[100:101], v2 offset:20480
  ds_read_b64_tr_b16 v[102:103], v2 offset:20992
  v_mul_f32 v128, v128, v136
  v_mul_f32 v129, v129, v137
  v_mfma_f32_32x32x16_bf16 v[176:191], v[108:111], a[28:31], v[176:191]
  s_add_u32 m0, s23, 69632
  s_add_u32 s24, s24, 147456
  buffer_load_dwordx4 v5, s[8:11], s24 offen lds
  v_mul_f32 v130, v130, v138
  v_mul_f32 v131, v131, v139
  s_waitcnt vmcnt(10)
  s_barrier
  s_waitcnt lgkmcnt(2)
  v_mfma_f32_32x32x16_bf16 v[160:175], v[96:99], a[32:35], v[160:175]
  ds_read_b64_tr_b16 v[104:105], v2 offset:24576
  ds_read_b64_tr_b16 v[106:107], v2 offset:25088
  v_mul_f32 v132, v132, v140
  v_mul_f32 v133, v133, v141
  v_mfma_f32_32x32x16_bf16 v[176:191], v[96:99], a[36:39], v[176:191]
  s_add_u32 m0, s23, 0
  s_add_u32 s24, s24, 147456
  buffer_load_dwordx4 v5, s[8:11], s24 offen lds
  v_mul_f32 v134, v134, v142
  v_mul_f32 v135, v135, v143
  s_waitcnt lgkmcnt(2)
  v_mfma_f32_32x32x16_bf16 v[160:175], v[100:103], a[40:43], v[160:175]
  ds_read_b64_tr_b16 v[108:109], v2 offset:28672
  ds_read_b64_tr_b16 v[110:111], v2 offset:29184
  v_cvt_pk_bf16_f32 v64, v128, v129
  v_cvt_pk_bf16_f32 v65, v130, v131
  v_mfma_f32_32x32x16_bf16 v[176:191], v[100:103], a[44:47], v[176:191]
  s_add_u32 m0, s23, 4096
  s_add_u32 s24, s24, 147456
  buffer_load_dwordx4 v5, s[8:11], s24 offen lds
  v_cvt_pk_bf16_f32 v66, v132, v133
  v_cvt_pk_bf16_f32 v67, v134, v135
  s_waitcnt lgkmcnt(2)
  v_mfma_f32_32x32x16_bf16 v[160:175], v[104:107], a[48:51], v[160:175]
  ds_read_b64_tr_b16 v[96:97], v2 offset:32768
  ds_read_b64_tr_b16 v[98:99], v2 offset:33280
  ds_write_b128 v8, v[64:67] offset:0
  v_mul_f32 v144, v144, v152
  v_mfma_f32_32x32x16_bf16 v[176:191], v[104:107], a[52:55], v[176:191]
  s_add_u32 m0, s23, 8192
  s_add_u32 s24, s24, 147456
  buffer_load_dwordx4 v5, s[8:11], s24 offen lds
  v_mul_f32 v145, v145, v153
  v_mul_f32 v146, v146, v154
  s_waitcnt vmcnt(10)
  s_barrier
  s_waitcnt lgkmcnt(3)
  v_mfma_f32_32x32x16_bf16 v[160:175], v[108:111], a[56:59], v[160:175]
  ds_read_b64_tr_b16 v[100:101], v90 offset:0
  ds_read_b64_tr_b16 v[102:103], v90 offset:512
  v_mul_f32 v147, v147, v155
  v_mul_f32 v148, v148, v156
  v_mfma_f32_32x32x16_bf16 v[176:191], v[108:111], a[60:63], v[176:191]
  s_add_u32 m0, s23, 12288
  s_add_u32 s24, s24, 147456
  buffer_load_dwordx4 v5, s[8:11], s24 offen lds
  v_mul_f32 v149, v149, v157
  v_mul_f32 v150, v150, v158
  s_waitcnt lgkmcnt(3)
  v_mfma_f32_32x32x16_bf16 v[160:175], v[96:99], a[64:67], v[160:175]
  ds_read_b64_tr_b16 v[104:105], v90 offset:4096
  ds_read_b64_tr_b16 v[106:107], v90 offset:4608
  v_mul_f32 v151, v151, v159
  v_cvt_pk_bf16_f32 v68, v144, v145
  v_mfma_f32_32x32x16_bf16 v[176:191], v[96:99], a[68:71], v[176:191]
  s_add_u32 m0, s23, 16384
  s_add_u32 s24, s24, 147456
  buffer_load_dwordx4 v5, s[8:11], s24 offen lds
  v_cvt_pk_bf16_f32 v69, v146, v147
  v_cvt_pk_bf16_f32 v70, v148, v149
  s_waitcnt lgkmcnt(2)
  v_mfma_f32_32x32x16_bf16 v[160:175], v[100:103], a[72:75], v[160:175]
  ds_read_b64_tr_b16 v[108:109], v90 offset:8192
  ds_read_b64_tr_b16 v[110:111], v90 offset:8704
  v_cvt_pk_bf16_f32 v71, v150, v151
  ds_write_b128 v8, v[68:71] offset:1024
  v_mfma_f32_32x32x16_bf16 v[176:191], v[100:103], a[76:79], v[176:191]
  s_add_u32 m0, s23, 20480
  s_add_u32 s24, s24, 147456
  buffer_load_dwordx4 v5, s[8:11], s24 offen lds
  v_add_u32 v8, s46, v8
  s_mov_b32 s46, 0x2000
  s_waitcnt vmcnt(10)
  s_barrier
  s_waitcnt lgkmcnt(3)
  v_mfma_f32_32x32x16_bf16 v[160:175], v[104:107], a[80:83], v[160:175]
  ds_read_b64_tr_b16 v[96:97], v90 offset:12288
  ds_read_b64_tr_b16 v[98:99], v90 offset:12800
  v_mfma_f32_32x32x16_bf16 v[176:191], v[104:107], a[84:87], v[176:191]
  s_add_u32 m0, s23, 24576
  s_add_u32 s24, s24, 147456
  buffer_load_dwordx4 v5, s[8:11], s24 offen lds
  s_waitcnt lgkmcnt(3)
  v_mfma_f32_32x32x16_bf16 v[160:175], v[108:111], a[88:91], v[160:175]
  ds_read_b64_tr_b16 v[100:101], v90 offset:16384
  ds_read_b64_tr_b16 v[102:103], v90 offset:16896
  v_mfma_f32_32x32x16_bf16 v[176:191], v[108:111], a[92:95], v[176:191]
  s_add_u32 m0, s23, 28672
  s_add_u32 s24, s24, 147456
  buffer_load_dwordx4 v5, s[8:11], s24 offen lds
  s_waitcnt lgkmcnt(2)
  v_mfma_f32_32x32x16_bf16 v[160:175], v[96:99], a[96:99], v[160:175]
  ds_read_b64_tr_b16 v[104:105], v90 offset:20480
  ds_read_b64_tr_b16 v[106:107], v90 offset:20992
  v_mfma_f32_32x32x16_bf16 v[176:191], v[96:99], a[100:103], v[176:191]
  s_add_u32 m0, s23, 32768
  s_add_u32 s24, s24, 147456
  buffer_load_dwordx4 v5, s[8:11], s24 offen lds
  s_waitcnt vmcnt(9)
  s_barrier
  s_waitcnt lgkmcnt(2)
  v_mfma_f32_32x32x16_bf16 v[160:175], v[100:103], a[104:107], v[160:175]
  ds_read_b64_tr_b16 v[108:109], v90 offset:24576
  ds_read_b64_tr_b16 v[110:111], v90 offset:25088
  v_mfma_f32_32x32x16_bf16 v[176:191], v[100:103], a[108:111], v[176:191]
  s_add_u32 m0, s23, 36864
  s_add_u32 s24, s24, 147456
  buffer_load_dwordx4 v5, s[8:11], s24 offen lds
  s_waitcnt lgkmcnt(2)
  v_mfma_f32_32x32x16_bf16 v[160:175], v[104:107], a[112:115], v[160:175]
  ds_read_b64_tr_b16 v[96:97], v90 offset:28672
  ds_read_b64_tr_b16 v[98:99], v90 offset:29184
  v_mfma_f32_32x32x16_bf16 v[176:191], v[104:107], a[116:119], v[176:191]
  s_add_u32 m0, s23, 40960
  s_add_u32 s24, s24, 147456
  buffer_load_dwordx4 v5, s[8:11], s24 offen lds
  s_waitcnt lgkmcnt(2)
  v_mfma_f32_32x32x16_bf16 v[160:175], v[108:111], a[120:123], v[160:175]
  ds_read_b64_tr_b16 v[100:101], v90 offset:32768
  ds_read_b64_tr_b16 v[102:103], v90 offset:33280
  v_mfma_f32_32x32x16_bf16 v[176:191], v[108:111], a[124:127], v[176:191]
  s_add_u32 m0, s23, 45056
  s_add_u32 s24, s24, 147456
  buffer_load_dwordx4 v5, s[8:11], s24 offen lds
  s_waitcnt vmcnt(9)
  s_barrier
  s_waitcnt lgkmcnt(2)
  v_mfma_f32_32x32x16_bf16 v[160:175], v[96:99], a[128:131], v[160:175]
  ds_read_b64_tr_b16 v[104:105], v2 offset:0
  ds_read_b64_tr_b16 v[106:107], v2 offset:512
  v_mfma_f32_32x32x16_bf16 v[176:191], v[96:99], a[132:135], v[176:191]
  s_add_u32 m0, s23, 49152
  s_add_u32 s24, s24, 147456
  buffer_load_dwordx4 v5, s[8:11], s24 offen lds
  s_waitcnt lgkmcnt(2)
  v_mfma_f32_32x32x16_bf16 v[160:175], v[100:103], a[136:139], v[160:175]
  ds_read_b64_tr_b16 v[108:109], v2 offset:4096
  ds_read_b64_tr_b16 v[110:111], v2 offset:4608
  v_mfma_f32_32x32x16_bf16 v[176:191], v[100:103], a[140:143], v[176:191]
  s_add_u32 m0, s23, 53248
  s_add_u32 s24, s24, 147456
  buffer_load_dwordx4 v5, s[8:11], s24 offen lds
  s_waitcnt lgkmcnt(2)
  v_mfma_f32_32x32x16_bf16 v[160:175], v[104:107], a[144:147], v[160:175]
  ds_read_b64_tr_b16 v[96:97], v2 offset:8192
  ds_read_b64_tr_b16 v[98:99], v2 offset:8704
  v_mfma_f32_32x32x16_bf16 v[176:191], v[104:107], a[148:151], v[176:191]
  s_add_u32 m0, s23, 57344
  s_add_u32 s24, s24, 147456
  buffer_load_dwordx4 v5, s[8:11], s24 offen lds
  s_waitcnt vmcnt(9)
  s_barrier
  s_waitcnt lgkmcnt(2)
  v_mfma_f32_32x32x16_bf16 v[160:175], v[108:111], a[152:155], v[160:175]
  ds_read_b64_tr_b16 v[100:101], v2 offset:12288
  ds_read_b64_tr_b16 v[102:103], v2 offset:12800
  v_mfma_f32_32x32x16_bf16 v[176:191], v[108:111], a[156:159], v[176:191]
  s_add_u32 m0, s23, 61440
  s_add_u32 s24, s24, 147456
  buffer_load_dwordx4 v5, s[8:11], s24 offen lds
  s_waitcnt lgkmcnt(2)
  v_mfma_f32_32x32x16_bf16 v[160:175], v[96:99], a[160:163], v[160:175]
  ds_read_b64_tr_b16 v[104:105], v2 offset:16384
  ds_read_b64_tr_b16 v[106:107], v2 offset:16896
  v_mfma_f32_32x32x16_bf16 v[176:191], v[96:99], a[164:167], v[176:191]
  s_add_u32 m0, s23, 65536
  s_add_u32 s24, s24, 147456
  buffer_load_dwordx4 v5, s[8:11], s24 offen lds
  s_waitcnt lgkmcnt(2)
  v_mfma_f32_32x32x16_bf16 v[160:175], v[100:103], a[168:171], v[160:175]
  ds_read_b64_tr_b16 v[108:109], v2 offset:20480
  ds_read_b64_tr_b16 v[110:111], v2 offset:20992
  v_mfma_f32_32x32x16_bf16 v[176:191], v[100:103], a[172:175], v[176:191]
  s_add_u32 m0, s23, 69632
  s_add_u32 s24, s24, 147456
  buffer_load_dwordx4 v5, s[8:11], s24 offen lds
  s_waitcnt vmcnt(9)
  s_barrier
  s_waitcnt lgkmcnt(2)
  v_mfma_f32_32x32x16_bf16 v[160:175], v[104:107], a[176:179], v[160:175]
  ds_read_b64_tr_b16 v[96:97], v2 offset:24576
  ds_read_b64_tr_b16 v[98:99], v2 offset:25088
  v_mfma_f32_32x32x16_bf16 v[176:191], v[104:107], a[180:183], v[176:191]
  s_add_u32 m0, s23, 0
  s_sub_u32 s24, s24, 5160832
  buffer_load_dwordx4 v5, s[8:11], s24 offen lds
  s_waitcnt lgkmcnt(2)
  v_mfma_f32_32x32x16_bf16 v[160:175], v[108:111], a[184:187], v[160:175]
  ds_read_b64_tr_b16 v[100:101], v2 offset:28672
  ds_read_b64_tr_b16 v[102:103], v2 offset:29184
  v_mfma_f32_32x32x16_bf16 v[176:191], v[108:111], a[188:191], v[176:191]
  s_add_u32 m0, s23, 4096
  s_add_u32 s24, s24, 147456
  buffer_load_dwordx4 v5, s[8:11], s24 offen lds
  s_waitcnt lgkmcnt(2)
  v_mfma_f32_32x32x16_bf16 v[160:175], v[96:99], a[192:195], v[160:175]
  ds_read_b64_tr_b16 v[104:105], v2 offset:32768
  ds_read_b64_tr_b16 v[106:107], v2 offset:33280
  v_mfma_f32_32x32x16_bf16 v[176:191], v[96:99], a[196:199], v[176:191]
  s_add_u32 m0, s23, 8192
  s_add_u32 s24, s24, 147456
  buffer_load_dwordx4 v5, s[8:11], s24 offen lds
  s_waitcnt vmcnt(9)
  s_barrier
  s_waitcnt lgkmcnt(2)
  v_mfma_f32_32x32x16_bf16 v[160:175], v[100:103], a[200:203], v[160:175]
  ds_read_b64_tr_b16 v[108:109], v90 offset:0
  ds_read_b64_tr_b16 v[110:111], v90 offset:512
  v_mfma_f32_32x32x16_bf16 v[176:191], v[100:103], a[204:207], v[176:191]
  s_add_u32 m0, s23, 12288
  s_add_u32 s24, s24, 147456
  buffer_load_dwordx4 v5, s[8:11], s24 offen lds
  s_waitcnt lgkmcnt(2)
  v_mfma_f32_32x32x16_bf16 v[160:175], v[104:107], a[208:211], v[160:175]
  ds_read_b64_tr_b16 v[96:97], v90 offset:4096
  ds_read_b64_tr_b16 v[98:99], v90 offset:4608
  v_mfma_f32_32x32x16_bf16 v[176:191], v[104:107], a[212:215], v[176:191]
  s_add_u32 m0, s23, 16384
  s_add_u32 s24, s24, 147456
  buffer_load_dwordx4 v5, s[8:11], s24 offen lds
  s_waitcnt lgkmcnt(2)
  v_mfma_f32_32x32x16_bf16 v[160:175], v[108:111], a[216:219], v[160:175]
  ds_read_b64_tr_b16 v[100:101], v90 offset:8192
  ds_read_b64_tr_b16 v[102:103], v90 offset:8704
  v_mfma_f32_32x32x16_bf16 v[176:191], v[108:111], a[220:223], v[176:191]
  s_add_u32 m0, s23, 20480
  s_add_u32 s24, s24, 147456
  buffer_load_dwordx4 v5, s[8:11], s24 offen lds
  s_waitcnt vmcnt(9)
  s_barrier
  s_waitcnt lgkmcnt(2)
  v_mfma_f32_32x32x16_bf16 v[160:175], v[96:99], a[224:227], v[160:175]
  ds_read_b64_tr_b16 v[104:105], v90 offset:12288
  ds_read_b64_tr_b16 v[106:107], v90 offset:12800
  v_mfma_f32_32x32x16_bf16 v[176:191], v[96:99], a[228:231], v[176:191]
  s_add_u32 m0, s23, 24576
  s_add_u32 s24, s24, 147456
  buffer_load_dwordx4 v5, s[8:11], s24 offen lds
  s_waitcnt lgkmcnt(2)
  v_mfma_f32_32x32x16_bf16 v[160:175], v[100:103], a[232:235], v[160:175]
  ds_read_b64_tr_b16 v[108:109], v90 offset:16384
  ds_read_b64_tr_b16 v[110:111], v90 offset:16896
  v_mfma_f32_32x32x16_bf16 v[176:191], v[100:103], a[236:239], v[176:191]
  s_add_u32 m0, s23, 28672
  s_add_u32 s24, s24, 147456
  buffer_load_dwordx4 v5, s[8:11], s24 offen lds
  s_waitcnt lgkmcnt(2)
  v_mfma_f32_32x32x16_bf16 v[160:175], v[104:107], a[240:243], v[160:175]
  ds_read_b64_tr_b16 v[96:97], v90 offset:20480
  ds_read_b64_tr_b16 v[98:99], v90 offset:20992
  v_mfma_f32_32x32x16_bf16 v[176:191], v[104:107], a[244:247], v[176:191]
  s_add_u32 m0, s23, 32768
  s_add_u32 s24, s24, 147456
  buffer_load_dwordx4 v5, s[8:11], s24 offen lds
  s_waitcnt vmcnt(9)
  s_barrier
  s_waitcnt lgkmcnt(2)
  v_mfma_f32_32x32x16_bf16 v[160:175], v[108:111], a[248:251], v[160:175]
  ds_read_b64_tr_b16 v[100:101], v90 offset:24576
  ds_read_b64_tr_b16 v[102:103], v90 offset:25088
  v_mfma_f32_32x32x16_bf16 v[176:191], v[108:111], a[252:255], v[176:191]
  s_add_u32 m0, s23, 36864
  s_add_u32 s24, s24, 147456
  buffer_load_dwordx4 v5, s[8:11], s24 offen lds
  s_waitcnt lgkmcnt(2)
  v_mfma_f32_32x32x16_bf16 v[160:175], v[96:99], v[224:227], v[160:175]
  ds_read_b64_tr_b16 v[104:105], v90 offset:28672
  ds_read_b64_tr_b16 v[106:107], v90 offset:29184
  v_mfma_f32_32x32x16_bf16 v[176:191], v[96:99], v[228:231], v[176:191]
  s_add_u32 m0, s23, 40960
  s_add_u32 s24, s24, 147456
  buffer_load_dwordx4 v5, s[8:11], s24 offen lds
  s_waitcnt lgkmcnt(2)
  v_mfma_f32_32x32x16_bf16 v[160:175], v[100:103], v[232:235], v[160:175]
  ds_read_b64_tr_b16 v[108:109], v90 offset:32768
  ds_read_b64_tr_b16 v[110:111], v90 offset:33280
  v_mfma_f32_32x32x16_bf16 v[176:191], v[100:103], v[236:239], v[176:191]
  s_add_u32 m0, s23, 45056
  s_add_u32 s24, s24, 147456
  buffer_load_dwordx4 v5, s[8:11], s24 offen lds
  s_waitcnt vmcnt(9)
  s_barrier
  s_waitcnt lgkmcnt(2)
  v_mfma_f32_32x32x16_bf16 v[160:175], v[104:107], v[240:243], v[160:175]
  ds_read_b64_tr_b16 v[96:97], v2 offset:0
  ds_read_b64_tr_b16 v[98:99], v2 offset:512
  v_mfma_f32_32x32x16_bf16 v[176:191], v[104:107], v[244:247], v[176:191]
  s_add_u32 m0, s23, 49152
  s_add_u32 s24, s24, 147456
  buffer_load_dwordx4 v5, s[8:11], s24 offen lds
  s_waitcnt lgkmcnt(2)
  v_mfma_f32_32x32x16_bf16 v[160:175], v[108:111], v[248:251], v[160:175]
  ds_read_b64_tr_b16 v[100:101], v2 offset:4096
  ds_read_b64_tr_b16 v[102:103], v2 offset:4608
  v_mfma_f32_32x32x16_bf16 v[176:191], v[108:111], v[252:255], v[176:191]
  s_add_u32 m0, s23, 53248
  s_add_u32 s24, s24, 147456
  buffer_load_dwordx4 v5, s[8:11], s24 offen lds
  s_waitcnt lgkmcnt(2)
  v_mfma_f32_32x32x16_bf16 v[192:207], v[96:99], a[0:3], 0
  ds_read_b64_tr_b16 v[104:105], v2 offset:8192
  ds_read_b64_tr_b16 v[106:107], v2 offset:8704
  v_mfma_f32_32x32x16_bf16 v[208:223], v[96:99], a[4:7], 0
  s_add_u32 m0, s23, 57344
  s_add_u32 s24, s24, 147456
  buffer_load_dwordx4 v5, s[8:11], s24 offen lds
  buffer_load_dword v15, v95, s[8:11], s56 offen
  s_add_u32 s56, s56, 128
  s_waitcnt vmcnt(10)
  s_barrier
  s_waitcnt lgkmcnt(2)
  v_mfma_f32_32x32x16_bf16 v[192:207], v[100:103], a[8:11], v[192:207]
  ds_read_b64_tr_b16 v[108:109], v2 offset:12288
  ds_read_b64_tr_b16 v[110:111], v2 offset:12800
  v_mfma_f32_32x32x16_bf16 v[208:223], v[100:103], a[12:15], v[208:223]
  s_add_u32 m0, s23, 61440
  s_add_u32 s24, s24, 147456
  buffer_load_dwordx4 v5, s[8:11], s24 offen lds
  s_waitcnt lgkmcnt(2)
  v_mfma_f32_32x32x16_bf16 v[192:207], v[104:107], a[16:19], v[192:207]
  ds_read_b64_tr_b16 v[96:97], v2 offset:16384
  ds_read_b64_tr_b16 v[98:99], v2 offset:16896
  v_mfma_f32_32x32x16_bf16 v[208:223], v[104:107], a[20:23], v[208:223]
  s_add_u32 m0, s23, 65536
  s_add_u32 s24, s24, 147456
  buffer_load_dwordx4 v5, s[8:11], s24 offen lds
  s_waitcnt lgkmcnt(2)
  v_mfma_f32_32x32x16_bf16 v[192:207], v[108:111], a[24:27], v[192:207]
  ds_read_b64_tr_b16 v[100:101], v2 offset:20480
  ds_read_b64_tr_b16 v[102:103], v2 offset:20992
  v_mul_f32 v160, v160, v168
  v_mul_f32 v161, v161, v169
  v_mfma_f32_32x32x16_bf16 v[208:223], v[108:111], a[28:31], v[208:223]
  s_add_u32 m0, s23, 69632
  s_add_u32 s24, s24, 147456
  buffer_load_dwordx4 v5, s[8:11], s24 offen lds
  v_mul_f32 v162, v162, v170
  v_mul_f32 v163, v163, v171
  s_waitcnt vmcnt(10)
  s_barrier
  s_waitcnt lgkmcnt(2)
  v_mfma_f32_32x32x16_bf16 v[192:207], v[96:99], a[32:35], v[192:207]
  ds_read_b64_tr_b16 v[104:105], v2 offset:24576
  ds_read_b64_tr_b16 v[106:107], v2 offset:25088
  v_mul_f32 v164, v164, v172
  v_mul_f32 v165, v165, v173
  v_mfma_f32_32x32x16_bf16 v[208:223], v[96:99], a[36:39], v[208:223]
  s_add_u32 m0, s23, 0
  s_add_u32 s24, s24, 147456
  buffer_load_dwordx4 v5, s[8:11], s24 offen lds
  v_mul_f32 v166, v166, v174
  v_mul_f32 v167, v167, v175
  s_waitcnt lgkmcnt(2)
  v_mfma_f32_32x32x16_bf16 v[192:207], v[100:103], a[40:43], v[192:207]
  ds_read_b64_tr_b16 v[108:109], v2 offset:28672
  ds_read_b64_tr_b16 v[110:111], v2 offset:29184
  v_cvt_pk_bf16_f32 v64, v160, v161
  v_cvt_pk_bf16_f32 v65, v162, v163
  v_mfma_f32_32x32x16_bf16 v[208:223], v[100:103], a[44:47], v[208:223]
  s_add_u32 m0, s23, 4096
  s_add_u32 s24, s24, 147456
  buffer_load_dwordx4 v5, s[8:11], s24 offen lds
  v_cvt_pk_bf16_f32 v66, v164, v165
  v_cvt_pk_bf16_f32 v67, v166, v167
  s_waitcnt lgkmcnt(2)
  v_mfma_f32_32x32x16_bf16 v[192:207], v[104:107], a[48:51], v[192:207]
  ds_read_b64_tr_b16 v[96:97], v2 offset:32768
  ds_read_b64_tr_b16 v[98:99], v2 offset:33280
  ds_write_b128 v8, v[64:67] offset:0
  v_mul_f32 v176, v176, v184
  v_mfma_f32_32x32x16_bf16 v[208:223], v[104:107], a[52:55], v[208:223]
  s_add_u32 m0, s23, 8192
  s_add_u32 s24, s24, 147456
  buffer_load_dwordx4 v5, s[8:11], s24 offen lds
  v_mul_f32 v177, v177, v185
  v_mul_f32 v178, v178, v186
  s_waitcnt vmcnt(10)
  s_barrier
  s_waitcnt lgkmcnt(3)
  v_mfma_f32_32x32x16_bf16 v[192:207], v[108:111], a[56:59], v[192:207]
  ds_read_b64_tr_b16 v[100:101], v90 offset:0
  ds_read_b64_tr_b16 v[102:103], v90 offset:512
  v_mul_f32 v179, v179, v187
  v_mul_f32 v180, v180, v188
  v_mfma_f32_32x32x16_bf16 v[208:223], v[108:111], a[60:63], v[208:223]
  s_add_u32 m0, s23, 12288
  s_add_u32 s24, s24, 147456
  buffer_load_dwordx4 v5, s[8:11], s24 offen lds
  v_mul_f32 v181, v181, v189
  v_mul_f32 v182, v182, v190
  s_waitcnt lgkmcnt(3)
  v_mfma_f32_32x32x16_bf16 v[192:207], v[96:99], a[64:67], v[192:207]
  ds_read_b64_tr_b16 v[104:105], v90 offset:4096
  ds_read_b64_tr_b16 v[106:107], v90 offset:4608
  v_mul_f32 v183, v183, v191
  v_cvt_pk_bf16_f32 v68, v176, v177
  v_mfma_f32_32x32x16_bf16 v[208:223], v[96:99], a[68:71], v[208:223]
  s_add_u32 m0, s23, 16384
  s_add_u32 s24, s24, 147456
  buffer_load_dwordx4 v5, s[8:11], s24 offen lds
  v_cvt_pk_bf16_f32 v69, v178, v179
  v_cvt_pk_bf16_f32 v70, v180, v181
  s_waitcnt lgkmcnt(2)
  v_mfma_f32_32x32x16_bf16 v[192:207], v[100:103], a[72:75], v[192:207]
  ds_read_b64_tr_b16 v[108:109], v90 offset:8192
  ds_read_b64_tr_b16 v[110:111], v90 offset:8704
  v_cvt_pk_bf16_f32 v71, v182, v183
  ds_write_b128 v8, v[68:71] offset:1024
  v_mfma_f32_32x32x16_bf16 v[208:223], v[100:103], a[76:79], v[208:223]
  s_add_u32 m0, s23, 20480
  s_add_u32 s24, s24, 147456
  buffer_load_dwordx4 v5, s[8:11], s24 offen lds
  v_add_u32 v8, s46, v8
  s_mov_b32 s46, 0x2000
  s_waitcnt vmcnt(10)
  s_barrier
  s_waitcnt lgkmcnt(3)
  v_mfma_f32_32x32x16_bf16 v[192:207], v[104:107], a[80:83], v[192:207]
  ds_read_b64_tr_b16 v[96:97], v90 offset:12288
  ds_read_b64_tr_b16 v[98:99], v90 offset:12800
  v_mfma_f32_32x32x16_bf16 v[208:223], v[104:107], a[84:87], v[208:223]
  s_add_u32 m0, s23, 24576
  s_add_u32 s24, s24, 147456
  buffer_load_dwordx4 v5, s[8:11], s24 offen lds
  s_waitcnt lgkmcnt(3)
  v_mfma_f32_32x32x16_bf16 v[192:207], v[108:111], a[88:91], v[192:207]
  ds_read_b64_tr_b16 v[100:101], v90 offset:16384
  ds_read_b64_tr_b16 v[102:103], v90 offset:16896
  v_mfma_f32_32x32x16_bf16 v[208:223], v[108:111], a[92:95], v[208:223]
  s_add_u32 m0, s23, 28672
  s_add_u32 s24, s24, 147456
  buffer_load_dwordx4 v5, s[8:11], s24 offen lds
  s_waitcnt lgkmcnt(2)
  v_mfma_f32_32x32x16_bf16 v[192:207], v[96:99], a[96:99], v[192:207]
  ds_read_b64_tr_b16 v[104:105], v90 offset:20480
  ds_read_b64_tr_b16 v[106:107], v90 offset:20992
  v_mfma_f32_32x32x16_bf16 v[208:223], v[96:99], a[100:103], v[208:223]
  s_add_u32 m0, s23, 32768
  s_add_u32 s24, s24, 147456
  buffer_load_dwordx4 v5, s[8:11], s24 offen lds
  s_waitcnt vmcnt(9)
  s_barrier
  s_waitcnt lgkmcnt(2)
  v_mfma_f32_32x32x16_bf16 v[192:207], v[100:103], a[104:107], v[192:207]
  ds_read_b64_tr_b16 v[108:109], v90 offset:24576
  ds_read_b64_tr_b16 v[110:111], v90 offset:25088
  v_mfma_f32_32x32x16_bf16 v[208:223], v[100:103], a[108:111], v[208:223]
  s_add_u32 m0, s23, 36864
  s_add_u32 s24, s24, 147456
  buffer_load_dwordx4 v5, s[8:11], s24 offen lds
  s_waitcnt lgkmcnt(2)
  v_mfma_f32_32x32x16_bf16 v[192:207], v[104:107], a[112:115], v[192:207]
  ds_read_b64_tr_b16 v[96:97], v90 offset:28672
  ds_read_b64_tr_b16 v[98:99], v90 offset:29184
  v_mfma_f32_32x32x16_bf16 v[208:223], v[104:107], a[116:119], v[208:223]
  s_add_u32 m0, s23, 40960
  s_add_u32 s24, s24, 147456
  buffer_load_dwordx4 v5, s[8:11], s24 offen lds
  s_waitcnt lgkmcnt(2)
  v_mfma_f32_32x32x16_bf16 v[192:207], v[108:111], a[120:123], v[192:207]
  ds_read_b64_tr_b16 v[100:101], v90 offset:32768
  ds_read_b64_tr_b16 v[102:103], v90 offset:33280
  v_mfma_f32_32x32x16_bf16 v[208:223], v[108:111], a[124:127], v[208:223]
  s_add_u32 m0, s23, 45056
  s_add_u32 s24, s24, 147456
  buffer_load_dwordx4 v5, s[8:11], s24 offen lds
  s_waitcnt vmcnt(9)
  s_barrier
  s_waitcnt lgkmcnt(2)
  v_mfma_f32_32x32x16_bf16 v[192:207], v[96:99], a[128:131], v[192:207]
  ds_read_b64_tr_b16 v[104:105], v2 offset:0
  ds_read_b64_tr_b16 v[106:107], v2 offset:512
  v_mfma_f32_32x32x16_bf16 v[208:223], v[96:99], a[132:135], v[208:223]
  s_add_u32 m0, s23, 49152
  s_add_u32 s24, s24, 147456
  buffer_load_dwordx4 v5, s[8:11], s24 offen lds
  s_waitcnt lgkmcnt(2)
  v_mfma_f32_32x32x16_bf16 v[192:207], v[100:103], a[136:139], v[192:207]
  ds_read_b64_tr_b16 v[108:109], v2 offset:4096
  ds_read_b64_tr_b16 v[110:111], v2 offset:4608
  v_mfma_f32_32x32x16_bf16 v[208:223], v[100:103], a[140:143], v[208:223]
  s_add_u32 m0, s23, 53248
  s_add_u32 s24, s24, 147456
  buffer_load_dwordx4 v5, s[8:11], s24 offen lds
  s_waitcnt lgkmcnt(2)
  v_mfma_f32_32x32x16_bf16 v[192:207], v[104:107], a[144:147], v[192:207]
  ds_read_b64_tr_b16 v[96:97], v2 offset:8192
  ds_read_b64_tr_b16 v[98:99], v2 offset:8704
  v_mfma_f32_32x32x16_bf16 v[208:223], v[104:107], a[148:151], v[208:223]
  s_add_u32 m0, s23, 57344
  s_add_u32 s24, s24, 147456
  buffer_load_dwordx4 v5, s[8:11], s24 offen lds
  s_waitcnt vmcnt(9)
  s_barrier
  s_waitcnt lgkmcnt(2)
  v_mfma_f32_32x32x16_bf16 v[192:207], v[108:111], a[152:155], v[192:207]
  ds_read_b64_tr_b16 v[100:101], v2 offset:12288
  ds_read_b64_tr_b16 v[102:103], v2 offset:12800
  v_mfma_f32_32x32x16_bf16 v[208:223], v[108:111], a[156:159], v[208:223]
  s_add_u32 m0, s23, 61440
  s_add_u32 s24, s24, 147456
  buffer_load_dwordx4 v5, s[8:11], s24 offen lds
  s_waitcnt lgkmcnt(2)
  v_mfma_f32_32x32x16_bf16 v[192:207], v[96:99], a[160:163], v[192:207]
  ds_read_b64_tr_b16 v[104:105], v2 offset:16384
  ds_read_b64_tr_b16 v[106:107], v2 offset:16896
  v_mfma_f32_32x32x16_bf16 v[208:223], v[96:99], a[164:167], v[208:223]
  s_add_u32 m0, s23, 65536
  s_add_u32 s24, s24, 147456
  buffer_load_dwordx4 v5, s[8:11], s24 offen lds
  s_waitcnt lgkmcnt(2)
  v_mfma_f32_32x32x16_bf16 v[192:207], v[100:103], a[168:171], v[192:207]
  ds_read_b64_tr_b16 v[108:109], v2 offset:20480
  ds_read_b64_tr_b16 v[110:111], v2 offset:20992
  v_mfma_f32_32x32x16_bf16 v[208:223], v[100:103], a[172:175], v[208:223]
  s_add_u32 m0, s23, 69632
  s_add_u32 s24, s24, 147456
  buffer_load_dwordx4 v5, s[8:11], s24 offen lds
  s_waitcnt vmcnt(9)
  s_barrier
  s_waitcnt lgkmcnt(2)
  v_mfma_f32_32x32x16_bf16 v[192:207], v[104:107], a[176:179], v[192:207]
  ds_read_b64_tr_b16 v[96:97], v2 offset:24576
  ds_read_b64_tr_b16 v[98:99], v2 offset:25088
  v_mfma_f32_32x32x16_bf16 v[208:223], v[104:107], a[180:183], v[208:223]
  s_add_u32 m0, s23, 0
  s_sub_u32 s24, s24, 5160832
  buffer_load_dwordx4 v5, s[8:11], s24 offen lds
  s_waitcnt lgkmcnt(2)
  v_mfma_f32_32x32x16_bf16 v[192:207], v[108:111], a[184:187], v[192:207]
  ds_read_b64_tr_b16 v[100:101], v2 offset:28672
  ds_read_b64_tr_b16 v[102:103], v2 offset:29184
  v_mfma_f32_32x32x16_bf16 v[208:223], v[108:111], a[188:191], v[208:223]
  s_add_u32 m0, s23, 4096
  s_add_u32 s24, s24, 147456
  buffer_load_dwordx4 v5, s[8:11], s24 offen lds
  s_waitcnt lgkmcnt(2)
  v_mfma_f32_32x32x16_bf16 v[192:207], v[96:99], a[192:195], v[192:207]
  ds_read_b64_tr_b16 v[104:105], v2 offset:32768
  ds_read_b64_tr_b16 v[106:107], v2 offset:33280
  v_mfma_f32_32x32x16_bf16 v[208:223], v[96:99], a[196:199], v[208:223]
  s_add_u32 m0, s23, 8192
  s_add_u32 s24, s24, 147456
  buffer_load_dwordx4 v5, s[8:11], s24 offen lds
  s_waitcnt vmcnt(9)
  s_barrier
  s_waitcnt lgkmcnt(2)
  v_mfma_f32_32x32x16_bf16 v[192:207], v[100:103], a[200:203], v[192:207]
  ds_read_b64_tr_b16 v[108:109], v90 offset:0
  ds_read_b64_tr_b16 v[110:111], v90 offset:512
  v_mfma_f32_32x32x16_bf16 v[208:223], v[100:103], a[204:207], v[208:223]
  s_add_u32 m0, s23, 12288
  s_add_u32 s24, s24, 147456
  buffer_load_dwordx4 v5, s[8:11], s24 offen lds
  s_waitcnt lgkmcnt(2)
  v_mfma_f32_32x32x16_bf16 v[192:207], v[104:107], a[208:211], v[192:207]
  ds_read_b64_tr_b16 v[96:97], v90 offset:4096
  ds_read_b64_tr_b16 v[98:99], v90 offset:4608
  v_mfma_f32_32x32x16_bf16 v[208:223], v[104:107], a[212:215], v[208:223]
  s_add_u32 m0, s23, 16384
  s_add_u32 s24, s24, 147456
  buffer_load_dwordx4 v5, s[8:11], s24 offen lds
  s_waitcnt lgkmcnt(2)
  v_mfma_f32_32x32x16_bf16 v[192:207], v[108:111], a[216:219], v[192:207]
  ds_read_b64_tr_b16 v[100:101], v90 offset:8192
  ds_read_b64_tr_b16 v[102:103], v90 offset:8704
  v_mfma_f32_32x32x16_bf16 v[208:223], v[108:111], a[220:223], v[208:223]
  s_add_u32 m0, s23, 20480
  s_add_u32 s24, s24, 147456
  buffer_load_dwordx4 v5, s[8:11], s24 offen lds
  s_waitcnt vmcnt(9)
  s_barrier
  s_waitcnt lgkmcnt(2)
  v_mfma_f32_32x32x16_bf16 v[192:207], v[96:99], a[224:227], v[192:207]
  ds_read_b64_tr_b16 v[104:105], v90 offset:12288
  ds_read_b64_tr_b16 v[106:107], v90 offset:12800
  v_mfma_f32_32x32x16_bf16 v[208:223], v[96:99], a[228:231], v[208:223]
  s_add_u32 m0, s23, 24576
  s_add_u32 s24, s24, 147456
  buffer_load_dwordx4 v5, s[8:11], s24 offen lds
  s_waitcnt lgkmcnt(2)
  v_mfma_f32_32x32x16_bf16 v[192:207], v[100:103], a[232:235], v[192:207]
  ds_read_b64_tr_b16 v[108:109], v90 offset:16384
  ds_read_b64_tr_b16 v[110:111], v90 offset:16896
  v_mfma_f32_32x32x16_bf16 v[208:223], v[100:103], a[236:239], v[208:223]
  s_add_u32 m0, s23, 28672
  s_add_u32 s24, s24, 147456
  buffer_load_dwordx4 v5, s[8:11], s24 offen lds
  s_waitcnt lgkmcnt(2)
  v_mfma_f32_32x32x16_bf16 v[192:207], v[104:107], a[240:243], v[192:207]
  ds_read_b64_tr_b16 v[96:97], v90 offset:20480
  ds_read_b64_tr_b16 v[98:99], v90 offset:20992
  v_mfma_f32_32x32x16_bf16 v[208:223], v[104:107], a[244:247], v[208:223]
  s_add_u32 m0, s23, 32768
  s_add_u32 s24, s24, 147456
  buffer_load_dwordx4 v5, s[8:11], s24 offen lds
  s_waitcnt vmcnt(9)
  s_barrier
  s_waitcnt lgkmcnt(2)
  v_mfma_f32_32x32x16_bf16 v[192:207], v[108:111], a[248:251], v[192:207]
  ds_read_b64_tr_b16 v[100:101], v90 offset:24576
  ds_read_b64_tr_b16 v[102:103], v90 offset:25088
  v_mfma_f32_32x32x16_bf16 v[208:223], v[108:111], a[252:255], v[208:223]
  s_add_u32 m0, s23, 36864
  s_add_u32 s24, s24, 147456
  buffer_load_dwordx4 v5, s[8:11], s24 offen lds
  s_waitcnt lgkmcnt(2)
  v_mfma_f32_32x32x16_bf16 v[192:207], v[96:99], v[224:227], v[192:207]
  ds_read_b64_tr_b16 v[104:105], v90 offset:28672
  ds_read_b64_tr_b16 v[106:107], v90 offset:29184
  v_mfma_f32_32x32x16_bf16 v[208:223], v[96:99], v[228:231], v[208:223]
  s_add_u32 m0, s23, 40960
  s_add_u32 s24, s24, 147456
  buffer_load_dwordx4 v5, s[8:11], s24 offen lds
  s_waitcnt lgkmcnt(2)
  v_mfma_f32_32x32x16_bf16 v[192:207], v[100:103], v[232:235], v[192:207]
  ds_read_b64_tr_b16 v[108:109], v90 offset:32768
  ds_read_b64_tr_b16 v[110:111], v90 offset:33280
  v_mfma_f32_32x32x16_bf16 v[208:223], v[100:103], v[236:239], v[208:223]
  s_add_u32 m0, s23, 45056
  s_add_u32 s24, s24, 147456
  buffer_load_dwordx4 v5, s[8:11], s24 offen lds
  s_waitcnt vmcnt(9)
  s_barrier
  s_waitcnt lgkmcnt(2)
  v_mfma_f32_32x32x16_bf16 v[192:207], v[104:107], v[240:243], v[192:207]
  ds_read_b64_tr_b16 v[96:97], v2 offset:0
  ds_read_b64_tr_b16 v[98:99], v2 offset:512
  v_mfma_f32_32x32x16_bf16 v[208:223], v[104:107], v[244:247], v[208:223]
  s_add_u32 m0, s23, 49152
  s_add_u32 s24, s24, 147456
  buffer_load_dwordx4 v5, s[8:11], s24 offen lds
  s_waitcnt lgkmcnt(2)
  v_mfma_f32_32x32x16_bf16 v[192:207], v[108:111], v[248:251], v[192:207]
  ds_read_b64_tr_b16 v[100:101], v2 offset:4096
  ds_read_b64_tr_b16 v[102:103], v2 offset:4608
  v_mfma_f32_32x32x16_bf16 v[208:223], v[108:111], v[252:255], v[208:223]
  s_add_u32 m0, s23, 53248
  s_add_u32 s24, s24, 147456
  buffer_load_dwordx4 v5, s[8:11], s24 offen lds
  s_waitcnt lgkmcnt(2)
  v_mfma_f32_32x32x16_bf16 v[128:143], v[96:99], a[0:3], 0
  ds_read_b64_tr_b16 v[104:105], v2 offset:8192
  ds_read_b64_tr_b16 v[106:107], v2 offset:8704
  v_mfma_f32_32x32x16_bf16 v[144:159], v[96:99], a[4:7], 0
  s_add_u32 m0, s23, 57344
  s_add_u32 s24, s24, 147456
  buffer_load_dwordx4 v5, s[8:11], s24 offen lds
  buffer_load_dword v15, v95, s[8:11], s56 offen
  s_add_u32 s56, s56, 128
  s_waitcnt vmcnt(10)
  s_barrier
  s_waitcnt lgkmcnt(2)
  v_mfma_f32_32x32x16_bf16 v[128:143], v[100:103], a[8:11], v[128:143]
  ds_read_b64_tr_b16 v[108:109], v2 offset:12288
  ds_read_b64_tr_b16 v[110:111], v2 offset:12800
  v_mfma_f32_32x32x16_bf16 v[144:159], v[100:103], a[12:15], v[144:159]
  s_add_u32 m0, s23, 61440
  s_add_u32 s24, s24, 147456
  buffer_load_dwordx4 v5, s[8:11], s24 offen lds
  s_waitcnt lgkmcnt(2)
  v_mfma_f32_32x32x16_bf16 v[128:143], v[104:107], a[16:19], v[128:143]
  ds_read_b64_tr_b16 v[96:97], v2 offset:16384
  ds_read_b64_tr_b16 v[98:99], v2 offset:16896
  v_mfma_f32_32x32x16_bf16 v[144:159], v[104:107], a[20:23], v[144:159]
  s_add_u32 m0, s23, 65536
  s_add_u32 s24, s24, 147456
  buffer_load_dwordx4 v5, s[8:11], s24 offen lds
  s_waitcnt lgkmcnt(2)
  v_mfma_f32_32x32x16_bf16 v[128:143], v[108:111], a[24:27], v[128:143]
  ds_read_b64_tr_b16 v[100:101], v2 offset:20480
  ds_read_b64_tr_b16 v[102:103], v2 offset:20992
  v_mul_f32 v192, v192, v200
  v_mul_f32 v193, v193, v201
  v_mfma_f32_32x32x16_bf16 v[144:159], v[108:111], a[28:31], v[144:159]
  s_add_u32 m0, s23, 69632
  s_add_u32 s24, s24, 147456
  buffer_load_dwordx4 v5, s[8:11], s24 offen lds
  v_mul_f32 v194, v194, v202
  v_mul_f32 v195, v195, v203
  s_waitcnt vmcnt(10)
  s_barrier
  s_waitcnt lgkmcnt(2)
  v_mfma_f32_32x32x16_bf16 v[128:143], v[96:99], a[32:35], v[128:143]
  ds_read_b64_tr_b16 v[104:105], v2 offset:24576
  ds_read_b64_tr_b16 v[106:107], v2 offset:25088
  v_mul_f32 v196, v196, v204
  v_mul_f32 v197, v197, v205
  v_mfma_f32_32x32x16_bf16 v[144:159], v[96:99], a[36:39], v[144:159]
  s_add_u32 m0, s23, 0
  s_add_u32 s24, s24, 147456
  buffer_load_dwordx4 v5, s[8:11], s24 offen lds
  v_mul_f32 v198, v198, v206
  v_mul_f32 v199, v199, v207
  s_waitcnt lgkmcnt(2)
  v_mfma_f32_32x32x16_bf16 v[128:143], v[100:103], a[40:43], v[128:143]
  ds_read_b64_tr_b16 v[108:109], v2 offset:28672
  ds_read_b64_tr_b16 v[110:111], v2 offset:29184
  v_cvt_pk_bf16_f32 v64, v192, v193
  v_cvt_pk_bf16_f32 v65, v194, v195
  v_mfma_f32_32x32x16_bf16 v[144:159], v[100:103], a[44:47], v[144:159]
  s_add_u32 m0, s23, 4096
  s_add_u32 s24, s24, 147456
  buffer_load_dwordx4 v5, s[8:11], s24 offen lds
  v_cvt_pk_bf16_f32 v66, v196, v197
  v_cvt_pk_bf16_f32 v67, v198, v199
  s_waitcnt lgkmcnt(2)
  v_mfma_f32_32x32x16_bf16 v[128:143], v[104:107], a[48:51], v[128:143]
  ds_read_b64_tr_b16 v[96:97], v2 offset:32768
  ds_read_b64_tr_b16 v[98:99], v2 offset:33280
  ds_write_b128 v8, v[64:67] offset:0
  v_mul_f32 v208, v208, v216
  v_mfma_f32_32x32x16_bf16 v[144:159], v[104:107], a[52:55], v[144:159]
  s_add_u32 m0, s23, 8192
  s_add_u32 s24, s24, 147456
  buffer_load_dwordx4 v5, s[8:11], s24 offen lds
  v_mul_f32 v209, v209, v217
  v_mul_f32 v210, v210, v218
  s_waitcnt vmcnt(10)
  s_barrier
  s_waitcnt lgkmcnt(3)
  v_mfma_f32_32x32x16_bf16 v[128:143], v[108:111], a[56:59], v[128:143]
  ds_read_b64_tr_b16 v[100:101], v90 offset:0
  ds_read_b64_tr_b16 v[102:103], v90 offset:512
  v_mul_f32 v211, v211, v219
  v_mul_f32 v212, v212, v220
  v_mfma_f32_32x32x16_bf16 v[144:159], v[108:111], a[60:63], v[144:159]
  s_add_u32 m0, s23, 12288
  s_add_u32 s24, s24, 147456
  buffer_load_dwordx4 v5, s[8:11], s24 offen lds
  v_mul_f32 v213, v213, v221
  v_mul_f32 v214, v214, v222
  s_waitcnt lgkmcnt(3)
  v_mfma_f32_32x32x16_bf16 v[128:143], v[96:99], a[64:67], v[128:143]
  ds_read_b64_tr_b16 v[104:105], v90 offset:4096
  ds_read_b64_tr_b16 v[106:107], v90 offset:4608
  v_mul_f32 v215, v215, v223
  v_cvt_pk_bf16_f32 v68, v208, v209
  v_mfma_f32_32x32x16_bf16 v[144:159], v[96:99], a[68:71], v[144:159]
  s_add_u32 m0, s23, 16384
  s_add_u32 s24, s24, 147456
  buffer_load_dwordx4 v5, s[8:11], s24 offen lds
  v_cvt_pk_bf16_f32 v69, v210, v211
  v_cvt_pk_bf16_f32 v70, v212, v213
  s_waitcnt lgkmcnt(2)
  v_mfma_f32_32x32x16_bf16 v[128:143], v[100:103], a[72:75], v[128:143]
  ds_read_b64_tr_b16 v[108:109], v90 offset:8192
  ds_read_b64_tr_b16 v[110:111], v90 offset:8704
  v_cvt_pk_bf16_f32 v71, v214, v215
  ds_write_b128 v8, v[68:71] offset:1024
  v_mfma_f32_32x32x16_bf16 v[144:159], v[100:103], a[76:79], v[144:159]
  s_add_u32 m0, s23, 20480
  s_add_u32 s24, s24, 147456
  buffer_load_dwordx4 v5, s[8:11], s24 offen lds
  v_add_u32 v8, s46, v8
  s_mov_b32 s46, 0x2000
  s_waitcnt vmcnt(10)
  s_barrier
  s_waitcnt lgkmcnt(3)
  v_mfma_f32_32x32x16_bf16 v[128:143], v[104:107], a[80:83], v[128:143]
  ds_read_b64_tr_b16 v[96:97], v90 offset:12288
  ds_read_b64_tr_b16 v[98:99], v90 offset:12800
  v_mfma_f32_32x32x16_bf16 v[144:159], v[104:107], a[84:87], v[144:159]
  s_add_u32 m0, s23, 24576
  s_add_u32 s24, s24, 147456
  buffer_load_dwordx4 v5, s[8:11], s24 offen lds
  s_waitcnt lgkmcnt(3)
  v_mfma_f32_32x32x16_bf16 v[128:143], v[108:111], a[88:91], v[128:143]
  ds_read_b64_tr_b16 v[100:101], v90 offset:16384
  ds_read_b64_tr_b16 v[102:103], v90 offset:16896
  v_mfma_f32_32x32x16_bf16 v[144:159], v[108:111], a[92:95], v[144:159]
  s_add_u32 m0, s23, 28672
  s_add_u32 s24, s24, 147456
  buffer_load_dwordx4 v5, s[8:11], s24 offen lds
  s_waitcnt lgkmcnt(2)
  v_mfma_f32_32x32x16_bf16 v[128:143], v[96:99], a[96:99], v[128:143]
  ds_read_b64_tr_b16 v[104:105], v90 offset:20480
  ds_read_b64_tr_b16 v[106:107], v90 offset:20992
  v_mfma_f32_32x32x16_bf16 v[144:159], v[96:99], a[100:103], v[144:159]
  s_add_u32 m0, s23, 32768
  s_add_u32 s24, s24, 147456
  buffer_load_dwordx4 v5, s[8:11], s24 offen lds
  s_waitcnt vmcnt(9)
  s_barrier
  s_waitcnt lgkmcnt(2)
  v_mfma_f32_32x32x16_bf16 v[128:143], v[100:103], a[104:107], v[128:143]
  ds_read_b64_tr_b16 v[108:109], v90 offset:24576
  ds_read_b64_tr_b16 v[110:111], v90 offset:25088
  v_mfma_f32_32x32x16_bf16 v[144:159], v[100:103], a[108:111], v[144:159]
  s_add_u32 m0, s23, 36864
  s_add_u32 s24, s24, 147456
  buffer_load_dwordx4 v5, s[8:11], s24 offen lds
  s_waitcnt lgkmcnt(2)
  v_mfma_f32_32x32x16_bf16 v[128:143], v[104:107], a[112:115], v[128:143]
  ds_read_b64_tr_b16 v[96:97], v90 offset:28672
  ds_read_b64_tr_b16 v[98:99], v90 offset:29184
  v_mfma_f32_32x32x16_bf16 v[144:159], v[104:107], a[116:119], v[144:159]
  s_add_u32 m0, s23, 40960
  s_add_u32 s24, s24, 147456
  buffer_load_dwordx4 v5, s[8:11], s24 offen lds
  s_waitcnt lgkmcnt(2)
  v_mfma_f32_32x32x16_bf16 v[128:143], v[108:111], a[120:123], v[128:143]
  ds_read_b64_tr_b16 v[100:101], v90 offset:32768
  ds_read_b64_tr_b16 v[102:103], v90 offset:33280
  v_mfma_f32_32x32x16_bf16 v[144:159], v[108:111], a[124:127], v[144:159]
  s_add_u32 m0, s23, 45056
  s_add_u32 s24, s24, 147456
  buffer_load_dwordx4 v5, s[8:11], s24 offen lds
  s_waitcnt vmcnt(9)
  s_barrier
  s_waitcnt lgkmcnt(2)
  v_mfma_f32_32x32x16_bf16 v[128:143], v[96:99], a[128:131], v[128:143]
  ds_read_b64_tr_b16 v[104:105], v2 offset:0
  ds_read_b64_tr_b16 v[106:107], v2 offset:512
  v_mfma_f32_32x32x16_bf16 v[144:159], v[96:99], a[132:135], v[144:159]
  s_add_u32 m0, s23, 49152
  s_add_u32 s24, s24, 147456
  buffer_load_dwordx4 v5, s[8:11], s24 offen lds
  s_waitcnt lgkmcnt(2)
  v_mfma_f32_32x32x16_bf16 v[128:143], v[100:103], a[136:139], v[128:143]
  ds_read_b64_tr_b16 v[108:109], v2 offset:4096
  ds_read_b64_tr_b16 v[110:111], v2 offset:4608
  v_mfma_f32_32x32x16_bf16 v[144:159], v[100:103], a[140:143], v[144:159]
  s_add_u32 m0, s23, 53248
  s_add_u32 s24, s24, 147456
  buffer_load_dwordx4 v5, s[8:11], s24 offen lds
  s_waitcnt lgkmcnt(2)
  v_mfma_f32_32x32x16_bf16 v[128:143], v[104:107], a[144:147], v[128:143]
  ds_read_b64_tr_b16 v[96:97], v2 offset:8192
  ds_read_b64_tr_b16 v[98:99], v2 offset:8704
  v_mfma_f32_32x32x16_bf16 v[144:159], v[104:107], a[148:151], v[144:159]
  s_add_u32 m0, s23, 57344
  s_add_u32 s24, s24, 147456
  buffer_load_dwordx4 v5, s[8:11], s24 offen lds
  s_waitcnt vmcnt(9)
  s_barrier
  s_waitcnt lgkmcnt(2)
  v_mfma_f32_32x32x16_bf16 v[128:143], v[108:111], a[152:155], v[128:143]
  ds_read_b64_tr_b16 v[100:101], v2 offset:12288
  ds_read_b64_tr_b16 v[102:103], v2 offset:12800
  v_mfma_f32_32x32x16_bf16 v[144:159], v[108:111], a[156:159], v[144:159]
  s_add_u32 m0, s23, 61440
  s_add_u32 s24, s24, 147456
  buffer_load_dwordx4 v5, s[8:11], s24 offen lds
  s_waitcnt lgkmcnt(2)
  v_mfma_f32_32x32x16_bf16 v[128:143], v[96:99], a[160:163], v[128:143]
  ds_read_b64_tr_b16 v[104:105], v2 offset:16384
  ds_read_b64_tr_b16 v[106:107], v2 offset:16896
  v_mfma_f32_32x32x16_bf16 v[144:159], v[96:99], a[164:167], v[144:159]
  s_add_u32 m0, s23, 65536
  s_add_u32 s24, s24, 147456
  buffer_load_dwordx4 v5, s[8:11], s24 offen lds
  s_waitcnt lgkmcnt(2)
  v_mfma_f32_32x32x16_bf16 v[128:143], v[100:103], a[168:171], v[128:143]
  ds_read_b64_tr_b16 v[108:109], v2 offset:20480
  ds_read_b64_tr_b16 v[110:111], v2 offset:20992
  v_mfma_f32_32x32x16_bf16 v[144:159], v[100:103], a[172:175], v[144:159]
  s_add_u32 m0, s23, 69632
  s_add_u32 s24, s24, 147456
  buffer_load_dwordx4 v5, s[8:11], s24 offen lds
  s_waitcnt vmcnt(9)
  s_barrier
  s_waitcnt lgkmcnt(2)
  v_mfma_f32_32x32x16_bf16 v[128:143], v[104:107], a[176:179], v[128:143]
  ds_read_b64_tr_b16 v[96:97], v2 offset:24576
  ds_read_b64_tr_b16 v[98:99], v2 offset:25088
  v_mfma_f32_32x32x16_bf16 v[144:159], v[104:107], a[180:183], v[144:159]
  s_add_u32 m0, s23, 0
  s_sub_u32 s24, s24, 5160832
  buffer_load_dwordx4 v5, s[8:11], s24 offen lds
  s_waitcnt lgkmcnt(2)
  v_mfma_f32_32x32x16_bf16 v[128:143], v[108:111], a[184:187], v[128:143]
  ds_read_b64_tr_b16 v[100:101], v2 offset:28672
  ds_read_b64_tr_b16 v[102:103], v2 offset:29184
  v_mfma_f32_32x32x16_bf16 v[144:159], v[108:111], a[188:191], v[144:159]
  s_add_u32 m0, s23, 4096
  s_add_u32 s24, s24, 147456
  buffer_load_dwordx4 v5, s[8:11], s24 offen lds
  s_waitcnt lgkmcnt(2)
  v_mfma_f32_32x32x16_bf16 v[128:143], v[96:99], a[192:195], v[128:143]
  ds_read_b64_tr_b16 v[104:105], v2 offset:32768
  ds_read_b64_tr_b16 v[106:107], v2 offset:33280
  v_mfma_f32_32x32x16_bf16 v[144:159], v[96:99], a[196:199], v[144:159]
  s_add_u32 m0, s23, 8192
  s_add_u32 s24, s24, 147456
  buffer_load_dwordx4 v5, s[8:11], s24 offen lds
  s_waitcnt vmcnt(9)
  s_barrier
  s_waitcnt lgkmcnt(2)
  v_mfma_f32_32x32x16_bf16 v[128:143], v[100:103], a[200:203], v[128:143]
  ds_read_b64_tr_b16 v[108:109], v90 offset:0
  ds_read_b64_tr_b16 v[110:111], v90 offset:512
  v_mfma_f32_32x32x16_bf16 v[144:159], v[100:103], a[204:207], v[144:159]
  s_add_u32 m0, s23, 12288
  s_add_u32 s24, s24, 147456
  buffer_load_dwordx4 v5, s[8:11], s24 offen lds
  s_waitcnt lgkmcnt(2)
  v_mfma_f32_32x32x16_bf16 v[128:143], v[104:107], a[208:211], v[128:143]
  ds_read_b64_tr_b16 v[96:97], v90 offset:4096
  ds_read_b64_tr_b16 v[98:99], v90 offset:4608
  v_mfma_f32_32x32x16_bf16 v[144:159], v[104:107], a[212:215], v[144:159]
  s_add_u32 m0, s23, 16384
  s_add_u32 s24, s24, 147456
  buffer_load_dwordx4 v5, s[8:11], s24 offen lds
  s_waitcnt lgkmcnt(2)
  v_mfma_f32_32x32x16_bf16 v[128:143], v[108:111], a[216:219], v[128:143]
  ds_read_b64_tr_b16 v[100:101], v90 offset:8192
  ds_read_b64_tr_b16 v[102:103], v90 offset:8704
  v_mfma_f32_32x32x16_bf16 v[144:159], v[108:111], a[220:223], v[144:159]
  s_add_u32 m0, s23, 20480
  s_add_u32 s24, s24, 147456
  buffer_load_dwordx4 v5, s[8:11], s24 offen lds
  s_waitcnt vmcnt(9)
  s_barrier
  s_waitcnt lgkmcnt(2)
  v_mfma_f32_32x32x16_bf16 v[128:143], v[96:99], a[224:227], v[128:143]
  ds_read_b64_tr_b16 v[104:105], v90 offset:12288
  ds_read_b64_tr_b16 v[106:107], v90 offset:12800
  v_mfma_f32_32x32x16_bf16 v[144:159], v[96:99], a[228:231], v[144:159]
  s_add_u32 m0, s23, 24576
  s_add_u32 s24, s24, 147456
  buffer_load_dwordx4 v5, s[8:11], s24 offen lds
  s_waitcnt lgkmcnt(2)
  v_mfma_f32_32x32x16_bf16 v[128:143], v[100:103], a[232:235], v[128:143]
  ds_read_b64_tr_b16 v[108:109], v90 offset:16384
  ds_read_b64_tr_b16 v[110:111], v90 offset:16896
  v_mfma_f32_32x32x16_bf16 v[144:159], v[100:103], a[236:239], v[144:159]
  s_add_u32 m0, s23, 28672
  s_add_u32 s24, s24, 147456
  buffer_load_dwordx4 v5, s[8:11], s24 offen lds
  s_waitcnt lgkmcnt(2)
  v_mfma_f32_32x32x16_bf16 v[128:143], v[104:107], a[240:243], v[128:143]
  ds_read_b64_tr_b16 v[96:97], v90 offset:20480
  ds_read_b64_tr_b16 v[98:99], v90 offset:20992
  v_mfma_f32_32x32x16_bf16 v[144:159], v[104:107], a[244:247], v[144:159]
  s_add_u32 m0, s23, 32768
  s_add_u32 s24, s24, 147456
  buffer_load_dwordx4 v5, s[8:11], s24 offen lds
  s_waitcnt vmcnt(9)
  s_barrier
  s_waitcnt lgkmcnt(2)
  v_mfma_f32_32x32x16_bf16 v[128:143], v[108:111], a[248:251], v[128:143]
  ds_read_b64_tr_b16 v[100:101], v90 offset:24576
  ds_read_b64_tr_b16 v[102:103], v90 offset:25088
  v_mfma_f32_32x32x16_bf16 v[144:159], v[108:111], a[252:255], v[144:159]
  s_add_u32 m0, s23, 36864
  s_add_u32 s24, s24, 147456
  buffer_load_dwordx4 v5, s[8:11], s24 offen lds
  s_waitcnt lgkmcnt(2)
  v_mfma_f32_32x32x16_bf16 v[128:143], v[96:99], v[224:227], v[128:143]
  ds_read_b64_tr_b16 v[104:105], v90 offset:28672
  ds_read_b64_tr_b16 v[106:107], v90 offset:29184
  v_mfma_f32_32x32x16_bf16 v[144:159], v[96:99], v[228:231], v[144:159]
  s_add_u32 m0, s23, 40960
  s_add_u32 s24, s24, 147456
  buffer_load_dwordx4 v5, s[8:11], s24 offen lds
  s_waitcnt lgkmcnt(2)
  v_mfma_f32_32x32x16_bf16 v[128:143], v[100:103], v[232:235], v[128:143]
  ds_read_b64_tr_b16 v[108:109], v90 offset:32768
  ds_read_b64_tr_b16 v[110:111], v90 offset:33280
  v_mfma_f32_32x32x16_bf16 v[144:159], v[100:103], v[236:239], v[144:159]
  s_add_u32 m0, s23, 45056
  s_add_u32 s24, s24, 147456
  buffer_load_dwordx4 v5, s[8:11], s24 offen lds
  s_waitcnt vmcnt(9)
  s_barrier
  s_waitcnt lgkmcnt(2)
  v_mfma_f32_32x32x16_bf16 v[128:143], v[104:107], v[240:243], v[128:143]
  ds_read_b64_tr_b16 v[96:97], v2 offset:0
  ds_read_b64_tr_b16 v[98:99], v2 offset:512
  v_mfma_f32_32x32x16_bf16 v[144:159], v[104:107], v[244:247], v[144:159]
  s_add_u32 m0, s23, 49152
  s_add_u32 s24, s24, 147456
  buffer_load_dwordx4 v5, s[8:11], s24 offen lds
  s_waitcnt lgkmcnt(2)
  v_mfma_f32_32x32x16_bf16 v[128:143], v[108:111], v[248:251], v[128:143]
  ds_read_b64_tr_b16 v[100:101], v2 offset:4096
  ds_read_b64_tr_b16 v[102:103], v2 offset:4608
  v_mfma_f32_32x32x16_bf16 v[144:159], v[108:111], v[252:255], v[144:159]
  s_add_u32 m0, s23, 53248
  s_add_u32 s24, s24, 147456
  buffer_load_dwordx4 v5, s[8:11], s24 offen lds
  s_waitcnt lgkmcnt(2)
  v_mfma_f32_32x32x16_bf16 v[160:175], v[96:99], a[0:3], 0
  ds_read_b64_tr_b16 v[104:105], v2 offset:8192
  ds_read_b64_tr_b16 v[106:107], v2 offset:8704
  v_mfma_f32_32x32x16_bf16 v[176:191], v[96:99], a[4:7], 0
  s_add_u32 m0, s23, 57344
  s_add_u32 s24, s24, 147456
  buffer_load_dwordx4 v5, s[8:11], s24 offen lds
  buffer_load_dword v15, v95, s[8:11], s56 offen
  s_add_u32 s56, s56, 128
  s_waitcnt vmcnt(10)
  s_barrier
  s_waitcnt lgkmcnt(2)
  v_mfma_f32_32x32x16_bf16 v[160:175], v[100:103], a[8:11], v[160:175]
  ds_read_b64_tr_b16 v[108:109], v2 offset:12288
  ds_read_b64_tr_b16 v[110:111], v2 offset:12800
  v_mfma_f32_32x32x16_bf16 v[176:191], v[100:103], a[12:15], v[176:191]
  s_add_u32 m0, s23, 61440
  s_add_u32 s24, s24, 147456
  buffer_load_dwordx4 v5, s[8:11], s24 offen lds
  s_waitcnt lgkmcnt(2)
  v_mfma_f32_32x32x16_bf16 v[160:175], v[104:107], a[16:19], v[160:175]
  ds_read_b64_tr_b16 v[96:97], v2 offset:16384
  ds_read_b64_tr_b16 v[98:99], v2 offset:16896
  v_mfma_f32_32x32x16_bf16 v[176:191], v[104:107], a[20:23], v[176:191]
  s_add_u32 m0, s23, 65536
  s_add_u32 s24, s24, 147456
  buffer_load_dwordx4 v5, s[8:11], s24 offen lds
  s_waitcnt lgkmcnt(2)
  v_mfma_f32_32x32x16_bf16 v[160:175], v[108:111], a[24:27], v[160:175]
  ds_read_b64_tr_b16 v[100:101], v2 offset:20480
  ds_read_b64_tr_b16 v[102:103], v2 offset:20992
  v_mul_f32 v128, v128, v136
  v_mul_f32 v129, v129, v137
  v_mfma_f32_32x32x16_bf16 v[176:191], v[108:111], a[28:31], v[176:191]
  s_add_u32 m0, s23, 69632
  s_add_u32 s24, s24, 147456
  buffer_load_dwordx4 v5, s[8:11], s24 offen lds
  v_mul_f32 v130, v130, v138
  v_mul_f32 v131, v131, v139
  s_waitcnt vmcnt(10)
  s_barrier
  s_waitcnt lgkmcnt(2)
  v_mfma_f32_32x32x16_bf16 v[160:175], v[96:99], a[32:35], v[160:175]
  ds_read_b64_tr_b16 v[104:105], v2 offset:24576
  ds_read_b64_tr_b16 v[106:107], v2 offset:25088
  v_mul_f32 v132, v132, v140
  v_mul_f32 v133, v133, v141
  v_mfma_f32_32x32x16_bf16 v[176:191], v[96:99], a[36:39], v[176:191]
  s_add_u32 m0, s23, 0
  s_add_u32 s24, s24, 147456
  buffer_load_dwordx4 v5, s[8:11], s24 offen lds
  v_mul_f32 v134, v134, v142
  v_mul_f32 v135, v135, v143
  s_waitcnt lgkmcnt(2)
  v_mfma_f32_32x32x16_bf16 v[160:175], v[100:103], a[40:43], v[160:175]
  ds_read_b64_tr_b16 v[108:109], v2 offset:28672
  ds_read_b64_tr_b16 v[110:111], v2 offset:29184
  v_cvt_pk_bf16_f32 v64, v128, v129
  v_cvt_pk_bf16_f32 v65, v130, v131
  v_mfma_f32_32x32x16_bf16 v[176:191], v[100:103], a[44:47], v[176:191]
  s_add_u32 m0, s23, 4096
  s_add_u32 s24, s24, 147456
  buffer_load_dwordx4 v5, s[8:11], s24 offen lds
  v_cvt_pk_bf16_f32 v66, v132, v133
  v_cvt_pk_bf16_f32 v67, v134, v135
  s_waitcnt lgkmcnt(2)
  v_mfma_f32_32x32x16_bf16 v[160:175], v[104:107], a[48:51], v[160:175]
  ds_read_b64_tr_b16 v[96:97], v2 offset:32768
  ds_read_b64_tr_b16 v[98:99], v2 offset:33280
  ds_write_b128 v8, v[64:67] offset:0
  v_mul_f32 v144, v144, v152
  v_mfma_f32_32x32x16_bf16 v[176:191], v[104:107], a[52:55], v[176:191]
  s_add_u32 m0, s23, 8192
  s_add_u32 s24, s24, 147456
  buffer_load_dwordx4 v5, s[8:11], s24 offen lds
  v_mul_f32 v145, v145, v153
  v_mul_f32 v146, v146, v154
  s_waitcnt vmcnt(10)
  s_barrier
  s_waitcnt lgkmcnt(3)
  v_mfma_f32_32x32x16_bf16 v[160:175], v[108:111], a[56:59], v[160:175]
  ds_read_b64_tr_b16 v[100:101], v90 offset:0
  ds_read_b64_tr_b16 v[102:103], v90 offset:512
  v_mul_f32 v147, v147, v155
  v_mul_f32 v148, v148, v156
  v_mfma_f32_32x32x16_bf16 v[176:191], v[108:111], a[60:63], v[176:191]
  s_add_u32 m0, s23, 12288
  s_add_u32 s24, s24, 147456
  buffer_load_dwordx4 v5, s[8:11], s24 offen lds
  v_mul_f32 v149, v149, v157
  v_mul_f32 v150, v150, v158
  s_waitcnt lgkmcnt(3)
  v_mfma_f32_32x32x16_bf16 v[160:175], v[96:99], a[64:67], v[160:175]
  ds_read_b64_tr_b16 v[104:105], v90 offset:4096
  ds_read_b64_tr_b16 v[106:107], v90 offset:4608
  v_mul_f32 v151, v151, v159
  v_cvt_pk_bf16_f32 v68, v144, v145
  v_mfma_f32_32x32x16_bf16 v[176:191], v[96:99], a[68:71], v[176:191]
  s_add_u32 m0, s23, 16384
  s_add_u32 s24, s24, 147456
  buffer_load_dwordx4 v5, s[8:11], s24 offen lds
  v_cvt_pk_bf16_f32 v69, v146, v147
  v_cvt_pk_bf16_f32 v70, v148, v149
  s_waitcnt lgkmcnt(2)
  v_mfma_f32_32x32x16_bf16 v[160:175], v[100:103], a[72:75], v[160:175]
  ds_read_b64_tr_b16 v[108:109], v90 offset:8192
  ds_read_b64_tr_b16 v[110:111], v90 offset:8704
  v_cvt_pk_bf16_f32 v71, v150, v151
  ds_write_b128 v8, v[68:71] offset:1024
  v_mfma_f32_32x32x16_bf16 v[176:191], v[100:103], a[76:79], v[176:191]
  s_add_u32 m0, s23, 20480
  s_add_u32 s24, s24, 147456
  buffer_load_dwordx4 v5, s[8:11], s24 offen lds
  v_add_u32 v8, s46, v8
  s_mov_b32 s46, 0x2000
  s_waitcnt vmcnt(10)
  s_barrier
  s_waitcnt lgkmcnt(3)
  v_mfma_f32_32x32x16_bf16 v[160:175], v[104:107], a[80:83], v[160:175]
  ds_read_b64_tr_b16 v[96:97], v90 offset:12288
  ds_read_b64_tr_b16 v[98:99], v90 offset:12800
  v_mfma_f32_32x32x16_bf16 v[176:191], v[104:107], a[84:87], v[176:191]
  s_add_u32 m0, s23, 24576
  s_add_u32 s24, s24, 147456
  buffer_load_dwordx4 v5, s[8:11], s24 offen lds
  s_waitcnt lgkmcnt(3)
  v_mfma_f32_32x32x16_bf16 v[160:175], v[108:111], a[88:91], v[160:175]
  ds_read_b64_tr_b16 v[100:101], v90 offset:16384
  ds_read_b64_tr_b16 v[102:103], v90 offset:16896
  v_mfma_f32_32x32x16_bf16 v[176:191], v[108:111], a[92:95], v[176:191]
  s_add_u32 m0, s23, 28672
  s_add_u32 s24, s24, 147456
  buffer_load_dwordx4 v5, s[8:11], s24 offen lds
  s_waitcnt lgkmcnt(2)
  v_mfma_f32_32x32x16_bf16 v[160:175], v[96:99], a[96:99], v[160:175]
  ds_read_b64_tr_b16 v[104:105], v90 offset:20480
  ds_read_b64_tr_b16 v[106:107], v90 offset:20992
  v_mfma_f32_32x32x16_bf16 v[176:191], v[96:99], a[100:103], v[176:191]
  s_add_u32 m0, s23, 32768
  s_add_u32 s24, s24, 147456
  buffer_load_dwordx4 v5, s[8:11], s24 offen lds
  s_waitcnt vmcnt(9)
  s_barrier
  s_waitcnt lgkmcnt(2)
  v_mfma_f32_32x32x16_bf16 v[160:175], v[100:103], a[104:107], v[160:175]
  ds_read_b64_tr_b16 v[108:109], v90 offset:24576
  ds_read_b64_tr_b16 v[110:111], v90 offset:25088
  v_mfma_f32_32x32x16_bf16 v[176:191], v[100:103], a[108:111], v[176:191]
  s_add_u32 m0, s23, 36864
  s_add_u32 s24, s24, 147456
  buffer_load_dwordx4 v5, s[8:11], s24 offen lds
  s_waitcnt lgkmcnt(2)
  v_mfma_f32_32x32x16_bf16 v[160:175], v[104:107], a[112:115], v[160:175]
  ds_read_b64_tr_b16 v[96:97], v90 offset:28672
  ds_read_b64_tr_b16 v[98:99], v90 offset:29184
  v_mfma_f32_32x32x16_bf16 v[176:191], v[104:107], a[116:119], v[176:191]
  s_add_u32 m0, s23, 40960
  s_add_u32 s24, s24, 147456
  buffer_load_dwordx4 v5, s[8:11], s24 offen lds
  s_waitcnt lgkmcnt(2)
  v_mfma_f32_32x32x16_bf16 v[160:175], v[108:111], a[120:123], v[160:175]
  ds_read_b64_tr_b16 v[100:101], v90 offset:32768
  ds_read_b64_tr_b16 v[102:103], v90 offset:33280
  v_mfma_f32_32x32x16_bf16 v[176:191], v[108:111], a[124:127], v[176:191]
  s_add_u32 m0, s23, 45056
  s_add_u32 s24, s24, 147456
  buffer_load_dwordx4 v5, s[8:11], s24 offen lds
  s_waitcnt vmcnt(9)
  s_barrier
  s_waitcnt lgkmcnt(2)
  v_mfma_f32_32x32x16_bf16 v[160:175], v[96:99], a[128:131], v[160:175]
  ds_read_b64_tr_b16 v[104:105], v2 offset:0
  ds_read_b64_tr_b16 v[106:107], v2 offset:512
  v_mfma_f32_32x32x16_bf16 v[176:191], v[96:99], a[132:135], v[176:191]
  s_add_u32 m0, s23, 49152
  s_add_u32 s24, s24, 147456
  buffer_load_dwordx4 v5, s[8:11], s24 offen lds
  s_waitcnt lgkmcnt(2)
  v_mfma_f32_32x32x16_bf16 v[160:175], v[100:103], a[136:139], v[160:175]
  ds_read_b64_tr_b16 v[108:109], v2 offset:4096
  ds_read_b64_tr_b16 v[110:111], v2 offset:4608
  v_mfma_f32_32x32x16_bf16 v[176:191], v[100:103], a[140:143], v[176:191]
  s_add_u32 m0, s23, 53248
  s_add_u32 s24, s24, 147456
  buffer_load_dwordx4 v5, s[8:11], s24 offen lds
  s_waitcnt lgkmcnt(2)
  v_mfma_f32_32x32x16_bf16 v[160:175], v[104:107], a[144:147], v[160:175]
  ds_read_b64_tr_b16 v[96:97], v2 offset:8192
  ds_read_b64_tr_b16 v[98:99], v2 offset:8704
  v_mfma_f32_32x32x16_bf16 v[176:191], v[104:107], a[148:151], v[176:191]
  s_add_u32 m0, s23, 57344
  s_add_u32 s24, s24, 147456
  buffer_load_dwordx4 v5, s[8:11], s24 offen lds
  s_waitcnt vmcnt(9)
  s_barrier
  s_waitcnt lgkmcnt(2)
  v_mfma_f32_32x32x16_bf16 v[160:175], v[108:111], a[152:155], v[160:175]
  ds_read_b64_tr_b16 v[100:101], v2 offset:12288
  ds_read_b64_tr_b16 v[102:103], v2 offset:12800
  v_mfma_f32_32x32x16_bf16 v[176:191], v[108:111], a[156:159], v[176:191]
  s_add_u32 m0, s23, 61440
  s_add_u32 s24, s24, 147456
  buffer_load_dwordx4 v5, s[8:11], s24 offen lds
  s_waitcnt lgkmcnt(2)
  v_mfma_f32_32x32x16_bf16 v[160:175], v[96:99], a[160:163], v[160:175]
  ds_read_b64_tr_b16 v[104:105], v2 offset:16384
  ds_read_b64_tr_b16 v[106:107], v2 offset:16896
  v_mfma_f32_32x32x16_bf16 v[176:191], v[96:99], a[164:167], v[176:191]
  s_add_u32 m0, s23, 65536
  s_add_u32 s24, s24, 147456
  buffer_load_dwordx4 v5, s[8:11], s24 offen lds
  s_waitcnt lgkmcnt(2)
  v_mfma_f32_32x32x16_bf16 v[160:175], v[100:103], a[168:171], v[160:175]
  ds_read_b64_tr_b16 v[108:109], v2 offset:20480
  ds_read_b64_tr_b16 v[110:111], v2 offset:20992
  v_mfma_f32_32x32x16_bf16 v[176:191], v[100:103], a[172:175], v[176:191]
  s_add_u32 m0, s23, 69632
  s_add_u32 s24, s24, 147456
  buffer_load_dwordx4 v5, s[8:11], s24 offen lds
  s_waitcnt vmcnt(9)
  s_barrier
  s_waitcnt lgkmcnt(2)
  v_mfma_f32_32x32x16_bf16 v[160:175], v[104:107], a[176:179], v[160:175]
  ds_read_b64_tr_b16 v[96:97], v2 offset:24576
  ds_read_b64_tr_b16 v[98:99], v2 offset:25088
  v_mfma_f32_32x32x16_bf16 v[176:191], v[104:107], a[180:183], v[176:191]
  s_add_u32 m0, s23, 0
  s_sub_u32 s24, s24, 5160832
  buffer_load_dwordx4 v5, s[8:11], s24 offen lds
  s_waitcnt lgkmcnt(2)
  v_mfma_f32_32x32x16_bf16 v[160:175], v[108:111], a[184:187], v[160:175]
  ds_read_b64_tr_b16 v[100:101], v2 offset:28672
  ds_read_b64_tr_b16 v[102:103], v2 offset:29184
  v_mfma_f32_32x32x16_bf16 v[176:191], v[108:111], a[188:191], v[176:191]
  s_add_u32 m0, s23, 4096
  s_add_u32 s24, s24, 147456
  buffer_load_dwordx4 v5, s[8:11], s24 offen lds
  s_waitcnt lgkmcnt(2)
  v_mfma_f32_32x32x16_bf16 v[160:175], v[96:99], a[192:195], v[160:175]
  ds_read_b64_tr_b16 v[104:105], v2 offset:32768
  ds_read_b64_tr_b16 v[106:107], v2 offset:33280
  v_mfma_f32_32x32x16_bf16 v[176:191], v[96:99], a[196:199], v[176:191]
  s_add_u32 m0, s23, 8192
  s_add_u32 s24, s24, 147456
  buffer_load_dwordx4 v5, s[8:11], s24 offen lds
  s_waitcnt vmcnt(9)
  s_barrier
  s_waitcnt lgkmcnt(2)
  v_mfma_f32_32x32x16_bf16 v[160:175], v[100:103], a[200:203], v[160:175]
  ds_read_b64_tr_b16 v[108:109], v90 offset:0
  ds_read_b64_tr_b16 v[110:111], v90 offset:512
  v_mfma_f32_32x32x16_bf16 v[176:191], v[100:103], a[204:207], v[176:191]
  s_add_u32 m0, s23, 12288
  s_add_u32 s24, s24, 147456
  buffer_load_dwordx4 v5, s[8:11], s24 offen lds
  s_waitcnt lgkmcnt(2)
  v_mfma_f32_32x32x16_bf16 v[160:175], v[104:107], a[208:211], v[160:175]
  ds_read_b64_tr_b16 v[96:97], v90 offset:4096
  ds_read_b64_tr_b16 v[98:99], v90 offset:4608
  v_mfma_f32_32x32x16_bf16 v[176:191], v[104:107], a[212:215], v[176:191]
  s_add_u32 m0, s23, 16384
  s_add_u32 s24, s24, 147456
  buffer_load_dwordx4 v5, s[8:11], s24 offen lds
  s_waitcnt lgkmcnt(2)
  v_mfma_f32_32x32x16_bf16 v[160:175], v[108:111], a[216:219], v[160:175]
  ds_read_b64_tr_b16 v[100:101], v90 offset:8192
  ds_read_b64_tr_b16 v[102:103], v90 offset:8704
  v_mfma_f32_32x32x16_bf16 v[176:191], v[108:111], a[220:223], v[176:191]
  s_add_u32 m0, s23, 20480
  s_add_u32 s24, s24, 147456
  buffer_load_dwordx4 v5, s[8:11], s24 offen lds
  s_waitcnt vmcnt(9)
  s_barrier
  s_waitcnt lgkmcnt(2)
  v_mfma_f32_32x32x16_bf16 v[160:175], v[96:99], a[224:227], v[160:175]
  ds_read_b64_tr_b16 v[104:105], v90 offset:12288
  ds_read_b64_tr_b16 v[106:107], v90 offset:12800
  v_mfma_f32_32x32x16_bf16 v[176:191], v[96:99], a[228:231], v[176:191]
  s_add_u32 m0, s23, 24576
  s_add_u32 s24, s24, 147456
  buffer_load_dwordx4 v5, s[8:11], s24 offen lds
  s_waitcnt lgkmcnt(2)
  v_mfma_f32_32x32x16_bf16 v[160:175], v[100:103], a[232:235], v[160:175]
  ds_read_b64_tr_b16 v[108:109], v90 offset:16384
  ds_read_b64_tr_b16 v[110:111], v90 offset:16896
  v_mfma_f32_32x32x16_bf16 v[176:191], v[100:103], a[236:239], v[176:191]
  s_add_u32 m0, s23, 28672
  s_add_u32 s24, s24, 147456
  buffer_load_dwordx4 v5, s[8:11], s24 offen lds
  s_waitcnt lgkmcnt(2)
  v_mfma_f32_32x32x16_bf16 v[160:175], v[104:107], a[240:243], v[160:175]
  ds_read_b64_tr_b16 v[96:97], v90 offset:20480
  ds_read_b64_tr_b16 v[98:99], v90 offset:20992
  v_mfma_f32_32x32x16_bf16 v[176:191], v[104:107], a[244:247], v[176:191]
  s_add_u32 m0, s23, 32768
  s_add_u32 s24, s24, 147456
  buffer_load_dwordx4 v5, s[8:11], s24 offen lds
  s_waitcnt vmcnt(9)
  s_barrier
  s_waitcnt lgkmcnt(2)
  v_mfma_f32_32x32x16_bf16 v[160:175], v[108:111], a[248:251], v[160:175]
  ds_read_b64_tr_b16 v[100:101], v90 offset:24576
  ds_read_b64_tr_b16 v[102:103], v90 offset:25088
  v_mfma_f32_32x32x16_bf16 v[176:191], v[108:111], a[252:255], v[176:191]
  s_add_u32 m0, s23, 36864
  s_add_u32 s24, s24, 147456
  buffer_load_dwordx4 v5, s[8:11], s24 offen lds
  s_waitcnt lgkmcnt(2)
  v_mfma_f32_32x32x16_bf16 v[160:175], v[96:99], v[224:227], v[160:175]
  ds_read_b64_tr_b16 v[104:105], v90 offset:28672
  ds_read_b64_tr_b16 v[106:107], v90 offset:29184
  v_mfma_f32_32x32x16_bf16 v[176:191], v[96:99], v[228:231], v[176:191]
  s_add_u32 m0, s23, 40960
  s_add_u32 s24, s24, 147456
  buffer_load_dwordx4 v5, s[8:11], s24 offen lds
  s_waitcnt lgkmcnt(2)
  v_mfma_f32_32x32x16_bf16 v[160:175], v[100:103], v[232:235], v[160:175]
  ds_read_b64_tr_b16 v[108:109], v90 offset:32768
  ds_read_b64_tr_b16 v[110:111], v90 offset:33280
  v_mfma_f32_32x32x16_bf16 v[176:191], v[100:103], v[236:239], v[176:191]
  s_add_u32 m0, s23, 45056
  s_add_u32 s24, s24, 147456
  buffer_load_dwordx4 v5, s[8:11], s24 offen lds
  s_waitcnt vmcnt(9)
  s_barrier
  s_waitcnt lgkmcnt(2)
  v_mfma_f32_32x32x16_bf16 v[160:175], v[104:107], v[240:243], v[160:175]
  ds_read_b64_tr_b16 v[96:97], v2 offset:0
  ds_read_b64_tr_b16 v[98:99], v2 offset:512
  v_mfma_f32_32x32x16_bf16 v[176:191], v[104:107], v[244:247], v[176:191]
  s_add_u32 m0, s23, 49152
  s_add_u32 s24, s24, 147456
  buffer_load_dwordx4 v5, s[8:11], s24 offen lds
  s_waitcnt lgkmcnt(2)
  v_mfma_f32_32x32x16_bf16 v[160:175], v[108:111], v[248:251], v[160:175]
  ds_read_b64_tr_b16 v[100:101], v2 offset:4096
  ds_read_b64_tr_b16 v[102:103], v2 offset:4608
  v_mfma_f32_32x32x16_bf16 v[176:191], v[108:111], v[252:255], v[176:191]
  s_add_u32 m0, s23, 53248
  s_add_u32 s24, s24, 147456
  buffer_load_dwordx4 v5, s[8:11], s24 offen lds
  s_waitcnt lgkmcnt(2)
  v_mfma_f32_32x32x16_bf16 v[192:207], v[96:99], a[0:3], 0
  ds_read_b64_tr_b16 v[104:105], v2 offset:8192
  ds_read_b64_tr_b16 v[106:107], v2 offset:8704
  v_mfma_f32_32x32x16_bf16 v[208:223], v[96:99], a[4:7], 0
  s_add_u32 m0, s23, 57344
  s_add_u32 s24, s24, 147456
  buffer_load_dwordx4 v5, s[8:11], s24 offen lds
  buffer_load_dword v15, v95, s[8:11], s56 offen
  s_add_u32 s56, s56, 128
  s_waitcnt vmcnt(10)
  s_barrier
  s_waitcnt lgkmcnt(2)
  v_mfma_f32_32x32x16_bf16 v[192:207], v[100:103], a[8:11], v[192:207]
  ds_read_b64_tr_b16 v[108:109], v2 offset:12288
  ds_read_b64_tr_b16 v[110:111], v2 offset:12800
  v_mfma_f32_32x32x16_bf16 v[208:223], v[100:103], a[12:15], v[208:223]
  s_add_u32 m0, s23, 61440
  s_add_u32 s24, s24, 147456
  buffer_load_dwordx4 v5, s[8:11], s24 offen lds
  s_waitcnt lgkmcnt(2)
  v_mfma_f32_32x32x16_bf16 v[192:207], v[104:107], a[16:19], v[192:207]
  ds_read_b64_tr_b16 v[96:97], v2 offset:16384
  ds_read_b64_tr_b16 v[98:99], v2 offset:16896
  v_mfma_f32_32x32x16_bf16 v[208:223], v[104:107], a[20:23], v[208:223]
  s_add_u32 m0, s23, 65536
  s_add_u32 s24, s24, 147456
  buffer_load_dwordx4 v5, s[8:11], s24 offen lds
  s_waitcnt lgkmcnt(2)
  v_mfma_f32_32x32x16_bf16 v[192:207], v[108:111], a[24:27], v[192:207]
  ds_read_b64_tr_b16 v[100:101], v2 offset:20480
  ds_read_b64_tr_b16 v[102:103], v2 offset:20992
  v_mul_f32 v160, v160, v168
  v_mul_f32 v161, v161, v169
  v_mfma_f32_32x32x16_bf16 v[208:223], v[108:111], a[28:31], v[208:223]
  s_add_u32 m0, s23, 69632
  s_add_u32 s24, s24, 147456
  buffer_load_dwordx4 v5, s[8:11], s24 offen lds
  v_mul_f32 v162, v162, v170
  v_mul_f32 v163, v163, v171
  s_waitcnt vmcnt(10)
  s_barrier
  s_waitcnt lgkmcnt(2)
  v_mfma_f32_32x32x16_bf16 v[192:207], v[96:99], a[32:35], v[192:207]
  ds_read_b64_tr_b16 v[104:105], v2 offset:24576
  ds_read_b64_tr_b16 v[106:107], v2 offset:25088
  v_mul_f32 v164, v164, v172
  v_mul_f32 v165, v165, v173
  v_mfma_f32_32x32x16_bf16 v[208:223], v[96:99], a[36:39], v[208:223]
  s_add_u32 m0, s23, 0
  s_add_u32 s24, s24, 147456
  buffer_load_dwordx4 v5, s[8:11], s24 offen lds
  v_mul_f32 v166, v166, v174
  v_mul_f32 v167, v167, v175
  s_waitcnt lgkmcnt(2)
  v_mfma_f32_32x32x16_bf16 v[192:207], v[100:103], a[40:43], v[192:207]
  ds_read_b64_tr_b16 v[108:109], v2 offset:28672
  ds_read_b64_tr_b16 v[110:111], v2 offset:29184
  v_cvt_pk_bf16_f32 v64, v160, v161
  v_cvt_pk_bf16_f32 v65, v162, v163
  v_mfma_f32_32x32x16_bf16 v[208:223], v[100:103], a[44:47], v[208:223]
  s_add_u32 m0, s23, 4096
  s_add_u32 s24, s24, 147456
  buffer_load_dwordx4 v5, s[8:11], s24 offen lds
  v_cvt_pk_bf16_f32 v66, v164, v165
  v_cvt_pk_bf16_f32 v67, v166, v167
  s_waitcnt lgkmcnt(2)
  v_mfma_f32_32x32x16_bf16 v[192:207], v[104:107], a[48:51], v[192:207]
  ds_read_b64_tr_b16 v[96:97], v2 offset:32768
  ds_read_b64_tr_b16 v[98:99], v2 offset:33280
  ds_write_b128 v8, v[64:67] offset:0
  v_mul_f32 v176, v176, v184
  v_mfma_f32_32x32x16_bf16 v[208:223], v[104:107], a[52:55], v[208:223]
  s_add_u32 m0, s23, 8192
  s_add_u32 s24, s24, 147456
  buffer_load_dwordx4 v5, s[8:11], s24 offen lds
  v_mul_f32 v177, v177, v185
  v_mul_f32 v178, v178, v186
  s_waitcnt vmcnt(10)
  s_barrier
  s_waitcnt lgkmcnt(3)
  v_mfma_f32_32x32x16_bf16 v[192:207], v[108:111], a[56:59], v[192:207]
  ds_read_b64_tr_b16 v[100:101], v90 offset:0
  ds_read_b64_tr_b16 v[102:103], v90 offset:512
  v_mul_f32 v179, v179, v187
  v_mul_f32 v180, v180, v188
  v_mfma_f32_32x32x16_bf16 v[208:223], v[108:111], a[60:63], v[208:223]
  s_add_u32 m0, s23, 12288
  s_add_u32 s24, s24, 147456
  buffer_load_dwordx4 v5, s[8:11], s24 offen lds
  v_mul_f32 v181, v181, v189
  v_mul_f32 v182, v182, v190
  s_waitcnt lgkmcnt(3)
  v_mfma_f32_32x32x16_bf16 v[192:207], v[96:99], a[64:67], v[192:207]
  ds_read_b64_tr_b16 v[104:105], v90 offset:4096
  ds_read_b64_tr_b16 v[106:107], v90 offset:4608
  v_mul_f32 v183, v183, v191
  v_cvt_pk_bf16_f32 v68, v176, v177
  v_mfma_f32_32x32x16_bf16 v[208:223], v[96:99], a[68:71], v[208:223]
  s_add_u32 m0, s23, 16384
  s_add_u32 s24, s24, 147456
  buffer_load_dwordx4 v5, s[8:11], s24 offen lds
  v_cvt_pk_bf16_f32 v69, v178, v179
  v_cvt_pk_bf16_f32 v70, v180, v181
  s_waitcnt lgkmcnt(2)
  v_mfma_f32_32x32x16_bf16 v[192:207], v[100:103], a[72:75], v[192:207]
  ds_read_b64_tr_b16 v[108:109], v90 offset:8192
  ds_read_b64_tr_b16 v[110:111], v90 offset:8704
  v_cvt_pk_bf16_f32 v71, v182, v183
  ds_write_b128 v8, v[68:71] offset:1024
  v_mfma_f32_32x32x16_bf16 v[208:223], v[100:103], a[76:79], v[208:223]
  s_add_u32 m0, s23, 20480
  s_add_u32 s24, s24, 147456
  buffer_load_dwordx4 v5, s[8:11], s24 offen lds
  v_add_u32 v8, s46, v8
  s_mov_b32 s46, 0x2000
  s_waitcnt vmcnt(10)
  s_barrier
  s_waitcnt lgkmcnt(3)
  v_mfma_f32_32x32x16_bf16 v[192:207], v[104:107], a[80:83], v[192:207]
  ds_read_b64_tr_b16 v[96:97], v90 offset:12288
  ds_read_b64_tr_b16 v[98:99], v90 offset:12800
  v_mfma_f32_32x32x16_bf16 v[208:223], v[104:107], a[84:87], v[208:223]
  s_add_u32 m0, s23, 24576
  s_add_u32 s24, s24, 147456
  buffer_load_dwordx4 v5, s[8:11], s24 offen lds
  s_waitcnt lgkmcnt(3)
  v_mfma_f32_32x32x16_bf16 v[192:207], v[108:111], a[88:91], v[192:207]
  ds_read_b64_tr_b16 v[100:101], v90 offset:16384
  ds_read_b64_tr_b16 v[102:103], v90 offset:16896
  v_mfma_f32_32x32x16_bf16 v[208:223], v[108:111], a[92:95], v[208:223]
  s_add_u32 m0, s23, 28672
  s_add_u32 s24, s24, 147456
  buffer_load_dwordx4 v5, s[8:11], s24 offen lds
  s_waitcnt lgkmcnt(2)
  v_mfma_f32_32x32x16_bf16 v[192:207], v[96:99], a[96:99], v[192:207]
  ds_read_b64_tr_b16 v[104:105], v90 offset:20480
  ds_read_b64_tr_b16 v[106:107], v90 offset:20992
  v_mfma_f32_32x32x16_bf16 v[208:223], v[96:99], a[100:103], v[208:223]
  s_add_u32 m0, s23, 32768
  s_add_u32 s24, s24, 147456
  buffer_load_dwordx4 v5, s[8:11], s24 offen lds
  s_waitcnt vmcnt(9)
  s_barrier
  s_waitcnt lgkmcnt(2)
  v_mfma_f32_32x32x16_bf16 v[192:207], v[100:103], a[104:107], v[192:207]
  ds_read_b64_tr_b16 v[108:109], v90 offset:24576
  ds_read_b64_tr_b16 v[110:111], v90 offset:25088
  v_mfma_f32_32x32x16_bf16 v[208:223], v[100:103], a[108:111], v[208:223]
  s_add_u32 m0, s23, 36864
  s_add_u32 s24, s24, 147456
  buffer_load_dwordx4 v5, s[8:11], s24 offen lds
  s_waitcnt lgkmcnt(2)
  v_mfma_f32_32x32x16_bf16 v[192:207], v[104:107], a[112:115], v[192:207]
  ds_read_b64_tr_b16 v[96:97], v90 offset:28672
  ds_read_b64_tr_b16 v[98:99], v90 offset:29184
  v_mfma_f32_32x32x16_bf16 v[208:223], v[104:107], a[116:119], v[208:223]
  s_add_u32 m0, s23, 40960
  s_add_u32 s24, s24, 147456
  buffer_load_dwordx4 v5, s[8:11], s24 offen lds
  s_waitcnt lgkmcnt(2)
  v_mfma_f32_32x32x16_bf16 v[192:207], v[108:111], a[120:123], v[192:207]
  ds_read_b64_tr_b16 v[100:101], v90 offset:32768
  ds_read_b64_tr_b16 v[102:103], v90 offset:33280
  v_mfma_f32_32x32x16_bf16 v[208:223], v[108:111], a[124:127], v[208:223]
  s_add_u32 m0, s23, 45056
  s_add_u32 s24, s24, 147456
  buffer_load_dwordx4 v5, s[8:11], s24 offen lds
  s_waitcnt vmcnt(9)
  s_barrier
  s_waitcnt lgkmcnt(2)
  v_mfma_f32_32x32x16_bf16 v[192:207], v[96:99], a[128:131], v[192:207]
  ds_read_b64_tr_b16 v[104:105], v2 offset:0
  ds_read_b64_tr_b16 v[106:107], v2 offset:512
  v_mfma_f32_32x32x16_bf16 v[208:223], v[96:99], a[132:135], v[208:223]
  s_add_u32 m0, s23, 49152
  s_add_u32 s24, s24, 147456
  buffer_load_dwordx4 v5, s[8:11], s24 offen lds
  s_waitcnt lgkmcnt(2)
  v_mfma_f32_32x32x16_bf16 v[192:207], v[100:103], a[136:139], v[192:207]
  ds_read_b64_tr_b16 v[108:109], v2 offset:4096
  ds_read_b64_tr_b16 v[110:111], v2 offset:4608
  v_mfma_f32_32x32x16_bf16 v[208:223], v[100:103], a[140:143], v[208:223]
  s_add_u32 m0, s23, 53248
  s_add_u32 s24, s24, 147456
  buffer_load_dwordx4 v5, s[8:11], s24 offen lds
  s_waitcnt lgkmcnt(2)
  v_mfma_f32_32x32x16_bf16 v[192:207], v[104:107], a[144:147], v[192:207]
  ds_read_b64_tr_b16 v[96:97], v2 offset:8192
  ds_read_b64_tr_b16 v[98:99], v2 offset:8704
  v_mfma_f32_32x32x16_bf16 v[208:223], v[104:107], a[148:151], v[208:223]
  s_add_u32 m0, s23, 57344
  s_add_u32 s24, s24, 147456
  buffer_load_dwordx4 v5, s[8:11], s24 offen lds
  s_waitcnt vmcnt(9)
  s_barrier
  s_waitcnt lgkmcnt(2)
  v_mfma_f32_32x32x16_bf16 v[192:207], v[108:111], a[152:155], v[192:207]
  ds_read_b64_tr_b16 v[100:101], v2 offset:12288
  ds_read_b64_tr_b16 v[102:103], v2 offset:12800
  v_mfma_f32_32x32x16_bf16 v[208:223], v[108:111], a[156:159], v[208:223]
  s_add_u32 m0, s23, 61440
  s_add_u32 s24, s24, 147456
  buffer_load_dwordx4 v5, s[8:11], s24 offen lds
  s_waitcnt lgkmcnt(2)
  v_mfma_f32_32x32x16_bf16 v[192:207], v[96:99], a[160:163], v[192:207]
  ds_read_b64_tr_b16 v[104:105], v2 offset:16384
  ds_read_b64_tr_b16 v[106:107], v2 offset:16896
  v_mfma_f32_32x32x16_bf16 v[208:223], v[96:99], a[164:167], v[208:223]
  s_add_u32 m0, s23, 65536
  s_add_u32 s24, s24, 147456
  buffer_load_dwordx4 v5, s[8:11], s24 offen lds
  s_waitcnt lgkmcnt(2)
  v_mfma_f32_32x32x16_bf16 v[192:207], v[100:103], a[168:171], v[192:207]
  ds_read_b64_tr_b16 v[108:109], v2 offset:20480
  ds_read_b64_tr_b16 v[110:111], v2 offset:20992
  v_mfma_f32_32x32x16_bf16 v[208:223], v[100:103], a[172:175], v[208:223]
  s_add_u32 m0, s23, 69632
  s_add_u32 s24, s24, 147456
  buffer_load_dwordx4 v5, s[8:11], s24 offen lds
  s_waitcnt vmcnt(9)
  s_barrier
  s_waitcnt lgkmcnt(2)
  v_mfma_f32_32x32x16_bf16 v[192:207], v[104:107], a[176:179], v[192:207]
  ds_read_b64_tr_b16 v[96:97], v2 offset:24576
  ds_read_b64_tr_b16 v[98:99], v2 offset:25088
  v_mfma_f32_32x32x16_bf16 v[208:223], v[104:107], a[180:183], v[208:223]
  s_add_u32 m0, s23, 0
  s_sub_u32 s24, s24, 5160832
  buffer_load_dwordx4 v5, s[8:11], s24 offen lds
  s_waitcnt lgkmcnt(2)
  v_mfma_f32_32x32x16_bf16 v[192:207], v[108:111], a[184:187], v[192:207]
  ds_read_b64_tr_b16 v[100:101], v2 offset:28672
  ds_read_b64_tr_b16 v[102:103], v2 offset:29184
  v_mfma_f32_32x32x16_bf16 v[208:223], v[108:111], a[188:191], v[208:223]
  s_add_u32 m0, s23, 4096
  s_add_u32 s24, s24, 147456
  buffer_load_dwordx4 v5, s[8:11], s24 offen lds
  s_waitcnt lgkmcnt(2)
  v_mfma_f32_32x32x16_bf16 v[192:207], v[96:99], a[192:195], v[192:207]
  ds_read_b64_tr_b16 v[104:105], v2 offset:32768
  ds_read_b64_tr_b16 v[106:107], v2 offset:33280
  v_mfma_f32_32x32x16_bf16 v[208:223], v[96:99], a[196:199], v[208:223]
  s_add_u32 m0, s23, 8192
  s_add_u32 s24, s24, 147456
  buffer_load_dwordx4 v5, s[8:11], s24 offen lds
  s_waitcnt vmcnt(9)
  s_barrier
  s_waitcnt lgkmcnt(2)
  v_mfma_f32_32x32x16_bf16 v[192:207], v[100:103], a[200:203], v[192:207]
  ds_read_b64_tr_b16 v[108:109], v90 offset:0
  ds_read_b64_tr_b16 v[110:111], v90 offset:512
  v_mfma_f32_32x32x16_bf16 v[208:223], v[100:103], a[204:207], v[208:223]
  s_add_u32 m0, s23, 12288
  s_add_u32 s24, s24, 147456
  buffer_load_dwordx4 v5, s[8:11], s24 offen lds
  s_waitcnt lgkmcnt(2)
  v_mfma_f32_32x32x16_bf16 v[192:207], v[104:107], a[208:211], v[192:207]
  ds_read_b64_tr_b16 v[96:97], v90 offset:4096
  ds_read_b64_tr_b16 v[98:99], v90 offset:4608
  v_mfma_f32_32x32x16_bf16 v[208:223], v[104:107], a[212:215], v[208:223]
  s_add_u32 m0, s23, 16384
  s_add_u32 s24, s24, 147456
  buffer_load_dwordx4 v5, s[8:11], s24 offen lds
  s_waitcnt lgkmcnt(2)
  v_mfma_f32_32x32x16_bf16 v[192:207], v[108:111], a[216:219], v[192:207]
  ds_read_b64_tr_b16 v[100:101], v90 offset:8192
  ds_read_b64_tr_b16 v[102:103], v90 offset:8704
  v_mfma_f32_32x32x16_bf16 v[208:223], v[108:111], a[220:223], v[208:223]
  s_add_u32 m0, s23, 20480
  s_add_u32 s24, s24, 147456
  buffer_load_dwordx4 v5, s[8:11], s24 offen lds
  s_waitcnt vmcnt(9)
  s_barrier
  s_waitcnt lgkmcnt(2)
  v_mfma_f32_32x32x16_bf16 v[192:207], v[96:99], a[224:227], v[192:207]
  ds_read_b64_tr_b16 v[104:105], v90 offset:12288
  ds_read_b64_tr_b16 v[106:107], v90 offset:12800
  v_mfma_f32_32x32x16_bf16 v[208:223], v[96:99], a[228:231], v[208:223]
  s_add_u32 m0, s23, 24576
  s_add_u32 s24, s24, 147456
  buffer_load_dwordx4 v5, s[8:11], s24 offen lds
  s_waitcnt lgkmcnt(2)
  v_mfma_f32_32x32x16_bf16 v[192:207], v[100:103], a[232:235], v[192:207]
  ds_read_b64_tr_b16 v[108:109], v90 offset:16384
  ds_read_b64_tr_b16 v[110:111], v90 offset:16896
  v_mfma_f32_32x32x16_bf16 v[208:223], v[100:103], a[236:239], v[208:223]
  s_add_u32 m0, s23, 28672
  s_add_u32 s24, s24, 147456
  buffer_load_dwordx4 v5, s[8:11], s24 offen lds
  s_waitcnt lgkmcnt(2)
  v_mfma_f32_32x32x16_bf16 v[192:207], v[104:107], a[240:243], v[192:207]
  ds_read_b64_tr_b16 v[96:97], v90 offset:20480
  ds_read_b64_tr_b16 v[98:99], v90 offset:20992
  v_mfma_f32_32x32x16_bf16 v[208:223], v[104:107], a[244:247], v[208:223]
  s_add_u32 m0, s23, 32768
  s_add_u32 s24, s24, 147456
  buffer_load_dwordx4 v5, s[8:11], s24 offen lds
  s_waitcnt vmcnt(9)
  s_barrier
  s_waitcnt lgkmcnt(2)
  v_mfma_f32_32x32x16_bf16 v[192:207], v[108:111], a[248:251], v[192:207]
  ds_read_b64_tr_b16 v[100:101], v90 offset:24576
  ds_read_b64_tr_b16 v[102:103], v90 offset:25088
  v_mfma_f32_32x32x16_bf16 v[208:223], v[108:111], a[252:255], v[208:223]
  s_add_u32 m0, s23, 36864
  s_add_u32 s24, s24, 147456
  buffer_load_dwordx4 v5, s[8:11], s24 offen lds
  s_waitcnt lgkmcnt(2)
  v_mfma_f32_32x32x16_bf16 v[192:207], v[96:99], v[224:227], v[192:207]
  ds_read_b64_tr_b16 v[104:105], v90 offset:28672
  ds_read_b64_tr_b16 v[106:107], v90 offset:29184
  v_mfma_f32_32x32x16_bf16 v[208:223], v[96:99], v[228:231], v[208:223]
  s_add_u32 m0, s23, 40960
  s_add_u32 s24, s24, 147456
  buffer_load_dwordx4 v5, s[8:11], s24 offen lds
  s_waitcnt lgkmcnt(2)
  v_mfma_f32_32x32x16_bf16 v[192:207], v[100:103], v[232:235], v[192:207]
  ds_read_b64_tr_b16 v[108:109], v90 offset:32768
  ds_read_b64_tr_b16 v[110:111], v90 offset:33280
  v_mfma_f32_32x32x16_bf16 v[208:223], v[100:103], v[236:239], v[208:223]
  s_add_u32 m0, s23, 45056
  s_add_u32 s24, s24, 147456
  buffer_load_dwordx4 v5, s[8:11], s24 offen lds
  s_waitcnt vmcnt(9)
  s_barrier
  s_waitcnt lgkmcnt(2)
  v_mfma_f32_32x32x16_bf16 v[192:207], v[104:107], v[240:243], v[192:207]
  ds_read_b64_tr_b16 v[96:97], v2 offset:0
  ds_read_b64_tr_b16 v[98:99], v2 offset:512
  v_mfma_f32_32x32x16_bf16 v[208:223], v[104:107], v[244:247], v[208:223]
  s_add_u32 m0, s23, 49152
  s_add_u32 s24, s24, 147456
  buffer_load_dwordx4 v5, s[8:11], s24 offen lds
  s_waitcnt lgkmcnt(2)
  v_mfma_f32_32x32x16_bf16 v[192:207], v[108:111], v[248:251], v[192:207]
  ds_read_b64_tr_b16 v[100:101], v2 offset:4096
  ds_read_b64_tr_b16 v[102:103], v2 offset:4608
  v_mfma_f32_32x32x16_bf16 v[208:223], v[108:111], v[252:255], v[208:223]
  s_add_u32 m0, s23, 53248
  s_add_u32 s24, s24, 147456
  buffer_load_dwordx4 v5, s[8:11], s24 offen lds
  s_waitcnt lgkmcnt(2)
  v_mfma_f32_32x32x16_bf16 v[128:143], v[96:99], a[0:3], 0
  ds_read_b64_tr_b16 v[104:105], v2 offset:8192
  ds_read_b64_tr_b16 v[106:107], v2 offset:8704
  v_mfma_f32_32x32x16_bf16 v[144:159], v[96:99], a[4:7], 0
  s_add_u32 m0, s23, 57344
  s_add_u32 s24, s24, 147456
  buffer_load_dwordx4 v5, s[8:11], s24 offen lds
  buffer_load_dword v15, v95, s[8:11], s56 offen
  s_add_u32 s56, s56, 128
  buffer_load_dword v15, v14, s[12:15], s57 offen
  s_add_u32 s57, s57, 13824
  s_waitcnt vmcnt(11)
  s_barrier
  s_waitcnt lgkmcnt(2)
  v_mfma_f32_32x32x16_bf16 v[128:143], v[100:103], a[8:11], v[128:143]
  ds_read_b64_tr_b16 v[108:109], v2 offset:12288
  ds_read_b64_tr_b16 v[110:111], v2 offset:12800
  v_mfma_f32_32x32x16_bf16 v[144:159], v[100:103], a[12:15], v[144:159]
  s_add_u32 m0, s23, 61440
  s_add_u32 s24, s24, 147456
  buffer_load_dwordx4 v5, s[8:11], s24 offen lds
  s_waitcnt lgkmcnt(2)
  v_mfma_f32_32x32x16_bf16 v[128:143], v[104:107], a[16:19], v[128:143]
  ds_read_b64_tr_b16 v[96:97], v2 offset:16384
  ds_read_b64_tr_b16 v[98:99], v2 offset:16896
  v_mfma_f32_32x32x16_bf16 v[144:159], v[104:107], a[20:23], v[144:159]
  s_add_u32 m0, s23, 65536
  s_add_u32 s24, s24, 147456
  buffer_load_dwordx4 v5, s[8:11], s24 offen lds
  s_waitcnt lgkmcnt(2)
  v_mfma_f32_32x32x16_bf16 v[128:143], v[108:111], a[24:27], v[128:143]
  ds_read_b64_tr_b16 v[100:101], v2 offset:20480
  ds_read_b64_tr_b16 v[102:103], v2 offset:20992
  v_mul_f32 v192, v192, v200
  v_mul_f32 v193, v193, v201
  v_mfma_f32_32x32x16_bf16 v[144:159], v[108:111], a[28:31], v[144:159]
  s_add_u32 m0, s23, 69632
  s_add_u32 s24, s24, 147456
  buffer_load_dwordx4 v5, s[8:11], s24 offen lds
  v_mul_f32 v194, v194, v202
  v_mul_f32 v195, v195, v203
  s_waitcnt vmcnt(11)
  s_barrier
  s_waitcnt lgkmcnt(2)
  v_mfma_f32_32x32x16_bf16 v[128:143], v[96:99], a[32:35], v[128:143]
  ds_read_b64_tr_b16 v[104:105], v2 offset:24576
  ds_read_b64_tr_b16 v[106:107], v2 offset:25088
  v_mul_f32 v196, v196, v204
  v_mul_f32 v197, v197, v205
  v_mfma_f32_32x32x16_bf16 v[144:159], v[96:99], a[36:39], v[144:159]
  s_add_u32 m0, s23, 0
  s_add_u32 s24, s24, 147456
  buffer_load_dwordx4 v5, s[8:11], s24 offen lds
  v_mul_f32 v198, v198, v206
  v_mul_f32 v199, v199, v207
  s_waitcnt lgkmcnt(2)
  v_mfma_f32_32x32x16_bf16 v[128:143], v[100:103], a[40:43], v[128:143]
  ds_read_b64_tr_b16 v[108:109], v2 offset:28672
  ds_read_b64_tr_b16 v[110:111], v2 offset:29184
  v_cvt_pk_bf16_f32 v64, v192, v193
  v_cvt_pk_bf16_f32 v65, v194, v195
  v_mfma_f32_32x32x16_bf16 v[144:159], v[100:103], a[44:47], v[144:159]
  s_add_u32 m0, s23, 4096
  s_add_u32 s24, s24, 147456
  buffer_load_dwordx4 v5, s[8:11], s24 offen lds
  v_cvt_pk_bf16_f32 v66, v196, v197
  v_cvt_pk_bf16_f32 v67, v198, v199
  s_waitcnt lgkmcnt(2)
  v_mfma_f32_32x32x16_bf16 v[128:143], v[104:107], a[48:51], v[128:143]
  ds_read_b64_tr_b16 v[96:97], v2 offset:32768
  ds_read_b64_tr_b16 v[98:99], v2 offset:33280
  ds_write_b128 v8, v[64:67] offset:0
  v_mul_f32 v208, v208, v216
  v_mfma_f32_32x32x16_bf16 v[144:159], v[104:107], a[52:55], v[144:159]
  s_add_u32 m0, s23, 8192
  s_add_u32 s24, s24, 147456
  buffer_load_dwordx4 v5, s[8:11], s24 offen lds
  v_mul_f32 v209, v209, v217
  v_mul_f32 v210, v210, v218
  s_waitcnt vmcnt(11)
  s_barrier
  s_waitcnt lgkmcnt(3)
  v_mfma_f32_32x32x16_bf16 v[128:143], v[108:111], a[56:59], v[128:143]
  ds_read_b64_tr_b16 v[100:101], v90 offset:0
  ds_read_b64_tr_b16 v[102:103], v90 offset:512
  v_mul_f32 v211, v211, v219
  v_mul_f32 v212, v212, v220
  v_mfma_f32_32x32x16_bf16 v[144:159], v[108:111], a[60:63], v[144:159]
  s_add_u32 m0, s23, 12288
  s_add_u32 s24, s24, 147456
  buffer_load_dwordx4 v5, s[8:11], s24 offen lds
  v_mul_f32 v213, v213, v221
  v_mul_f32 v214, v214, v222
  s_waitcnt lgkmcnt(3)
  v_mfma_f32_32x32x16_bf16 v[128:143], v[96:99], a[64:67], v[128:143]
  ds_read_b64_tr_b16 v[104:105], v90 offset:4096
  ds_read_b64_tr_b16 v[106:107], v90 offset:4608
  v_mul_f32 v215, v215, v223
  v_cvt_pk_bf16_f32 v68, v208, v209
  v_mfma_f32_32x32x16_bf16 v[144:159], v[96:99], a[68:71], v[144:159]
  s_add_u32 m0, s23, 16384
  s_add_u32 s24, s24, 147456
  buffer_load_dwordx4 v5, s[8:11], s24 offen lds
  v_cvt_pk_bf16_f32 v69, v210, v211
  v_cvt_pk_bf16_f32 v70, v212, v213
  s_waitcnt lgkmcnt(2)
  v_mfma_f32_32x32x16_bf16 v[128:143], v[100:103], a[72:75], v[128:143]
  ds_read_b64_tr_b16 v[108:109], v90 offset:8192
  ds_read_b64_tr_b16 v[110:111], v90 offset:8704
  v_cvt_pk_bf16_f32 v71, v214, v215
  ds_write_b128 v8, v[68:71] offset:1024
  v_mfma_f32_32x32x16_bf16 v[144:159], v[100:103], a[76:79], v[144:159]
  s_add_u32 m0, s23, 20480
  s_add_u32 s24, s24, 147456
  buffer_load_dwordx4 v5, s[8:11], s24 offen lds
  v_add_u32 v8, s46, v8
  s_mov_b32 s46, 0x2000
  s_waitcnt vmcnt(11)
  s_barrier
  s_waitcnt lgkmcnt(3)
  v_mfma_f32_32x32x16_bf16 v[128:143], v[104:107], a[80:83], v[128:143]
  ds_read_b64_tr_b16 v[96:97], v90 offset:12288
  ds_read_b64_tr_b16 v[98:99], v90 offset:12800
  v_mfma_f32_32x32x16_bf16 v[144:159], v[104:107], a[84:87], v[144:159]
  s_add_u32 m0, s23, 24576
  s_add_u32 s24, s24, 147456
  buffer_load_dwordx4 v5, s[8:11], s24 offen lds
  s_waitcnt lgkmcnt(3)
  v_mfma_f32_32x32x16_bf16 v[128:143], v[108:111], a[88:91], v[128:143]
  ds_read_b64_tr_b16 v[100:101], v90 offset:16384
  ds_read_b64_tr_b16 v[102:103], v90 offset:16896
  v_mfma_f32_32x32x16_bf16 v[144:159], v[108:111], a[92:95], v[144:159]
  s_add_u32 m0, s23, 28672
  s_add_u32 s24, s24, 147456
  buffer_load_dwordx4 v5, s[8:11], s24 offen lds
  s_waitcnt lgkmcnt(2)
  v_mfma_f32_32x32x16_bf16 v[128:143], v[96:99], a[96:99], v[128:143]
  ds_read_b64_tr_b16 v[104:105], v90 offset:20480
  ds_read_b64_tr_b16 v[106:107], v90 offset:20992
  v_mfma_f32_32x32x16_bf16 v[144:159], v[96:99], a[100:103], v[144:159]
  s_add_u32 m0, s23, 32768
  s_add_u32 s24, s24, 147456
  buffer_load_dwordx4 v5, s[8:11], s24 offen lds
  s_waitcnt vmcnt(9)
  s_barrier
  s_waitcnt lgkmcnt(2)
  v_mfma_f32_32x32x16_bf16 v[128:143], v[100:103], a[104:107], v[128:143]
  ds_read_b64_tr_b16 v[108:109], v90 offset:24576
  ds_read_b64_tr_b16 v[110:111], v90 offset:25088
  v_mfma_f32_32x32x16_bf16 v[144:159], v[100:103], a[108:111], v[144:159]
  s_add_u32 m0, s23, 36864
  s_add_u32 s24, s24, 147456
  buffer_load_dwordx4 v5, s[8:11], s24 offen lds
  s_waitcnt lgkmcnt(2)
  v_mfma_f32_32x32x16_bf16 v[128:143], v[104:107], a[112:115], v[128:143]
  ds_read_b64_tr_b16 v[96:97], v90 offset:28672
  ds_read_b64_tr_b16 v[98:99], v90 offset:29184
  v_mfma_f32_32x32x16_bf16 v[144:159], v[104:107], a[116:119], v[144:159]
  s_add_u32 m0, s23, 40960
  s_add_u32 s24, s24, 147456
  buffer_load_dwordx4 v5, s[8:11], s24 offen lds
  s_waitcnt lgkmcnt(2)
  v_mfma_f32_32x32x16_bf16 v[128:143], v[108:111], a[120:123], v[128:143]
  ds_read_b64_tr_b16 v[100:101], v90 offset:32768
  ds_read_b64_tr_b16 v[102:103], v90 offset:33280
  v_mfma_f32_32x32x16_bf16 v[144:159], v[108:111], a[124:127], v[144:159]
  s_add_u32 m0, s23, 45056
  s_add_u32 s24, s24, 147456
  buffer_load_dwordx4 v5, s[8:11], s24 offen lds
  s_waitcnt vmcnt(9)
  s_barrier
  s_waitcnt lgkmcnt(2)
  v_mfma_f32_32x32x16_bf16 v[128:143], v[96:99], a[128:131], v[128:143]
  ds_read_b64_tr_b16 v[104:105], v2 offset:0
  ds_read_b64_tr_b16 v[106:107], v2 offset:512
  v_mfma_f32_32x32x16_bf16 v[144:159], v[96:99], a[132:135], v[144:159]
  s_add_u32 m0, s23, 49152
  s_add_u32 s24, s24, 147456
  buffer_load_dwordx4 v5, s[8:11], s24 offen lds
  s_waitcnt lgkmcnt(2)
  v_mfma_f32_32x32x16_bf16 v[128:143], v[100:103], a[136:139], v[128:143]
  ds_read_b64_tr_b16 v[108:109], v2 offset:4096
  ds_read_b64_tr_b16 v[110:111], v2 offset:4608
  v_mfma_f32_32x32x16_bf16 v[144:159], v[100:103], a[140:143], v[144:159]
  s_add_u32 m0, s23, 53248
  s_add_u32 s24, s24, 147456
  buffer_load_dwordx4 v5, s[8:11], s24 offen lds
  s_waitcnt lgkmcnt(2)
  v_mfma_f32_32x32x16_bf16 v[128:143], v[104:107], a[144:147], v[128:143]
  ds_read_b64_tr_b16 v[96:97], v2 offset:8192
  ds_read_b64_tr_b16 v[98:99], v2 offset:8704
  v_mfma_f32_32x32x16_bf16 v[144:159], v[104:107], a[148:151], v[144:159]
  s_add_u32 m0, s23, 57344
  s_add_u32 s24, s24, 147456
  buffer_load_dwordx4 v5, s[8:11], s24 offen lds
  s_waitcnt vmcnt(9)
  s_barrier
  s_waitcnt lgkmcnt(2)
  v_mfma_f32_32x32x16_bf16 v[128:143], v[108:111], a[152:155], v[128:143]
  ds_read_b64_tr_b16 v[100:101], v2 offset:12288
  ds_read_b64_tr_b16 v[102:103], v2 offset:12800
  v_mfma_f32_32x32x16_bf16 v[144:159], v[108:111], a[156:159], v[144:159]
  s_add_u32 m0, s23, 61440
  s_add_u32 s24, s24, 147456
  buffer_load_dwordx4 v5, s[8:11], s24 offen lds
  s_waitcnt lgkmcnt(2)
  v_mfma_f32_32x32x16_bf16 v[128:143], v[96:99], a[160:163], v[128:143]
  ds_read_b64_tr_b16 v[104:105], v2 offset:16384
  ds_read_b64_tr_b16 v[106:107], v2 offset:16896
  v_mfma_f32_32x32x16_bf16 v[144:159], v[96:99], a[164:167], v[144:159]
  s_add_u32 m0, s23, 65536
  s_add_u32 s24, s24, 147456
  buffer_load_dwordx4 v5, s[8:11], s24 offen lds
  s_waitcnt lgkmcnt(2)
  v_mfma_f32_32x32x16_bf16 v[128:143], v[100:103], a[168:171], v[128:143]
  ds_read_b64_tr_b16 v[108:109], v2 offset:20480
  ds_read_b64_tr_b16 v[110:111], v2 offset:20992
  v_mfma_f32_32x32x16_bf16 v[144:159], v[100:103], a[172:175], v[144:159]
  s_add_u32 m0, s23, 69632
  s_add_u32 s24, s24, 147456
  buffer_load_dwordx4 v5, s[8:11], s24 offen lds
  s_waitcnt vmcnt(9)
  s_barrier
  s_waitcnt lgkmcnt(2)
  v_mfma_f32_32x32x16_bf16 v[128:143], v[104:107], a[176:179], v[128:143]
  ds_read_b64_tr_b16 v[96:97], v2 offset:24576
  ds_read_b64_tr_b16 v[98:99], v2 offset:25088
  v_mfma_f32_32x32x16_bf16 v[144:159], v[104:107], a[180:183], v[144:159]
  s_add_u32 m0, s23, 0
  s_sub_u32 s24, s24, 5160832
  buffer_load_dwordx4 v5, s[8:11], s24 offen lds
  s_waitcnt lgkmcnt(2)
  v_mfma_f32_32x32x16_bf16 v[128:143], v[108:111], a[184:187], v[128:143]
  ds_read_b64_tr_b16 v[100:101], v2 offset:28672
  ds_read_b64_tr_b16 v[102:103], v2 offset:29184
  v_mfma_f32_32x32x16_bf16 v[144:159], v[108:111], a[188:191], v[144:159]
  s_add_u32 m0, s23, 4096
  s_add_u32 s24, s24, 147456
  buffer_load_dwordx4 v5, s[8:11], s24 offen lds
  s_waitcnt lgkmcnt(2)
  v_mfma_f32_32x32x16_bf16 v[128:143], v[96:99], a[192:195], v[128:143]
  ds_read_b64_tr_b16 v[104:105], v2 offset:32768
  ds_read_b64_tr_b16 v[106:107], v2 offset:33280
  v_mfma_f32_32x32x16_bf16 v[144:159], v[96:99], a[196:199], v[144:159]
  s_add_u32 m0, s23, 8192
  s_add_u32 s24, s24, 147456
  buffer_load_dwordx4 v5, s[8:11], s24 offen lds
  s_waitcnt vmcnt(9)
  s_barrier
  s_waitcnt lgkmcnt(2)
  v_mfma_f32_32x32x16_bf16 v[128:143], v[100:103], a[200:203], v[128:143]
  ds_read_b64_tr_b16 v[108:109], v90 offset:0
  ds_read_b64_tr_b16 v[110:111], v90 offset:512
  v_mfma_f32_32x32x16_bf16 v[144:159], v[100:103], a[204:207], v[144:159]
  s_add_u32 m0, s23, 12288
  s_add_u32 s24, s24, 147456
  buffer_load_dwordx4 v5, s[8:11], s24 offen lds
  s_waitcnt lgkmcnt(2)
  v_mfma_f32_32x32x16_bf16 v[128:143], v[104:107], a[208:211], v[128:143]
  ds_read_b64_tr_b16 v[96:97], v90 offset:4096
  ds_read_b64_tr_b16 v[98:99], v90 offset:4608
  v_mfma_f32_32x32x16_bf16 v[144:159], v[104:107], a[212:215], v[144:159]
  s_add_u32 m0, s23, 16384
  s_add_u32 s24, s24, 147456
  buffer_load_dwordx4 v5, s[8:11], s24 offen lds
  s_waitcnt lgkmcnt(2)
  v_mfma_f32_32x32x16_bf16 v[128:143], v[108:111], a[216:219], v[128:143]
  ds_read_b64_tr_b16 v[100:101], v90 offset:8192
  ds_read_b64_tr_b16 v[102:103], v90 offset:8704
  v_mfma_f32_32x32x16_bf16 v[144:159], v[108:111], a[220:223], v[144:159]
  s_add_u32 m0, s23, 20480
  s_add_u32 s24, s24, 147456
  buffer_load_dwordx4 v5, s[8:11], s24 offen lds
  s_waitcnt vmcnt(9)
  s_barrier
  s_waitcnt lgkmcnt(2)
  v_mfma_f32_32x32x16_bf16 v[128:143], v[96:99], a[224:227], v[128:143]
  ds_read_b64_tr_b16 v[104:105], v90 offset:12288
  ds_read_b64_tr_b16 v[106:107], v90 offset:12800
  v_mfma_f32_32x32x16_bf16 v[144:159], v[96:99], a[228:231], v[144:159]
  s_add_u32 m0, s23, 24576
  s_add_u32 s24, s24, 147456
  buffer_load_dwordx4 v5, s[8:11], s24 offen lds
  s_waitcnt lgkmcnt(2)
  v_mfma_f32_32x32x16_bf16 v[128:143], v[100:103], a[232:235], v[128:143]
  ds_read_b64_tr_b16 v[108:109], v90 offset:16384
  ds_read_b64_tr_b16 v[110:111], v90 offset:16896
  v_mfma_f32_32x32x16_bf16 v[144:159], v[100:103], a[236:239], v[144:159]
  s_add_u32 m0, s23, 28672
  s_add_u32 s24, s24, 147456
  buffer_load_dwordx4 v5, s[8:11], s24 offen lds
  s_waitcnt lgkmcnt(2)
  v_mfma_f32_32x32x16_bf16 v[128:143], v[104:107], a[240:243], v[128:143]
  ds_read_b64_tr_b16 v[96:97], v90 offset:20480
  ds_read_b64_tr_b16 v[98:99], v90 offset:20992
  v_mfma_f32_32x32x16_bf16 v[144:159], v[104:107], a[244:247], v[144:159]
  s_add_u32 m0, s23, 32768
  s_add_u32 s24, s24, 147456
  buffer_load_dwordx4 v5, s[8:11], s24 offen lds
  s_waitcnt vmcnt(9)
  s_barrier
  s_waitcnt lgkmcnt(2)
  v_mfma_f32_32x32x16_bf16 v[128:143], v[108:111], a[248:251], v[128:143]
  ds_read_b64_tr_b16 v[100:101], v90 offset:24576
  ds_read_b64_tr_b16 v[102:103], v90 offset:25088
  v_mfma_f32_32x32x16_bf16 v[144:159], v[108:111], a[252:255], v[144:159]
  s_add_u32 m0, s23, 36864
  s_add_u32 s24, s24, 147456
  buffer_load_dwordx4 v5, s[8:11], s24 offen lds
  s_waitcnt lgkmcnt(2)
  v_mfma_f32_32x32x16_bf16 v[128:143], v[96:99], v[224:227], v[128:143]
  ds_read_b64_tr_b16 v[104:105], v90 offset:28672
  ds_read_b64_tr_b16 v[106:107], v90 offset:29184
  v_mfma_f32_32x32x16_bf16 v[144:159], v[96:99], v[228:231], v[144:159]
  s_add_u32 m0, s23, 40960
  s_add_u32 s24, s24, 147456
  buffer_load_dwordx4 v5, s[8:11], s24 offen lds
  s_waitcnt lgkmcnt(2)
  v_mfma_f32_32x32x16_bf16 v[128:143], v[100:103], v[232:235], v[128:143]
  ds_read_b64_tr_b16 v[108:109], v90 offset:32768
  ds_read_b64_tr_b16 v[110:111], v90 offset:33280
  v_mfma_f32_32x32x16_bf16 v[144:159], v[100:103], v[236:239], v[144:159]
  s_add_u32 m0, s23, 45056
  s_add_u32 s24, s24, 147456
  buffer_load_dwordx4 v5, s[8:11], s24 offen lds
  s_waitcnt vmcnt(9)
  s_barrier
  s_waitcnt lgkmcnt(2)
  v_mfma_f32_32x32x16_bf16 v[128:143], v[104:107], v[240:243], v[128:143]
  ds_read_b64_tr_b16 v[96:97], v2 offset:0
  ds_read_b64_tr_b16 v[98:99], v2 offset:512
  v_mfma_f32_32x32x16_bf16 v[144:159], v[104:107], v[244:247], v[144:159]
  s_add_u32 m0, s23, 49152
  s_add_u32 s24, s24, 147456
  buffer_load_dwordx4 v5, s[8:11], s24 offen lds
  s_waitcnt lgkmcnt(2)
  v_mfma_f32_32x32x16_bf16 v[128:143], v[108:111], v[248:251], v[128:143]
  ds_read_b64_tr_b16 v[100:101], v2 offset:4096
  ds_read_b64_tr_b16 v[102:103], v2 offset:4608
  v_mfma_f32_32x32x16_bf16 v[144:159], v[108:111], v[252:255], v[144:159]
  s_add_u32 m0, s23, 53248
  s_add_u32 s24, s24, 147456
  buffer_load_dwordx4 v5, s[8:11], s24 offen lds
  s_waitcnt lgkmcnt(2)
  v_mfma_f32_32x32x16_bf16 v[160:175], v[96:99], a[0:3], 0
  ds_read_b64_tr_b16 v[104:105], v2 offset:8192
  ds_read_b64_tr_b16 v[106:107], v2 offset:8704
  v_mfma_f32_32x32x16_bf16 v[176:191], v[96:99], a[4:7], 0
  s_add_u32 m0, s23, 57344
  s_add_u32 s24, s24, 147456
  buffer_load_dwordx4 v5, s[8:11], s24 offen lds
  buffer_load_dword v15, v14, s[12:15], s57 offen
  s_add_u32 s57, s57, 13824
  s_waitcnt vmcnt(10)
  s_barrier
  s_waitcnt lgkmcnt(2)
  v_mfma_f32_32x32x16_bf16 v[160:175], v[100:103], a[8:11], v[160:175]
  ds_read_b64_tr_b16 v[108:109], v2 offset:12288
  ds_read_b64_tr_b16 v[110:111], v2 offset:12800
  v_mfma_f32_32x32x16_bf16 v[176:191], v[100:103], a[12:15], v[176:191]
  s_add_u32 m0, s23, 61440
  s_add_u32 s24, s24, 147456
  buffer_load_dwordx4 v5, s[8:11], s24 offen lds
  s_waitcnt lgkmcnt(2)
  v_mfma_f32_32x32x16_bf16 v[160:175], v[104:107], a[16:19], v[160:175]
  ds_read_b64_tr_b16 v[96:97], v2 offset:16384
  ds_read_b64_tr_b16 v[98:99], v2 offset:16896
  v_mfma_f32_32x32x16_bf16 v[176:191], v[104:107], a[20:23], v[176:191]
  s_add_u32 m0, s23, 65536
  s_add_u32 s24, s24, 147456
  buffer_load_dwordx4 v5, s[8:11], s24 offen lds
  s_waitcnt lgkmcnt(2)
  v_mfma_f32_32x32x16_bf16 v[160:175], v[108:111], a[24:27], v[160:175]
  ds_read_b64_tr_b16 v[100:101], v2 offset:20480
  ds_read_b64_tr_b16 v[102:103], v2 offset:20992
  v_mul_f32 v128, v128, v136
  v_mul_f32 v129, v129, v137
  v_mfma_f32_32x32x16_bf16 v[176:191], v[108:111], a[28:31], v[176:191]
  s_add_u32 m0, s23, 69632
  s_add_u32 s24, s24, 147456
  buffer_load_dwordx4 v5, s[8:11], s24 offen lds
  v_mul_f32 v130, v130, v138
  v_mul_f32 v131, v131, v139
  s_waitcnt vmcnt(10)
  s_barrier
  s_waitcnt lgkmcnt(2)
  v_mfma_f32_32x32x16_bf16 v[160:175], v[96:99], a[32:35], v[160:175]
  ds_read_b64_tr_b16 v[104:105], v2 offset:24576
  ds_read_b64_tr_b16 v[106:107], v2 offset:25088
  v_mul_f32 v132, v132, v140
  v_mul_f32 v133, v133, v141
  v_mfma_f32_32x32x16_bf16 v[176:191], v[96:99], a[36:39], v[176:191]
  s_add_u32 m0, s23, 0
  s_add_u32 s24, s24, 147456
  buffer_load_dwordx4 v5, s[8:11], s24 offen lds
  v_mul_f32 v134, v134, v142
  v_mul_f32 v135, v135, v143
  s_waitcnt lgkmcnt(2)
  v_mfma_f32_32x32x16_bf16 v[160:175], v[100:103], a[40:43], v[160:175]
  ds_read_b64_tr_b16 v[108:109], v2 offset:28672
  ds_read_b64_tr_b16 v[110:111], v2 offset:29184
  v_cvt_pk_bf16_f32 v64, v128, v129
  v_cvt_pk_bf16_f32 v65, v130, v131
  v_mfma_f32_32x32x16_bf16 v[176:191], v[100:103], a[44:47], v[176:191]
  s_add_u32 m0, s23, 4096
  s_add_u32 s24, s24, 147456
  buffer_load_dwordx4 v5, s[8:11], s24 offen lds
  v_cvt_pk_bf16_f32 v66, v132, v133
  v_cvt_pk_bf16_f32 v67, v134, v135
  s_waitcnt lgkmcnt(2)
  v_mfma_f32_32x32x16_bf16 v[160:175], v[104:107], a[48:51], v[160:175]
  ds_read_b64_tr_b16 v[96:97], v2 offset:32768
  ds_read_b64_tr_b16 v[98:99], v2 offset:33280
  ds_write_b128 v8, v[64:67] offset:0
  v_mul_f32 v144, v144, v152
  v_mfma_f32_32x32x16_bf16 v[176:191], v[104:107], a[52:55], v[176:191]
  s_add_u32 m0, s23, 8192
  s_add_u32 s24, s24, 147456
  buffer_load_dwordx4 v5, s[8:11], s24 offen lds
  v_mul_f32 v145, v145, v153
  v_mul_f32 v146, v146, v154
  s_waitcnt vmcnt(10)
  s_barrier
  s_waitcnt lgkmcnt(3)
  v_mfma_f32_32x32x16_bf16 v[160:175], v[108:111], a[56:59], v[160:175]
  ds_read_b64_tr_b16 v[100:101], v90 offset:0
  ds_read_b64_tr_b16 v[102:103], v90 offset:512
  v_mul_f32 v147, v147, v155
  v_mul_f32 v148, v148, v156
  v_mfma_f32_32x32x16_bf16 v[176:191], v[108:111], a[60:63], v[176:191]
  s_add_u32 m0, s23, 12288
  s_add_u32 s24, s24, 147456
  buffer_load_dwordx4 v5, s[8:11], s24 offen lds
  v_mul_f32 v149, v149, v157
  v_mul_f32 v150, v150, v158
  s_waitcnt lgkmcnt(3)
  v_mfma_f32_32x32x16_bf16 v[160:175], v[96:99], a[64:67], v[160:175]
  ds_read_b64_tr_b16 v[104:105], v90 offset:4096
  ds_read_b64_tr_b16 v[106:107], v90 offset:4608
  v_mul_f32 v151, v151, v159
  v_cvt_pk_bf16_f32 v68, v144, v145
  v_mfma_f32_32x32x16_bf16 v[176:191], v[96:99], a[68:71], v[176:191]
  s_add_u32 m0, s23, 16384
  s_add_u32 s24, s24, 147456
  buffer_load_dwordx4 v5, s[8:11], s24 offen lds
  v_cvt_pk_bf16_f32 v69, v146, v147
  v_cvt_pk_bf16_f32 v70, v148, v149
  s_waitcnt lgkmcnt(2)
  v_mfma_f32_32x32x16_bf16 v[160:175], v[100:103], a[72:75], v[160:175]
  ds_read_b64_tr_b16 v[108:109], v90 offset:8192
  ds_read_b64_tr_b16 v[110:111], v90 offset:8704
  v_cvt_pk_bf16_f32 v71, v150, v151
  ds_write_b128 v8, v[68:71] offset:1024
  v_mfma_f32_32x32x16_bf16 v[176:191], v[100:103], a[76:79], v[176:191]
  s_add_u32 m0, s23, 20480
  s_add_u32 s24, s24, 147456
  buffer_load_dwordx4 v5, s[8:11], s24 offen lds
  v_add_u32 v8, s46, v8
  s_mov_b32 s46, 0x2000
  s_waitcnt vmcnt(10)
  s_barrier
  s_waitcnt lgkmcnt(3)
  v_mfma_f32_32x32x16_bf16 v[160:175], v[104:107], a[80:83], v[160:175]
  ds_read_b64_tr_b16 v[96:97], v90 offset:12288
  ds_read_b64_tr_b16 v[98:99], v90 offset:12800
  v_mfma_f32_32x32x16_bf16 v[176:191], v[104:107], a[84:87], v[176:191]
  s_add_u32 m0, s23, 24576
  s_add_u32 s24, s24, 147456
  buffer_load_dwordx4 v5, s[8:11], s24 offen lds
  s_waitcnt lgkmcnt(3)
  v_mfma_f32_32x32x16_bf16 v[160:175], v[108:111], a[88:91], v[160:175]
  ds_read_b64_tr_b16 v[100:101], v90 offset:16384
  ds_read_b64_tr_b16 v[102:103], v90 offset:16896
  v_mfma_f32_32x32x16_bf16 v[176:191], v[108:111], a[92:95], v[176:191]
  s_add_u32 m0, s23, 28672
  s_add_u32 s24, s24, 147456
  buffer_load_dwordx4 v5, s[8:11], s24 offen lds
  s_waitcnt lgkmcnt(2)
  v_mfma_f32_32x32x16_bf16 v[160:175], v[96:99], a[96:99], v[160:175]
  ds_read_b64_tr_b16 v[104:105], v90 offset:20480
  ds_read_b64_tr_b16 v[106:107], v90 offset:20992
  v_mfma_f32_32x32x16_bf16 v[176:191], v[96:99], a[100:103], v[176:191]
  s_add_u32 m0, s23, 32768
  s_add_u32 s24, s24, 147456
  buffer_load_dwordx4 v5, s[8:11], s24 offen lds
  s_waitcnt vmcnt(9)
  s_barrier
  s_waitcnt lgkmcnt(2)
  v_mfma_f32_32x32x16_bf16 v[160:175], v[100:103], a[104:107], v[160:175]
  ds_read_b64_tr_b16 v[108:109], v90 offset:24576
  ds_read_b64_tr_b16 v[110:111], v90 offset:25088
  v_mfma_f32_32x32x16_bf16 v[176:191], v[100:103], a[108:111], v[176:191]
  s_add_u32 m0, s23, 36864
  s_add_u32 s24, s24, 147456
  buffer_load_dwordx4 v5, s[8:11], s24 offen lds
  s_waitcnt lgkmcnt(2)
  v_mfma_f32_32x32x16_bf16 v[160:175], v[104:107], a[112:115], v[160:175]
  ds_read_b64_tr_b16 v[96:97], v90 offset:28672
  ds_read_b64_tr_b16 v[98:99], v90 offset:29184
  v_mfma_f32_32x32x16_bf16 v[176:191], v[104:107], a[116:119], v[176:191]
  s_add_u32 m0, s23, 40960
  s_add_u32 s24, s24, 147456
  buffer_load_dwordx4 v5, s[8:11], s24 offen lds
  s_waitcnt lgkmcnt(2)
  v_mfma_f32_32x32x16_bf16 v[160:175], v[108:111], a[120:123], v[160:175]
  ds_read_b64_tr_b16 v[100:101], v90 offset:32768
  ds_read_b64_tr_b16 v[102:103], v90 offset:33280
  v_mfma_f32_32x32x16_bf16 v[176:191], v[108:111], a[124:127], v[176:191]
  s_add_u32 m0, s23, 45056
  s_add_u32 s24, s24, 147456
  buffer_load_dwordx4 v5, s[8:11], s24 offen lds
  s_waitcnt vmcnt(9)
  s_barrier
  s_waitcnt lgkmcnt(2)
  v_mfma_f32_32x32x16_bf16 v[160:175], v[96:99], a[128:131], v[160:175]
  ds_read_b64_tr_b16 v[104:105], v2 offset:0
  ds_read_b64_tr_b16 v[106:107], v2 offset:512
  v_mfma_f32_32x32x16_bf16 v[176:191], v[96:99], a[132:135], v[176:191]
  s_add_u32 m0, s23, 49152
  s_add_u32 s24, s24, 147456
  buffer_load_dwordx4 v5, s[8:11], s24 offen lds
  s_waitcnt lgkmcnt(2)
  v_mfma_f32_32x32x16_bf16 v[160:175], v[100:103], a[136:139], v[160:175]
  ds_read_b64_tr_b16 v[108:109], v2 offset:4096
  ds_read_b64_tr_b16 v[110:111], v2 offset:4608
  v_mfma_f32_32x32x16_bf16 v[176:191], v[100:103], a[140:143], v[176:191]
  s_add_u32 m0, s23, 53248
  s_add_u32 s24, s24, 147456
  buffer_load_dwordx4 v5, s[8:11], s24 offen lds
  s_waitcnt lgkmcnt(2)
  v_mfma_f32_32x32x16_bf16 v[160:175], v[104:107], a[144:147], v[160:175]
  ds_read_b64_tr_b16 v[96:97], v2 offset:8192
  ds_read_b64_tr_b16 v[98:99], v2 offset:8704
  v_mfma_f32_32x32x16_bf16 v[176:191], v[104:107], a[148:151], v[176:191]
  s_add_u32 m0, s23, 57344
  s_add_u32 s24, s24, 147456
  buffer_load_dwordx4 v5, s[8:11], s24 offen lds
  s_waitcnt vmcnt(9)
  s_barrier
  s_waitcnt lgkmcnt(2)
  v_mfma_f32_32x32x16_bf16 v[160:175], v[108:111], a[152:155], v[160:175]
  ds_read_b64_tr_b16 v[100:101], v2 offset:12288
  ds_read_b64_tr_b16 v[102:103], v2 offset:12800
  v_mfma_f32_32x32x16_bf16 v[176:191], v[108:111], a[156:159], v[176:191]
  s_add_u32 m0, s23, 61440
  s_add_u32 s24, s24, 147456
  buffer_load_dwordx4 v5, s[8:11], s24 offen lds
  s_waitcnt lgkmcnt(2)
  v_mfma_f32_32x32x16_bf16 v[160:175], v[96:99], a[160:163], v[160:175]
  ds_read_b64_tr_b16 v[104:105], v2 offset:16384
  ds_read_b64_tr_b16 v[106:107], v2 offset:16896
  v_mfma_f32_32x32x16_bf16 v[176:191], v[96:99], a[164:167], v[176:191]
  s_add_u32 m0, s23, 65536
  s_add_u32 s24, s24, 147456
  buffer_load_dwordx4 v5, s[8:11], s24 offen lds
  s_waitcnt lgkmcnt(2)
  v_mfma_f32_32x32x16_bf16 v[160:175], v[100:103], a[168:171], v[160:175]
  ds_read_b64_tr_b16 v[108:109], v2 offset:20480
  ds_read_b64_tr_b16 v[110:111], v2 offset:20992
  v_mfma_f32_32x32x16_bf16 v[176:191], v[100:103], a[172:175], v[176:191]
  s_add_u32 m0, s23, 69632
  s_add_u32 s24, s24, 147456
  buffer_load_dwordx4 v5, s[8:11], s24 offen lds
  s_waitcnt vmcnt(9)
  s_barrier
  s_waitcnt lgkmcnt(2)
  v_mfma_f32_32x32x16_bf16 v[160:175], v[104:107], a[176:179], v[160:175]
  ds_read_b64_tr_b16 v[96:97], v2 offset:24576
  ds_read_b64_tr_b16 v[98:99], v2 offset:25088
  v_mfma_f32_32x32x16_bf16 v[176:191], v[104:107], a[180:183], v[176:191]
  s_add_u32 m0, s23, 0
  s_sub_u32 s24, s24, 5160832
  buffer_load_dwordx4 v5, s[8:11], s24 offen lds
  s_waitcnt lgkmcnt(2)
  v_mfma_f32_32x32x16_bf16 v[160:175], v[108:111], a[184:187], v[160:175]
  ds_read_b64_tr_b16 v[100:101], v2 offset:28672
  ds_read_b64_tr_b16 v[102:103], v2 offset:29184
  v_mfma_f32_32x32x16_bf16 v[176:191], v[108:111], a[188:191], v[176:191]
  s_add_u32 m0, s23, 4096
  s_add_u32 s24, s24, 147456
  buffer_load_dwordx4 v5, s[8:11], s24 offen lds
  s_waitcnt lgkmcnt(2)
  v_mfma_f32_32x32x16_bf16 v[160:175], v[96:99], a[192:195], v[160:175]
  ds_read_b64_tr_b16 v[104:105], v2 offset:32768
  ds_read_b64_tr_b16 v[106:107], v2 offset:33280
  v_mfma_f32_32x32x16_bf16 v[176:191], v[96:99], a[196:199], v[176:191]
  s_add_u32 m0, s23, 8192
  s_add_u32 s24, s24, 147456
  buffer_load_dwordx4 v5, s[8:11], s24 offen lds
  s_waitcnt vmcnt(9)
  s_barrier
  s_waitcnt lgkmcnt(2)
  v_mfma_f32_32x32x16_bf16 v[160:175], v[100:103], a[200:203], v[160:175]
  ds_read_b64_tr_b16 v[108:109], v90 offset:0
  ds_read_b64_tr_b16 v[110:111], v90 offset:512
  v_mfma_f32_32x32x16_bf16 v[176:191], v[100:103], a[204:207], v[176:191]
  s_add_u32 m0, s23, 12288
  s_add_u32 s24, s24, 147456
  buffer_load_dwordx4 v5, s[8:11], s24 offen lds
  s_waitcnt lgkmcnt(2)
  v_mfma_f32_32x32x16_bf16 v[160:175], v[104:107], a[208:211], v[160:175]
  ds_read_b64_tr_b16 v[96:97], v90 offset:4096
  ds_read_b64_tr_b16 v[98:99], v90 offset:4608
  v_mfma_f32_32x32x16_bf16 v[176:191], v[104:107], a[212:215], v[176:191]
  s_add_u32 m0, s23, 16384
  s_add_u32 s24, s24, 147456
  buffer_load_dwordx4 v5, s[8:11], s24 offen lds
  s_waitcnt lgkmcnt(2)
  v_mfma_f32_32x32x16_bf16 v[160:175], v[108:111], a[216:219], v[160:175]
  ds_read_b64_tr_b16 v[100:101], v90 offset:8192
  ds_read_b64_tr_b16 v[102:103], v90 offset:8704
  v_mfma_f32_32x32x16_bf16 v[176:191], v[108:111], a[220:223], v[176:191]
  s_add_u32 m0, s23, 20480
  s_add_u32 s24, s24, 147456
  buffer_load_dwordx4 v5, s[8:11], s24 offen lds
  s_waitcnt vmcnt(9)
  s_barrier
  s_waitcnt lgkmcnt(2)
  v_mfma_f32_32x32x16_bf16 v[160:175], v[96:99], a[224:227], v[160:175]
  ds_read_b64_tr_b16 v[104:105], v90 offset:12288
  ds_read_b64_tr_b16 v[106:107], v90 offset:12800
  v_mfma_f32_32x32x16_bf16 v[176:191], v[96:99], a[228:231], v[176:191]
  s_add_u32 m0, s23, 24576
  s_add_u32 s24, s24, 147456
  buffer_load_dwordx4 v5, s[8:11], s24 offen lds
  s_waitcnt lgkmcnt(2)
  v_mfma_f32_32x32x16_bf16 v[160:175], v[100:103], a[232:235], v[160:175]
  ds_read_b64_tr_b16 v[108:109], v90 offset:16384
  ds_read_b64_tr_b16 v[110:111], v90 offset:16896
  v_mfma_f32_32x32x16_bf16 v[176:191], v[100:103], a[236:239], v[176:191]
  s_add_u32 m0, s23, 28672
  s_add_u32 s24, s24, 147456
  buffer_load_dwordx4 v5, s[8:11], s24 offen lds
  s_waitcnt lgkmcnt(2)
  v_mfma_f32_32x32x16_bf16 v[160:175], v[104:107], a[240:243], v[160:175]
  ds_read_b64_tr_b16 v[96:97], v90 offset:20480
  ds_read_b64_tr_b16 v[98:99], v90 offset:20992
  v_mfma_f32_32x32x16_bf16 v[176:191], v[104:107], a[244:247], v[176:191]
  s_add_u32 m0, s23, 32768
  s_add_u32 s24, s24, 147456
  buffer_load_dwordx4 v5, s[8:11], s24 offen lds
  s_waitcnt vmcnt(9)
  s_barrier
  s_waitcnt lgkmcnt(2)
  v_mfma_f32_32x32x16_bf16 v[160:175], v[108:111], a[248:251], v[160:175]
  ds_read_b64_tr_b16 v[100:101], v90 offset:24576
  ds_read_b64_tr_b16 v[102:103], v90 offset:25088
  v_mfma_f32_32x32x16_bf16 v[176:191], v[108:111], a[252:255], v[176:191]
  s_add_u32 m0, s23, 36864
  s_add_u32 s24, s24, 147456
  buffer_load_dwordx4 v5, s[8:11], s24 offen lds
  s_waitcnt lgkmcnt(2)
  v_mfma_f32_32x32x16_bf16 v[160:175], v[96:99], v[224:227], v[160:175]
  ds_read_b64_tr_b16 v[104:105], v90 offset:28672
  ds_read_b64_tr_b16 v[106:107], v90 offset:29184
  v_mfma_f32_32x32x16_bf16 v[176:191], v[96:99], v[228:231], v[176:191]
  s_add_u32 m0, s23, 40960
  s_add_u32 s24, s24, 147456
  buffer_load_dwordx4 v5, s[8:11], s24 offen lds
  s_waitcnt lgkmcnt(2)
  v_mfma_f32_32x32x16_bf16 v[160:175], v[100:103], v[232:235], v[160:175]
  ds_read_b64_tr_b16 v[108:109], v90 offset:32768
  ds_read_b64_tr_b16 v[110:111], v90 offset:33280
  v_mfma_f32_32x32x16_bf16 v[176:191], v[100:103], v[236:239], v[176:191]
  s_add_u32 m0, s23, 45056
  s_add_u32 s24, s24, 147456
  buffer_load_dwordx4 v5, s[8:11], s24 offen lds
  s_waitcnt vmcnt(9)
  s_barrier
  s_waitcnt lgkmcnt(2)
  v_mfma_f32_32x32x16_bf16 v[160:175], v[104:107], v[240:243], v[160:175]
  ds_read_b64_tr_b16 v[96:97], v2 offset:0
  ds_read_b64_tr_b16 v[98:99], v2 offset:512
  v_mfma_f32_32x32x16_bf16 v[176:191], v[104:107], v[244:247], v[176:191]
  s_add_u32 m0, s23, 49152
  s_add_u32 s24, s24, 147456
  buffer_load_dwordx4 v5, s[8:11], s24 offen lds
  s_waitcnt lgkmcnt(2)
  v_mfma_f32_32x32x16_bf16 v[160:175], v[108:111], v[248:251], v[160:175]
  ds_read_b64_tr_b16 v[100:101], v2 offset:4096
  ds_read_b64_tr_b16 v[102:103], v2 offset:4608
  v_mfma_f32_32x32x16_bf16 v[176:191], v[108:111], v[252:255], v[176:191]
  s_add_u32 m0, s23, 53248
  s_add_u32 s24, s24, 147456
  buffer_load_dwordx4 v5, s[8:11], s24 offen lds
  s_waitcnt lgkmcnt(2)
  v_mfma_f32_32x32x16_bf16 v[192:207], v[96:99], a[0:3], 0
  ds_read_b64_tr_b16 v[104:105], v2 offset:8192
  ds_read_b64_tr_b16 v[106:107], v2 offset:8704
  ds_read_b128 a[0:3], v93 offset:0
  v_mfma_f32_32x32x16_bf16 v[208:223], v[96:99], a[4:7], 0
  s_add_u32 m0, s23, 57344
  s_add_u32 s24, s24, 147456
  buffer_load_dwordx4 v5, s[8:11], s24 offen lds
  ds_read_b128 a[4:7], v93 offset:1024
  buffer_load_dword v15, v14, s[12:15], s57 offen
  s_add_u32 s57, s57, 13824
  s_waitcnt vmcnt(10)
  s_barrier
  s_waitcnt lgkmcnt(4)
  v_mfma_f32_32x32x16_bf16 v[192:207], v[100:103], a[8:11], v[192:207]
  ds_read_b64_tr_b16 v[108:109], v2 offset:12288
  ds_read_b64_tr_b16 v[110:111], v2 offset:12800
  ds_read_b128 a[8:11], v93 offset:2048
  v_mfma_f32_32x32x16_bf16 v[208:223], v[100:103], a[12:15], v[208:223]
  s_add_u32 m0, s23, 61440
  s_add_u32 s24, s24, 147456
  buffer_load_dwordx4 v5, s[8:11], s24 offen lds
  ds_read_b128 a[12:15], v93 offset:3072
  s_waitcnt lgkmcnt(6)
  v_mfma_f32_32x32x16_bf16 v[192:207], v[104:107], a[16:19], v[192:207]
  ds_read_b64_tr_b16 v[96:97], v2 offset:16384
  ds_read_b64_tr_b16 v[98:99], v2 offset:16896
  ds_read_b128 a[16:19], v93 offset:4096
  v_mfma_f32_32x32x16_bf16 v[208:223], v[104:107], a[20:23], v[208:223]
  s_add_u32 m0, s23, 65536
  s_add_u32 s24, s24, 147456
  buffer_load_dwordx4 v5, s[8:11], s24 offen lds
  ds_read_b128 a[20:23], v93 offset:5120
  s_waitcnt lgkmcnt(6)
  v_mfma_f32_32x32x16_bf16 v[192:207], v[108:111], a[24:27], v[192:207]
  ds_read_b64_tr_b16 v[100:101], v2 offset:20480
  ds_read_b64_tr_b16 v[102:103], v2 offset:20992
  ds_read_b128 a[24:27], v93 offset:6144
  v_mul_f32 v160, v160, v168
  v_mul_f32 v161, v161, v169
  v_mfma_f32_32x32x16_bf16 v[208:223], v[108:111], a[28:31], v[208:223]
  s_add_u32 m0, s23, 69632
  s_add_u32 s24, s24, 147456
  buffer_load_dwordx4 v5, s[8:11], s24 offen lds
  ds_read_b128 a[28:31], v93 offset:7168
  v_mul_f32 v162, v162, v170
  v_mul_f32 v163, v163, v171
  s_waitcnt vmcnt(10)
  s_barrier
  s_waitcnt lgkmcnt(6)
  v_mfma_f32_32x32x16_bf16 v[192:207], v[96:99], a[32:35], v[192:207]
  ds_read_b64_tr_b16 v[104:105], v2 offset:24576
  ds_read_b64_tr_b16 v[106:107], v2 offset:25088
  ds_read_b128 a[32:35], v93 offset:8192
  v_mul_f32 v164, v164, v172
  v_mul_f32 v165, v165, v173
  v_mfma_f32_32x32x16_bf16 v[208:223], v[96:99], a[36:39], v[208:223]
  s_add_u32 m0, s23, 0
  s_add_u32 s24, s24, 147456
  buffer_load_dwordx4 v5, s[8:11], s24 offen lds
  ds_read_b128 a[36:39], v93 offset:9216
  v_mul_f32 v166, v166, v174
  v_mul_f32 v167, v167, v175
  s_waitcnt lgkmcnt(6)
  v_mfma_f32_32x32x16_bf16 v[192:207], v[100:103], a[40:43], v[192:207]
  ds_read_b64_tr_b16 v[108:109], v2 offset:28672
  ds_read_b64_tr_b16 v[110:111], v2 offset:29184
  ds_read_b128 a[40:43], v93 offset:10240
  v_cvt_pk_bf16_f32 v64, v160, v161
  v_cvt_pk_bf16_f32 v65, v162, v163
  v_mfma_f32_32x32x16_bf16 v[208:223], v[100:103], a[44:47], v[208:223]
  s_add_u32 m0, s23, 4096
  s_add_u32 s24, s24, 147456
  buffer_load_dwordx4 v5, s[8:11], s24 offen lds
  ds_read_b128 a[44:47], v93 offset:11264
  v_cvt_pk_bf16_f32 v66, v164, v165
  v_cvt_pk_bf16_f32 v67, v166, v167
  s_waitcnt lgkmcnt(6)
  v_mfma_f32_32x32x16_bf16 v[192:207], v[104:107], a[48:51], v[192:207]
  ds_read_b64_tr_b16 v[96:97], v2 offset:32768
  ds_read_b64_tr_b16 v[98:99], v2 offset:33280
  ds_read_b128 a[48:51], v93 offset:12288
  ds_write_b128 v8, v[64:67] offset:0
  v_mul_f32 v176, v176, v184
  v_mfma_f32_32x32x16_bf16 v[208:223], v[104:107], a[52:55], v[208:223]
  s_add_u32 m0, s23, 8192
  s_add_u32 s24, s24, 147456
  buffer_load_dwordx4 v5, s[8:11], s24 offen lds
  ds_read_b128 a[52:55], v93 offset:13312
  v_mul_f32 v177, v177, v185
  v_mul_f32 v178, v178, v186
  s_waitcnt vmcnt(10)
  s_barrier
  s_waitcnt lgkmcnt(7)
  v_mfma_f32_32x32x16_bf16 v[192:207], v[108:111], a[56:59], v[192:207]
  ds_read_b64_tr_b16 v[100:101], v90 offset:0
  ds_read_b64_tr_b16 v[102:103], v90 offset:512
  ds_read_b128 a[56:59], v93 offset:14336
  v_mul_f32 v179, v179, v187
  v_mul_f32 v180, v180, v188
  v_mfma_f32_32x32x16_bf16 v[208:223], v[108:111], a[60:63], v[208:223]
  s_add_u32 m0, s23, 12288
  s_add_u32 s24, s24, 147456
  buffer_load_dwordx4 v5, s[8:11], s24 offen lds
  ds_read_b128 a[60:63], v93 offset:15360
  v_mul_f32 v181, v181, v189
  v_mul_f32 v182, v182, v190
  s_waitcnt lgkmcnt(7)
  v_mfma_f32_32x32x16_bf16 v[192:207], v[96:99], a[64:67], v[192:207]
  ds_read_b64_tr_b16 v[104:105], v90 offset:4096
  ds_read_b64_tr_b16 v[106:107], v90 offset:4608
  ds_read_b128 a[64:67], v93 offset:16384
  v_mul_f32 v183, v183, v191
  v_cvt_pk_bf16_f32 v68, v176, v177
  v_mfma_f32_32x32x16_bf16 v[208:223], v[96:99], a[68:71], v[208:223]
  s_add_u32 m0, s23, 16384
  s_add_u32 s24, s24, 147456
  buffer_load_dwordx4 v5, s[8:11], s24 offen lds
  ds_read_b128 a[68:71], v93 offset:17408
  v_cvt_pk_bf16_f32 v69, v178, v179
  v_cvt_pk_bf16_f32 v70, v180, v181
  s_waitcnt lgkmcnt(6)
  v_mfma_f32_32x32x16_bf16 v[192:207], v[100:103], a[72:75], v[192:207]
  ds_read_b64_tr_b16 v[108:109], v90 offset:8192
  ds_read_b64_tr_b16 v[110:111], v90 offset:8704
  ds_read_b128 a[72:75], v93 offset:18432
  v_cvt_pk_bf16_f32 v71, v182, v183
  ds_write_b128 v8, v[68:71] offset:1024
  v_mfma_f32_32x32x16_bf16 v[208:223], v[100:103], a[76:79], v[208:223]
  s_add_u32 m0, s23, 20480
  s_add_u32 s24, s24, 147456
  buffer_load_dwordx4 v5, s[8:11], s24 offen lds
  ds_read_b128 a[76:79], v93 offset:19456
  v_add_u32 v8, s46, v8
  s_mov_b32 s46, 0x2000
  s_waitcnt vmcnt(10)
  s_barrier
  s_waitcnt lgkmcnt(7)
  v_mfma_f32_32x32x16_bf16 v[192:207], v[104:107], a[80:83], v[192:207]
  ds_read_b64_tr_b16 v[96:97], v90 offset:12288
  ds_read_b64_tr_b16 v[98:99], v90 offset:12800
  ds_read_b128 a[80:83], v93 offset:20480
  v_mfma_f32_32x32x16_bf16 v[208:223], v[104:107], a[84:87], v[208:223]
  s_add_u32 m0, s23, 24576
  s_add_u32 s24, s24, 147456
  buffer_load_dwordx4 v5, s[8:11], s24 offen lds
  ds_read_b128 a[84:87], v93 offset:21504
  s_waitcnt lgkmcnt(7)
  v_mfma_f32_32x32x16_bf16 v[192:207], v[108:111], a[88:91], v[192:207]
  ds_read_b64_tr_b16 v[100:101], v90 offset:16384
  ds_read_b64_tr_b16 v[102:103], v90 offset:16896
  ds_read_b128 a[88:91], v93 offset:22528
  v_mfma_f32_32x32x16_bf16 v[208:223], v[108:111], a[92:95], v[208:223]
  s_add_u32 m0, s23, 28672
  s_add_u32 s24, s24, 147456
  buffer_load_dwordx4 v5, s[8:11], s24 offen lds
  ds_read_b128 a[92:95], v93 offset:23552
  s_waitcnt lgkmcnt(6)
  v_mfma_f32_32x32x16_bf16 v[192:207], v[96:99], a[96:99], v[192:207]
  ds_read_b64_tr_b16 v[104:105], v90 offset:20480
  ds_read_b64_tr_b16 v[106:107], v90 offset:20992
  ds_read_b128 a[96:99], v93 offset:24576
  v_mfma_f32_32x32x16_bf16 v[208:223], v[96:99], a[100:103], v[208:223]
  s_add_u32 m0, s23, 32768
  s_add_u32 s24, s24, 147456
  buffer_load_dwordx4 v5, s[8:11], s24 offen lds
  ds_read_b128 a[100:103], v93 offset:25600
  s_waitcnt vmcnt(9)
  s_barrier
  s_waitcnt lgkmcnt(6)
  v_mfma_f32_32x32x16_bf16 v[192:207], v[100:103], a[104:107], v[192:207]
  ds_read_b64_tr_b16 v[108:109], v90 offset:24576
  ds_read_b64_tr_b16 v[110:111], v90 offset:25088
  ds_read_b128 a[104:107], v93 offset:26624
  v_mfma_f32_32x32x16_bf16 v[208:223], v[100:103], a[108:111], v[208:223]
  s_add_u32 m0, s23, 36864
  s_add_u32 s24, s24, 147456
  buffer_load_dwordx4 v5, s[8:11], s24 offen lds
  ds_read_b128 a[108:111], v93 offset:27648
  s_waitcnt lgkmcnt(6)
  v_mfma_f32_32x32x16_bf16 v[192:207], v[104:107], a[112:115], v[192:207]
  ds_read_b64_tr_b16 v[96:97], v90 offset:28672
  ds_read_b64_tr_b16 v[98:99], v90 offset:29184
  ds_read_b128 a[112:115], v93 offset:28672
  v_mfma_f32_32x32x16_bf16 v[208:223], v[104:107], a[116:119], v[208:223]
  s_add_u32 m0, s23, 40960
  s_add_u32 s24, s24, 147456
  buffer_load_dwordx4 v5, s[8:11], s24 offen lds
  ds_read_b128 a[116:119], v93 offset:29696
  s_waitcnt lgkmcnt(6)
  v_mfma_f32_32x32x16_bf16 v[192:207], v[108:111], a[120:123], v[192:207]
  ds_read_b64_tr_b16 v[100:101], v90 offset:32768
  ds_read_b64_tr_b16 v[102:103], v90 offset:33280
  ds_read_b128 a[120:123], v93 offset:30720
  v_mfma_f32_32x32x16_bf16 v[208:223], v[108:111], a[124:127], v[208:223]
  s_add_u32 m0, s23, 45056
  s_add_u32 s24, s24, 147456
  buffer_load_dwordx4 v5, s[8:11], s24 offen lds
  ds_read_b128 a[124:127], v93 offset:31744
  s_waitcnt vmcnt(9)
  s_barrier
  s_waitcnt lgkmcnt(6)
  v_mfma_f32_32x32x16_bf16 v[192:207], v[96:99], a[128:131], v[192:207]
  ds_read_b64_tr_b16 v[104:105], v2 offset:0
  ds_read_b64_tr_b16 v[106:107], v2 offset:512
  ds_read_b128 a[128:131], v93 offset:32768
  v_mfma_f32_32x32x16_bf16 v[208:223], v[96:99], a[132:135], v[208:223]
  s_add_u32 m0, s23, 49152
  s_add_u32 s24, s24, 147456
  buffer_load_dwordx4 v5, s[8:11], s24 offen lds
  ds_read_b128 a[132:135], v93 offset:33792
  s_waitcnt lgkmcnt(6)
  v_mfma_f32_32x32x16_bf16 v[192:207], v[100:103], a[136:139], v[192:207]
  ds_read_b64_tr_b16 v[108:109], v2 offset:4096
  ds_read_b64_tr_b16 v[110:111], v2 offset:4608
  ds_read_b128 a[136:139], v93 offset:34816
  v_mfma_f32_32x32x16_bf16 v[208:223], v[100:103], a[140:143], v[208:223]
  s_add_u32 m0, s23, 53248
  s_add_u32 s24, s24, 147456
  buffer_load_dwordx4 v5, s[8:11], s24 offen lds
  ds_read_b128 a[140:143], v93 offset:35840
  s_waitcnt lgkmcnt(6)
  v_mfma_f32_32x32x16_bf16 v[192:207], v[104:107], a[144:147], v[192:207]
  ds_read_b64_tr_b16 v[96:97], v2 offset:8192
  ds_read_b64_tr_b16 v[98:99], v2 offset:8704
  ds_read_b128 a[144:147], v93 offset:36864
  v_mfma_f32_32x32x16_bf16 v[208:223], v[104:107], a[148:151], v[208:223]
  s_add_u32 m0, s23, 57344
  s_add_u32 s24, s24, 147456
  buffer_load_dwordx4 v5, s[8:11], s24 offen lds
  ds_read_b128 a[148:151], v93 offset:37888
  s_waitcnt vmcnt(9)
  s_barrier
  s_waitcnt lgkmcnt(6)
  v_mfma_f32_32x32x16_bf16 v[192:207], v[108:111], a[152:155], v[192:207]
  ds_read_b64_tr_b16 v[100:101], v2 offset:12288
  ds_read_b64_tr_b16 v[102:103], v2 offset:12800
  ds_read_b128 a[152:155], v93 offset:38912
  v_mfma_f32_32x32x16_bf16 v[208:223], v[108:111], a[156:159], v[208:223]
  s_add_u32 m0, s23, 61440
  s_add_u32 s24, s24, 147456
  buffer_load_dwordx4 v5, s[8:11], s24 offen lds
  ds_read_b128 a[156:159], v93 offset:39936
  s_waitcnt lgkmcnt(6)
  v_mfma_f32_32x32x16_bf16 v[192:207], v[96:99], a[160:163], v[192:207]
  ds_read_b64_tr_b16 v[104:105], v2 offset:16384
  ds_read_b64_tr_b16 v[106:107], v2 offset:16896
  ds_read_b128 a[160:163], v93 offset:40960
  v_mfma_f32_32x32x16_bf16 v[208:223], v[96:99], a[164:167], v[208:223]
  s_add_u32 m0, s23, 65536
  s_add_u32 s24, s24, 147456
  buffer_load_dwordx4 v5, s[8:11], s24 offen lds
  ds_read_b128 a[164:167], v93 offset:41984
  s_waitcnt lgkmcnt(6)
  v_mfma_f32_32x32x16_bf16 v[192:207], v[100:103], a[168:171], v[192:207]
  ds_read_b64_tr_b16 v[108:109], v2 offset:20480
  ds_read_b64_tr_b16 v[110:111], v2 offset:20992
  ds_read_b128 a[168:171], v93 offset:43008
  v_mfma_f32_32x32x16_bf16 v[208:223], v[100:103], a[172:175], v[208:223]
  s_add_u32 m0, s23, 69632
  s_add_u32 s24, s24, 147456
  buffer_load_dwordx4 v5, s[8:11], s24 offen lds
  ds_read_b128 a[172:175], v93 offset:44032
  s_waitcnt vmcnt(9)
  s_barrier
  s_waitcnt lgkmcnt(6)
  v_mfma_f32_32x32x16_bf16 v[192:207], v[104:107], a[176:179], v[192:207]
  ds_read_b64_tr_b16 v[96:97], v2 offset:24576
  ds_read_b64_tr_b16 v[98:99], v2 offset:25088
  ds_read_b128 a[176:179], v93 offset:45056
  v_mfma_f32_32x32x16_bf16 v[208:223], v[104:107], a[180:183], v[208:223]
  s_add_u32 m0, s23, 0
  s_mov_b32 s24, s38
  buffer_load_dwordx4 v6, s[12:15], s24 offen lds
  ds_read_b128 a[180:183], v93 offset:46080
  s_waitcnt lgkmcnt(6)
  v_mfma_f32_32x32x16_bf16 v[192:207], v[108:111], a[184:187], v[192:207]
  ds_read_b64_tr_b16 v[100:101], v2 offset:28672
  ds_read_b64_tr_b16 v[102:103], v2 offset:29184
  ds_read_b128 a[184:187], v93 offset:47104
  v_mfma_f32_32x32x16_bf16 v[208:223], v[108:111], a[188:191], v[208:223]
  s_add_u32 m0, s23, 4096
  s_add_u32 s24, s24, 18432
  buffer_load_dwordx4 v6, s[12:15], s24 offen lds
  ds_read_b128 a[188:191], v93 offset:48128
  s_waitcnt lgkmcnt(6)
  v_mfma_f32_32x32x16_bf16 v[192:207], v[96:99], a[192:195], v[192:207]
  ds_read_b64_tr_b16 v[104:105], v2 offset:32768
  ds_read_b64_tr_b16 v[106:107], v2 offset:33280
  ds_read_b128 a[192:195], v93 offset:49152
  v_mfma_f32_32x32x16_bf16 v[208:223], v[96:99], a[196:199], v[208:223]
  s_add_u32 m0, s23, 8192
  s_add_u32 s24, s24, 18432
  buffer_load_dwordx4 v6, s[12:15], s24 offen lds
  ds_read_b128 a[196:199], v93 offset:50176
  s_waitcnt vmcnt(9)
  s_barrier
  s_waitcnt lgkmcnt(6)
  v_mfma_f32_32x32x16_bf16 v[192:207], v[100:103], a[200:203], v[192:207]
  ds_read_b64_tr_b16 v[108:109], v90 offset:0
  ds_read_b64_tr_b16 v[110:111], v90 offset:512
  ds_read_b128 a[200:203], v93 offset:51200
  v_mfma_f32_32x32x16_bf16 v[208:223], v[100:103], a[204:207], v[208:223]
  s_add_u32 m0, s23, 12288
  s_add_u32 s24, s24, 18432
  buffer_load_dwordx4 v6, s[12:15], s24 offen lds
  ds_read_b128 a[204:207], v93 offset:52224
  s_waitcnt lgkmcnt(6)
  v_mfma_f32_32x32x16_bf16 v[192:207], v[104:107], a[208:211], v[192:207]
  ds_read_b64_tr_b16 v[96:97], v90 offset:4096
  ds_read_b64_tr_b16 v[98:99], v90 offset:4608
  ds_read_b128 a[208:211], v93 offset:53248
  v_mfma_f32_32x32x16_bf16 v[208:223], v[104:107], a[212:215], v[208:223]
  s_add_u32 m0, s23, 16384
  s_add_u32 s24, s24, 18432
  buffer_load_dwordx4 v6, s[12:15], s24 offen lds
  ds_read_b128 a[212:215], v93 offset:54272
  s_waitcnt lgkmcnt(6)
  v_mfma_f32_32x32x16_bf16 v[192:207], v[108:111], a[216:219], v[192:207]
  ds_read_b64_tr_b16 v[100:101], v90 offset:8192
  ds_read_b64_tr_b16 v[102:103], v90 offset:8704
  ds_read_b128 a[216:219], v93 offset:55296
  v_mfma_f32_32x32x16_bf16 v[208:223], v[108:111], a[220:223], v[208:223]
  s_add_u32 m0, s23, 20480
  s_add_u32 s24, s24, 18432
  buffer_load_dwordx4 v6, s[12:15], s24 offen lds
  ds_read_b128 a[220:223], v93 offset:56320
  s_waitcnt vmcnt(9)
  s_barrier
  s_waitcnt lgkmcnt(6)
  v_mfma_f32_32x32x16_bf16 v[192:207], v[96:99], a[224:227], v[192:207]
  ds_read_b64_tr_b16 v[104:105], v90 offset:12288
  ds_read_b64_tr_b16 v[106:107], v90 offset:12800
  ds_read_b128 a[224:227], v93 offset:57344
  v_mfma_f32_32x32x16_bf16 v[208:223], v[96:99], a[228:231], v[208:223]
  s_add_u32 m0, s23, 24576
  s_add_u32 s24, s24, 18432
  buffer_load_dwordx4 v6, s[12:15], s24 offen lds
  ds_read_b128 a[228:231], v93 offset:58368
  s_waitcnt lgkmcnt(6)
  v_mfma_f32_32x32x16_bf16 v[192:207], v[100:103], a[232:235], v[192:207]
  ds_read_b64_tr_b16 v[108:109], v90 offset:16384
  ds_read_b64_tr_b16 v[110:111], v90 offset:16896
  ds_read_b128 a[232:235], v93 offset:59392
  v_mfma_f32_32x32x16_bf16 v[208:223], v[100:103], a[236:239], v[208:223]
  s_add_u32 m0, s23, 28672
  s_add_u32 s24, s24, 18432
  buffer_load_dwordx4 v6, s[12:15], s24 offen lds
  ds_read_b128 a[236:239], v93 offset:60416
  s_waitcnt lgkmcnt(6)
  v_mfma_f32_32x32x16_bf16 v[192:207], v[104:107], a[240:243], v[192:207]
  ds_read_b64_tr_b16 v[96:97], v90 offset:20480
  ds_read_b64_tr_b16 v[98:99], v90 offset:20992
  ds_read_b128 a[240:243], v93 offset:61440
  v_mfma_f32_32x32x16_bf16 v[208:223], v[104:107], a[244:247], v[208:223]
  s_add_u32 m0, s23, 32768
  s_add_u32 s24, s24, 18432
  buffer_load_dwordx4 v6, s[12:15], s24 offen lds
  ds_read_b128 a[244:247], v93 offset:62464
  s_waitcnt vmcnt(9)
  s_barrier
  s_waitcnt lgkmcnt(6)
  v_mfma_f32_32x32x16_bf16 v[192:207], v[108:111], a[248:251], v[192:207]
  ds_read_b64_tr_b16 v[100:101], v90 offset:24576
  ds_read_b64_tr_b16 v[102:103], v90 offset:25088
  ds_read_b128 a[248:251], v93 offset:63488
  v_mfma_f32_32x32x16_bf16 v[208:223], v[108:111], a[252:255], v[208:223]
  s_add_u32 m0, s23, 36864
  s_add_u32 s24, s24, 18432
  buffer_load_dwordx4 v6, s[12:15], s24 offen lds
  ds_read_b128 a[252:255], v93 offset:64512
  s_waitcnt lgkmcnt(6)
  v_mfma_f32_32x32x16_bf16 v[192:207], v[96:99], v[224:227], v[192:207]
  ds_read_b64_tr_b16 v[104:105], v90 offset:28672
  ds_read_b64_tr_b16 v[106:107], v90 offset:29184
  v_mfma_f32_32x32x16_bf16 v[208:223], v[96:99], v[228:231], v[208:223]
  s_add_u32 m0, s23, 40960
  s_add_u32 s24, s24, 18432
  buffer_load_dwordx4 v6, s[12:15], s24 offen lds
  s_waitcnt lgkmcnt(4)
  v_mfma_f32_32x32x16_bf16 v[192:207], v[100:103], v[232:235], v[192:207]
  ds_read_b64_tr_b16 v[108:109], v90 offset:32768
  ds_read_b64_tr_b16 v[110:111], v90 offset:33280
  v_mfma_f32_32x32x16_bf16 v[208:223], v[100:103], v[236:239], v[208:223]
  s_add_u32 m0, s23, 45056
  s_add_u32 s24, s24, 18432
  buffer_load_dwordx4 v6, s[12:15], s24 offen lds
  s_waitcnt vmcnt(9)
  s_barrier
  s_waitcnt lgkmcnt(2)
  v_mfma_f32_32x32x16_bf16 v[192:207], v[104:107], v[240:243], v[192:207]
  ds_read_b64_tr_b16 v[96:97], v3 offset:0
  ds_read_b64_tr_b16 v[98:99], v3 offset:2048
  v_mfma_f32_32x32x16_bf16 v[208:223], v[104:107], v[244:247], v[208:223]
  s_add_u32 m0, s23, 49152
  s_add_u32 s24, s24, 18432
  buffer_load_dwordx4 v6, s[12:15], s24 offen lds
  s_waitcnt lgkmcnt(2)
  v_mfma_f32_32x32x16_bf16 v[192:207], v[108:111], v[248:251], v[192:207]
  ds_read_b64_tr_b16 v[100:101], v3 offset:4096
  ds_read_b64_tr_b16 v[102:103], v3 offset:6144
  v_mfma_f32_32x32x16_bf16 v[208:223], v[108:111], v[252:255], v[208:223]
  s_add_u32 m0, s23, 53248
  s_add_u32 s24, s24, 18432
  buffer_load_dwordx4 v6, s[12:15], s24 offen lds
  s_lshl_b32 s27, s20, 12
  s_add_u32 s27, s27, s26
  s_waitcnt lgkmcnt(2)
  v_mfma_f32_32x32x16_bf16 v[128:143], v[96:99], a[0:3], 0
  ds_read_b64_tr_b16 v[104:105], v3 offset:8192
  ds_read_b64_tr_b16 v[106:107], v3 offset:10240
  v_mfma_f32_32x32x16_bf16 v[144:159], v[96:99], a[4:7], 0
  s_add_u32 m0, s23, 57344
  s_add_u32 s24, s24, 18432
  buffer_load_dwordx4 v6, s[12:15], s24 offen lds
  s_waitcnt vmcnt(9)
  s_barrier
  s_waitcnt lgkmcnt(2)
  v_mfma_f32_32x32x16_bf16 v[128:143], v[100:103], a[8:11], v[128:143]
  ds_read_b64_tr_b16 v[108:109], v3 offset:12288
  ds_read_b64_tr_b16 v[110:111], v3 offset:14336
  v_mfma_f32_32x32x16_bf16 v[144:159], v[100:103], a[12:15], v[144:159]
  s_add_u32 m0, s23, 61440
  s_add_u32 s24, s24, 18432
  buffer_load_dwordx4 v6, s[12:15], s24 offen lds
  s_waitcnt lgkmcnt(2)
  v_mfma_f32_32x32x16_bf16 v[128:143], v[104:107], a[16:19], v[128:143]
  ds_read_b64_tr_b16 v[96:97], v3 offset:16384
  ds_read_b64_tr_b16 v[98:99], v3 offset:18432
  v_mfma_f32_32x32x16_bf16 v[144:159], v[104:107], a[20:23], v[144:159]
  s_add_u32 m0, s23, 65536
  s_add_u32 s24, s24, 18432
  buffer_load_dwordx4 v6, s[12:15], s24 offen lds
  s_waitcnt lgkmcnt(2)
  v_mfma_f32_32x32x16_bf16 v[128:143], v[108:111], a[24:27], v[128:143]
  ds_read_b64_tr_b16 v[100:101], v3 offset:20480
  ds_read_b64_tr_b16 v[102:103], v3 offset:22528
  v_mul_f32 v192, v192, v200
  v_mul_f32 v193, v193, v201
  v_mfma_f32_32x32x16_bf16 v[144:159], v[108:111], a[28:31], v[144:159]
  s_add_u32 m0, s23, 69632
  s_add_u32 s24, s24, 18432
  buffer_load_dwordx4 v6, s[12:15], s24 offen lds
  v_mul_f32 v194, v194, v202
  v_mul_f32 v195, v195, v203
  s_waitcnt vmcnt(9)
  s_barrier
  s_waitcnt lgkmcnt(2)
  v_mfma_f32_32x32x16_bf16 v[128:143], v[96:99], a[32:35], v[128:143]
  ds_read_b64_tr_b16 v[104:105], v3 offset:24576
  ds_read_b64_tr_b16 v[106:107], v3 offset:26624
  v_mul_f32 v196, v196, v204
  v_mul_f32 v197, v197, v205
  v_mfma_f32_32x32x16_bf16 v[144:159], v[96:99], a[36:39], v[144:159]
  s_add_u32 m0, s23, 0
  s_add_u32 s24, s24, 18432
  buffer_load_dwordx4 v6, s[12:15], s24 offen lds
  v_mul_f32 v198, v198, v206
  v_mul_f32 v199, v199, v207
  s_waitcnt lgkmcnt(2)
  v_mfma_f32_32x32x16_bf16 v[128:143], v[100:103], a[40:43], v[128:143]
  ds_read_b64_tr_b16 v[108:109], v3 offset:28672
  ds_read_b64_tr_b16 v[110:111], v3 offset:30720
  v_cvt_pk_bf16_f32 v64, v192, v193
  v_cvt_pk_bf16_f32 v65, v194, v195
  v_mfma_f32_32x32x16_bf16 v[144:159], v[100:103], a[44:47], v[144:159]
  s_add_u32 m0, s23, 4096
  s_add_u32 s24, s24, 18432
  buffer_load_dwordx4 v6, s[12:15], s24 offen lds
  v_cvt_pk_bf16_f32 v66, v196, v197
  v_cvt_pk_bf16_f32 v67, v198, v199
  s_waitcnt lgkmcnt(2)
  v_mfma_f32_32x32x16_bf16 v[128:143], v[104:107], a[48:51], v[128:143]
  ds_read_b64_tr_b16 v[96:97], v3 offset:32768
  ds_read_b64_tr_b16 v[98:99], v3 offset:34816
  ds_write_b128 v8, v[64:67] offset:0
  v_mul_f32 v208, v208, v216
  v_mfma_f32_32x32x16_bf16 v[144:159], v[104:107], a[52:55], v[144:159]
  s_add_u32 m0, s23, 8192
  s_add_u32 s24, s24, 18432
  buffer_load_dwordx4 v6, s[12:15], s24 offen lds
  v_mul_f32 v209, v209, v217
  v_mul_f32 v210, v210, v218
  s_waitcnt vmcnt(9)
  s_barrier
  s_waitcnt lgkmcnt(3)
  v_mfma_f32_32x32x16_bf16 v[128:143], v[108:111], a[56:59], v[128:143]
  ds_read_b64_tr_b16 v[100:101], v91 offset:0
  ds_read_b64_tr_b16 v[102:103], v91 offset:2048
  v_mul_f32 v211, v211, v219
  v_mul_f32 v212, v212, v220
  v_mfma_f32_32x32x16_bf16 v[144:159], v[108:111], a[60:63], v[144:159]
  s_add_u32 m0, s23, 12288
  s_add_u32 s24, s24, 18432
  buffer_load_dwordx4 v6, s[12:15], s24 offen lds
  v_mul_f32 v213, v213, v221
  v_mul_f32 v214, v214, v222
  s_waitcnt lgkmcnt(3)
  v_mfma_f32_32x32x16_bf16 v[128:143], v[96:99], a[64:67], v[128:143]
  ds_read_b64_tr_b16 v[104:105], v91 offset:4096
  ds_read_b64_tr_b16 v[106:107], v91 offset:6144
  v_mul_f32 v215, v215, v223
  v_cvt_pk_bf16_f32 v68, v208, v209
  v_mfma_f32_32x32x16_bf16 v[144:159], v[96:99], a[68:71], v[144:159]
  s_add_u32 m0, s23, 16384
  s_add_u32 s24, s24, 18432
  buffer_load_dwordx4 v6, s[12:15], s24 offen lds
  v_cvt_pk_bf16_f32 v69, v210, v211
  v_cvt_pk_bf16_f32 v70, v212, v213
  s_waitcnt lgkmcnt(2)
  v_mfma_f32_32x32x16_bf16 v[128:143], v[100:103], a[72:75], v[128:143]
  ds_read_b64_tr_b16 v[108:109], v91 offset:8192
  ds_read_b64_tr_b16 v[110:111], v91 offset:10240
  v_cvt_pk_bf16_f32 v71, v214, v215
  ds_write_b128 v8, v[68:71] offset:1024
  v_mfma_f32_32x32x16_bf16 v[144:159], v[100:103], a[76:79], v[144:159]
  s_add_u32 m0, s23, 20480
  s_add_u32 s24, s24, 18432
  buffer_load_dwordx4 v6, s[12:15], s24 offen lds
  v_add_u32 v8, s46, v8
  s_mov_b32 s46, 0x2000
  s_waitcnt vmcnt(9)
  s_barrier
  s_waitcnt lgkmcnt(3)
  v_mfma_f32_32x32x16_bf16 v[128:143], v[104:107], a[80:83], v[128:143]
  ds_read_b64_tr_b16 v[96:97], v91 offset:12288
  ds_read_b64_tr_b16 v[98:99], v91 offset:14336
  v_mfma_f32_32x32x16_bf16 v[144:159], v[104:107], a[84:87], v[144:159]
  s_add_u32 m0, s23, 24576
  s_add_u32 s24, s24, 18432
  buffer_load_dwordx4 v6, s[12:15], s24 offen lds
  s_waitcnt lgkmcnt(3)
  v_mfma_f32_32x32x16_bf16 v[128:143], v[108:111], a[88:91], v[128:143]
  ds_read_b64_tr_b16 v[100:101], v91 offset:16384
  ds_read_b64_tr_b16 v[102:103], v91 offset:18432
  v_mfma_f32_32x32x16_bf16 v[144:159], v[108:111], a[92:95], v[144:159]
  s_add_u32 m0, s23, 28672
  s_add_u32 s24, s24, 18432
  buffer_load_dwordx4 v6, s[12:15], s24 offen lds
  s_waitcnt lgkmcnt(2)
  v_mfma_f32_32x32x16_bf16 v[128:143], v[96:99], a[96:99], v[128:143]
  ds_read_b64_tr_b16 v[104:105], v91 offset:20480
  ds_read_b64_tr_b16 v[106:107], v91 offset:22528
  v_mfma_f32_32x32x16_bf16 v[144:159], v[96:99], a[100:103], v[144:159]
  s_add_u32 m0, s23, 32768
  s_add_u32 s24, s24, 18432
  buffer_load_dwordx4 v6, s[12:15], s24 offen lds
  s_waitcnt vmcnt(9)
  s_barrier
  s_waitcnt lgkmcnt(2)
  v_mfma_f32_32x32x16_bf16 v[128:143], v[100:103], a[104:107], v[128:143]
  ds_read_b64_tr_b16 v[108:109], v91 offset:24576
  ds_read_b64_tr_b16 v[110:111], v91 offset:26624
  v_mfma_f32_32x32x16_bf16 v[144:159], v[100:103], a[108:111], v[144:159]
  s_add_u32 m0, s23, 36864
  s_add_u32 s24, s24, 18432
  buffer_load_dwordx4 v6, s[12:15], s24 offen lds
  s_waitcnt lgkmcnt(2)
  v_mfma_f32_32x32x16_bf16 v[128:143], v[104:107], a[112:115], v[128:143]
  ds_read_b64_tr_b16 v[96:97], v91 offset:28672
  ds_read_b64_tr_b16 v[98:99], v91 offset:30720
  v_mfma_f32_32x32x16_bf16 v[144:159], v[104:107], a[116:119], v[144:159]
  s_add_u32 m0, s23, 40960
  s_add_u32 s24, s24, 18432
  buffer_load_dwordx4 v6, s[12:15], s24 offen lds
  s_waitcnt lgkmcnt(2)
  v_mfma_f32_32x32x16_bf16 v[128:143], v[108:111], a[120:123], v[128:143]
  ds_read_b64_tr_b16 v[100:101], v91 offset:32768
  ds_read_b64_tr_b16 v[102:103], v91 offset:34816
  v_mfma_f32_32x32x16_bf16 v[144:159], v[108:111], a[124:127], v[144:159]
  s_add_u32 m0, s23, 45056
  s_add_u32 s24, s24, 18432
  buffer_load_dwordx4 v6, s[12:15], s24 offen lds
  s_waitcnt vmcnt(9)
  s_barrier
  s_waitcnt lgkmcnt(2)
  v_mfma_f32_32x32x16_bf16 v[128:143], v[96:99], a[128:131], v[128:143]
  ds_read_b64_tr_b16 v[104:105], v3 offset:0
  ds_read_b64_tr_b16 v[106:107], v3 offset:2048
  v_mfma_f32_32x32x16_bf16 v[144:159], v[96:99], a[132:135], v[144:159]
  s_add_u32 m0, s23, 49152
  s_add_u32 s24, s24, 18432
  buffer_load_dwordx4 v6, s[12:15], s24 offen lds
  s_waitcnt lgkmcnt(2)
  v_mfma_f32_32x32x16_bf16 v[128:143], v[100:103], a[136:139], v[128:143]
  ds_read_b64_tr_b16 v[108:109], v3 offset:4096
  ds_read_b64_tr_b16 v[110:111], v3 offset:6144
  v_mfma_f32_32x32x16_bf16 v[144:159], v[100:103], a[140:143], v[144:159]
  s_add_u32 m0, s23, 53248
  s_add_u32 s24, s24, 18432
  buffer_load_dwordx4 v6, s[12:15], s24 offen lds
  s_waitcnt lgkmcnt(2)
  v_mfma_f32_32x32x16_bf16 v[128:143], v[104:107], a[144:147], v[128:143]
  ds_read_b64_tr_b16 v[96:97], v3 offset:8192
  ds_read_b64_tr_b16 v[98:99], v3 offset:10240
  v_mfma_f32_32x32x16_bf16 v[144:159], v[104:107], a[148:151], v[144:159]
  s_add_u32 m0, s23, 57344
  s_add_u32 s24, s24, 18432
  buffer_load_dwordx4 v6, s[12:15], s24 offen lds
  s_waitcnt vmcnt(9)
  s_barrier
  s_waitcnt lgkmcnt(2)
  v_mfma_f32_32x32x16_bf16 v[128:143], v[108:111], a[152:155], v[128:143]
  ds_read_b64_tr_b16 v[100:101], v3 offset:12288
  ds_read_b64_tr_b16 v[102:103], v3 offset:14336
  v_mfma_f32_32x32x16_bf16 v[144:159], v[108:111], a[156:159], v[144:159]
  s_add_u32 m0, s23, 61440
  s_add_u32 s24, s24, 18432
  buffer_load_dwordx4 v6, s[12:15], s24 offen lds
  s_waitcnt lgkmcnt(2)
  v_mfma_f32_32x32x16_bf16 v[128:143], v[96:99], a[160:163], v[128:143]
  ds_read_b64_tr_b16 v[104:105], v3 offset:16384
  ds_read_b64_tr_b16 v[106:107], v3 offset:18432
  ds_read_b128 v[224:227], v94 offset:0
  v_mfma_f32_32x32x16_bf16 v[144:159], v[96:99], a[164:167], v[144:159]
  s_add_u32 m0, s23, 65536
  s_add_u32 s24, s24, 18432
  buffer_load_dwordx4 v6, s[12:15], s24 offen lds
  ds_read_b128 v[228:231], v94 offset:1024
  s_waitcnt lgkmcnt(4)
  v_mfma_f32_32x32x16_bf16 v[128:143], v[100:103], a[168:171], v[128:143]
  ds_read_b64_tr_b16 v[108:109], v3 offset:20480
  ds_read_b64_tr_b16 v[110:111], v3 offset:22528
  ds_read_b128 v[232:235], v94 offset:2048
  v_mfma_f32_32x32x16_bf16 v[144:159], v[100:103], a[172:175], v[144:159]
  s_add_u32 m0, s23, 69632
  s_add_u32 s24, s24, 18432
  buffer_load_dwordx4 v6, s[12:15], s24 offen lds
  ds_read_b128 v[236:239], v94 offset:3072
  s_waitcnt vmcnt(9)
  s_barrier
  s_waitcnt lgkmcnt(6)
  v_mfma_f32_32x32x16_bf16 v[128:143], v[104:107], a[176:179], v[128:143]
  ds_read_b64_tr_b16 v[96:97], v3 offset:24576
  ds_read_b64_tr_b16 v[98:99], v3 offset:26624
  ds_read_b128 v[240:243], v94 offset:4096
  v_mfma_f32_32x32x16_bf16 v[144:159], v[104:107], a[180:183], v[144:159]
  s_add_u32 m0, s23, 0
  s_sub_u32 s24, s24, 644864
  buffer_load_dwordx4 v6, s[12:15], s24 offen lds
  ds_read_b128 v[244:247], v94 offset:5120
  s_waitcnt lgkmcnt(6)
  v_mfma_f32_32x32x16_bf16 v[128:143], v[108:111], a[184:187], v[128:143]
  ds_read_b64_tr_b16 v[100:101], v3 offset:28672
  ds_read_b64_tr_b16 v[102:103], v3 offset:30720
  ds_read_b128 v[248:251], v94 offset:6144
  v_mfma_f32_32x32x16_bf16 v[144:159], v[108:111], a[188:191], v[144:159]
  s_add_u32 m0, s23, 4096
  s_add_u32 s24, s24, 18432
  buffer_load_dwordx4 v6, s[12:15], s24 offen lds
  ds_read_b128 v[252:255], v94 offset:7168
  s_waitcnt lgkmcnt(6)
  v_mfma_f32_32x32x16_bf16 v[128:143], v[96:99], a[192:195], v[128:143]
  ds_read_b64_tr_b16 v[104:105], v3 offset:32768
  ds_read_b64_tr_b16 v[106:107], v3 offset:34816
  v_mfma_f32_32x32x16_bf16 v[144:159], v[96:99], a[196:199], v[144:159]
  s_add_u32 m0, s23, 8192
  s_add_u32 s24, s24, 18432
  buffer_load_dwordx4 v6, s[12:15], s24 offen lds
  s_waitcnt vmcnt(9)
  s_barrier
  s_waitcnt lgkmcnt(4)
  v_mfma_f32_32x32x16_bf16 v[128:143], v[100:103], a[200:203], v[128:143]
  ds_read_b64_tr_b16 v[108:109], v91 offset:0
  ds_read_b64_tr_b16 v[110:111], v91 offset:2048
  v_mfma_f32_32x32x16_bf16 v[144:159], v[100:103], a[204:207], v[144:159]
  s_add_u32 m0, s23, 12288
  s_add_u32 s24, s24, 18432
  buffer_load_dwordx4 v6, s[12:15], s24 offen lds
  s_waitcnt lgkmcnt(2)
  v_mfma_f32_32x32x16_bf16 v[128:143], v[104:107], a[208:211], v[128:143]
  ds_read_b64_tr_b16 v[96:97], v91 offset:4096
  ds_read_b64_tr_b16 v[98:99], v91 offset:6144
  v_mfma_f32_32x32x16_bf16 v[144:159], v[104:107], a[212:215], v[144:159]
  s_add_u32 m0, s23, 16384
  s_add_u32 s24, s24, 18432
  buffer_load_dwordx4 v6, s[12:15], s24 offen lds
  s_waitcnt lgkmcnt(2)
  v_mfma_f32_32x32x16_bf16 v[128:143], v[108:111], a[216:219], v[128:143]
  ds_read_b64_tr_b16 v[100:101], v91 offset:8192
  ds_read_b64_tr_b16 v[102:103], v91 offset:10240
  v_mfma_f32_32x32x16_bf16 v[144:159], v[108:111], a[220:223], v[144:159]
  s_add_u32 m0, s23, 20480
  s_add_u32 s24, s24, 18432
  buffer_load_dwordx4 v6, s[12:15], s24 offen lds
  s_waitcnt vmcnt(9)
  s_barrier
  s_waitcnt lgkmcnt(2)
  v_mfma_f32_32x32x16_bf16 v[128:143], v[96:99], a[224:227], v[128:143]
  ds_read_b64_tr_b16 v[104:105], v91 offset:12288
  ds_read_b64_tr_b16 v[106:107], v91 offset:14336
  v_mfma_f32_32x32x16_bf16 v[144:159], v[96:99], a[228:231], v[144:159]
  s_add_u32 m0, s23, 24576
  s_add_u32 s24, s24, 18432
  buffer_load_dwordx4 v6, s[12:15], s24 offen lds
  s_waitcnt lgkmcnt(2)
  v_mfma_f32_32x32x16_bf16 v[128:143], v[100:103], a[232:235], v[128:143]
  ds_read_b64_tr_b16 v[108:109], v91 offset:16384
  ds_read_b64_tr_b16 v[110:111], v91 offset:18432
  v_mfma_f32_32x32x16_bf16 v[144:159], v[100:103], a[236:239], v[144:159]
  s_add_u32 m0, s23, 28672
  s_add_u32 s24, s24, 18432
  buffer_load_dwordx4 v6, s[12:15], s24 offen lds
  s_waitcnt lgkmcnt(2)
  v_mfma_f32_32x32x16_bf16 v[128:143], v[104:107], a[240:243], v[128:143]
  ds_read_b64_tr_b16 v[96:97], v91 offset:20480
  ds_read_b64_tr_b16 v[98:99], v91 offset:22528
  v_mfma_f32_32x32x16_bf16 v[144:159], v[104:107], a[244:247], v[144:159]
  s_add_u32 m0, s23, 32768
  s_add_u32 s24, s24, 18432
  buffer_load_dwordx4 v6, s[12:15], s24 offen lds
  s_waitcnt vmcnt(9)
  s_barrier
  s_waitcnt lgkmcnt(2)
  v_mfma_f32_32x32x16_bf16 v[128:143], v[108:111], a[248:251], v[128:143]
  ds_read_b64_tr_b16 v[100:101], v91 offset:24576
  ds_read_b64_tr_b16 v[102:103], v91 offset:26624
  v_mfma_f32_32x32x16_bf16 v[144:159], v[108:111], a[252:255], v[144:159]
  s_add_u32 m0, s23, 36864
  s_add_u32 s24, s24, 18432
  buffer_load_dwordx4 v6, s[12:15], s24 offen lds
  s_waitcnt lgkmcnt(2)
  v_mfma_f32_32x32x16_bf16 v[128:143], v[96:99], v[224:227], v[128:143]
  ds_read_b64_tr_b16 v[104:105], v91 offset:28672
  ds_read_b64_tr_b16 v[106:107], v91 offset:30720
  v_mfma_f32_32x32x16_bf16 v[144:159], v[96:99], v[228:231], v[144:159]
  s_add_u32 m0, s23, 40960
  s_add_u32 s24, s24, 18432
  buffer_load_dwordx4 v6, s[12:15], s24 offen lds
  s_waitcnt lgkmcnt(2)
  v_mfma_f32_32x32x16_bf16 v[128:143], v[100:103], v[232:235], v[128:143]
  ds_read_b64_tr_b16 v[108:109], v91 offset:32768
  ds_read_b64_tr_b16 v[110:111], v91 offset:34816
  v_mfma_f32_32x32x16_bf16 v[144:159], v[100:103], v[236:239], v[144:159]
  s_add_u32 m0, s23, 45056
  s_add_u32 s24, s24, 18432
  buffer_load_dwordx4 v6, s[12:15], s24 offen lds
  s_waitcnt vmcnt(9)
  s_barrier
  s_waitcnt lgkmcnt(2)
  v_mfma_f32_32x32x16_bf16 v[128:143], v[104:107], v[240:243], v[128:143]
  ds_read_b64_tr_b16 v[96:97], v3 offset:0
  ds_read_b64_tr_b16 v[98:99], v3 offset:2048
  v_mfma_f32_32x32x16_bf16 v[144:159], v[104:107], v[244:247], v[144:159]
  s_add_u32 m0, s23, 49152
  s_add_u32 s24, s24, 18432
  buffer_load_dwordx4 v6, s[12:15], s24 offen lds
  s_waitcnt lgkmcnt(2)
  v_mfma_f32_32x32x16_bf16 v[128:143], v[108:111], v[248:251], v[128:143]
  ds_read_b64_tr_b16 v[100:101], v3 offset:4096
  ds_read_b64_tr_b16 v[102:103], v3 offset:6144
  v_mfma_f32_32x32x16_bf16 v[144:159], v[108:111], v[252:255], v[144:159]
  s_add_u32 m0, s23, 53248
  s_add_u32 s24, s24, 18432
  buffer_load_dwordx4 v6, s[12:15], s24 offen lds
  s_waitcnt lgkmcnt(2)
  v_mfma_f32_32x32x16_bf16 v[160:175], v[96:99], a[0:3], 0
  ds_read_b64_tr_b16 v[104:105], v3 offset:8192
  ds_read_b64_tr_b16 v[106:107], v3 offset:10240
  v_mfma_f32_32x32x16_bf16 v[176:191], v[96:99], a[4:7], 0
  s_add_u32 m0, s23, 57344
  s_add_u32 s24, s24, 18432
  buffer_load_dwordx4 v6, s[12:15], s24 offen lds
  s_waitcnt vmcnt(9)
  s_barrier
  s_waitcnt lgkmcnt(2)
  v_mfma_f32_32x32x16_bf16 v[160:175], v[100:103], a[8:11], v[160:175]
  ds_read_b64_tr_b16 v[108:109], v3 offset:12288
  ds_read_b64_tr_b16 v[110:111], v3 offset:14336
  v_mfma_f32_32x32x16_bf16 v[176:191], v[100:103], a[12:15], v[176:191]
  s_add_u32 m0, s23, 61440
  s_add_u32 s24, s24, 18432
  buffer_load_dwordx4 v6, s[12:15], s24 offen lds
  s_waitcnt lgkmcnt(2)
  v_mfma_f32_32x32x16_bf16 v[160:175], v[104:107], a[16:19], v[160:175]
  ds_read_b64_tr_b16 v[96:97], v3 offset:16384
  ds_read_b64_tr_b16 v[98:99], v3 offset:18432
  v_mfma_f32_32x32x16_bf16 v[176:191], v[104:107], a[20:23], v[176:191]
  s_add_u32 m0, s23, 65536
  s_add_u32 s24, s24, 18432
  buffer_load_dwordx4 v6, s[12:15], s24 offen lds
  s_waitcnt lgkmcnt(2)
  v_mfma_f32_32x32x16_bf16 v[160:175], v[108:111], a[24:27], v[160:175]
  ds_read_b64_tr_b16 v[100:101], v3 offset:20480
  ds_read_b64_tr_b16 v[102:103], v3 offset:22528
  v_cvt_pk_bf16_f32 v64, v128, v129
  v_cvt_pk_bf16_f32 v65, v130, v131
  v_mfma_f32_32x32x16_bf16 v[176:191], v[108:111], a[28:31], v[176:191]
  s_add_u32 m0, s23, 69632
  s_add_u32 s24, s24, 18432
  buffer_load_dwordx4 v6, s[12:15], s24 offen lds
  v_cvt_pk_bf16_f32 v66, v132, v133
  v_cvt_pk_bf16_f32 v67, v134, v135
  s_waitcnt vmcnt(9)
  s_barrier
  s_waitcnt lgkmcnt(2)
  v_mfma_f32_32x32x16_bf16 v[160:175], v[96:99], a[32:35], v[160:175]
  ds_read_b64_tr_b16 v[104:105], v3 offset:24576
  ds_read_b64_tr_b16 v[106:107], v3 offset:26624
  v_cvt_pk_bf16_f32 v68, v136, v137
  v_cvt_pk_bf16_f32 v69, v138, v139
  v_mfma_f32_32x32x16_bf16 v[176:191], v[96:99], a[36:39], v[176:191]
  s_add_u32 m0, s23, 0
  s_add_u32 s24, s24, 18432
  buffer_load_dwordx4 v6, s[12:15], s24 offen lds
  v_cvt_pk_bf16_f32 v70, v140, v141
  v_cvt_pk_bf16_f32 v71, v142, v143
  s_waitcnt lgkmcnt(2)
  v_mfma_f32_32x32x16_bf16 v[160:175], v[100:103], a[40:43], v[160:175]
  ds_read_b64_tr_b16 v[108:109], v3 offset:28672
  ds_read_b64_tr_b16 v[110:111], v3 offset:30720
  buffer_store_dwordx4 v[64:67], v9, s[16:19], s27 offen offset:0 sc1
  buffer_store_dwordx4 v[68:71], v9, s[16:19], s27 offen offset:1024 sc1
  v_mfma_f32_32x32x16_bf16 v[176:191], v[100:103], a[44:47], v[176:191]
  s_add_u32 m0, s23, 4096
  s_add_u32 s24, s24, 18432
  buffer_load_dwordx4 v6, s[12:15], s24 offen lds
  v_cvt_pk_bf16_f32 v72, v144, v145
  v_cvt_pk_bf16_f32 v73, v146, v147
  s_waitcnt lgkmcnt(2)
  v_mfma_f32_32x32x16_bf16 v[160:175], v[104:107], a[48:51], v[160:175]
  ds_read_b64_tr_b16 v[96:97], v3 offset:32768
  ds_read_b64_tr_b16 v[98:99], v3 offset:34816
  v_cvt_pk_bf16_f32 v74, v148, v149
  v_cvt_pk_bf16_f32 v75, v150, v151
  v_mfma_f32_32x32x16_bf16 v[176:191], v[104:107], a[52:55], v[176:191]
  s_add_u32 m0, s23, 8192
  s_add_u32 s24, s24, 18432
  buffer_load_dwordx4 v6, s[12:15], s24 offen lds
  v_cvt_pk_bf16_f32 v76, v152, v153
  v_cvt_pk_bf16_f32 v77, v154, v155
  s_waitcnt vmcnt(11)
  s_barrier
  s_waitcnt lgkmcnt(2)
  v_mfma_f32_32x32x16_bf16 v[160:175], v[108:111], a[56:59], v[160:175]
  ds_read_b64_tr_b16 v[100:101], v91 offset:0
  ds_read_b64_tr_b16 v[102:103], v91 offset:2048
  v_cvt_pk_bf16_f32 v78, v156, v157
  v_cvt_pk_bf16_f32 v79, v158, v159
  v_mfma_f32_32x32x16_bf16 v[176:191], v[108:111], a[60:63], v[176:191]
  s_add_u32 m0, s23, 12288
  s_add_u32 s24, s24, 18432
  buffer_load_dwordx4 v6, s[12:15], s24 offen lds
  buffer_store_dwordx4 v[72:75], v9, s[16:19], s27 offen offset:2048 sc1
  buffer_store_dwordx4 v[76:79], v9, s[16:19], s27 offen offset:3072 sc1
  s_waitcnt lgkmcnt(2)
  v_mfma_f32_32x32x16_bf16 v[160:175], v[96:99], a[64:67], v[160:175]
  ds_read_b64_tr_b16 v[104:105], v91 offset:4096
  ds_read_b64_tr_b16 v[106:107], v91 offset:6144
  s_add_u32 s27, s27, 0x4000
  v_mfma_f32_32x32x16_bf16 v[176:191], v[96:99], a[68:71], v[176:191]
  s_add_u32 m0, s23, 16384
  s_add_u32 s24, s24, 18432
  buffer_load_dwordx4 v6, s[12:15], s24 offen lds
  s_waitcnt lgkmcnt(2)
  v_mfma_f32_32x32x16_bf16 v[160:175], v[100:103], a[72:75], v[160:175]
  ds_read_b64_tr_b16 v[108:109], v91 offset:8192
  ds_read_b64_tr_b16 v[110:111], v91 offset:10240
  v_mfma_f32_32x32x16_bf16 v[176:191], v[100:103], a[76:79], v[176:191]
  s_add_u32 m0, s23, 20480
  s_add_u32 s24, s24, 18432
  buffer_load_dwordx4 v6, s[12:15], s24 offen lds
  s_waitcnt vmcnt(13)
  s_barrier
  s_waitcnt lgkmcnt(2)
  v_mfma_f32_32x32x16_bf16 v[160:175], v[104:107], a[80:83], v[160:175]
  ds_read_b64_tr_b16 v[96:97], v91 offset:12288
  ds_read_b64_tr_b16 v[98:99], v91 offset:14336
  v_mfma_f32_32x32x16_bf16 v[176:191], v[104:107], a[84:87], v[176:191]
  s_add_u32 m0, s23, 24576
  s_add_u32 s24, s24, 18432
  buffer_load_dwordx4 v6, s[12:15], s24 offen lds
  s_waitcnt lgkmcnt(2)
  v_mfma_f32_32x32x16_bf16 v[160:175], v[108:111], a[88:91], v[160:175]
  ds_read_b64_tr_b16 v[100:101], v91 offset:16384
  ds_read_b64_tr_b16 v[102:103], v91 offset:18432
  v_mfma_f32_32x32x16_bf16 v[176:191], v[108:111], a[92:95], v[176:191]
  s_add_u32 m0, s23, 28672
  s_add_u32 s24, s24, 18432
  buffer_load_dwordx4 v6, s[12:15], s24 offen lds
  s_waitcnt lgkmcnt(2)
  v_mfma_f32_32x32x16_bf16 v[160:175], v[96:99], a[96:99], v[160:175]
  ds_read_b64_tr_b16 v[104:105], v91 offset:20480
  ds_read_b64_tr_b16 v[106:107], v91 offset:22528
  v_mfma_f32_32x32x16_bf16 v[176:191], v[96:99], a[100:103], v[176:191]
  s_add_u32 m0, s23, 32768
  s_add_u32 s24, s24, 18432
  buffer_load_dwordx4 v6, s[12:15], s24 offen lds
  s_waitcnt vmcnt(13)
  s_barrier
  s_waitcnt lgkmcnt(2)
  v_mfma_f32_32x32x16_bf16 v[160:175], v[100:103], a[104:107], v[160:175]
  ds_read_b64_tr_b16 v[108:109], v91 offset:24576
  ds_read_b64_tr_b16 v[110:111], v91 offset:26624
  v_mfma_f32_32x32x16_bf16 v[176:191], v[100:103], a[108:111], v[176:191]
  s_add_u32 m0, s23, 36864
  s_add_u32 s24, s24, 18432
  buffer_load_dwordx4 v6, s[12:15], s24 offen lds
  s_waitcnt lgkmcnt(2)
  v_mfma_f32_32x32x16_bf16 v[160:175], v[104:107], a[112:115], v[160:175]
  ds_read_b64_tr_b16 v[96:97], v91 offset:28672
  ds_read_b64_tr_b16 v[98:99], v91 offset:30720
  v_mfma_f32_32x32x16_bf16 v[176:191], v[104:107], a[116:119], v[176:191]
  s_add_u32 m0, s23, 40960
  s_add_u32 s24, s24, 18432
  buffer_load_dwordx4 v6, s[12:15], s24 offen lds
  s_waitcnt lgkmcnt(2)
  v_mfma_f32_32x32x16_bf16 v[160:175], v[108:111], a[120:123], v[160:175]
  ds_read_b64_tr_b16 v[100:101], v91 offset:32768
  ds_read_b64_tr_b16 v[102:103], v91 offset:34816
  v_mfma_f32_32x32x16_bf16 v[176:191], v[108:111], a[124:127], v[176:191]
  s_add_u32 m0, s23, 45056
  s_add_u32 s24, s24, 18432
  buffer_load_dwordx4 v6, s[12:15], s24 offen lds
  s_waitcnt vmcnt(11)
  s_barrier
  s_waitcnt lgkmcnt(2)
  v_mfma_f32_32x32x16_bf16 v[160:175], v[96:99], a[128:131], v[160:175]
  ds_read_b64_tr_b16 v[104:105], v3 offset:0
  ds_read_b64_tr_b16 v[106:107], v3 offset:2048
  v_mfma_f32_32x32x16_bf16 v[176:191], v[96:99], a[132:135], v[176:191]
  s_add_u32 m0, s23, 49152
  s_add_u32 s24, s24, 18432
  buffer_load_dwordx4 v6, s[12:15], s24 offen lds
  s_waitcnt lgkmcnt(2)
  v_mfma_f32_32x32x16_bf16 v[160:175], v[100:103], a[136:139], v[160:175]
  ds_read_b64_tr_b16 v[108:109], v3 offset:4096
  ds_read_b64_tr_b16 v[110:111], v3 offset:6144
  v_mfma_f32_32x32x16_bf16 v[176:191], v[100:103], a[140:143], v[176:191]
  s_add_u32 m0, s23, 53248
  s_add_u32 s24, s24, 18432
  buffer_load_dwordx4 v6, s[12:15], s24 offen lds
  s_waitcnt lgkmcnt(2)
  v_mfma_f32_32x32x16_bf16 v[160:175], v[104:107], a[144:147], v[160:175]
  ds_read_b64_tr_b16 v[96:97], v3 offset:8192
  ds_read_b64_tr_b16 v[98:99], v3 offset:10240
  v_mfma_f32_32x32x16_bf16 v[176:191], v[104:107], a[148:151], v[176:191]
  s_add_u32 m0, s23, 57344
  s_add_u32 s24, s24, 18432
  buffer_load_dwordx4 v6, s[12:15], s24 offen lds
  s_waitcnt vmcnt(9)
  s_barrier
  s_waitcnt lgkmcnt(2)
  v_mfma_f32_32x32x16_bf16 v[160:175], v[108:111], a[152:155], v[160:175]
  ds_read_b64_tr_b16 v[100:101], v3 offset:12288
  ds_read_b64_tr_b16 v[102:103], v3 offset:14336
  v_mfma_f32_32x32x16_bf16 v[176:191], v[108:111], a[156:159], v[176:191]
  s_add_u32 m0, s23, 61440
  s_add_u32 s24, s24, 18432
  buffer_load_dwordx4 v6, s[12:15], s24 offen lds
  s_waitcnt lgkmcnt(2)
  v_mfma_f32_32x32x16_bf16 v[160:175], v[96:99], a[160:163], v[160:175]
  ds_read_b64_tr_b16 v[104:105], v3 offset:16384
  ds_read_b64_tr_b16 v[106:107], v3 offset:18432
  v_mfma_f32_32x32x16_bf16 v[176:191], v[96:99], a[164:167], v[176:191]
  s_add_u32 m0, s23, 65536
  s_add_u32 s24, s24, 18432
  buffer_load_dwordx4 v6, s[12:15], s24 offen lds
  s_waitcnt lgkmcnt(2)
  v_mfma_f32_32x32x16_bf16 v[160:175], v[100:103], a[168:171], v[160:175]
  ds_read_b64_tr_b16 v[108:109], v3 offset:20480
  ds_read_b64_tr_b16 v[110:111], v3 offset:22528
  v_mfma_f32_32x32x16_bf16 v[176:191], v[100:103], a[172:175], v[176:191]
  s_add_u32 m0, s23, 69632
  s_add_u32 s24, s24, 18432
  buffer_load_dwordx4 v6, s[12:15], s24 offen lds
  s_waitcnt vmcnt(9)
  s_barrier
  s_waitcnt lgkmcnt(2)
  v_mfma_f32_32x32x16_bf16 v[160:175], v[104:107], a[176:179], v[160:175]
  ds_read_b64_tr_b16 v[96:97], v3 offset:24576
  ds_read_b64_tr_b16 v[98:99], v3 offset:26624
  v_mfma_f32_32x32x16_bf16 v[176:191], v[104:107], a[180:183], v[176:191]
  s_add_u32 m0, s23, 0
  s_sub_u32 s24, s24, 644864
  buffer_load_dwordx4 v6, s[12:15], s24 offen lds
  s_waitcnt lgkmcnt(2)
  v_mfma_f32_32x32x16_bf16 v[160:175], v[108:111], a[184:187], v[160:175]
  ds_read_b64_tr_b16 v[100:101], v3 offset:28672
  ds_read_b64_tr_b16 v[102:103], v3 offset:30720
  v_mfma_f32_32x32x16_bf16 v[176:191], v[108:111], a[188:191], v[176:191]
  s_add_u32 m0, s23, 4096
  s_add_u32 s24, s24, 18432
  buffer_load_dwordx4 v6, s[12:15], s24 offen lds
  s_waitcnt lgkmcnt(2)
  v_mfma_f32_32x32x16_bf16 v[160:175], v[96:99], a[192:195], v[160:175]
  ds_read_b64_tr_b16 v[104:105], v3 offset:32768
  ds_read_b64_tr_b16 v[106:107], v3 offset:34816
  v_mfma_f32_32x32x16_bf16 v[176:191], v[96:99], a[196:199], v[176:191]
  s_add_u32 m0, s23, 8192
  s_add_u32 s24, s24, 18432
  buffer_load_dwordx4 v6, s[12:15], s24 offen lds
  s_waitcnt vmcnt(9)
  s_barrier
  s_waitcnt lgkmcnt(2)
  v_mfma_f32_32x32x16_bf16 v[160:175], v[100:103], a[200:203], v[160:175]
  ds_read_b64_tr_b16 v[108:109], v91 offset:0
  ds_read_b64_tr_b16 v[110:111], v91 offset:2048
  v_mfma_f32_32x32x16_bf16 v[176:191], v[100:103], a[204:207], v[176:191]
  s_add_u32 m0, s23, 12288
  s_add_u32 s24, s24, 18432
  buffer_load_dwordx4 v6, s[12:15], s24 offen lds
  s_waitcnt lgkmcnt(2)
  v_mfma_f32_32x32x16_bf16 v[160:175], v[104:107], a[208:211], v[160:175]
  ds_read_b64_tr_b16 v[96:97], v91 offset:4096
  ds_read_b64_tr_b16 v[98:99], v91 offset:6144
  v_mfma_f32_32x32x16_bf16 v[176:191], v[104:107], a[212:215], v[176:191]
  s_add_u32 m0, s23, 16384
  s_add_u32 s24, s24, 18432
  buffer_load_dwordx4 v6, s[12:15], s24 offen lds
  s_waitcnt lgkmcnt(2)
  v_mfma_f32_32x32x16_bf16 v[160:175], v[108:111], a[216:219], v[160:175]
  ds_read_b64_tr_b16 v[100:101], v91 offset:8192
  ds_read_b64_tr_b16 v[102:103], v91 offset:10240
  v_mfma_f32_32x32x16_bf16 v[176:191], v[108:111], a[220:223], v[176:191]
  s_add_u32 m0, s23, 20480
  s_add_u32 s24, s24, 18432
  buffer_load_dwordx4 v6, s[12:15], s24 offen lds
  s_waitcnt vmcnt(9)
  s_barrier
  s_waitcnt lgkmcnt(2)
  v_mfma_f32_32x32x16_bf16 v[160:175], v[96:99], a[224:227], v[160:175]
  ds_read_b64_tr_b16 v[104:105], v91 offset:12288
  ds_read_b64_tr_b16 v[106:107], v91 offset:14336
  v_mfma_f32_32x32x16_bf16 v[176:191], v[96:99], a[228:231], v[176:191]
  s_add_u32 m0, s23, 24576
  s_add_u32 s24, s24, 18432
  buffer_load_dwordx4 v6, s[12:15], s24 offen lds
  s_waitcnt lgkmcnt(2)
  v_mfma_f32_32x32x16_bf16 v[160:175], v[100:103], a[232:235], v[160:175]
  ds_read_b64_tr_b16 v[108:109], v91 offset:16384
  ds_read_b64_tr_b16 v[110:111], v91 offset:18432
  v_mfma_f32_32x32x16_bf16 v[176:191], v[100:103], a[236:239], v[176:191]
  s_add_u32 m0, s23, 28672
  s_add_u32 s24, s24, 18432
  buffer_load_dwordx4 v6, s[12:15], s24 offen lds
  s_waitcnt lgkmcnt(2)
  v_mfma_f32_32x32x16_bf16 v[160:175], v[104:107], a[240:243], v[160:175]
  ds_read_b64_tr_b16 v[96:97], v91 offset:20480
  ds_read_b64_tr_b16 v[98:99], v91 offset:22528
  v_mfma_f32_32x32x16_bf16 v[176:191], v[104:107], a[244:247], v[176:191]
  s_add_u32 m0, s23, 32768
  s_add_u32 s24, s24, 18432
  buffer_load_dwordx4 v6, s[12:15], s24 offen lds
  s_waitcnt vmcnt(9)
  s_barrier
  s_waitcnt lgkmcnt(2)
  v_mfma_f32_32x32x16_bf16 v[160:175], v[108:111], a[248:251], v[160:175]
  ds_read_b64_tr_b16 v[100:101], v91 offset:24576
  ds_read_b64_tr_b16 v[102:103], v91 offset:26624
  v_mfma_f32_32x32x16_bf16 v[176:191], v[108:111], a[252:255], v[176:191]
  s_add_u32 m0, s23, 36864
  s_add_u32 s24, s24, 18432
  buffer_load_dwordx4 v6, s[12:15], s24 offen lds
  s_waitcnt lgkmcnt(2)
  v_mfma_f32_32x32x16_bf16 v[160:175], v[96:99], v[224:227], v[160:175]
  ds_read_b64_tr_b16 v[104:105], v91 offset:28672
  ds_read_b64_tr_b16 v[106:107], v91 offset:30720
  v_mfma_f32_32x32x16_bf16 v[176:191], v[96:99], v[228:231], v[176:191]
  s_add_u32 m0, s23, 40960
  s_add_u32 s24, s24, 18432
  buffer_load_dwordx4 v6, s[12:15], s24 offen lds
  s_waitcnt lgkmcnt(2)
  v_mfma_f32_32x32x16_bf16 v[160:175], v[100:103], v[232:235], v[160:175]
  ds_read_b64_tr_b16 v[108:109], v91 offset:32768
  ds_read_b64_tr_b16 v[110:111], v91 offset:34816
  v_mfma_f32_32x32x16_bf16 v[176:191], v[100:103], v[236:239], v[176:191]
  s_add_u32 m0, s23, 45056
  s_add_u32 s24, s24, 18432
  buffer_load_dwordx4 v6, s[12:15], s24 offen lds
  s_waitcnt vmcnt(9)
  s_barrier
  s_waitcnt lgkmcnt(2)
  v_mfma_f32_32x32x16_bf16 v[160:175], v[104:107], v[240:243], v[160:175]
  ds_read_b64_tr_b16 v[96:97], v3 offset:0
  ds_read_b64_tr_b16 v[98:99], v3 offset:2048
  v_mfma_f32_32x32x16_bf16 v[176:191], v[104:107], v[244:247], v[176:191]
  s_add_u32 m0, s23, 49152
  s_add_u32 s24, s24, 18432
  buffer_load_dwordx4 v6, s[12:15], s24 offen lds
  s_waitcnt lgkmcnt(2)
  v_mfma_f32_32x32x16_bf16 v[160:175], v[108:111], v[248:251], v[160:175]
  ds_read_b64_tr_b16 v[100:101], v3 offset:4096
  ds_read_b64_tr_b16 v[102:103], v3 offset:6144
  v_mfma_f32_32x32x16_bf16 v[176:191], v[108:111], v[252:255], v[176:191]
  s_add_u32 m0, s23, 53248
  s_add_u32 s24, s24, 18432
  buffer_load_dwordx4 v6, s[12:15], s24 offen lds
  s_waitcnt lgkmcnt(2)
  v_mfma_f32_32x32x16_bf16 v[128:143], v[96:99], a[0:3], 0
  ds_read_b64_tr_b16 v[104:105], v3 offset:8192
  ds_read_b64_tr_b16 v[106:107], v3 offset:10240
  v_mfma_f32_32x32x16_bf16 v[144:159], v[96:99], a[4:7], 0
  s_add_u32 m0, s23, 57344
  s_add_u32 s24, s24, 18432
  buffer_load_dwordx4 v6, s[12:15], s24 offen lds
  s_waitcnt vmcnt(9)
  s_barrier
  s_waitcnt lgkmcnt(2)
  v_mfma_f32_32x32x16_bf16 v[128:143], v[100:103], a[8:11], v[128:143]
  ds_read_b64_tr_b16 v[108:109], v3 offset:12288
  ds_read_b64_tr_b16 v[110:111], v3 offset:14336
  v_mfma_f32_32x32x16_bf16 v[144:159], v[100:103], a[12:15], v[144:159]
  s_add_u32 m0, s23, 61440
  s_add_u32 s24, s24, 18432
  buffer_load_dwordx4 v6, s[12:15], s24 offen lds
  s_waitcnt lgkmcnt(2)
  v_mfma_f32_32x32x16_bf16 v[128:143], v[104:107], a[16:19], v[128:143]
  ds_read_b64_tr_b16 v[96:97], v3 offset:16384
  ds_read_b64_tr_b16 v[98:99], v3 offset:18432
  v_mfma_f32_32x32x16_bf16 v[144:159], v[104:107], a[20:23], v[144:159]
  s_add_u32 m0, s23, 65536
  s_add_u32 s24, s24, 18432
  buffer_load_dwordx4 v6, s[12:15], s24 offen lds
  s_waitcnt lgkmcnt(2)
  v_mfma_f32_32x32x16_bf16 v[128:143], v[108:111], a[24:27], v[128:143]
  ds_read_b64_tr_b16 v[100:101], v3 offset:20480
  ds_read_b64_tr_b16 v[102:103], v3 offset:22528
  v_cvt_pk_bf16_f32 v64, v160, v161
  v_cvt_pk_bf16_f32 v65, v162, v163
  v_mfma_f32_32x32x16_bf16 v[144:159], v[108:111], a[28:31], v[144:159]
  s_add_u32 m0, s23, 69632
  s_add_u32 s24, s24, 18432
  buffer_load_dwordx4 v6, s[12:15], s24 offen lds
  v_cvt_pk_bf16_f32 v66, v164, v165
  v_cvt_pk_bf16_f32 v67, v166, v167
  s_waitcnt vmcnt(9)
  s_barrier
  s_waitcnt lgkmcnt(2)
  v_mfma_f32_32x32x16_bf16 v[128:143], v[96:99], a[32:35], v[128:143]
  ds_read_b64_tr_b16 v[104:105], v3 offset:24576
  ds_read_b64_tr_b16 v[106:107], v3 offset:26624
  v_cvt_pk_bf16_f32 v68, v168, v169
  v_cvt_pk_bf16_f32 v69, v170, v171
  v_mfma_f32_32x32x16_bf16 v[144:159], v[96:99], a[36:39], v[144:159]
  s_add_u32 m0, s23, 0
  s_add_u32 s24, s24, 18432
  buffer_load_dwordx4 v6, s[12:15], s24 offen lds
  v_cvt_pk_bf16_f32 v70, v172, v173
  v_cvt_pk_bf16_f32 v71, v174, v175
  s_waitcnt lgkmcnt(2)
  v_mfma_f32_32x32x16_bf16 v[128:143], v[100:103], a[40:43], v[128:143]
  ds_read_b64_tr_b16 v[108:109], v3 offset:28672
  ds_read_b64_tr_b16 v[110:111], v3 offset:30720
  buffer_store_dwordx4 v[64:67], v9, s[16:19], s27 offen offset:0 sc1
  buffer_store_dwordx4 v[68:71], v9, s[16:19], s27 offen offset:1024 sc1
  v_mfma_f32_32x32x16_bf16 v[144:159], v[100:103], a[44:47], v[144:159]
  s_add_u32 m0, s23, 4096
  s_add_u32 s24, s24, 18432
  buffer_load_dwordx4 v6, s[12:15], s24 offen lds
  v_cvt_pk_bf16_f32 v72, v176, v177
  v_cvt_pk_bf16_f32 v73, v178, v179
  s_waitcnt lgkmcnt(2)
  v_mfma_f32_32x32x16_bf16 v[128:143], v[104:107], a[48:51], v[128:143]
  ds_read_b64_tr_b16 v[96:97], v3 offset:32768
  ds_read_b64_tr_b16 v[98:99], v3 offset:34816
  v_cvt_pk_bf16_f32 v74, v180, v181
  v_cvt_pk_bf16_f32 v75, v182, v183
  v_mfma_f32_32x32x16_bf16 v[144:159], v[104:107], a[52:55], v[144:159]
  s_add_u32 m0, s23, 8192
  s_add_u32 s24, s24, 18432
  buffer_load_dwordx4 v6, s[12:15], s24 offen lds
  v_cvt_pk_bf16_f32 v76, v184, v185
  v_cvt_pk_bf16_f32 v77, v186, v187
  s_waitcnt vmcnt(11)
  s_barrier
  s_waitcnt lgkmcnt(2)
  v_mfma_f32_32x32x16_bf16 v[128:143], v[108:111], a[56:59], v[128:143]
  ds_read_b64_tr_b16 v[100:101], v91 offset:0
  ds_read_b64_tr_b16 v[102:103], v91 offset:2048
  v_cvt_pk_bf16_f32 v78, v188, v189
  v_cvt_pk_bf16_f32 v79, v190, v191
  v_mfma_f32_32x32x16_bf16 v[144:159], v[108:111], a[60:63], v[144:159]
  s_add_u32 m0, s23, 12288
  s_add_u32 s24, s24, 18432
  buffer_load_dwordx4 v6, s[12:15], s24 offen lds
  buffer_store_dwordx4 v[72:75], v9, s[16:19], s27 offen offset:2048 sc1
  buffer_store_dwordx4 v[76:79], v9, s[16:19], s27 offen offset:3072 sc1
  s_waitcnt lgkmcnt(2)
  v_mfma_f32_32x32x16_bf16 v[128:143], v[96:99], a[64:67], v[128:143]
  ds_read_b64_tr_b16 v[104:105], v91 offset:4096
  ds_read_b64_tr_b16 v[106:107], v91 offset:6144
  s_add_u32 s27, s27, 0x4000
  v_mfma_f32_32x32x16_bf16 v[144:159], v[96:99], a[68:71], v[144:159]
  s_add_u32 m0, s23, 16384
  s_add_u32 s24, s24, 18432
  buffer_load_dwordx4 v6, s[12:15], s24 offen lds
  s_waitcnt lgkmcnt(2)
  v_mfma_f32_32x32x16_bf16 v[128:143], v[100:103], a[72:75], v[128:143]
  ds_read_b64_tr_b16 v[108:109], v91 offset:8192
  ds_read_b64_tr_b16 v[110:111], v91 offset:10240
  v_mfma_f32_32x32x16_bf16 v[144:159], v[100:103], a[76:79], v[144:159]
  s_add_u32 m0, s23, 20480
  s_add_u32 s24, s24, 18432
  buffer_load_dwordx4 v6, s[12:15], s24 offen lds
  s_waitcnt vmcnt(13)
  s_barrier
  s_waitcnt lgkmcnt(2)
  v_mfma_f32_32x32x16_bf16 v[128:143], v[104:107], a[80:83], v[128:143]
  ds_read_b64_tr_b16 v[96:97], v91 offset:12288
  ds_read_b64_tr_b16 v[98:99], v91 offset:14336
  v_mfma_f32_32x32x16_bf16 v[144:159], v[104:107], a[84:87], v[144:159]
  s_add_u32 m0, s23, 24576
  s_add_u32 s24, s24, 18432
  buffer_load_dwordx4 v6, s[12:15], s24 offen lds
  s_waitcnt lgkmcnt(2)
  v_mfma_f32_32x32x16_bf16 v[128:143], v[108:111], a[88:91], v[128:143]
  ds_read_b64_tr_b16 v[100:101], v91 offset:16384
  ds_read_b64_tr_b16 v[102:103], v91 offset:18432
  v_mfma_f32_32x32x16_bf16 v[144:159], v[108:111], a[92:95], v[144:159]
  s_add_u32 m0, s23, 28672
  s_add_u32 s24, s24, 18432
  buffer_load_dwordx4 v6, s[12:15], s24 offen lds
  s_waitcnt lgkmcnt(2)
  v_mfma_f32_32x32x16_bf16 v[128:143], v[96:99], a[96:99], v[128:143]
  ds_read_b64_tr_b16 v[104:105], v91 offset:20480
  ds_read_b64_tr_b16 v[106:107], v91 offset:22528
  v_mfma_f32_32x32x16_bf16 v[144:159], v[96:99], a[100:103], v[144:159]
  s_add_u32 m0, s23, 32768
  s_add_u32 s24, s24, 18432
  buffer_load_dwordx4 v6, s[12:15], s24 offen lds
  s_waitcnt vmcnt(13)
  s_barrier
  s_waitcnt lgkmcnt(2)
  v_mfma_f32_32x32x16_bf16 v[128:143], v[100:103], a[104:107], v[128:143]
  ds_read_b64_tr_b16 v[108:109], v91 offset:24576
  ds_read_b64_tr_b16 v[110:111], v91 offset:26624
  v_mfma_f32_32x32x16_bf16 v[144:159], v[100:103], a[108:111], v[144:159]
  s_add_u32 m0, s23, 36864
  s_add_u32 s24, s24, 18432
  buffer_load_dwordx4 v6, s[12:15], s24 offen lds
  s_waitcnt lgkmcnt(2)
  v_mfma_f32_32x32x16_bf16 v[128:143], v[104:107], a[112:115], v[128:143]
  ds_read_b64_tr_b16 v[96:97], v91 offset:28672
  ds_read_b64_tr_b16 v[98:99], v91 offset:30720
  v_mfma_f32_32x32x16_bf16 v[144:159], v[104:107], a[116:119], v[144:159]
  s_add_u32 m0, s23, 40960
  s_add_u32 s24, s24, 18432
  buffer_load_dwordx4 v6, s[12:15], s24 offen lds
  s_waitcnt lgkmcnt(2)
  v_mfma_f32_32x32x16_bf16 v[128:143], v[108:111], a[120:123], v[128:143]
  ds_read_b64_tr_b16 v[100:101], v91 offset:32768
  ds_read_b64_tr_b16 v[102:103], v91 offset:34816
  v_mfma_f32_32x32x16_bf16 v[144:159], v[108:111], a[124:127], v[144:159]
  s_add_u32 m0, s23, 45056
  s_add_u32 s24, s24, 18432
  buffer_load_dwordx4 v6, s[12:15], s24 offen lds
  s_waitcnt vmcnt(11)
  s_barrier
  s_waitcnt lgkmcnt(2)
  v_mfma_f32_32x32x16_bf16 v[128:143], v[96:99], a[128:131], v[128:143]
  ds_read_b64_tr_b16 v[104:105], v3 offset:0
  ds_read_b64_tr_b16 v[106:107], v3 offset:2048
  v_mfma_f32_32x32x16_bf16 v[144:159], v[96:99], a[132:135], v[144:159]
  s_add_u32 m0, s23, 49152
  s_add_u32 s24, s24, 18432
  buffer_load_dwordx4 v6, s[12:15], s24 offen lds
  s_waitcnt lgkmcnt(2)
  v_mfma_f32_32x32x16_bf16 v[128:143], v[100:103], a[136:139], v[128:143]
  ds_read_b64_tr_b16 v[108:109], v3 offset:4096
  ds_read_b64_tr_b16 v[110:111], v3 offset:6144
  v_mfma_f32_32x32x16_bf16 v[144:159], v[100:103], a[140:143], v[144:159]
  s_add_u32 m0, s23, 53248
  s_add_u32 s24, s24, 18432
  buffer_load_dwordx4 v6, s[12:15], s24 offen lds
  s_waitcnt lgkmcnt(2)
  v_mfma_f32_32x32x16_bf16 v[128:143], v[104:107], a[144:147], v[128:143]
  ds_read_b64_tr_b16 v[96:97], v3 offset:8192
  ds_read_b64_tr_b16 v[98:99], v3 offset:10240
  v_mfma_f32_32x32x16_bf16 v[144:159], v[104:107], a[148:151], v[144:159]
  s_add_u32 m0, s23, 57344
  s_add_u32 s24, s24, 18432
  buffer_load_dwordx4 v6, s[12:15], s24 offen lds
  s_waitcnt vmcnt(9)
  s_barrier
  s_waitcnt lgkmcnt(2)
  v_mfma_f32_32x32x16_bf16 v[128:143], v[108:111], a[152:155], v[128:143]
  ds_read_b64_tr_b16 v[100:101], v3 offset:12288
  ds_read_b64_tr_b16 v[102:103], v3 offset:14336
  v_mfma_f32_32x32x16_bf16 v[144:159], v[108:111], a[156:159], v[144:159]
  s_add_u32 m0, s23, 61440
  s_add_u32 s24, s24, 18432
  buffer_load_dwordx4 v6, s[12:15], s24 offen lds
  s_waitcnt lgkmcnt(2)
  v_mfma_f32_32x32x16_bf16 v[128:143], v[96:99], a[160:163], v[128:143]
  ds_read_b64_tr_b16 v[104:105], v3 offset:16384
  ds_read_b64_tr_b16 v[106:107], v3 offset:18432
  v_mfma_f32_32x32x16_bf16 v[144:159], v[96:99], a[164:167], v[144:159]
  s_add_u32 m0, s23, 65536
  s_add_u32 s24, s24, 18432
  buffer_load_dwordx4 v6, s[12:15], s24 offen lds
  s_waitcnt lgkmcnt(2)
  v_mfma_f32_32x32x16_bf16 v[128:143], v[100:103], a[168:171], v[128:143]
  ds_read_b64_tr_b16 v[108:109], v3 offset:20480
  ds_read_b64_tr_b16 v[110:111], v3 offset:22528
  v_mfma_f32_32x32x16_bf16 v[144:159], v[100:103], a[172:175], v[144:159]
  s_add_u32 m0, s23, 69632
  s_add_u32 s24, s24, 18432
  buffer_load_dwordx4 v6, s[12:15], s24 offen lds
  s_waitcnt vmcnt(9)
  s_barrier
  s_waitcnt lgkmcnt(2)
  v_mfma_f32_32x32x16_bf16 v[128:143], v[104:107], a[176:179], v[128:143]
  ds_read_b64_tr_b16 v[96:97], v3 offset:24576
  ds_read_b64_tr_b16 v[98:99], v3 offset:26624
  v_mfma_f32_32x32x16_bf16 v[144:159], v[104:107], a[180:183], v[144:159]
  s_add_u32 m0, s23, 0
  s_sub_u32 s24, s24, 644864
  buffer_load_dwordx4 v6, s[12:15], s24 offen lds
  s_waitcnt lgkmcnt(2)
  v_mfma_f32_32x32x16_bf16 v[128:143], v[108:111], a[184:187], v[128:143]
  ds_read_b64_tr_b16 v[100:101], v3 offset:28672
  ds_read_b64_tr_b16 v[102:103], v3 offset:30720
  v_mfma_f32_32x32x16_bf16 v[144:159], v[108:111], a[188:191], v[144:159]
  s_add_u32 m0, s23, 4096
  s_add_u32 s24, s24, 18432
  buffer_load_dwordx4 v6, s[12:15], s24 offen lds
  s_waitcnt lgkmcnt(2)
  v_mfma_f32_32x32x16_bf16 v[128:143], v[96:99], a[192:195], v[128:143]
  ds_read_b64_tr_b16 v[104:105], v3 offset:32768
  ds_read_b64_tr_b16 v[106:107], v3 offset:34816
  v_mfma_f32_32x32x16_bf16 v[144:159], v[96:99], a[196:199], v[144:159]
  s_add_u32 m0, s23, 8192
  s_add_u32 s24, s24, 18432
  buffer_load_dwordx4 v6, s[12:15], s24 offen lds
  s_waitcnt vmcnt(9)
  s_barrier
  s_waitcnt lgkmcnt(2)
  v_mfma_f32_32x32x16_bf16 v[128:143], v[100:103], a[200:203], v[128:143]
  ds_read_b64_tr_b16 v[108:109], v91 offset:0
  ds_read_b64_tr_b16 v[110:111], v91 offset:2048
  v_mfma_f32_32x32x16_bf16 v[144:159], v[100:103], a[204:207], v[144:159]
  s_add_u32 m0, s23, 12288
  s_add_u32 s24, s24, 18432
  buffer_load_dwordx4 v6, s[12:15], s24 offen lds
  s_waitcnt lgkmcnt(2)
  v_mfma_f32_32x32x16_bf16 v[128:143], v[104:107], a[208:211], v[128:143]
  ds_read_b64_tr_b16 v[96:97], v91 offset:4096
  ds_read_b64_tr_b16 v[98:99], v91 offset:6144
  v_mfma_f32_32x32x16_bf16 v[144:159], v[104:107], a[212:215], v[144:159]
  s_add_u32 m0, s23, 16384
  s_add_u32 s24, s24, 18432
  buffer_load_dwordx4 v6, s[12:15], s24 offen lds
  s_waitcnt lgkmcnt(2)
  v_mfma_f32_32x32x16_bf16 v[128:143], v[108:111], a[216:219], v[128:143]
  ds_read_b64_tr_b16 v[100:101], v91 offset:8192
  ds_read_b64_tr_b16 v[102:103], v91 offset:10240
  v_mfma_f32_32x32x16_bf16 v[144:159], v[108:111], a[220:223], v[144:159]
  s_add_u32 m0, s23, 20480
  s_add_u32 s24, s24, 18432
  buffer_load_dwordx4 v6, s[12:15], s24 offen lds
  s_waitcnt vmcnt(9)
  s_barrier
  s_waitcnt lgkmcnt(2)
  v_mfma_f32_32x32x16_bf16 v[128:143], v[96:99], a[224:227], v[128:143]
  ds_read_b64_tr_b16 v[104:105], v91 offset:12288
  ds_read_b64_tr_b16 v[106:107], v91 offset:14336
  v_mfma_f32_32x32x16_bf16 v[144:159], v[96:99], a[228:231], v[144:159]
  s_add_u32 m0, s23, 24576
  s_add_u32 s24, s24, 18432
  buffer_load_dwordx4 v6, s[12:15], s24 offen lds
  s_waitcnt lgkmcnt(2)
  v_mfma_f32_32x32x16_bf16 v[128:143], v[100:103], a[232:235], v[128:143]
  ds_read_b64_tr_b16 v[108:109], v91 offset:16384
  ds_read_b64_tr_b16 v[110:111], v91 offset:18432
  v_mfma_f32_32x32x16_bf16 v[144:159], v[100:103], a[236:239], v[144:159]
  s_add_u32 m0, s23, 28672
  s_add_u32 s24, s24, 18432
  buffer_load_dwordx4 v6, s[12:15], s24 offen lds
  s_waitcnt lgkmcnt(2)
  v_mfma_f32_32x32x16_bf16 v[128:143], v[104:107], a[240:243], v[128:143]
  ds_read_b64_tr_b16 v[96:97], v91 offset:20480
  ds_read_b64_tr_b16 v[98:99], v91 offset:22528
  v_mfma_f32_32x32x16_bf16 v[144:159], v[104:107], a[244:247], v[144:159]
  s_add_u32 m0, s23, 32768
  s_add_u32 s24, s24, 18432
  buffer_load_dwordx4 v6, s[12:15], s24 offen lds
  s_waitcnt vmcnt(9)
  s_barrier
  s_waitcnt lgkmcnt(2)
  v_mfma_f32_32x32x16_bf16 v[128:143], v[108:111], a[248:251], v[128:143]
  ds_read_b64_tr_b16 v[100:101], v91 offset:24576
  ds_read_b64_tr_b16 v[102:103], v91 offset:26624
  v_mfma_f32_32x32x16_bf16 v[144:159], v[108:111], a[252:255], v[144:159]
  s_add_u32 m0, s23, 36864
  s_add_u32 s24, s24, 18432
  buffer_load_dwordx4 v6, s[12:15], s24 offen lds
  s_waitcnt lgkmcnt(2)
  v_mfma_f32_32x32x16_bf16 v[128:143], v[96:99], v[224:227], v[128:143]
  ds_read_b64_tr_b16 v[104:105], v91 offset:28672
  ds_read_b64_tr_b16 v[106:107], v91 offset:30720
  v_mfma_f32_32x32x16_bf16 v[144:159], v[96:99], v[228:231], v[144:159]
  s_add_u32 m0, s23, 40960
  s_add_u32 s24, s24, 18432
  buffer_load_dwordx4 v6, s[12:15], s24 offen lds
  s_waitcnt lgkmcnt(2)
  v_mfma_f32_32x32x16_bf16 v[128:143], v[100:103], v[232:235], v[128:143]
  ds_read_b64_tr_b16 v[108:109], v91 offset:32768
  ds_read_b64_tr_b16 v[110:111], v91 offset:34816
  v_mfma_f32_32x32x16_bf16 v[144:159], v[100:103], v[236:239], v[144:159]
  s_add_u32 m0, s23, 45056
  s_add_u32 s24, s24, 18432
  buffer_load_dwordx4 v6, s[12:15], s24 offen lds
  s_waitcnt vmcnt(9)
  s_barrier
  s_waitcnt lgkmcnt(2)
  v_mfma_f32_32x32x16_bf16 v[128:143], v[104:107], v[240:243], v[128:143]
  ds_read_b64_tr_b16 v[96:97], v3 offset:0
  ds_read_b64_tr_b16 v[98:99], v3 offset:2048
  v_mfma_f32_32x32x16_bf16 v[144:159], v[104:107], v[244:247], v[144:159]
  s_add_u32 m0, s23, 49152
  s_add_u32 s24, s24, 18432
  buffer_load_dwordx4 v6, s[12:15], s24 offen lds
  s_waitcnt lgkmcnt(2)
  v_mfma_f32_32x32x16_bf16 v[128:143], v[108:111], v[248:251], v[128:143]
  ds_read_b64_tr_b16 v[100:101], v3 offset:4096
  ds_read_b64_tr_b16 v[102:103], v3 offset:6144
  v_mfma_f32_32x32x16_bf16 v[144:159], v[108:111], v[252:255], v[144:159]
  s_add_u32 m0, s23, 53248
  s_add_u32 s24, s24, 18432
  buffer_load_dwordx4 v6, s[12:15], s24 offen lds
  s_waitcnt lgkmcnt(2)
  v_mfma_f32_32x32x16_bf16 v[160:175], v[96:99], a[0:3], 0
  ds_read_b64_tr_b16 v[104:105], v3 offset:8192
  ds_read_b64_tr_b16 v[106:107], v3 offset:10240
  v_mfma_f32_32x32x16_bf16 v[176:191], v[96:99], a[4:7], 0
  s_add_u32 m0, s23, 57344
  s_add_u32 s24, s24, 18432
  buffer_load_dwordx4 v6, s[12:15], s24 offen lds
  s_waitcnt vmcnt(9)
  s_barrier
  s_waitcnt lgkmcnt(2)
  v_mfma_f32_32x32x16_bf16 v[160:175], v[100:103], a[8:11], v[160:175]
  ds_read_b64_tr_b16 v[108:109], v3 offset:12288
  ds_read_b64_tr_b16 v[110:111], v3 offset:14336
  v_mfma_f32_32x32x16_bf16 v[176:191], v[100:103], a[12:15], v[176:191]
  s_add_u32 m0, s23, 61440
  s_add_u32 s24, s24, 18432
  buffer_load_dwordx4 v6, s[12:15], s24 offen lds
  s_waitcnt lgkmcnt(2)
  v_mfma_f32_32x32x16_bf16 v[160:175], v[104:107], a[16:19], v[160:175]
  ds_read_b64_tr_b16 v[96:97], v3 offset:16384
  ds_read_b64_tr_b16 v[98:99], v3 offset:18432
  v_mfma_f32_32x32x16_bf16 v[176:191], v[104:107], a[20:23], v[176:191]
  s_add_u32 m0, s23, 65536
  s_add_u32 s24, s24, 18432
  buffer_load_dwordx4 v6, s[12:15], s24 offen lds
  s_waitcnt lgkmcnt(2)
  v_mfma_f32_32x32x16_bf16 v[160:175], v[108:111], a[24:27], v[160:175]
  ds_read_b64_tr_b16 v[100:101], v3 offset:20480
  ds_read_b64_tr_b16 v[102:103], v3 offset:22528
  v_cvt_pk_bf16_f32 v64, v128, v129
  v_cvt_pk_bf16_f32 v65, v130, v131
  v_mfma_f32_32x32x16_bf16 v[176:191], v[108:111], a[28:31], v[176:191]
  s_add_u32 m0, s23, 69632
  s_add_u32 s24, s24, 18432
  buffer_load_dwordx4 v6, s[12:15], s24 offen lds
  v_cvt_pk_bf16_f32 v66, v132, v133
  v_cvt_pk_bf16_f32 v67, v134, v135
  s_waitcnt vmcnt(9)
  s_barrier
  s_waitcnt lgkmcnt(2)
  v_mfma_f32_32x32x16_bf16 v[160:175], v[96:99], a[32:35], v[160:175]
  ds_read_b64_tr_b16 v[104:105], v3 offset:24576
  ds_read_b64_tr_b16 v[106:107], v3 offset:26624
  v_cvt_pk_bf16_f32 v68, v136, v137
  v_cvt_pk_bf16_f32 v69, v138, v139
  v_mfma_f32_32x32x16_bf16 v[176:191], v[96:99], a[36:39], v[176:191]
  s_add_u32 m0, s23, 0
  s_add_u32 s24, s24, 18432
  buffer_load_dwordx4 v6, s[12:15], s24 offen lds
  v_cvt_pk_bf16_f32 v70, v140, v141
  v_cvt_pk_bf16_f32 v71, v142, v143
  s_waitcnt lgkmcnt(2)
  v_mfma_f32_32x32x16_bf16 v[160:175], v[100:103], a[40:43], v[160:175]
  ds_read_b64_tr_b16 v[108:109], v3 offset:28672
  ds_read_b64_tr_b16 v[110:111], v3 offset:30720
  buffer_store_dwordx4 v[64:67], v9, s[16:19], s27 offen offset:0 sc1
  buffer_store_dwordx4 v[68:71], v9, s[16:19], s27 offen offset:1024 sc1
  v_mfma_f32_32x32x16_bf16 v[176:191], v[100:103], a[44:47], v[176:191]
  s_add_u32 m0, s23, 4096
  s_add_u32 s24, s24, 18432
  buffer_load_dwordx4 v6, s[12:15], s24 offen lds
  v_cvt_pk_bf16_f32 v72, v144, v145
  v_cvt_pk_bf16_f32 v73, v146, v147
  s_waitcnt lgkmcnt(2)
  v_mfma_f32_32x32x16_bf16 v[160:175], v[104:107], a[48:51], v[160:175]
  ds_read_b64_tr_b16 v[96:97], v3 offset:32768
  ds_read_b64_tr_b16 v[98:99], v3 offset:34816
  v_cvt_pk_bf16_f32 v74, v148, v149
  v_cvt_pk_bf16_f32 v75, v150, v151
  v_mfma_f32_32x32x16_bf16 v[176:191], v[104:107], a[52:55], v[176:191]
  s_add_u32 m0, s23, 8192
  s_add_u32 s24, s24, 18432
  buffer_load_dwordx4 v6, s[12:15], s24 offen lds
  v_cvt_pk_bf16_f32 v76, v152, v153
  v_cvt_pk_bf16_f32 v77, v154, v155
  s_waitcnt vmcnt(11)
  s_barrier
  s_waitcnt lgkmcnt(2)
  v_mfma_f32_32x32x16_bf16 v[160:175], v[108:111], a[56:59], v[160:175]
  ds_read_b64_tr_b16 v[100:101], v91 offset:0
  ds_read_b64_tr_b16 v[102:103], v91 offset:2048
  v_cvt_pk_bf16_f32 v78, v156, v157
  v_cvt_pk_bf16_f32 v79, v158, v159
  v_mfma_f32_32x32x16_bf16 v[176:191], v[108:111], a[60:63], v[176:191]
  s_add_u32 m0, s23, 12288
  s_add_u32 s24, s24, 18432
  buffer_load_dwordx4 v6, s[12:15], s24 offen lds
  buffer_store_dwordx4 v[72:75], v9, s[16:19], s27 offen offset:2048 sc1
  buffer_store_dwordx4 v[76:79], v9, s[16:19], s27 offen offset:3072 sc1
  s_waitcnt lgkmcnt(2)
  v_mfma_f32_32x32x16_bf16 v[160:175], v[96:99], a[64:67], v[160:175]
  ds_read_b64_tr_b16 v[104:105], v91 offset:4096
  ds_read_b64_tr_b16 v[106:107], v91 offset:6144
  s_add_u32 s27, s27, 0x4000
  v_mfma_f32_32x32x16_bf16 v[176:191], v[96:99], a[68:71], v[176:191]
  s_add_u32 m0, s23, 16384
  s_add_u32 s24, s24, 18432
  buffer_load_dwordx4 v6, s[12:15], s24 offen lds
  s_waitcnt lgkmcnt(2)
  v_mfma_f32_32x32x16_bf16 v[160:175], v[100:103], a[72:75], v[160:175]
  ds_read_b64_tr_b16 v[108:109], v91 offset:8192
  ds_read_b64_tr_b16 v[110:111], v91 offset:10240
  v_mfma_f32_32x32x16_bf16 v[176:191], v[100:103], a[76:79], v[176:191]
  s_add_u32 m0, s23, 20480
  s_add_u32 s24, s24, 18432
  buffer_load_dwordx4 v6, s[12:15], s24 offen lds
  s_waitcnt vmcnt(13)
  s_barrier
  s_waitcnt lgkmcnt(2)
  v_mfma_f32_32x32x16_bf16 v[160:175], v[104:107], a[80:83], v[160:175]
  ds_read_b64_tr_b16 v[96:97], v91 offset:12288
  ds_read_b64_tr_b16 v[98:99], v91 offset:14336
  v_mfma_f32_32x32x16_bf16 v[176:191], v[104:107], a[84:87], v[176:191]
  s_add_u32 m0, s23, 24576
  s_add_u32 s24, s24, 18432
  buffer_load_dwordx4 v6, s[12:15], s24 offen lds
  s_waitcnt lgkmcnt(2)
  v_mfma_f32_32x32x16_bf16 v[160:175], v[108:111], a[88:91], v[160:175]
  ds_read_b64_tr_b16 v[100:101], v91 offset:16384
  ds_read_b64_tr_b16 v[102:103], v91 offset:18432
  v_mfma_f32_32x32x16_bf16 v[176:191], v[108:111], a[92:95], v[176:191]
  s_add_u32 m0, s23, 28672
  s_add_u32 s24, s24, 18432
  buffer_load_dwordx4 v6, s[12:15], s24 offen lds
  s_waitcnt lgkmcnt(2)
  v_mfma_f32_32x32x16_bf16 v[160:175], v[96:99], a[96:99], v[160:175]
  ds_read_b64_tr_b16 v[104:105], v91 offset:20480
  ds_read_b64_tr_b16 v[106:107], v91 offset:22528
  v_mfma_f32_32x32x16_bf16 v[176:191], v[96:99], a[100:103], v[176:191]
  s_add_u32 m0, s23, 32768
  s_add_u32 s24, s24, 18432
  buffer_load_dwordx4 v6, s[12:15], s24 offen lds
  s_waitcnt vmcnt(13)
  s_barrier
  s_waitcnt lgkmcnt(2)
  v_mfma_f32_32x32x16_bf16 v[160:175], v[100:103], a[104:107], v[160:175]
  ds_read_b64_tr_b16 v[108:109], v91 offset:24576
  ds_read_b64_tr_b16 v[110:111], v91 offset:26624
  v_mfma_f32_32x32x16_bf16 v[176:191], v[100:103], a[108:111], v[176:191]
  s_add_u32 m0, s23, 36864
  s_add_u32 s24, s24, 18432
  buffer_load_dwordx4 v6, s[12:15], s24 offen lds
  s_waitcnt lgkmcnt(2)
  v_mfma_f32_32x32x16_bf16 v[160:175], v[104:107], a[112:115], v[160:175]
  ds_read_b64_tr_b16 v[96:97], v91 offset:28672
  ds_read_b64_tr_b16 v[98:99], v91 offset:30720
  v_mfma_f32_32x32x16_bf16 v[176:191], v[104:107], a[116:119], v[176:191]
  s_add_u32 m0, s23, 40960
  s_add_u32 s24, s24, 18432
  buffer_load_dwordx4 v6, s[12:15], s24 offen lds
  s_waitcnt lgkmcnt(2)
  v_mfma_f32_32x32x16_bf16 v[160:175], v[108:111], a[120:123], v[160:175]
  ds_read_b64_tr_b16 v[100:101], v91 offset:32768
  ds_read_b64_tr_b16 v[102:103], v91 offset:34816
  v_mfma_f32_32x32x16_bf16 v[176:191], v[108:111], a[124:127], v[176:191]
  s_add_u32 m0, s23, 45056
  s_add_u32 s24, s24, 18432
  buffer_load_dwordx4 v6, s[12:15], s24 offen lds
  s_waitcnt vmcnt(11)
  s_barrier
  s_waitcnt lgkmcnt(2)
  v_mfma_f32_32x32x16_bf16 v[160:175], v[96:99], a[128:131], v[160:175]
  ds_read_b64_tr_b16 v[104:105], v3 offset:0
  ds_read_b64_tr_b16 v[106:107], v3 offset:2048
  v_mfma_f32_32x32x16_bf16 v[176:191], v[96:99], a[132:135], v[176:191]
  s_add_u32 m0, s23, 49152
  s_add_u32 s24, s24, 18432
  buffer_load_dwordx4 v6, s[12:15], s24 offen lds
  s_waitcnt lgkmcnt(2)
  v_mfma_f32_32x32x16_bf16 v[160:175], v[100:103], a[136:139], v[160:175]
  ds_read_b64_tr_b16 v[108:109], v3 offset:4096
  ds_read_b64_tr_b16 v[110:111], v3 offset:6144
  v_mfma_f32_32x32x16_bf16 v[176:191], v[100:103], a[140:143], v[176:191]
  s_add_u32 m0, s23, 53248
  s_add_u32 s24, s24, 18432
  buffer_load_dwordx4 v6, s[12:15], s24 offen lds
  s_waitcnt lgkmcnt(2)
  v_mfma_f32_32x32x16_bf16 v[160:175], v[104:107], a[144:147], v[160:175]
  ds_read_b64_tr_b16 v[96:97], v3 offset:8192
  ds_read_b64_tr_b16 v[98:99], v3 offset:10240
  v_mfma_f32_32x32x16_bf16 v[176:191], v[104:107], a[148:151], v[176:191]
  s_add_u32 m0, s23, 57344
  s_add_u32 s24, s24, 18432
  buffer_load_dwordx4 v6, s[12:15], s24 offen lds
  s_waitcnt vmcnt(9)
  s_barrier
  s_waitcnt lgkmcnt(2)
  v_mfma_f32_32x32x16_bf16 v[160:175], v[108:111], a[152:155], v[160:175]
  ds_read_b64_tr_b16 v[100:101], v3 offset:12288
  ds_read_b64_tr_b16 v[102:103], v3 offset:14336
  v_mfma_f32_32x32x16_bf16 v[176:191], v[108:111], a[156:159], v[176:191]
  s_add_u32 m0, s23, 61440
  s_add_u32 s24, s24, 18432
  buffer_load_dwordx4 v6, s[12:15], s24 offen lds
  s_waitcnt lgkmcnt(2)
  v_mfma_f32_32x32x16_bf16 v[160:175], v[96:99], a[160:163], v[160:175]
  ds_read_b64_tr_b16 v[104:105], v3 offset:16384
  ds_read_b64_tr_b16 v[106:107], v3 offset:18432
  v_mfma_f32_32x32x16_bf16 v[176:191], v[96:99], a[164:167], v[176:191]
  s_add_u32 m0, s23, 65536
  s_add_u32 s24, s24, 18432
  buffer_load_dwordx4 v6, s[12:15], s24 offen lds
  s_waitcnt lgkmcnt(2)
  v_mfma_f32_32x32x16_bf16 v[160:175], v[100:103], a[168:171], v[160:175]
  ds_read_b64_tr_b16 v[108:109], v3 offset:20480
  ds_read_b64_tr_b16 v[110:111], v3 offset:22528
  v_mfma_f32_32x32x16_bf16 v[176:191], v[100:103], a[172:175], v[176:191]
  s_add_u32 m0, s23, 69632
  s_add_u32 s24, s24, 18432
  buffer_load_dwordx4 v6, s[12:15], s24 offen lds
  s_waitcnt vmcnt(9)
  s_barrier
  s_waitcnt lgkmcnt(2)
  v_mfma_f32_32x32x16_bf16 v[160:175], v[104:107], a[176:179], v[160:175]
  ds_read_b64_tr_b16 v[96:97], v3 offset:24576
  ds_read_b64_tr_b16 v[98:99], v3 offset:26624
  v_mfma_f32_32x32x16_bf16 v[176:191], v[104:107], a[180:183], v[176:191]
  s_add_u32 m0, s23, 0
  s_mov_b32 s24, s39
  buffer_load_dwordx4 v7, s[12:15], s24 offen lds
  s_waitcnt lgkmcnt(2)
  v_mfma_f32_32x32x16_bf16 v[160:175], v[108:111], a[184:187], v[160:175]
  ds_read_b64_tr_b16 v[100:101], v3 offset:28672
  ds_read_b64_tr_b16 v[102:103], v3 offset:30720
  v_mfma_f32_32x32x16_bf16 v[176:191], v[108:111], a[188:191], v[176:191]
  s_add_u32 m0, s23, 4096
  s_add_u32 s24, s24, 36864
  buffer_load_dwordx4 v7, s[12:15], s24 offen lds
  s_waitcnt lgkmcnt(2)
  v_mfma_f32_32x32x16_bf16 v[160:175], v[96:99], a[192:195], v[160:175]
  ds_read_b64_tr_b16 v[104:105], v3 offset:32768
  ds_read_b64_tr_b16 v[106:107], v3 offset:34816
  v_mfma_f32_32x32x16_bf16 v[176:191], v[96:99], a[196:199], v[176:191]
  s_add_u32 m0, s23, 8192
  s_add_u32 s24, s24, 36864
  buffer_load_dwordx4 v7, s[12:15], s24 offen lds
  s_waitcnt vmcnt(9)
  s_barrier
  s_waitcnt lgkmcnt(2)
  v_mfma_f32_32x32x16_bf16 v[160:175], v[100:103], a[200:203], v[160:175]
  ds_read_b64_tr_b16 v[108:109], v91 offset:0
  ds_read_b64_tr_b16 v[110:111], v91 offset:2048
  v_mfma_f32_32x32x16_bf16 v[176:191], v[100:103], a[204:207], v[176:191]
  s_add_u32 m0, s23, 12288
  s_add_u32 s24, s24, 36864
  buffer_load_dwordx4 v7, s[12:15], s24 offen lds
  s_waitcnt lgkmcnt(2)
  v_mfma_f32_32x32x16_bf16 v[160:175], v[104:107], a[208:211], v[160:175]
  ds_read_b64_tr_b16 v[96:97], v91 offset:4096
  ds_read_b64_tr_b16 v[98:99], v91 offset:6144
  v_mfma_f32_32x32x16_bf16 v[176:191], v[104:107], a[212:215], v[176:191]
  s_add_u32 m0, s23, 16384
  s_add_u32 s24, s24, 36864
  buffer_load_dwordx4 v7, s[12:15], s24 offen lds
  s_waitcnt lgkmcnt(2)
  v_mfma_f32_32x32x16_bf16 v[160:175], v[108:111], a[216:219], v[160:175]
  ds_read_b64_tr_b16 v[100:101], v91 offset:8192
  ds_read_b64_tr_b16 v[102:103], v91 offset:10240
  v_mfma_f32_32x32x16_bf16 v[176:191], v[108:111], a[220:223], v[176:191]
  s_add_u32 m0, s23, 20480
  s_add_u32 s24, s24, 36864
  buffer_load_dwordx4 v7, s[12:15], s24 offen lds
  s_waitcnt vmcnt(9)
  s_barrier
  s_waitcnt lgkmcnt(2)
  v_mfma_f32_32x32x16_bf16 v[160:175], v[96:99], a[224:227], v[160:175]
  ds_read_b64_tr_b16 v[104:105], v91 offset:12288
  ds_read_b64_tr_b16 v[106:107], v91 offset:14336
  v_mfma_f32_32x32x16_bf16 v[176:191], v[96:99], a[228:231], v[176:191]
  s_add_u32 m0, s23, 24576
  s_add_u32 s24, s24, 36864
  buffer_load_dwordx4 v7, s[12:15], s24 offen lds
  s_waitcnt lgkmcnt(2)
  v_mfma_f32_32x32x16_bf16 v[160:175], v[100:103], a[232:235], v[160:175]
  ds_read_b64_tr_b16 v[108:109], v91 offset:16384
  ds_read_b64_tr_b16 v[110:111], v91 offset:18432
  v_mfma_f32_32x32x16_bf16 v[176:191], v[100:103], a[236:239], v[176:191]
  s_add_u32 m0, s23, 28672
  s_add_u32 s24, s24, 36864
  buffer_load_dwordx4 v7, s[12:15], s24 offen lds
  s_waitcnt lgkmcnt(2)
  v_mfma_f32_32x32x16_bf16 v[160:175], v[104:107], a[240:243], v[160:175]
  ds_read_b64_tr_b16 v[96:97], v91 offset:20480
  ds_read_b64_tr_b16 v[98:99], v91 offset:22528
  v_mfma_f32_32x32x16_bf16 v[176:191], v[104:107], a[244:247], v[176:191]
  s_add_u32 m0, s23, 32768
  s_add_u32 s24, s24, 36864
  buffer_load_dwordx4 v7, s[12:15], s24 offen lds
  s_waitcnt vmcnt(9)
  s_barrier
  s_waitcnt lgkmcnt(2)
  v_mfma_f32_32x32x16_bf16 v[160:175], v[108:111], a[248:251], v[160:175]
  ds_read_b64_tr_b16 v[100:101], v91 offset:24576
  ds_read_b64_tr_b16 v[102:103], v91 offset:26624
  v_mfma_f32_32x32x16_bf16 v[176:191], v[108:111], a[252:255], v[176:191]
  s_add_u32 m0, s23, 36864
  s_add_u32 s24, s24, 36864
  buffer_load_dwordx4 v7, s[12:15], s24 offen lds
  s_waitcnt lgkmcnt(2)
  v_mfma_f32_32x32x16_bf16 v[160:175], v[96:99], v[224:227], v[160:175]
  ds_read_b64_tr_b16 v[104:105], v91 offset:28672
  ds_read_b64_tr_b16 v[106:107], v91 offset:30720
  v_mfma_f32_32x32x16_bf16 v[176:191], v[96:99], v[228:231], v[176:191]
  s_add_u32 m0, s23, 40960
  s_add_u32 s24, s24, 36864
  buffer_load_dwordx4 v7, s[12:15], s24 offen lds
  s_waitcnt lgkmcnt(2)
  v_mfma_f32_32x32x16_bf16 v[160:175], v[100:103], v[232:235], v[160:175]
  ds_read_b64_tr_b16 v[108:109], v91 offset:32768
  ds_read_b64_tr_b16 v[110:111], v91 offset:34816
  v_mfma_f32_32x32x16_bf16 v[176:191], v[100:103], v[236:239], v[176:191]
  s_add_u32 m0, s23, 45056
  s_add_u32 s24, s24, 36864
  buffer_load_dwordx4 v7, s[12:15], s24 offen lds
  s_waitcnt vmcnt(9)
  s_barrier
  s_waitcnt lgkmcnt(2)
  v_mfma_f32_32x32x16_bf16 v[160:175], v[104:107], v[240:243], v[160:175]
  ds_read_b64_tr_b16 v[96:97], v4 offset:0
  ds_read_b64_tr_b16 v[98:99], v4 offset:1024
  ds_read_b64_tr_b16 v[100:101], v4 offset:2048
  ds_read_b64_tr_b16 v[102:103], v4 offset:3072
  v_mfma_f32_32x32x16_bf16 v[176:191], v[104:107], v[244:247], v[176:191]
  s_add_u32 m0, s23, 49152
  s_add_u32 s24, s24, 36864
  buffer_load_dwordx4 v7, s[12:15], s24 offen lds
  s_waitcnt lgkmcnt(4)
  v_mfma_f32_32x32x16_bf16 v[160:175], v[108:111], v[248:251], v[160:175]
  ds_read_b64_tr_b16 v[104:105], v4 offset:4096
  ds_read_b64_tr_b16 v[106:107], v4 offset:5120
  ds_read_b64_tr_b16 v[108:109], v4 offset:6144
  ds_read_b64_tr_b16 v[110:111], v4 offset:7168
  v_mfma_f32_32x32x16_bf16 v[176:191], v[108:111], v[252:255], v[176:191]
  s_add_u32 m0, s23, 53248
  s_add_u32 s24, s24, 36864
  buffer_load_dwordx4 v7, s[12:15], s24 offen lds
  s_lshr_b32 s36, s20, 1
  s_add_u32 s36, s36, 16
  s_lshl_b32 s36, s36, 12
  s_and_b32 s37, s20, 1
  s_lshl_b32 s37, s37, 11
  s_add_u32 s36, s36, s37
  s_add_u32 s47, s36, s26
  s_bitcmp1_b32 s20, 0
  s_cbranch_scc1 f_kernel_h1
  s_waitcnt lgkmcnt(6)
  v_mfma_f32_32x32x16_bf16 v[128:143], v[96:99], a[0:3], 0
  ds_read_b64_tr_b16 v[112:113], v4 offset:8192
  ds_read_b64_tr_b16 v[114:115], v4 offset:9216
  ds_read_b64_tr_b16 v[116:117], v4 offset:10240
  ds_read_b64_tr_b16 v[118:119], v4 offset:11264
  s_waitcnt lgkmcnt(8)
  v_mfma_f32_32x32x16_bf16 v[128:143], v[100:103], a[8:11], v[128:143]
  s_add_u32 m0, s23, 57344
  s_add_u32 s24, s24, 36864
  buffer_load_dwordx4 v7, s[12:15], s24 offen lds
  s_waitcnt vmcnt(9)
  s_barrier
  s_waitcnt lgkmcnt(6)
  v_mfma_f32_32x32x16_bf16 v[128:143], v[104:107], a[16:19], v[128:143]
  ds_read_b64_tr_b16 v[120:121], v4 offset:12288
  ds_read_b64_tr_b16 v[122:123], v4 offset:13312
  ds_read_b64_tr_b16 v[124:125], v4 offset:14336
  ds_read_b64_tr_b16 v[126:127], v4 offset:15360
  s_waitcnt lgkmcnt(8)
  v_mfma_f32_32x32x16_bf16 v[128:143], v[108:111], a[24:27], v[128:143]
  s_add_u32 m0, s23, 61440
  s_add_u32 s24, s24, 36864
  buffer_load_dwordx4 v7, s[12:15], s24 offen lds
  s_waitcnt lgkmcnt(6)
  v_mfma_f32_32x32x16_bf16 v[128:143], v[112:115], a[32:35], v[128:143]
  ds_read_b64_tr_b16 v[96:97], v4 offset:16384
  ds_read_b64_tr_b16 v[98:99], v4 offset:17408
  ds_read_b64_tr_b16 v[100:101], v4 offset:18432
  ds_read_b64_tr_b16 v[102:103], v4 offset:19456
  v_cvt_pk_bf16_f32 v64, v160, v161
  v_cvt_pk_bf16_f32 v65, v162, v163
  s_waitcnt lgkmcnt(8)
  v_mfma_f32_32x32x16_bf16 v[128:143], v[116:119], a[40:43], v[128:143]
  s_add_u32 m0, s23, 65536
  s_add_u32 s24, s24, 36864
  buffer_load_dwordx4 v7, s[12:15], s24 offen lds
  v_cvt_pk_bf16_f32 v66, v164, v165
  v_cvt_pk_bf16_f32 v67, v166, v167
  s_waitcnt lgkmcnt(6)
  v_mfma_f32_32x32x16_bf16 v[128:143], v[120:123], a[48:51], v[128:143]
  ds_read_b64_tr_b16 v[104:105], v4 offset:20480
  ds_read_b64_tr_b16 v[106:107], v4 offset:21504
  ds_read_b64_tr_b16 v[108:109], v4 offset:22528
  ds_read_b64_tr_b16 v[110:111], v4 offset:23552
  v_cvt_pk_bf16_f32 v68, v168, v169
  v_cvt_pk_bf16_f32 v69, v170, v171
  s_waitcnt lgkmcnt(8)
  v_mfma_f32_32x32x16_bf16 v[128:143], v[124:127], a[56:59], v[128:143]
  s_add_u32 m0, s23, 69632
  s_add_u32 s24, s24, 36864
  buffer_load_dwordx4 v7, s[12:15], s24 offen lds
  v_cvt_pk_bf16_f32 v70, v172, v173
  v_cvt_pk_bf16_f32 v71, v174, v175
  s_waitcnt vmcnt(9)
  s_barrier
  s_waitcnt lgkmcnt(6)
  v_mfma_f32_32x32x16_bf16 v[128:143], v[96:99], a[64:67], v[128:143]
  ds_read_b64_tr_b16 v[112:113], v4 offset:24576
  ds_read_b64_tr_b16 v[114:115], v4 offset:25600
  ds_read_b64_tr_b16 v[116:117], v4 offset:26624
  ds_read_b64_tr_b16 v[118:119], v4 offset:27648
  buffer_store_dwordx4 v[64:67], v9, s[16:19], s27 offen offset:0 sc1
  buffer_store_dwordx4 v[68:71], v9, s[16:19], s27 offen offset:1024 sc1
  s_waitcnt lgkmcnt(8)
  v_mfma_f32_32x32x16_bf16 v[128:143], v[100:103], a[72:75], v[128:143]
  v_cvt_pk_bf16_f32 v72, v176, v177
  v_cvt_pk_bf16_f32 v73, v178, v179
  s_waitcnt lgkmcnt(6)
  v_mfma_f32_32x32x16_bf16 v[128:143], v[104:107], a[80:83], v[128:143]
  ds_read_b64_tr_b16 v[120:121], v4 offset:28672
  ds_read_b64_tr_b16 v[122:123], v4 offset:29696
  ds_read_b64_tr_b16 v[124:125], v4 offset:30720
  ds_read_b64_tr_b16 v[126:127], v4 offset:31744
  v_cvt_pk_bf16_f32 v74, v180, v181
  v_cvt_pk_bf16_f32 v75, v182, v183
  s_waitcnt lgkmcnt(8)
  v_mfma_f32_32x32x16_bf16 v[128:143], v[108:111], a[88:91], v[128:143]
  v_cvt_pk_bf16_f32 v76, v184, v185
  v_cvt_pk_bf16_f32 v77, v186, v187
  s_waitcnt lgkmcnt(6)
  v_mfma_f32_32x32x16_bf16 v[128:143], v[112:115], a[96:99], v[128:143]
  ds_read_b64_tr_b16 v[96:97], v4 offset:32768
  ds_read_b64_tr_b16 v[98:99], v4 offset:33792
  ds_read_b64_tr_b16 v[100:101], v4 offset:34816
  ds_read_b64_tr_b16 v[102:103], v4 offset:35840
  v_cvt_pk_bf16_f32 v78, v188, v189
  v_cvt_pk_bf16_f32 v79, v190, v191
  s_waitcnt lgkmcnt(8)
  v_mfma_f32_32x32x16_bf16 v[128:143], v[116:119], a[104:107], v[128:143]
  buffer_store_dwordx4 v[72:75], v9, s[16:19], s27 offen offset:2048 sc1
  buffer_store_dwordx4 v[76:79], v9, s[16:19], s27 offen offset:3072 sc1
  s_waitcnt vmcnt(10)
  s_barrier
  s_waitcnt lgkmcnt(6)
  v_mfma_f32_32x32x16_bf16 v[128:143], v[120:123], a[112:115], v[128:143]
  ds_read_b64_tr_b16 v[104:105], v92 offset:0
  ds_read_b64_tr_b16 v[106:107], v92 offset:1024
  ds_read_b64_tr_b16 v[108:109], v92 offset:2048
  ds_read_b64_tr_b16 v[110:111], v92 offset:3072
  s_waitcnt lgkmcnt(8)
  v_mfma_f32_32x32x16_bf16 v[128:143], v[124:127], a[120:123], v[128:143]
  s_waitcnt lgkmcnt(6)
  v_mfma_f32_32x32x16_bf16 v[128:143], v[96:99], a[128:131], v[128:143]
  ds_read_b64_tr_b16 v[112:113], v92 offset:4096
  ds_read_b64_tr_b16 v[114:115], v92 offset:5120
  ds_read_b64_tr_b16 v[116:117], v92 offset:6144
  ds_read_b64_tr_b16 v[118:119], v92 offset:7168
  s_waitcnt lgkmcnt(8)
  v_mfma_f32_32x32x16_bf16 v[128:143], v[100:103], a[136:139], v[128:143]
  s_waitcnt lgkmcnt(6)
  v_mfma_f32_32x32x16_bf16 v[128:143], v[104:107], a[144:147], v[128:143]
  ds_read_b64_tr_b16 v[120:121], v92 offset:8192
  ds_read_b64_tr_b16 v[122:123], v92 offset:9216
  ds_read_b64_tr_b16 v[124:125], v92 offset:10240
  ds_read_b64_tr_b16 v[126:127], v92 offset:11264
  s_waitcnt lgkmcnt(8)
  v_mfma_f32_32x32x16_bf16 v[128:143], v[108:111], a[152:155], v[128:143]
  s_waitcnt vmcnt(7)
  s_barrier
  s_waitcnt lgkmcnt(6)
  v_mfma_f32_32x32x16_bf16 v[128:143], v[112:115], a[160:163], v[128:143]
  ds_read_b64_tr_b16 v[96:97], v92 offset:12288
  ds_read_b64_tr_b16 v[98:99], v92 offset:13312
  ds_read_b64_tr_b16 v[100:101], v92 offset:14336
  ds_read_b64_tr_b16 v[102:103], v92 offset:15360
  s_waitcnt lgkmcnt(8)
  v_mfma_f32_32x32x16_bf16 v[128:143], v[116:119], a[168:171], v[128:143]
  s_waitcnt lgkmcnt(6)
  v_mfma_f32_32x32x16_bf16 v[128:143], v[120:123], a[176:179], v[128:143]
  ds_read_b64_tr_b16 v[104:105], v92 offset:16384
  ds_read_b64_tr_b16 v[106:107], v92 offset:17408
  ds_read_b64_tr_b16 v[108:109], v92 offset:18432
  ds_read_b64_tr_b16 v[110:111], v92 offset:19456
  s_waitcnt lgkmcnt(8)
  v_mfma_f32_32x32x16_bf16 v[128:143], v[124:127], a[184:187], v[128:143]
  s_waitcnt lgkmcnt(6)
  v_mfma_f32_32x32x16_bf16 v[128:143], v[96:99], a[192:195], v[128:143]
  ds_read_b64_tr_b16 v[112:113], v92 offset:20480
  ds_read_b64_tr_b16 v[114:115], v92 offset:21504
  ds_read_b64_tr_b16 v[116:117], v92 offset:22528
  ds_read_b64_tr_b16 v[118:119], v92 offset:23552
  s_waitcnt lgkmcnt(8)
  v_mfma_f32_32x32x16_bf16 v[128:143], v[100:103], a[200:203], v[128:143]
  s_waitcnt vmcnt(4)
  s_barrier
  s_waitcnt lgkmcnt(6)
  v_mfma_f32_32x32x16_bf16 v[128:143], v[104:107], a[208:211], v[128:143]
  ds_read_b64_tr_b16 v[120:121], v92 offset:24576
  ds_read_b64_tr_b16 v[122:123], v92 offset:25600
  ds_read_b64_tr_b16 v[124:125], v92 offset:26624
  ds_read_b64_tr_b16 v[126:127], v92 offset:27648
  s_waitcnt lgkmcnt(8)
  v_mfma_f32_32x32x16_bf16 v[128:143], v[108:111], a[216:219], v[128:143]
  s_waitcnt lgkmcnt(6)
  v_mfma_f32_32x32x16_bf16 v[128:143], v[112:115], a[224:227], v[128:143]
  ds_read_b64_tr_b16 v[96:97], v92 offset:28672
  ds_read_b64_tr_b16 v[98:99], v92 offset:29696
  ds_read_b64_tr_b16 v[100:101], v92 offset:30720
  ds_read_b64_tr_b16 v[102:103], v92 offset:31744
  s_waitcnt lgkmcnt(8)
  v_mfma_f32_32x32x16_bf16 v[128:143], v[116:119], a[232:235], v[128:143]
  s_waitcnt lgkmcnt(6)
  v_mfma_f32_32x32x16_bf16 v[128:143], v[120:123], a[240:243], v[128:143]
  ds_read_b64_tr_b16 v[104:105], v92 offset:32768
  ds_read_b64_tr_b16 v[106:107], v92 offset:33792
  ds_read_b64_tr_b16 v[108:109], v92 offset:34816
  ds_read_b64_tr_b16 v[110:111], v92 offset:35840
  s_waitcnt lgkmcnt(8)
  v_mfma_f32_32x32x16_bf16 v[128:143], v[124:127], a[248:251], v[128:143]
  s_waitcnt lgkmcnt(6)
  v_mfma_f32_32x32x16_bf16 v[128:143], v[96:99], v[224:227], v[128:143]
  s_waitcnt lgkmcnt(4)
  v_mfma_f32_32x32x16_bf16 v[128:143], v[100:103], v[232:235], v[128:143]
  s_waitcnt lgkmcnt(2)
  v_mfma_f32_32x32x16_bf16 v[128:143], v[104:107], v[240:243], v[128:143]
  s_waitcnt lgkmcnt(0)
  v_mfma_f32_32x32x16_bf16 v[128:143], v[108:111], v[248:251], v[128:143]
  s_nop 15
  v_cvt_pk_bf16_f32 v64, v128, v129
  v_cvt_pk_bf16_f32 v65, v130, v131
  v_cvt_pk_bf16_f32 v66, v132, v133
  v_cvt_pk_bf16_f32 v67, v134, v135
  v_cvt_pk_bf16_f32 v68, v136, v137
  v_cvt_pk_bf16_f32 v69, v138, v139
  v_cvt_pk_bf16_f32 v70, v140, v141
  v_cvt_pk_bf16_f32 v71, v142, v143
  buffer_store_dwordx4 v[64:67], v9, s[16:19], s47 offen offset:0 sc1
  buffer_store_dwordx4 v[68:71], v9, s[16:19], s47 offen offset:1024 sc1
  s_waitcnt vmcnt(0)
  s_branch f_kernel_fin
f_kernel_h1:
  s_waitcnt lgkmcnt(6)
  v_mfma_f32_32x32x16_bf16 v[128:143], v[96:99], a[4:7], 0
  ds_read_b64_tr_b16 v[112:113], v4 offset:8192
  ds_read_b64_tr_b16 v[114:115], v4 offset:9216
  ds_read_b64_tr_b16 v[116:117], v4 offset:10240
  ds_read_b64_tr_b16 v[118:119], v4 offset:11264
  s_waitcnt lgkmcnt(8)
  v_mfma_f32_32x32x16_bf16 v[128:143], v[100:103], a[12:15], v[128:143]
  s_add_u32 m0, s23, 57344
  s_add_u32 s24, s24, 36864
  buffer_load_dwordx4 v7, s[12:15], s24 offen lds
  s_waitcnt vmcnt(9)
  s_barrier
  s_waitcnt lgkmcnt(6)
  v_mfma_f32_32x32x16_bf16 v[128:143], v[104:107], a[20:23], v[128:143]
  ds_read_b64_tr_b16 v[120:121], v4 offset:12288
  ds_read_b64_tr_b16 v[122:123], v4 offset:13312
  ds_read_b64_tr_b16 v[124:125], v4 offset:14336
  ds_read_b64_tr_b16 v[126:127], v4 offset:15360
  s_waitcnt lgkmcnt(8)
  v_mfma_f32_32x32x16_bf16 v[128:143], v[108:111], a[28:31], v[128:143]
  s_add_u32 m0, s23, 61440
  s_add_u32 s24, s24, 36864
  buffer_load_dwordx4 v7, s[12:15], s24 offen lds
  s_waitcnt lgkmcnt(6)
  v_mfma_f32_32x32x16_bf16 v[128:143], v[112:115], a[36:39], v[128:143]
  ds_read_b64_tr_b16 v[96:97], v4 offset:16384
  ds_read_b64_tr_b16 v[98:99], v4 offset:17408
  ds_read_b64_tr_b16 v[100:101], v4 offset:18432
  ds_read_b64_tr_b16 v[102:103], v4 offset:19456
  v_cvt_pk_bf16_f32 v64, v160, v161
  v_cvt_pk_bf16_f32 v65, v162, v163
  s_waitcnt lgkmcnt(8)
  v_mfma_f32_32x32x16_bf16 v[128:143], v[116:119], a[44:47], v[128:143]
  s_add_u32 m0, s23, 65536
  s_add_u32 s24, s24, 36864
  buffer_load_dwordx4 v7, s[12:15], s24 offen lds
  v_cvt_pk_bf16_f32 v66, v164, v165
  v_cvt_pk_bf16_f32 v67, v166, v167
  s_waitcnt lgkmcnt(6)
  v_mfma_f32_32x32x16_bf16 v[128:143], v[120:123], a[52:55], v[128:143]
  ds_read_b64_tr_b16 v[104:105], v4 offset:20480
  ds_read_b64_tr_b16 v[106:107], v4 offset:21504
  ds_read_b64_tr_b16 v[108:109], v4 offset:22528
  ds_read_b64_tr_b16 v[110:111], v4 offset:23552
  v_cvt_pk_bf16_f32 v68, v168, v169
  v_cvt_pk_bf16_f32 v69, v170, v171
  s_waitcnt lgkmcnt(8)
  v_mfma_f32_32x32x16_bf16 v[128:143], v[124:127], a[60:63], v[128:143]
  s_add_u32 m0, s23, 69632
  s_add_u32 s24, s24, 36864
  buffer_load_dwordx4 v7, s[12:15], s24 offen lds
  v_cvt_pk_bf16_f32 v70, v172, v173
  v_cvt_pk_bf16_f32 v71, v174, v175
  s_waitcnt vmcnt(9)
  s_barrier
  s_waitcnt lgkmcnt(6)
  v_mfma_f32_32x32x16_bf16 v[128:143], v[96:99], a[68:71], v[128:143]
  ds_read_b64_tr_b16 v[112:113], v4 offset:24576
  ds_read_b64_tr_b16 v[114:115], v4 offset:25600
  ds_read_b64_tr_b16 v[116:117], v4 offset:26624
  ds_read_b64_tr_b16 v[118:119], v4 offset:27648
  buffer_store_dwordx4 v[64:67], v9, s[16:19], s27 offen offset:0 sc1
  buffer_store_dwordx4 v[68:71], v9, s[16:19], s27 offen offset:1024 sc1
  s_waitcnt lgkmcnt(8)
  v_mfma_f32_32x32x16_bf16 v[128:143], v[100:103], a[76:79], v[128:143]
  v_cvt_pk_bf16_f32 v72, v176, v177
  v_cvt_pk_bf16_f32 v73, v178, v179
  s_waitcnt lgkmcnt(6)
  v_mfma_f32_32x32x16_bf16 v[128:143], v[104:107], a[84:87], v[128:143]
  ds_read_b64_tr_b16 v[120:121], v4 offset:28672
  ds_read_b64_tr_b16 v[122:123], v4 offset:29696
  ds_read_b64_tr_b16 v[124:125], v4 offset:30720
  ds_read_b64_tr_b16 v[126:127], v4 offset:31744
  v_cvt_pk_bf16_f32 v74, v180, v181
  v_cvt_pk_bf16_f32 v75, v182, v183
  s_waitcnt lgkmcnt(8)
  v_mfma_f32_32x32x16_bf16 v[128:143], v[108:111], a[92:95], v[128:143]
  v_cvt_pk_bf16_f32 v76, v184, v185
  v_cvt_pk_bf16_f32 v77, v186, v187
  s_waitcnt lgkmcnt(6)
  v_mfma_f32_32x32x16_bf16 v[128:143], v[112:115], a[100:103], v[128:143]
  ds_read_b64_tr_b16 v[96:97], v4 offset:32768
  ds_read_b64_tr_b16 v[98:99], v4 offset:33792
  ds_read_b64_tr_b16 v[100:101], v4 offset:34816
  ds_read_b64_tr_b16 v[102:103], v4 offset:35840
  v_cvt_pk_bf16_f32 v78, v188, v189
  v_cvt_pk_bf16_f32 v79, v190, v191
  s_waitcnt lgkmcnt(8)
  v_mfma_f32_32x32x16_bf16 v[128:143], v[116:119], a[108:111], v[128:143]
  buffer_store_dwordx4 v[72:75], v9, s[16:19], s27 offen offset:2048 sc1
  buffer_store_dwordx4 v[76:79], v9, s[16:19], s27 offen offset:3072 sc1
  s_waitcnt vmcnt(10)
  s_barrier
  s_waitcnt lgkmcnt(6)
  v_mfma_f32_32x32x16_bf16 v[128:143], v[120:123], a[116:119], v[128:143]
  ds_read_b64_tr_b16 v[104:105], v92 offset:0
  ds_read_b64_tr_b16 v[106:107], v92 offset:1024
  ds_read_b64_tr_b16 v[108:109], v92 offset:2048
  ds_read_b64_tr_b16 v[110:111], v92 offset:3072
  s_waitcnt lgkmcnt(8)
  v_mfma_f32_32x32x16_bf16 v[128:143], v[124:127], a[124:127], v[128:143]
  s_waitcnt lgkmcnt(6)
  v_mfma_f32_32x32x16_bf16 v[128:143], v[96:99], a[132:135], v[128:143]
  ds_read_b64_tr_b16 v[112:113], v92 offset:4096
  ds_read_b64_tr_b16 v[114:115], v92 offset:5120
  ds_read_b64_tr_b16 v[116:117], v92 offset:6144
  ds_read_b64_tr_b16 v[118:119], v92 offset:7168
  s_waitcnt lgkmcnt(8)
  v_mfma_f32_32x32x16_bf16 v[128:143], v[100:103], a[140:143], v[128:143]
  s_waitcnt lgkmcnt(6)
  v_mfma_f32_32x32x16_bf16 v[128:143], v[104:107], a[148:151], v[128:143]
  ds_read_b64_tr_b16 v[120:121], v92 offset:8192
  ds_read_b64_tr_b16 v[122:123], v92 offset:9216
  ds_read_b64_tr_b16 v[124:125], v92 offset:10240
  ds_read_b64_tr_b16 v[126:127], v92 offset:11264
  s_waitcnt lgkmcnt(8)
  v_mfma_f32_32x32x16_bf16 v[128:143], v[108:111], a[156:159], v[128:143]
  s_waitcnt vmcnt(7)
  s_barrier
  s_waitcnt lgkmcnt(6)
  v_mfma_f32_32x32x16_bf16 v[128:143], v[112:115], a[164:167], v[128:143]
  ds_read_b64_tr_b16 v[96:97], v92 offset:12288
  ds_read_b64_tr_b16 v[98:99], v92 offset:13312
  ds_read_b64_tr_b16 v[100:101], v92 offset:14336
  ds_read_b64_tr_b16 v[102:103], v92 offset:15360
  s_waitcnt lgkmcnt(8)
  v_mfma_f32_32x32x16_bf16 v[128:143], v[116:119], a[172:175], v[128:143]
  s_waitcnt lgkmcnt(6)
  v_mfma_f32_32x32x16_bf16 v[128:143], v[120:123], a[180:183], v[128:143]
  ds_read_b64_tr_b16 v[104:105], v92 offset:16384
  ds_read_b64_tr_b16 v[106:107], v92 offset:17408
  ds_read_b64_tr_b16 v[108:109], v92 offset:18432
  ds_read_b64_tr_b16 v[110:111], v92 offset:19456
  s_waitcnt lgkmcnt(8)
  v_mfma_f32_32x32x16_bf16 v[128:143], v[124:127], a[188:191], v[128:143]
  s_waitcnt lgkmcnt(6)
  v_mfma_f32_32x32x16_bf16 v[128:143], v[96:99], a[196:199], v[128:143]
  ds_read_b64_tr_b16 v[112:113], v92 offset:20480
  ds_read_b64_tr_b16 v[114:115], v92 offset:21504
  ds_read_b64_tr_b16 v[116:117], v92 offset:22528
  ds_read_b64_tr_b16 v[118:119], v92 offset:23552
  s_waitcnt lgkmcnt(8)
  v_mfma_f32_32x32x16_bf16 v[128:143], v[100:103], a[204:207], v[128:143]
  s_waitcnt vmcnt(4)
  s_barrier
  s_waitcnt lgkmcnt(6)
  v_mfma_f32_32x32x16_bf16 v[128:143], v[104:107], a[212:215], v[128:143]
  ds_read_b64_tr_b16 v[120:121], v92 offset:24576
  ds_read_b64_tr_b16 v[122:123], v92 offset:25600
  ds_read_b64_tr_b16 v[124:125], v92 offset:26624
  ds_read_b64_tr_b16 v[126:127], v92 offset:27648
  s_waitcnt lgkmcnt(8)
  v_mfma_f32_32x32x16_bf16 v[128:143], v[108:111], a[220:223], v[128:143]
  s_waitcnt lgkmcnt(6)
  v_mfma_f32_32x32x16_bf16 v[128:143], v[112:115], a[228:231], v[128:143]
  ds_read_b64_tr_b16 v[96:97], v92 offset:28672
  ds_read_b64_tr_b16 v[98:99], v92 offset:29696
  ds_read_b64_tr_b16 v[100:101], v92 offset:30720
  ds_read_b64_tr_b16 v[102:103], v92 offset:31744
  s_waitcnt lgkmcnt(8)
  v_mfma_f32_32x32x16_bf16 v[128:143], v[116:119], a[236:239], v[128:143]
  s_waitcnt lgkmcnt(6)
  v_mfma_f32_32x32x16_bf16 v[128:143], v[120:123], a[244:247], v[128:143]
  ds_read_b64_tr_b16 v[104:105], v92 offset:32768
  ds_read_b64_tr_b16 v[106:107], v92 offset:33792
  ds_read_b64_tr_b16 v[108:109], v92 offset:34816
  ds_read_b64_tr_b16 v[110:111], v92 offset:35840
  s_waitcnt lgkmcnt(8)
  v_mfma_f32_32x32x16_bf16 v[128:143], v[124:127], a[252:255], v[128:143]
  s_waitcnt lgkmcnt(6)
  v_mfma_f32_32x32x16_bf16 v[128:143], v[96:99], v[228:231], v[128:143]
  s_waitcnt lgkmcnt(4)
  v_mfma_f32_32x32x16_bf16 v[128:143], v[100:103], v[236:239], v[128:143]
  s_waitcnt lgkmcnt(2)
  v_mfma_f32_32x32x16_bf16 v[128:143], v[104:107], v[244:247], v[128:143]
  s_waitcnt lgkmcnt(0)
  v_mfma_f32_32x32x16_bf16 v[128:143], v[108:111], v[252:255], v[128:143]
  s_nop 15
  v_cvt_pk_bf16_f32 v64, v128, v129
  v_cvt_pk_bf16_f32 v65, v130, v131
  v_cvt_pk_bf16_f32 v66, v132, v133
  v_cvt_pk_bf16_f32 v67, v134, v135
  v_cvt_pk_bf16_f32 v68, v136, v137
  v_cvt_pk_bf16_f32 v69, v138, v139
  v_cvt_pk_bf16_f32 v70, v140, v141
  v_cvt_pk_bf16_f32 v71, v142, v143
  buffer_store_dwordx4 v[64:67], v9, s[16:19], s47 offen offset:0 sc1
  buffer_store_dwordx4 v[68:71], v9, s[16:19], s47 offen offset:1024 sc1
  s_waitcnt vmcnt(0)
f_kernel_fin:
  s_load_dwordx2 s[4:5], s[0:1], 72
  s_barrier
  s_cmp_lg_u32 s20, 0
  s_cbranch_scc1 f_kernel_h2_seen
  s_lshl_b32 s36, s21, 7
  s_add_u32 s36, s36, 40960
  s_lshl_b32 s37, s22, 2
  s_add_u32 s37, s37, s36
  v_mov_b32 v10, 0
  v_mov_b32 v11, 1
  v_lshlrev_b32 v14, 2, v1
  s_mov_b64 exec, 1
  buffer_store_dword v11, v10, s[16:19], s37 offen sc1
  s_mov_b64 exec, 0xff
  s_mov_b32 s40, 0
f_kernel_h2_poll:
  buffer_load_dword v15, v14, s[16:19], s36 offen sc1
  s_waitcnt vmcnt(0)
  v_cmp_eq_u32 vcc, 1, v15
  s_add_u32 s40, s40, 1
  s_cmp_eq_u32 vcc_lo, 0xff
  s_cbranch_scc1 f_kernel_h2_got
  s_cmp_lt_u32 s40, 400000
  s_cbranch_scc1 f_kernel_h2_poll
f_kernel_h2_got:
  s_mov_b64 exec, -1
f_kernel_h2_seen:
  s_barrier
  s_waitcnt lgkmcnt(0)
  s_mov_b32 s8, s4
  s_and_b32 s9, s5, 0xffff
  s_mov_b32 s10, 2359296
  s_mov_b32 s11, 0x20000

  v_lshlrev_b32 v9, 4, v1
  v_and_b32 v2, 31, v1
  v_lshrrev_b32 v3, 5, v1
  v_lshlrev_b32 v4, 4, v2
  v_lshl_add_u32 v4, v3, 3, v4
  v_lshlrev_b32 v5, 4, v3
  v_mul_u32_u24 v6, 1152, v2
  v_lshl_add_u32 v6, v3, 4, v6
  s_mul_i32 s41, s22, 9
  s_add_u32 s41, s41, s20
  s_add_u32 s41, s41, 0
  s_mul_i32 s42, s21, 72
  s_add_u32 s42, s42, s41
  s_lshl_b32 s42, s42, 10
  s_add_u32 s42, s42, 10485760
  buffer_load_dwordx4 v[16:19], v9, s[16:19], s42 offen sc1
  s_add_u32 s42, s42, 2359296
  buffer_load_dwordx4 v[20:23], v9, s[16:19], s42 offen sc1
  s_add_u32 s42, s42, 2359296
  buffer_load_dwordx4 v[24:27], v9, s[16:19], s42 offen sc1
  s_add_u32 s42, s42, 2359296
  buffer_load_dwordx4 v[28:31], v9, s[16:19], s42 offen sc1
  s_add_u32 s42, s42, 2359296
  buffer_load_dwordx4 v[32:35], v9, s[16:19], s42 offen sc1
  s_add_u32 s42, s42, 2359296
  buffer_load_dwordx4 v[36:39], v9, s[16:19], s42 offen sc1
  s_add_u32 s42, s42, 2359296
  buffer_load_dwordx4 v[40:43], v9, s[16:19], s42 offen sc1
  s_add_u32 s42, s42, 2359296
  buffer_load_dwordx4 v[44:47], v9, s[16:19], s42 offen sc1
  s_lshr_b32 s43, s41, 2
  s_bfe_u32 s44, s41, 0x10001
  s_and_b32 s45, s41, 1
  s_lshl_b32 s46, s21, 1
  s_add_u32 s46, s46, s44
  s_mul_i32 s47, s46, 36
  s_lshl_b32 s48, s43, 1
  s_add_u32 s47, s47, s48
  s_add_u32 s47, s47, s45
  s_lshl_b32 s47, s47, 10
  s_add_u32 s47, s47, 7798784
  buffer_load_dwordx2 v[48:49], v4, s[16:19], s47 offen offset:0 sc1
  buffer_load_dwordx2 v[50:51], v4, s[16:19], s47 offen offset:512 sc1
  s_lshl_b32 s48, s43, 7
  s_lshl_b32 s49, s45, 6
  s_add_u32 s48, s48, s49
  s_add_u32 s48, s48, 11520
  buffer_load_dwordx4 v[52:55], v5, s[16:19], s48 offen offset:0
  buffer_load_dwordx4 v[56:59], v5, s[16:19], s48 offen offset:32
  s_mul_i32 s49, s46, 36864
  s_lshl_b32 s51, s43, 6
  s_add_u32 s49, s49, s51
  s_lshl_b32 s51, s45, 5
  s_add_u32 s52, s49, s51
  s_mul_i32 s41, s22, 9
  s_add_u32 s41, s41, s20
  s_add_u32 s41, s41, 4
  s_mul_i32 s42, s21, 72
  s_add_u32 s42, s42, s41
  s_lshl_b32 s42, s42, 10
  s_add_u32 s42, s42, 10485760
  buffer_load_dwordx4 v[68:71], v9, s[16:19], s42 offen sc1
  s_add_u32 s42, s42, 2359296
  buffer_load_dwordx4 v[72:75], v9, s[16:19], s42 offen sc1
  s_add_u32 s42, s42, 2359296
  buffer_load_dwordx4 v[76:79], v9, s[16:19], s42 offen sc1
  s_add_u32 s42, s42, 2359296
  buffer_load_dwordx4 v[80:83], v9, s[16:19], s42 offen sc1
  s_add_u32 s42, s42, 2359296
  buffer_load_dwordx4 v[84:87], v9, s[16:19], s42 offen sc1
  s_add_u32 s42, s42, 2359296
  buffer_load_dwordx4 v[88:91], v9, s[16:19], s42 offen sc1
  s_add_u32 s42, s42, 2359296
  buffer_load_dwordx4 v[92:95], v9, s[16:19], s42 offen sc1
  s_add_u32 s42, s42, 2359296
  buffer_load_dwordx4 v[96:99], v9, s[16:19], s42 offen sc1
  s_lshr_b32 s43, s41, 2
  s_bfe_u32 s44, s41, 0x10001
  s_and_b32 s45, s41, 1
  s_lshl_b32 s46, s21, 1
  s_add_u32 s46, s46, s44
  s_mul_i32 s47, s46, 36
  s_lshl_b32 s48, s43, 1
  s_add_u32 s47, s47, s48
  s_add_u32 s47, s47, s45
  s_lshl_b32 s47, s47, 10
  s_add_u32 s47, s47, 7798784
  buffer_load_dwordx2 v[100:101], v4, s[16:19], s47 offen offset:0 sc1
  buffer_load_dwordx2 v[102:103], v4, s[16:19], s47 offen offset:512 sc1
  s_lshl_b32 s48, s43, 7
  s_lshl_b32 s49, s45, 6
  s_add_u32 s48, s48, s49
  s_add_u32 s48, s48, 11520
  buffer_load_dwordx4 v[104:107], v5, s[16:19], s48 offen offset:0
  buffer_load_dwordx4 v[108:111], v5, s[16:19], s48 offen offset:32
  s_mul_i32 s49, s46, 36864
  s_lshl_b32 s51, s43, 6
  s_add_u32 s49, s49, s51
  s_lshl_b32 s51, s45, 5
  s_add_u32 s53, s49, s51
  s_cmp_eq_u32 s20, 0
  s_cselect_b32 s50, 0, 0x7ff00000
  v_add_u32 v229, s50, v9
  v_add_u32 v224, s50, v4
  v_add_u32 v225, s50, v5
  v_add_u32 v226, s50, v6
  s_mul_i32 s41, s22, 9
  s_add_u32 s41, s41, s20
  s_add_u32 s41, s41, 8
  s_mul_i32 s42, s21, 72
  s_add_u32 s42, s42, s41
  s_lshl_b32 s42, s42, 10
  s_add_u32 s42, s42, 10485760
  buffer_load_dwordx4 v[120:123], v229, s[16:19], s42 offen sc1
  s_add_u32 s42, s42, 2359296
  buffer_load_dwordx4 v[124:127], v229, s[16:19], s42 offen sc1
  s_add_u32 s42, s42, 2359296
  buffer_load_dwordx4 v[128:131], v229, s[16:19], s42 offen sc1
  s_add_u32 s42, s42, 2359296
  buffer_load_dwordx4 v[132:135], v229, s[16:19], s42 offen sc1
  s_add_u32 s42, s42, 2359296
  buffer_load_dwordx4 v[136:139], v229, s[16:19], s42 offen sc1
  s_add_u32 s42, s42, 2359296
  buffer_load_dwordx4 v[140:143], v229, s[16:19], s42 offen sc1
  s_add_u32 s42, s42, 2359296
  buffer_load_dwordx4 v[144:147], v229, s[16:19], s42 offen sc1
  s_add_u32 s42, s42, 2359296
  buffer_load_dwordx4 v[148:151], v229, s[16:19], s42 offen sc1
  s_lshr_b32 s43, s41, 2
  s_bfe_u32 s44, s41, 0x10001
  s_and_b32 s45, s41, 1
  s_lshl_b32 s46, s21, 1
  s_add_u32 s46, s46, s44
  s_mul_i32 s47, s46, 36
  s_lshl_b32 s48, s43, 1
  s_add_u32 s47, s47, s48
  s_add_u32 s47, s47, s45
  s_lshl_b32 s47, s47, 10
  s_add_u32 s47, s47, 7798784
  buffer_load_dwordx2 v[152:153], v224, s[16:19], s47 offen offset:0 sc1
  buffer_load_dwordx2 v[154:155], v224, s[16:19], s47 offen offset:512 sc1
  s_lshl_b32 s48, s43, 7
  s_lshl_b32 s49, s45, 6
  s_add_u32 s48, s48, s49
  s_add_u32 s48, s48, 11520
  buffer_load_dwordx4 v[156:159], v225, s[16:19], s48 offen offset:0
  buffer_load_dwordx4 v[160:163], v225, s[16:19], s48 offen offset:32
  s_mul_i32 s49, s46, 36864
  s_lshl_b32 s51, s43, 6
  s_add_u32 s49, s49, s51
  s_lshl_b32 s51, s45, 5
  s_add_u32 s54, s49, s51
  s_waitcnt vmcnt(24)
  v_lshlrev_b32 v200, 16, v16
  v_and_b32 v201, 0xffff0000, v16
  v_lshlrev_b32 v10, 16, v20
  v_and_b32 v11, 0xffff0000, v20
  v_add_f32 v200, v200, v10
  v_add_f32 v201, v201, v11
  v_lshlrev_b32 v10, 16, v24
  v_and_b32 v11, 0xffff0000, v24
  v_add_f32 v200, v200, v10
  v_add_f32 v201, v201, v11
  v_lshlrev_b32 v10, 16, v28
  v_and_b32 v11, 0xffff0000, v28
  v_add_f32 v200, v200, v10
  v_add_f32 v201, v201, v11
  v_lshlrev_b32 v10, 16, v32
  v_and_b32 v11, 0xffff0000, v32
  v_add_f32 v200, v200, v10
  v_add_f32 v201, v201, v11
  v_lshlrev_b32 v10, 16, v36
  v_and_b32 v11, 0xffff0000, v36
  v_add_f32 v200, v200, v10
  v_add_f32 v201, v201, v11
  v_lshlrev_b32 v10, 16, v40
  v_and_b32 v11, 0xffff0000, v40
  v_add_f32 v200, v200, v10
  v_add_f32 v201, v201, v11
  v_lshlrev_b32 v10, 16, v44
  v_and_b32 v11, 0xffff0000, v44
  v_add_f32 v200, v200, v10
  v_add_f32 v201, v201, v11
  v_lshlrev_b32 v10, 16, v48
  v_and_b32 v11, 0xffff0000, v48
  v_fma_f32 v10, v200, v52, v10
  v_fma_f32 v11, v201, v53, v11
  v_cvt_pk_bf16_f32 v208, v10, v11
  v_lshlrev_b32 v202, 16, v17
  v_and_b32 v203, 0xffff0000, v17
  v_lshlrev_b32 v10, 16, v21
  v_and_b32 v11, 0xffff0000, v21
  v_add_f32 v202, v202, v10
  v_add_f32 v203, v203, v11
  v_lshlrev_b32 v10, 16, v25
  v_and_b32 v11, 0xffff0000, v25
  v_add_f32 v202, v202, v10
  v_add_f32 v203, v203, v11
  v_lshlrev_b32 v10, 16, v29
  v_and_b32 v11, 0xffff0000, v29
  v_add_f32 v202, v202, v10
  v_add_f32 v203, v203, v11
  v_lshlrev_b32 v10, 16, v33
  v_and_b32 v11, 0xffff0000, v33
  v_add_f32 v202, v202, v10
  v_add_f32 v203, v203, v11
  v_lshlrev_b32 v10, 16, v37
  v_and_b32 v11, 0xffff0000, v37
  v_add_f32 v202, v202, v10
  v_add_f32 v203, v203, v11
  v_lshlrev_b32 v10, 16, v41
  v_and_b32 v11, 0xffff0000, v41
  v_add_f32 v202, v202, v10
  v_add_f32 v203, v203, v11
  v_lshlrev_b32 v10, 16, v45
  v_and_b32 v11, 0xffff0000, v45
  v_add_f32 v202, v202, v10
  v_add_f32 v203, v203, v11
  v_lshlrev_b32 v10, 16, v49
  v_and_b32 v11, 0xffff0000, v49
  v_fma_f32 v10, v202, v54, v10
  v_fma_f32 v11, v203, v55, v11
  v_cvt_pk_bf16_f32 v209, v10, v11
  v_lshlrev_b32 v204, 16, v18
  v_and_b32 v205, 0xffff0000, v18
  v_lshlrev_b32 v10, 16, v22
  v_and_b32 v11, 0xffff0000, v22
  v_add_f32 v204, v204, v10
  v_add_f32 v205, v205, v11
  v_lshlrev_b32 v10, 16, v26
  v_and_b32 v11, 0xffff0000, v26
  v_add_f32 v204, v204, v10
  v_add_f32 v205, v205, v11
  v_lshlrev_b32 v10, 16, v30
  v_and_b32 v11, 0xffff0000, v30
  v_add_f32 v204, v204, v10
  v_add_f32 v205, v205, v11
  v_lshlrev_b32 v10, 16, v34
  v_and_b32 v11, 0xffff0000, v34
  v_add_f32 v204, v204, v10
  v_add_f32 v205, v205, v11
  v_lshlrev_b32 v10, 16, v38
  v_and_b32 v11, 0xffff0000, v38
  v_add_f32 v204, v204, v10
  v_add_f32 v205, v205, v11
  v_lshlrev_b32 v10, 16, v42
  v_and_b32 v11, 0xffff0000, v42
  v_add_f32 v204, v204, v10
  v_add_f32 v205, v205, v11
  v_lshlrev_b32 v10, 16, v46
  v_and_b32 v11, 0xffff0000, v46
  v_add_f32 v204, v204, v10
  v_add_f32 v205, v205, v11
  v_lshlrev_b32 v10, 16, v50
  v_and_b32 v11, 0xffff0000, v50
  v_fma_f32 v10, v204, v56, v10
  v_fma_f32 v11, v205, v57, v11
  v_cvt_pk_bf16_f32 v210, v10, v11
  v_lshlrev_b32 v206, 16, v19
  v_and_b32 v207, 0xffff0000, v19
  v_lshlrev_b32 v10, 16, v23
  v_and_b32 v11, 0xffff0000, v23
  v_add_f32 v206, v206, v10
  v_add_f32 v207, v207, v11
  v_lshlrev_b32 v10, 16, v27
  v_and_b32 v11, 0xffff0000, v27
  v_add_f32 v206, v206, v10
  v_add_f32 v207, v207, v11
  v_lshlrev_b32 v10, 16, v31
  v_and_b32 v11, 0xffff0000, v31
  v_add_f32 v206, v206, v10
  v_add_f32 v207, v207, v11
  v_lshlrev_b32 v10, 16, v35
  v_and_b32 v11, 0xffff0000, v35
  v_add_f32 v206, v206, v10
  v_add_f32 v207, v207, v11
  v_lshlrev_b32 v10, 16, v39
  v_and_b32 v11, 0xffff0000, v39
  v_add_f32 v206, v206, v10
  v_add_f32 v207, v207, v11
  v_lshlrev_b32 v10, 16, v43
  v_and_b32 v11, 0xffff0000, v43
  v_add_f32 v206, v206, v10
  v_add_f32 v207, v207, v11
  v_lshlrev_b32 v10, 16, v47
  v_and_b32 v11, 0xffff0000, v47
  v_add_f32 v206, v206, v10
  v_add_f32 v207, v207, v11
  v_lshlrev_b32 v10, 16, v51
  v_and_b32 v11, 0xffff0000, v51
  v_fma_f32 v10, v206, v58, v10
  v_fma_f32 v11, v207, v59, v11
  v_cvt_pk_bf16_f32 v211, v10, v11
  s_nop 1
  v_permlane32_swap_b32 v208, v210
  v_permlane32_swap_b32 v209, v211
  s_nop 1
  buffer_store_dwordx4 v[208:211], v6, s[8:11], s52 offen
  s_nop 1
  s_waitcnt vmcnt(13)
  v_lshlrev_b32 v200, 16, v68
  v_and_b32 v201, 0xffff0000, v68
  v_lshlrev_b32 v10, 16, v72
  v_and_b32 v11, 0xffff0000, v72
  v_add_f32 v200, v200, v10
  v_add_f32 v201, v201, v11
  v_lshlrev_b32 v10, 16, v76
  v_and_b32 v11, 0xffff0000, v76
  v_add_f32 v200, v200, v10
  v_add_f32 v201, v201, v11
  v_lshlrev_b32 v10, 16, v80
  v_and_b32 v11, 0xffff0000, v80
  v_add_f32 v200, v200, v10
  v_add_f32 v201, v201, v11
  v_lshlrev_b32 v10, 16, v84
  v_and_b32 v11, 0xffff0000, v84
  v_add_f32 v200, v200, v10
  v_add_f32 v201, v201, v11
  v_lshlrev_b32 v10, 16, v88
  v_and_b32 v11, 0xffff0000, v88
  v_add_f32 v200, v200, v10
  v_add_f32 v201, v201, v11
  v_lshlrev_b32 v10, 16, v92
  v_and_b32 v11, 0xffff0000, v92
  v_add_f32 v200, v200, v10
  v_add_f32 v201, v201, v11
  v_lshlrev_b32 v10, 16, v96
  v_and_b32 v11, 0xffff0000, v96
  v_add_f32 v200, v200, v10
  v_add_f32 v201, v201, v11
  v_lshlrev_b32 v10, 16, v100
  v_and_b32 v11, 0xffff0000, v100
  v_fma_f32 v10, v200, v104, v10
  v_fma_f32 v11, v201, v105, v11
  v_cvt_pk_bf16_f32 v208, v10, v11
  v_lshlrev_b32 v202, 16, v69
  v_and_b32 v203, 0xffff0000, v69
  v_lshlrev_b32 v10, 16, v73
  v_and_b32 v11, 0xffff0000, v73
  v_add_f32 v202, v202, v10
  v_add_f32 v203, v203, v11
  v_lshlrev_b32 v10, 16, v77
  v_and_b32 v11, 0xffff0000, v77
  v_add_f32 v202, v202, v10
  v_add_f32 v203, v203, v11
  v_lshlrev_b32 v10, 16, v81
  v_and_b32 v11, 0xffff0000, v81
  v_add_f32 v202, v202, v10
  v_add_f32 v203, v203, v11
  v_lshlrev_b32 v10, 16, v85
  v_and_b32 v11, 0xffff0000, v85
  v_add_f32 v202, v202, v10
  v_add_f32 v203, v203, v11
  v_lshlrev_b32 v10, 16, v89
  v_and_b32 v11, 0xffff0000, v89
  v_add_f32 v202, v202, v10
  v_add_f32 v203, v203, v11
  v_lshlrev_b32 v10, 16, v93
  v_and_b32 v11, 0xffff0000, v93
  v_add_f32 v202, v202, v10
  v_add_f32 v203, v203, v11
  v_lshlrev_b32 v10, 16, v97
  v_and_b32 v11, 0xffff0000, v97
  v_add_f32 v202, v202, v10
  v_add_f32 v203, v203, v11
  v_lshlrev_b32 v10, 16, v101
  v_and_b32 v11, 0xffff0000, v101
  v_fma_f32 v10, v202, v106, v10
  v_fma_f32 v11, v203, v107, v11
  v_cvt_pk_bf16_f32 v209, v10, v11
  v_lshlrev_b32 v204, 16, v70
  v_and_b32 v205, 0xffff0000, v70
  v_lshlrev_b32 v10, 16, v74
  v_and_b32 v11, 0xffff0000, v74
  v_add_f32 v204, v204, v10
  v_add_f32 v205, v205, v11
  v_lshlrev_b32 v10, 16, v78
  v_and_b32 v11, 0xffff0000, v78
  v_add_f32 v204, v204, v10
  v_add_f32 v205, v205, v11
  v_lshlrev_b32 v10, 16, v82
  v_and_b32 v11, 0xffff0000, v82
  v_add_f32 v204, v204, v10
  v_add_f32 v205, v205, v11
  v_lshlrev_b32 v10, 16, v86
  v_and_b32 v11, 0xffff0000, v86
  v_add_f32 v204, v204, v10
  v_add_f32 v205, v205, v11
  v_lshlrev_b32 v10, 16, v90
  v_and_b32 v11, 0xffff0000, v90
  v_add_f32 v204, v204, v10
  v_add_f32 v205, v205, v11
  v_lshlrev_b32 v10, 16, v94
  v_and_b32 v11, 0xffff0000, v94
  v_add_f32 v204, v204, v10
  v_add_f32 v205, v205, v11
  v_lshlrev_b32 v10, 16, v98
  v_and_b32 v11, 0xffff0000, v98
  v_add_f32 v204, v204, v10
  v_add_f32 v205, v205, v11
  v_lshlrev_b32 v10, 16, v102
  v_and_b32 v11, 0xffff0000, v102
  v_fma_f32 v10, v204, v108, v10
  v_fma_f32 v11, v205, v109, v11
  v_cvt_pk_bf16_f32 v210, v10, v11
  v_lshlrev_b32 v206, 16, v71
  v_and_b32 v207, 0xffff0000, v71
  v_lshlrev_b32 v10, 16, v75
  v_and_b32 v11, 0xffff0000, v75
  v_add_f32 v206, v206, v10
  v_add_f32 v207, v207, v11
  v_lshlrev_b32 v10, 16, v79
  v_and_b32 v11, 0xffff0000, v79
  v_add_f32 v206, v206, v10
  v_add_f32 v207, v207, v11
  v_lshlrev_b32 v10, 16, v83
  v_and_b32 v11, 0xffff0000, v83
  v_add_f32 v206, v206, v10
  v_add_f32 v207, v207, v11
  v_lshlrev_b32 v10, 16, v87
  v_and_b32 v11, 0xffff0000, v87
  v_add_f32 v206, v206, v10
  v_add_f32 v207, v207, v11
  v_lshlrev_b32 v10, 16, v91
  v_and_b32 v11, 0xffff0000, v91
  v_add_f32 v206, v206, v10
  v_add_f32 v207, v207, v11
  v_lshlrev_b32 v10, 16, v95
  v_and_b32 v11, 0xffff0000, v95
  v_add_f32 v206, v206, v10
  v_add_f32 v207, v207, v11
  v_lshlrev_b32 v10, 16, v99
  v_and_b32 v11, 0xffff0000, v99
  v_add_f32 v206, v206, v10
  v_add_f32 v207, v207, v11
  v_lshlrev_b32 v10, 16, v103
  v_and_b32 v11, 0xffff0000, v103
  v_fma_f32 v10, v206, v110, v10
  v_fma_f32 v11, v207, v111, v11
  v_cvt_pk_bf16_f32 v211, v10, v11
  s_nop 1
  v_permlane32_swap_b32 v208, v210
  v_permlane32_swap_b32 v209, v211
  s_nop 1
  buffer_store_dwordx4 v[208:211], v6, s[8:11], s53 offen
  s_nop 1
  s_waitcnt vmcnt(2)
  v_lshlrev_b32 v200, 16, v120
  v_and_b32 v201, 0xffff0000, v120
  v_lshlrev_b32 v10, 16, v124
  v_and_b32 v11, 0xffff0000, v124
  v_add_f32 v200, v200, v10
  v_add_f32 v201, v201, v11
  v_lshlrev_b32 v10, 16, v128
  v_and_b32 v11, 0xffff0000, v128
  v_add_f32 v200, v200, v10
  v_add_f32 v201, v201, v11
  v_lshlrev_b32 v10, 16, v132
  v_and_b32 v11, 0xffff0000, v132
  v_add_f32 v200, v200, v10
  v_add_f32 v201, v201, v11
  v_lshlrev_b32 v10, 16, v136
  v_and_b32 v11, 0xffff0000, v136
  v_add_f32 v200, v200, v10
  v_add_f32 v201, v201, v11
  v_lshlrev_b32 v10, 16, v140
  v_and_b32 v11, 0xffff0000, v140
  v_add_f32 v200, v200, v10
  v_add_f32 v201, v201, v11
  v_lshlrev_b32 v10, 16, v144
  v_and_b32 v11, 0xffff0000, v144
  v_add_f32 v200, v200, v10
  v_add_f32 v201, v201, v11
  v_lshlrev_b32 v10, 16, v148
  v_and_b32 v11, 0xffff0000, v148
  v_add_f32 v200, v200, v10
  v_add_f32 v201, v201, v11
  v_lshlrev_b32 v10, 16, v152
  v_and_b32 v11, 0xffff0000, v152
  v_fma_f32 v10, v200, v156, v10
  v_fma_f32 v11, v201, v157, v11
  v_cvt_pk_bf16_f32 v208, v10, v11
  v_lshlrev_b32 v202, 16, v121
  v_and_b32 v203, 0xffff0000, v121
  v_lshlrev_b32 v10, 16, v125
  v_and_b32 v11, 0xffff0000, v125
  v_add_f32 v202, v202, v10
  v_add_f32 v203, v203, v11
  v_lshlrev_b32 v10, 16, v129
  v_and_b32 v11, 0xffff0000, v129
  v_add_f32 v202, v202, v10
  v_add_f32 v203, v203, v11
  v_lshlrev_b32 v10, 16, v133
  v_and_b32 v11, 0xffff0000, v133
  v_add_f32 v202, v202, v10
  v_add_f32 v203, v203, v11
  v_lshlrev_b32 v10, 16, v137
  v_and_b32 v11, 0xffff0000, v137
  v_add_f32 v202, v202, v10
  v_add_f32 v203, v203, v11
  v_lshlrev_b32 v10, 16, v141
  v_and_b32 v11, 0xffff0000, v141
  v_add_f32 v202, v202, v10
  v_add_f32 v203, v203, v11
  v_lshlrev_b32 v10, 16, v145
  v_and_b32 v11, 0xffff0000, v145
  v_add_f32 v202, v202, v10
  v_add_f32 v203, v203, v11
  v_lshlrev_b32 v10, 16, v149
  v_and_b32 v11, 0xffff0000, v149
  v_add_f32 v202, v202, v10
  v_add_f32 v203, v203, v11
  v_lshlrev_b32 v10, 16, v153
  v_and_b32 v11, 0xffff0000, v153
  v_fma_f32 v10, v202, v158, v10
  v_fma_f32 v11, v203, v159, v11
  v_cvt_pk_bf16_f32 v209, v10, v11
  v_lshlrev_b32 v204, 16, v122
  v_and_b32 v205, 0xffff0000, v122
  v_lshlrev_b32 v10, 16, v126
  v_and_b32 v11, 0xffff0000, v126
  v_add_f32 v204, v204, v10
  v_add_f32 v205, v205, v11
  v_lshlrev_b32 v10, 16, v130
  v_and_b32 v11, 0xffff0000, v130
  v_add_f32 v204, v204, v10
  v_add_f32 v205, v205, v11
  v_lshlrev_b32 v10, 16, v134
  v_and_b32 v11, 0xffff0000, v134
  v_add_f32 v204, v204, v10
  v_add_f32 v205, v205, v11
  v_lshlrev_b32 v10, 16, v138
  v_and_b32 v11, 0xffff0000, v138
  v_add_f32 v204, v204, v10
  v_add_f32 v205, v205, v11
  v_lshlrev_b32 v10, 16, v142
  v_and_b32 v11, 0xffff0000, v142
  v_add_f32 v204, v204, v10
  v_add_f32 v205, v205, v11
  v_lshlrev_b32 v10, 16, v146
  v_and_b32 v11, 0xffff0000, v146
  v_add_f32 v204, v204, v10
  v_add_f32 v205, v205, v11
  v_lshlrev_b32 v10, 16, v150
  v_and_b32 v11, 0xffff0000, v150
  v_add_f32 v204, v204, v10
  v_add_f32 v205, v205, v11
  v_lshlrev_b32 v10, 16, v154
  v_and_b32 v11, 0xffff0000, v154
  v_fma_f32 v10, v204, v160, v10
  v_fma_f32 v11, v205, v161, v11
  v_cvt_pk_bf16_f32 v210, v10, v11
  v_lshlrev_b32 v206, 16, v123
  v_and_b32 v207, 0xffff0000, v123
  v_lshlrev_b32 v10, 16, v127
  v_and_b32 v11, 0xffff0000, v127
  v_add_f32 v206, v206, v10
  v_add_f32 v207, v207, v11
  v_lshlrev_b32 v10, 16, v131
  v_and_b32 v11, 0xffff0000, v131
  v_add_f32 v206, v206, v10
  v_add_f32 v207, v207, v11
  v_lshlrev_b32 v10, 16, v135
  v_and_b32 v11, 0xffff0000, v135
  v_add_f32 v206, v206, v10
  v_add_f32 v207, v207, v11
  v_lshlrev_b32 v10, 16, v139
  v_and_b32 v11, 0xffff0000, v139
  v_add_f32 v206, v206, v10
  v_add_f32 v207, v207, v11
  v_lshlrev_b32 v10, 16, v143
  v_and_b32 v11, 0xffff0000, v143
  v_add_f32 v206, v206, v10
  v_add_f32 v207, v207, v11
  v_lshlrev_b32 v10, 16, v147
  v_and_b32 v11, 0xffff0000, v147
  v_add_f32 v206, v206, v10
  v_add_f32 v207, v207, v11
  v_lshlrev_b32 v10, 16, v151
  v_and_b32 v11, 0xffff0000, v151
  v_add_f32 v206, v206, v10
  v_add_f32 v207, v207, v11
  v_lshlrev_b32 v10, 16, v155
  v_and_b32 v11, 0xffff0000, v155
  v_fma_f32 v10, v206, v162, v10
  v_fma_f32 v11, v207, v163, v11
  v_cvt_pk_bf16_f32 v211, v10, v11
  s_nop 1
  v_permlane32_swap_b32 v208, v210
  v_permlane32_swap_b32 v209, v211
  s_nop 1
  buffer_store_dwordx4 v[208:211], v226, s[8:11], s54 offen
f_kernel_end:
  s_endpgm
.section .rodata,"a"
.p2align 6
.amdhsa_kernel f_kernel
  .amdhsa_next_free_vgpr 512
  .amdhsa_next_free_sgpr 102
  .amdhsa_accum_offset 256
  .amdhsa_group_segment_fixed_size 0
  .amdhsa_kernarg_size 96
  .amdhsa_user_sgpr_count 2
  .amdhsa_user_sgpr_kernarg_segment_ptr 1
  .amdhsa_system_sgpr_workgroup_id_x 1
.end_amdhsa_kernel
.text
```
